```python
import torch

def _softmax(x, axis=-1):
    return torch.softmax(x, dim=axis)

def _gelu(x):
    return torch.nn.functional.gelu(x, approximate='tanh')

def _silu(x):
    return torch.nn.functional.silu(x)

def _sigmoid(x):
    return torch.sigmoid(x)

def _layernorm(x, axis=-1, eps=1e-05):
    m = x.mean(dim=axis, keepdim=True)
    v = x.var(dim=axis, keepdim=True, unbiased=False)
    return (x - m) / torch.sqrt(v + eps)

def _scatter_add(tgt, idx, src, axis=0):
    return tgt.clone().index_add_(axis, idx, src)

def _segment_sum(src, seg, n):
    out = torch.zeros((n,) + src.shape[1:], dtype=src.dtype)
    return out.index_add_(0, seg, src)

def _pad(x, pw):
    flat = tuple((v for pair in reversed(pw) for v in pair))
    return torch.nn.functional.pad(x, flat)
kernel_name = 'interleave_layers__memory_aug_recurrent_mem_tr__dense_activation_relu__prompt'

def setup_inputs():

    _w = lambda a: (lambda t: t.to(torch.bfloat16) if t.is_floating_point() else t)(torch.as_tensor(a))

    def _A_setup():
        B, S, Dm = (1, 2048, 512)
        H, Dh = (32, 128)
        M, seg = (8, 32)
        seg = min(seg, S)
        S = S // seg * seg
        return {'x': _w((lambda *s: torch.randn(*s, dtype=torch.bfloat16) * 0.05)(B, S, Dm)), 'mem0': _w((lambda *s: torch.randn(*s, dtype=torch.bfloat16) * 0.8)(B, M, Dm)), 'Wq': _w((lambda *s: torch.randn(*s, dtype=torch.bfloat16) * 0.8)(Dm, H, Dh) * Dm ** (-0.5)), 'Wk': _w((lambda *s: torch.randn(*s, dtype=torch.bfloat16) * 0.8)(Dm, H, Dh) * Dm ** (-0.5)), 'Wv': _w((lambda *s: torch.randn(*s, dtype=torch.bfloat16) * 0.8)(Dm, H, Dh) * Dm ** (-0.5)), 'Wo': _w((lambda *s: torch.randn(*s, dtype=torch.bfloat16) * 0.8)(H, Dh, Dm) * (H * Dh) ** (-0.5)), 'seg_len': seg}
    _A_in = _A_setup()

    def _B_setup():
        B, S, D, Dff = (1, 2048, 512, 1792)
        return {'x': _w((lambda *s: torch.randn(*s, dtype=torch.bfloat16) * 0.05)(B, S, D)), 'w1': _w((lambda *s: torch.randn(*s, dtype=torch.bfloat16) * 0.05)(D, Dff)), 'w2': _w((lambda *s: torch.randn(*s, dtype=torch.bfloat16) * 0.05)(Dff, D))}
    _B_in = _B_setup()
    return {'A_x': _A_in['x'], 'A_mem0': _A_in['mem0'], 'A_Wq': _A_in['Wq'], 'A_Wk': _A_in['Wk'], 'A_Wv': _A_in['Wv'], 'A_Wo': _A_in['Wo'], 'A_seg_len': _A_in['seg_len'], 'B_x': _B_in['x'], 'B_w1': _B_in['w1'], 'B_w2': _B_in['w2']}

def reference(A_x, A_mem0, A_Wq, A_Wk, A_Wv, A_Wo, A_seg_len, B_x, B_w1, B_w2):

    def _A_ref(x, mem0, Wq, Wk, Wv, Wo, seg_len):
        B, S, Dm = x.shape
        H, Dh = (Wq.shape[1], Wq.shape[2])
        M = mem0.shape[1]
        scale = Dh ** (-0.5)
        n_seg = S // seg_len
        L = M + seg_len
        idx = torch.arange(L)
        mask = (idx[:, None] < M) | (idx[:, None] >= idx[None, :])
        mem = mem0
        outs = []
        for s in range(n_seg):
            xs = x[:, s * seg_len:(s + 1) * seg_len, :].clone()
            h = torch.concatenate([mem, xs], axis=1)
            q = torch.einsum('btd,dhe->bhte', h, Wq)
            k = torch.einsum('btd,dhe->bhte', h, Wk)
            v = torch.einsum('btd,dhe->bhte', h, Wv)
            scores = torch.einsum('bhqe,bhke->bhqk', q, k) * scale
            scores = torch.where(mask[None, None], scores, -1000000000.0)
            p = _softmax(scores, axis=-1)
            o = torch.einsum('bhqk,bhke->bhqe', p, v)
            o = torch.einsum('bhte,hed->btd', o, Wo)
            mem = o[:, :M, :].clone()
            outs.append(o[:, M:, :])
        return torch.concatenate(outs, axis=1)

    def _B_ref(x, w1, w2):
        h = torch.einsum('bsd,df->bsf', x, w1)
        zero = torch.zeros_like(h)
        h = torch.maximum(h, zero)
        return torch.einsum('bsf,fd->bsd', h, w2)
    x = A_x
    x = x + _A_ref(_layernorm(x, axis=-1), A_mem0, A_Wq, A_Wk, A_Wv, A_Wo, A_seg_len)
    x = x + _B_ref(_layernorm(x, axis=-1), B_w1, B_w2)
    x = x + _A_ref(_layernorm(x, axis=-1), A_mem0, A_Wq, A_Wk, A_Wv, A_Wo, A_seg_len)
    x = x + _B_ref(_layernorm(x, axis=-1), B_w1, B_w2)
    return x
```

```asm
; @launch grid=(256,1,1) block=(256,1,1) lds=163840
.amdgcn_target "amdgcn-amd-amdhsa--gfx950"
.text
.globl interleave_layers__memory_aug_recurrent_mem_tr__dense_activation_relu__prompt_kernel
.p2align 8
.type interleave_layers__memory_aug_recurrent_mem_tr__dense_activation_relu__prompt_kernel,@function
interleave_layers__memory_aug_recurrent_mem_tr__dense_activation_relu__prompt_kernel:
    s_cmp_ge_u32 s2, 256
    s_cbranch_scc1 END
    s_load_dwordx2 s[4:5], s[0:1], 96
    s_load_dwordx2 s[6:7], s[0:1], 88
    v_lshrrev_b32 v1, 6, v0
    v_and_b32 v0, 63, v0
    v_readfirstlane_b32 s9, v1
    s_and_b32 s10, s2, 7
    s_lshr_b32 s11, s2, 3
    s_lshl_b32 s10, s10, 2
    s_lshr_b32 s10, 0x76541032, s10
    s_and_b32 s10, s10, 7
    s_lshl3_add_u32 s2, s11, s10
    s_sub_u32 s14, s10, 2
    s_cmp_lt_u32 s14, 4
    s_cselect_b32 s14, 16, 31
    s_cmp_lg_u32 s14, s11
    s_cbranch_scc1 NOTLB
    v_lshl_add_u32 v255, v1, 6, v0
    v_lshlrev_b32 v255, 20, v255
    v_or_b32 v255, 0x7800, v255
    s_waitcnt lgkmcnt(0)
    global_load_dword v255, v255, s[4:5]
NOTLB:
    s_cmp_lt_u32 s10, 2
    s_cbranch_scc1 ROLE_CHAIN
    s_cmp_ge_u32 s10, 6
    s_cbranch_scc1 ROLE_G67
    s_cmp_lt_u32 s11, 16
    s_cbranch_scc1 ROLE_QKV
    s_bfe_u32 s13, s11, 0x10002
    s_cmp_lt_u32 s11, 24
    s_cbranch_scc1 ROLE_ATT
    s_branch ROLE_WO
ROLE_G67:
    s_cmp_lt_u32 s11, 14
    s_cbranch_scc1 ROLE_FFN
    s_branch ROLE_RED
TIMEOUT:
    s_lshl_b32 s14, s17, 2
    v_mov_b32 v1, s14
    v_mov_b32 v2, s2
    v_or_b32 v2, 0x1000, v2
    global_store_dword v1, v2, s[6:7]
END:
    s_endpgm
ROLE_RED:
    s_load_dwordx2 s[20:21], s[0:1], 0
    s_load_dwordx2 s[42:43], s[0:1], 80
    s_sub_u32 s13, s10, 6
    s_lshr_b32 s11, s2, 3
    s_sub_u32 s11, s11, 14
    v_lshrrev_b32 v1, 3, v0
    v_and_b32 v2, 7, v0
    v_lshlrev_b32 v3, 4, v2
    v_lshl_add_u32 v3, v1, 10, v3
    s_lshl_b32 s14, s9, 13
    v_add_u32 v48, s14, v3
    v_lshrrev_b32 v1, 2, v0
    v_and_b32 v2, 3, v0
    v_add_u32 v49, 32768, v48
    v_add_u32 v50, 65536, v48
    v_add_u32 v51, 98304, v48
    v_add_u32 v52, 131072, v48
    v_add_u32 v53, 163840, v48
    v_add_u32 v54, 196608, v48
    v_add_u32 v55, 229376, v48
    v_add_u32 v56, 262144, v48
    v_add_u32 v57, 294912, v48
    v_add_u32 v58, 327680, v48
    v_add_u32 v59, 360448, v48
    v_add_u32 v60, 393216, v48
    v_add_u32 v61, 425984, v48
    v_lshlrev_b32 v3, 4, v1
    v_lshl_add_u32 v3, v2, 10, v3
    s_lshl_b32 s14, s9, 8
    v_add_u32 v4, s14, v3
    v_min_u32 v3, 13, v1
    v_and_b32 v45, 3, v3
    v_lshlrev_b32 v3, 15, v3
    v_lshl_add_u32 v3, v45, 11, v3
    s_lshl_b32 s14, s9, 13
    s_add_u32 s14, s14, 1024
    v_add_u32 v5, s14, v3
    v_min_u32 v3, 13, v1
    v_add_u32 v3, s9, v3
    v_add_u32 v3, s11, v3
    v_and_b32 v3, 7, v3
    v_lshl_add_u32 v5, v3, 7, v5
    v_lshlrev_b32 v41, 5, v2
    v_lshrrev_b32 v3, 5, v0
    v_lshl_add_u32 v3, v3, 7, v41
    v_bfe_u32 v1, v0, 4, 1
    v_lshl_add_u32 v3, v1, 2, v3
    s_lshl_b32 s14, s9, 3
    v_add_u32 v40, s14, v3
    s_mov_b32 s44, 0x000f000f
    s_mov_b32 s45, 0x000f000f
    v_mov_b32 v36, -1
    v_mov_b32 v37, -1
    v_mov_b32 v38, -1
    v_mov_b32 v39, -1
    s_waitcnt lgkmcnt(0)
    s_xor_b32 s14, s13, 1
    s_lshl_b32 s14, s14, 4
    s_add_u32 s14, s14, s11
    s_lshl_b32 s14, s14, 16
    s_min_u32 s14, s14, 0x1f0000
    s_add_u32 s38, s20, s14
    s_addc_u32 s39, s21, 0
    s_add_u32 s40, s38, 0x8000
    s_addc_u32 s41, s39, 0
    s_add_u32 s14, s14, 4194304
    s_add_u32 s36, s4, s14
    s_addc_u32 s37, s5, 0
    v_and_b32 v1, 7, v0
    v_lshrrev_b32 v2, 3, v0
    v_lshlrev_b32 v3, 4, v2
    v_lshl_add_u32 v3, v1, 10, v3
    s_lshl_b32 s14, s9, 13
    v_add_u32 v124, s14, v3
    v_and_b32 v3, 3, v1
    v_lshlrev_b32 v3, 4, v3
    v_lshrrev_b32 v1, 2, v1
    v_lshl_add_u32 v3, v1, 7, v3
    v_and_b32 v1, 1, v2
    v_lshl_add_u32 v3, v1, 6, v3
    v_lshrrev_b32 v1, 1, v2
    v_lshl_add_u32 v3, v1, 10, v3
    s_lshl_b32 s14, s9, 8
    s_add_u32 s14, s14, 4096
    v_add_u32 v120, s14, v3
    v_add_u32 v121, 8192, v120
    v_add_u32 v122, 16384, v120
    v_add_u32 v123, 24576, v120
    s_cmp_ge_u32 s11, 16
    s_cbranch_scc1 LN0_SK1
    global_load_dwordx4 v[128:131], v124, s[38:39] offset:0
    global_load_dwordx4 v[132:135], v124, s[38:39] offset:128
    global_load_dwordx4 v[136:139], v124, s[38:39] offset:256
    global_load_dwordx4 v[140:143], v124, s[38:39] offset:384
    global_load_dwordx4 v[144:147], v124, s[38:39] offset:512
    global_load_dwordx4 v[148:151], v124, s[38:39] offset:640
    global_load_dwordx4 v[152:155], v124, s[38:39] offset:768
    global_load_dwordx4 v[156:159], v124, s[38:39] offset:896
    global_load_dwordx4 v[160:163], v124, s[40:41] offset:0
    global_load_dwordx4 v[164:167], v124, s[40:41] offset:128
    global_load_dwordx4 v[168:171], v124, s[40:41] offset:256
    global_load_dwordx4 v[172:175], v124, s[40:41] offset:384
    global_load_dwordx4 v[176:179], v124, s[40:41] offset:512
    global_load_dwordx4 v[180:183], v124, s[40:41] offset:640
    global_load_dwordx4 v[184:187], v124, s[40:41] offset:768
    global_load_dwordx4 v[188:191], v124, s[40:41] offset:896
LN0_SK1:
    v_mov_b32 v8, 0
    global_load_dword v8, v8, s[4:5] sc1
    s_waitcnt vmcnt(0)
    v_readfirstlane_b32 s8, v8
    s_add_u32 s8, s8, 1
    s_cmp_ge_u32 s11, 8
    s_cbranch_scc1 RED_NP
    s_lshl_b32 s14, s13, 22
    s_lshl_b32 s15, s11, 7
    s_add_u32 s14, s14, s15
    s_add_u32 s14, s14, 6291456
    s_add_u32 s34, s4, s14
    s_addc_u32 s35, s5, 0
    global_store_dwordx4 v48, v[36:39], s[34:35] offset:0 sc1
    global_store_dwordx4 v49, v[36:39], s[34:35] offset:0 sc1
    s_add_u32 s34, s34, 0x600000
    s_addc_u32 s35, s35, 0
    global_store_dwordx4 v48, v[36:39], s[34:35] offset:0 sc1
    global_store_dwordx4 v49, v[36:39], s[34:35] offset:0 sc1
RED_NP:
    s_sub_u32 s14, s11, 8
    s_lshl_b32 s15, s13, 3
    s_or_b32 s15, s15, s14
    s_cmp_ge_u32 s15, 8
    s_cbranch_scc1 RED_NQ
    s_lshl_b32 s14, s14, 7
    s_add_u32 s15, s14, 8388608
    s_add_u32 s34, s4, s15
    s_addc_u32 s35, s5, 0
    global_store_dwordx4 v48, v[36:39], s[34:35] sc1
    global_store_dwordx4 v49, v[36:39], s[34:35] sc1
    global_store_dwordx4 v50, v[36:39], s[34:35] sc1
    s_add_u32 s15, s14, 14680064
    s_add_u32 s34, s4, s15
    s_addc_u32 s35, s5, 0
    global_store_dwordx4 v48, v[36:39], s[34:35] sc1
    global_store_dwordx4 v49, v[36:39], s[34:35] sc1
    global_store_dwordx4 v50, v[36:39], s[34:35] sc1
RED_NQ:
    s_lshl_b32 s14, s13, 10
    s_lshl_b32 s15, s11, 7
    s_add_u32 s14, s14, s15
    s_add_u32 s14, s14, 344064
    s_lshl_b32 s15, s13, 8
    s_lshl_b32 s16, s11, 4
    s_add_u32 s15, s15, s16
    s_lshl_b32 s16, s9, 2
    s_add_u32 s15, s15, s16
    s_add_u32 s15, s15, 341888
    s_cmp_lt_u32 s11, 8
    s_cselect_b32 s14, s14, s15
    s_add_u32 s46, s4, s14
    s_addc_u32 s47, s5, 0
    v_add_u32 v46, 6291456, v48
    v_mov_b32 v43, 0
    v_mov_b32 v7, s8
    global_store_dword v43, v43, s[46:47] sc1
    s_cmp_ge_u32 s11, 16
    s_cbranch_scc1 LN0_SK2
    v_lshlrev_b32 v192, 16, v128
    v_and_b32 v193, 0xffff0000, v128
    v_lshlrev_b32 v194, 16, v129
    v_and_b32 v195, 0xffff0000, v129
    v_lshlrev_b32 v196, 16, v130
    v_and_b32 v197, 0xffff0000, v130
    v_lshlrev_b32 v198, 16, v131
    v_and_b32 v199, 0xffff0000, v131
    v_lshlrev_b32 v200, 16, v132
    v_and_b32 v201, 0xffff0000, v132
    v_lshlrev_b32 v202, 16, v133
    v_and_b32 v203, 0xffff0000, v133
    v_lshlrev_b32 v204, 16, v134
    v_and_b32 v205, 0xffff0000, v134
    v_lshlrev_b32 v206, 16, v135
    v_and_b32 v207, 0xffff0000, v135
    v_lshlrev_b32 v208, 16, v136
    v_and_b32 v209, 0xffff0000, v136
    v_lshlrev_b32 v210, 16, v137
    v_and_b32 v211, 0xffff0000, v137
    v_lshlrev_b32 v212, 16, v138
    v_and_b32 v213, 0xffff0000, v138
    v_lshlrev_b32 v214, 16, v139
    v_and_b32 v215, 0xffff0000, v139
    v_lshlrev_b32 v216, 16, v140
    v_and_b32 v217, 0xffff0000, v140
    v_lshlrev_b32 v218, 16, v141
    v_and_b32 v219, 0xffff0000, v141
    v_lshlrev_b32 v220, 16, v142
    v_and_b32 v221, 0xffff0000, v142
    v_lshlrev_b32 v222, 16, v143
    v_and_b32 v223, 0xffff0000, v143
    v_lshlrev_b32 v224, 16, v144
    v_and_b32 v225, 0xffff0000, v144
    v_lshlrev_b32 v226, 16, v145
    v_and_b32 v227, 0xffff0000, v145
    v_lshlrev_b32 v228, 16, v146
    v_and_b32 v229, 0xffff0000, v146
    v_lshlrev_b32 v230, 16, v147
    v_and_b32 v231, 0xffff0000, v147
    v_lshlrev_b32 v232, 16, v148
    v_and_b32 v233, 0xffff0000, v148
    v_lshlrev_b32 v234, 16, v149
    v_and_b32 v235, 0xffff0000, v149
    v_lshlrev_b32 v236, 16, v150
    v_and_b32 v237, 0xffff0000, v150
    v_lshlrev_b32 v238, 16, v151
    v_and_b32 v239, 0xffff0000, v151
    v_lshlrev_b32 v240, 16, v152
    v_and_b32 v241, 0xffff0000, v152
    v_lshlrev_b32 v242, 16, v153
    v_and_b32 v243, 0xffff0000, v153
    v_lshlrev_b32 v244, 16, v154
    v_and_b32 v245, 0xffff0000, v154
    v_lshlrev_b32 v246, 16, v155
    v_and_b32 v247, 0xffff0000, v155
    v_lshlrev_b32 v248, 16, v156
    v_and_b32 v249, 0xffff0000, v156
    v_lshlrev_b32 v250, 16, v157
    v_and_b32 v251, 0xffff0000, v157
    v_lshlrev_b32 v252, 16, v158
    v_and_b32 v253, 0xffff0000, v158
    v_lshlrev_b32 v254, 16, v159
    v_and_b32 v255, 0xffff0000, v159
    v_add_f32 v8, v192, v194
    v_mul_f32 v9, v192, v192
    v_fmac_f32 v9, v194, v194
    v_add_f32 v10, v193, v195
    v_mul_f32 v11, v193, v193
    v_fmac_f32 v11, v195, v195
    v_add_f32 v8, v8, v196
    v_fmac_f32 v9, v196, v196
    v_add_f32 v10, v10, v197
    v_fmac_f32 v11, v197, v197
    v_add_f32 v8, v8, v198
    v_fmac_f32 v9, v198, v198
    v_add_f32 v10, v10, v199
    v_fmac_f32 v11, v199, v199
    v_add_f32 v8, v8, v200
    v_fmac_f32 v9, v200, v200
    v_add_f32 v10, v10, v201
    v_fmac_f32 v11, v201, v201
    v_add_f32 v8, v8, v202
    v_fmac_f32 v9, v202, v202
    v_add_f32 v10, v10, v203
    v_fmac_f32 v11, v203, v203
    v_add_f32 v8, v8, v204
    v_fmac_f32 v9, v204, v204
    v_add_f32 v10, v10, v205
    v_fmac_f32 v11, v205, v205
    v_add_f32 v8, v8, v206
    v_fmac_f32 v9, v206, v206
    v_add_f32 v10, v10, v207
    v_fmac_f32 v11, v207, v207
    v_add_f32 v8, v8, v208
    v_fmac_f32 v9, v208, v208
    v_add_f32 v10, v10, v209
    v_fmac_f32 v11, v209, v209
    v_add_f32 v8, v8, v210
    v_fmac_f32 v9, v210, v210
    v_add_f32 v10, v10, v211
    v_fmac_f32 v11, v211, v211
    v_add_f32 v8, v8, v212
    v_fmac_f32 v9, v212, v212
    v_add_f32 v10, v10, v213
    v_fmac_f32 v11, v213, v213
    v_add_f32 v8, v8, v214
    v_fmac_f32 v9, v214, v214
    v_add_f32 v10, v10, v215
    v_fmac_f32 v11, v215, v215
    v_add_f32 v8, v8, v216
    v_fmac_f32 v9, v216, v216
    v_add_f32 v10, v10, v217
    v_fmac_f32 v11, v217, v217
    v_add_f32 v8, v8, v218
    v_fmac_f32 v9, v218, v218
    v_add_f32 v10, v10, v219
    v_fmac_f32 v11, v219, v219
    v_add_f32 v8, v8, v220
    v_fmac_f32 v9, v220, v220
    v_add_f32 v10, v10, v221
    v_fmac_f32 v11, v221, v221
    v_add_f32 v8, v8, v222
    v_fmac_f32 v9, v222, v222
    v_add_f32 v10, v10, v223
    v_fmac_f32 v11, v223, v223
    v_add_f32 v8, v8, v224
    v_fmac_f32 v9, v224, v224
    v_add_f32 v10, v10, v225
    v_fmac_f32 v11, v225, v225
    v_add_f32 v8, v8, v226
    v_fmac_f32 v9, v226, v226
    v_add_f32 v10, v10, v227
    v_fmac_f32 v11, v227, v227
    v_add_f32 v8, v8, v228
    v_fmac_f32 v9, v228, v228
    v_add_f32 v10, v10, v229
    v_fmac_f32 v11, v229, v229
    v_add_f32 v8, v8, v230
    v_fmac_f32 v9, v230, v230
    v_add_f32 v10, v10, v231
    v_fmac_f32 v11, v231, v231
    v_add_f32 v8, v8, v232
    v_fmac_f32 v9, v232, v232
    v_add_f32 v10, v10, v233
    v_fmac_f32 v11, v233, v233
    v_add_f32 v8, v8, v234
    v_fmac_f32 v9, v234, v234
    v_add_f32 v10, v10, v235
    v_fmac_f32 v11, v235, v235
    v_add_f32 v8, v8, v236
    v_fmac_f32 v9, v236, v236
    v_add_f32 v10, v10, v237
    v_fmac_f32 v11, v237, v237
    v_add_f32 v8, v8, v238
    v_fmac_f32 v9, v238, v238
    v_add_f32 v10, v10, v239
    v_fmac_f32 v11, v239, v239
    v_add_f32 v8, v8, v240
    v_fmac_f32 v9, v240, v240
    v_add_f32 v10, v10, v241
    v_fmac_f32 v11, v241, v241
    v_add_f32 v8, v8, v242
    v_fmac_f32 v9, v242, v242
    v_add_f32 v10, v10, v243
    v_fmac_f32 v11, v243, v243
    v_add_f32 v8, v8, v244
    v_fmac_f32 v9, v244, v244
    v_add_f32 v10, v10, v245
    v_fmac_f32 v11, v245, v245
    v_add_f32 v8, v8, v246
    v_fmac_f32 v9, v246, v246
    v_add_f32 v10, v10, v247
    v_fmac_f32 v11, v247, v247
    v_add_f32 v8, v8, v248
    v_fmac_f32 v9, v248, v248
    v_add_f32 v10, v10, v249
    v_fmac_f32 v11, v249, v249
    v_add_f32 v8, v8, v250
    v_fmac_f32 v9, v250, v250
    v_add_f32 v10, v10, v251
    v_fmac_f32 v11, v251, v251
    v_add_f32 v8, v8, v252
    v_fmac_f32 v9, v252, v252
    v_add_f32 v10, v10, v253
    v_fmac_f32 v11, v253, v253
    v_add_f32 v8, v8, v254
    v_fmac_f32 v9, v254, v254
    v_add_f32 v10, v10, v255
    v_fmac_f32 v11, v255, v255
    v_add_f32 v8, v8, v10
    v_add_f32 v9, v9, v11
    s_nop 1
    v_permlane32_swap_b32 v8, v9
    v_add_f32 v8, v8, v9
    v_mov_b32 v9, v8
    s_nop 1
    v_permlane16_swap_b32 v8, v9
    v_add_f32 v8, v8, v9
    s_nop 1
    v_add_f32_dpp v8, v8, v8 row_ror:8 row_mask:0xf bank_mask:0xf
    v_mul_f32 v8, 0x3b000000, v8
    v_mov_b32 v9, v8
    s_nop 1
    v_permlane32_swap_b32 v8, v9
    v_fma_f32 v9, -v8, v8, v9
    v_max_f32 v9, 0, v9
    v_add_f32 v9, 0x3727c5ac, v9
    v_rsq_f32 v9, v9
    v_sub_f32 v192, v192, v8
    v_sub_f32 v193, v193, v8
    v_sub_f32 v194, v194, v8
    v_sub_f32 v195, v195, v8
    v_sub_f32 v196, v196, v8
    v_sub_f32 v197, v197, v8
    v_sub_f32 v198, v198, v8
    v_sub_f32 v199, v199, v8
    v_mul_f32 v192, v192, v9
    v_mul_f32 v193, v193, v9
    v_mul_f32 v194, v194, v9
    v_mul_f32 v195, v195, v9
    v_mul_f32 v196, v196, v9
    v_mul_f32 v197, v197, v9
    v_mul_f32 v198, v198, v9
    v_mul_f32 v199, v199, v9
    v_cvt_pk_bf16_f32 v128, v192, v193
    v_cvt_pk_bf16_f32 v129, v194, v195
    v_cvt_pk_bf16_f32 v130, v196, v197
    v_cvt_pk_bf16_f32 v131, v198, v199
    v_min_u32 v128, -2, v128
    global_store_dwordx4 v120, v[128:131], s[36:37] offset:-4096 sc1
    v_sub_f32 v200, v200, v8
    v_sub_f32 v201, v201, v8
    v_sub_f32 v202, v202, v8
    v_sub_f32 v203, v203, v8
    v_sub_f32 v204, v204, v8
    v_sub_f32 v205, v205, v8
    v_sub_f32 v206, v206, v8
    v_sub_f32 v207, v207, v8
    v_mul_f32 v200, v200, v9
    v_mul_f32 v201, v201, v9
    v_mul_f32 v202, v202, v9
    v_mul_f32 v203, v203, v9
    v_mul_f32 v204, v204, v9
    v_mul_f32 v205, v205, v9
    v_mul_f32 v206, v206, v9
    v_mul_f32 v207, v207, v9
    v_cvt_pk_bf16_f32 v132, v200, v201
    v_cvt_pk_bf16_f32 v133, v202, v203
    v_cvt_pk_bf16_f32 v134, v204, v205
    v_cvt_pk_bf16_f32 v135, v206, v207
    v_min_u32 v132, -2, v132
    global_store_dwordx4 v120, v[132:135], s[36:37] offset:0 sc1
    v_sub_f32 v208, v208, v8
    v_sub_f32 v209, v209, v8
    v_sub_f32 v210, v210, v8
    v_sub_f32 v211, v211, v8
    v_sub_f32 v212, v212, v8
    v_sub_f32 v213, v213, v8
    v_sub_f32 v214, v214, v8
    v_sub_f32 v215, v215, v8
    v_mul_f32 v208, v208, v9
    v_mul_f32 v209, v209, v9
    v_mul_f32 v210, v210, v9
    v_mul_f32 v211, v211, v9
    v_mul_f32 v212, v212, v9
    v_mul_f32 v213, v213, v9
    v_mul_f32 v214, v214, v9
    v_mul_f32 v215, v215, v9
    v_cvt_pk_bf16_f32 v136, v208, v209
    v_cvt_pk_bf16_f32 v137, v210, v211
    v_cvt_pk_bf16_f32 v138, v212, v213
    v_cvt_pk_bf16_f32 v139, v214, v215
    v_min_u32 v136, -2, v136
    global_store_dwordx4 v121, v[136:139], s[36:37] offset:-4096 sc1
    v_sub_f32 v216, v216, v8
    v_sub_f32 v217, v217, v8
    v_sub_f32 v218, v218, v8
    v_sub_f32 v219, v219, v8
    v_sub_f32 v220, v220, v8
    v_sub_f32 v221, v221, v8
    v_sub_f32 v222, v222, v8
    v_sub_f32 v223, v223, v8
    v_mul_f32 v216, v216, v9
    v_mul_f32 v217, v217, v9
    v_mul_f32 v218, v218, v9
    v_mul_f32 v219, v219, v9
    v_mul_f32 v220, v220, v9
    v_mul_f32 v221, v221, v9
    v_mul_f32 v222, v222, v9
    v_mul_f32 v223, v223, v9
    v_cvt_pk_bf16_f32 v140, v216, v217
    v_cvt_pk_bf16_f32 v141, v218, v219
    v_cvt_pk_bf16_f32 v142, v220, v221
    v_cvt_pk_bf16_f32 v143, v222, v223
    v_min_u32 v140, -2, v140
    global_store_dwordx4 v121, v[140:143], s[36:37] offset:0 sc1
    v_sub_f32 v224, v224, v8
    v_sub_f32 v225, v225, v8
    v_sub_f32 v226, v226, v8
    v_sub_f32 v227, v227, v8
    v_sub_f32 v228, v228, v8
    v_sub_f32 v229, v229, v8
    v_sub_f32 v230, v230, v8
    v_sub_f32 v231, v231, v8
    v_mul_f32 v224, v224, v9
    v_mul_f32 v225, v225, v9
    v_mul_f32 v226, v226, v9
    v_mul_f32 v227, v227, v9
    v_mul_f32 v228, v228, v9
    v_mul_f32 v229, v229, v9
    v_mul_f32 v230, v230, v9
    v_mul_f32 v231, v231, v9
    v_cvt_pk_bf16_f32 v144, v224, v225
    v_cvt_pk_bf16_f32 v145, v226, v227
    v_cvt_pk_bf16_f32 v146, v228, v229
    v_cvt_pk_bf16_f32 v147, v230, v231
    v_min_u32 v144, -2, v144
    global_store_dwordx4 v122, v[144:147], s[36:37] offset:-4096 sc1
    v_sub_f32 v232, v232, v8
    v_sub_f32 v233, v233, v8
    v_sub_f32 v234, v234, v8
    v_sub_f32 v235, v235, v8
    v_sub_f32 v236, v236, v8
    v_sub_f32 v237, v237, v8
    v_sub_f32 v238, v238, v8
    v_sub_f32 v239, v239, v8
    v_mul_f32 v232, v232, v9
    v_mul_f32 v233, v233, v9
    v_mul_f32 v234, v234, v9
    v_mul_f32 v235, v235, v9
    v_mul_f32 v236, v236, v9
    v_mul_f32 v237, v237, v9
    v_mul_f32 v238, v238, v9
    v_mul_f32 v239, v239, v9
    v_cvt_pk_bf16_f32 v148, v232, v233
    v_cvt_pk_bf16_f32 v149, v234, v235
    v_cvt_pk_bf16_f32 v150, v236, v237
    v_cvt_pk_bf16_f32 v151, v238, v239
    v_min_u32 v148, -2, v148
    global_store_dwordx4 v122, v[148:151], s[36:37] offset:0 sc1
    v_sub_f32 v240, v240, v8
    v_sub_f32 v241, v241, v8
    v_sub_f32 v242, v242, v8
    v_sub_f32 v243, v243, v8
    v_sub_f32 v244, v244, v8
    v_sub_f32 v245, v245, v8
    v_sub_f32 v246, v246, v8
    v_sub_f32 v247, v247, v8
    v_mul_f32 v240, v240, v9
    v_mul_f32 v241, v241, v9
    v_mul_f32 v242, v242, v9
    v_mul_f32 v243, v243, v9
    v_mul_f32 v244, v244, v9
    v_mul_f32 v245, v245, v9
    v_mul_f32 v246, v246, v9
    v_mul_f32 v247, v247, v9
    v_cvt_pk_bf16_f32 v152, v240, v241
    v_cvt_pk_bf16_f32 v153, v242, v243
    v_cvt_pk_bf16_f32 v154, v244, v245
    v_cvt_pk_bf16_f32 v155, v246, v247
    v_min_u32 v152, -2, v152
    global_store_dwordx4 v123, v[152:155], s[36:37] offset:-4096 sc1
    v_sub_f32 v248, v248, v8
    v_sub_f32 v249, v249, v8
    v_sub_f32 v250, v250, v8
    v_sub_f32 v251, v251, v8
    v_sub_f32 v252, v252, v8
    v_sub_f32 v253, v253, v8
    v_sub_f32 v254, v254, v8
    v_sub_f32 v255, v255, v8
    v_mul_f32 v248, v248, v9
    v_mul_f32 v249, v249, v9
    v_mul_f32 v250, v250, v9
    v_mul_f32 v251, v251, v9
    v_mul_f32 v252, v252, v9
    v_mul_f32 v253, v253, v9
    v_mul_f32 v254, v254, v9
    v_mul_f32 v255, v255, v9
    v_cvt_pk_bf16_f32 v156, v248, v249
    v_cvt_pk_bf16_f32 v157, v250, v251
    v_cvt_pk_bf16_f32 v158, v252, v253
    v_cvt_pk_bf16_f32 v159, v254, v255
    v_min_u32 v156, -2, v156
    global_store_dwordx4 v123, v[156:159], s[36:37] offset:0 sc1
    s_add_u32 s36, s36, 0x8000
    s_addc_u32 s37, s37, 0
    v_lshlrev_b32 v192, 16, v160
    v_and_b32 v193, 0xffff0000, v160
    v_lshlrev_b32 v194, 16, v161
    v_and_b32 v195, 0xffff0000, v161
    v_lshlrev_b32 v196, 16, v162
    v_and_b32 v197, 0xffff0000, v162
    v_lshlrev_b32 v198, 16, v163
    v_and_b32 v199, 0xffff0000, v163
    v_lshlrev_b32 v200, 16, v164
    v_and_b32 v201, 0xffff0000, v164
    v_lshlrev_b32 v202, 16, v165
    v_and_b32 v203, 0xffff0000, v165
    v_lshlrev_b32 v204, 16, v166
    v_and_b32 v205, 0xffff0000, v166
    v_lshlrev_b32 v206, 16, v167
    v_and_b32 v207, 0xffff0000, v167
    v_lshlrev_b32 v208, 16, v168
    v_and_b32 v209, 0xffff0000, v168
    v_lshlrev_b32 v210, 16, v169
    v_and_b32 v211, 0xffff0000, v169
    v_lshlrev_b32 v212, 16, v170
    v_and_b32 v213, 0xffff0000, v170
    v_lshlrev_b32 v214, 16, v171
    v_and_b32 v215, 0xffff0000, v171
    v_lshlrev_b32 v216, 16, v172
    v_and_b32 v217, 0xffff0000, v172
    v_lshlrev_b32 v218, 16, v173
    v_and_b32 v219, 0xffff0000, v173
    v_lshlrev_b32 v220, 16, v174
    v_and_b32 v221, 0xffff0000, v174
    v_lshlrev_b32 v222, 16, v175
    v_and_b32 v223, 0xffff0000, v175
    v_lshlrev_b32 v224, 16, v176
    v_and_b32 v225, 0xffff0000, v176
    v_lshlrev_b32 v226, 16, v177
    v_and_b32 v227, 0xffff0000, v177
    v_lshlrev_b32 v228, 16, v178
    v_and_b32 v229, 0xffff0000, v178
    v_lshlrev_b32 v230, 16, v179
    v_and_b32 v231, 0xffff0000, v179
    v_lshlrev_b32 v232, 16, v180
    v_and_b32 v233, 0xffff0000, v180
    v_lshlrev_b32 v234, 16, v181
    v_and_b32 v235, 0xffff0000, v181
    v_lshlrev_b32 v236, 16, v182
    v_and_b32 v237, 0xffff0000, v182
    v_lshlrev_b32 v238, 16, v183
    v_and_b32 v239, 0xffff0000, v183
    v_lshlrev_b32 v240, 16, v184
    v_and_b32 v241, 0xffff0000, v184
    v_lshlrev_b32 v242, 16, v185
    v_and_b32 v243, 0xffff0000, v185
    v_lshlrev_b32 v244, 16, v186
    v_and_b32 v245, 0xffff0000, v186
    v_lshlrev_b32 v246, 16, v187
    v_and_b32 v247, 0xffff0000, v187
    v_lshlrev_b32 v248, 16, v188
    v_and_b32 v249, 0xffff0000, v188
    v_lshlrev_b32 v250, 16, v189
    v_and_b32 v251, 0xffff0000, v189
    v_lshlrev_b32 v252, 16, v190
    v_and_b32 v253, 0xffff0000, v190
    v_lshlrev_b32 v254, 16, v191
    v_and_b32 v255, 0xffff0000, v191
    v_add_f32 v8, v192, v194
    v_mul_f32 v9, v192, v192
    v_fmac_f32 v9, v194, v194
    v_add_f32 v10, v193, v195
    v_mul_f32 v11, v193, v193
    v_fmac_f32 v11, v195, v195
    v_add_f32 v8, v8, v196
    v_fmac_f32 v9, v196, v196
    v_add_f32 v10, v10, v197
    v_fmac_f32 v11, v197, v197
    v_add_f32 v8, v8, v198
    v_fmac_f32 v9, v198, v198
    v_add_f32 v10, v10, v199
    v_fmac_f32 v11, v199, v199
    v_add_f32 v8, v8, v200
    v_fmac_f32 v9, v200, v200
    v_add_f32 v10, v10, v201
    v_fmac_f32 v11, v201, v201
    v_add_f32 v8, v8, v202
    v_fmac_f32 v9, v202, v202
    v_add_f32 v10, v10, v203
    v_fmac_f32 v11, v203, v203
    v_add_f32 v8, v8, v204
    v_fmac_f32 v9, v204, v204
    v_add_f32 v10, v10, v205
    v_fmac_f32 v11, v205, v205
    v_add_f32 v8, v8, v206
    v_fmac_f32 v9, v206, v206
    v_add_f32 v10, v10, v207
    v_fmac_f32 v11, v207, v207
    v_add_f32 v8, v8, v208
    v_fmac_f32 v9, v208, v208
    v_add_f32 v10, v10, v209
    v_fmac_f32 v11, v209, v209
    v_add_f32 v8, v8, v210
    v_fmac_f32 v9, v210, v210
    v_add_f32 v10, v10, v211
    v_fmac_f32 v11, v211, v211
    v_add_f32 v8, v8, v212
    v_fmac_f32 v9, v212, v212
    v_add_f32 v10, v10, v213
    v_fmac_f32 v11, v213, v213
    v_add_f32 v8, v8, v214
    v_fmac_f32 v9, v214, v214
    v_add_f32 v10, v10, v215
    v_fmac_f32 v11, v215, v215
    v_add_f32 v8, v8, v216
    v_fmac_f32 v9, v216, v216
    v_add_f32 v10, v10, v217
    v_fmac_f32 v11, v217, v217
    v_add_f32 v8, v8, v218
    v_fmac_f32 v9, v218, v218
    v_add_f32 v10, v10, v219
    v_fmac_f32 v11, v219, v219
    v_add_f32 v8, v8, v220
    v_fmac_f32 v9, v220, v220
    v_add_f32 v10, v10, v221
    v_fmac_f32 v11, v221, v221
    v_add_f32 v8, v8, v222
    v_fmac_f32 v9, v222, v222
    v_add_f32 v10, v10, v223
    v_fmac_f32 v11, v223, v223
    v_add_f32 v8, v8, v224
    v_fmac_f32 v9, v224, v224
    v_add_f32 v10, v10, v225
    v_fmac_f32 v11, v225, v225
    v_add_f32 v8, v8, v226
    v_fmac_f32 v9, v226, v226
    v_add_f32 v10, v10, v227
    v_fmac_f32 v11, v227, v227
    v_add_f32 v8, v8, v228
    v_fmac_f32 v9, v228, v228
    v_add_f32 v10, v10, v229
    v_fmac_f32 v11, v229, v229
    v_add_f32 v8, v8, v230
    v_fmac_f32 v9, v230, v230
    v_add_f32 v10, v10, v231
    v_fmac_f32 v11, v231, v231
    v_add_f32 v8, v8, v232
    v_fmac_f32 v9, v232, v232
    v_add_f32 v10, v10, v233
    v_fmac_f32 v11, v233, v233
    v_add_f32 v8, v8, v234
    v_fmac_f32 v9, v234, v234
    v_add_f32 v10, v10, v235
    v_fmac_f32 v11, v235, v235
    v_add_f32 v8, v8, v236
    v_fmac_f32 v9, v236, v236
    v_add_f32 v10, v10, v237
    v_fmac_f32 v11, v237, v237
    v_add_f32 v8, v8, v238
    v_fmac_f32 v9, v238, v238
    v_add_f32 v10, v10, v239
    v_fmac_f32 v11, v239, v239
    v_add_f32 v8, v8, v240
    v_fmac_f32 v9, v240, v240
    v_add_f32 v10, v10, v241
    v_fmac_f32 v11, v241, v241
    v_add_f32 v8, v8, v242
    v_fmac_f32 v9, v242, v242
    v_add_f32 v10, v10, v243
    v_fmac_f32 v11, v243, v243
    v_add_f32 v8, v8, v244
    v_fmac_f32 v9, v244, v244
    v_add_f32 v10, v10, v245
    v_fmac_f32 v11, v245, v245
    v_add_f32 v8, v8, v246
    v_fmac_f32 v9, v246, v246
    v_add_f32 v10, v10, v247
    v_fmac_f32 v11, v247, v247
    v_add_f32 v8, v8, v248
    v_fmac_f32 v9, v248, v248
    v_add_f32 v10, v10, v249
    v_fmac_f32 v11, v249, v249
    v_add_f32 v8, v8, v250
    v_fmac_f32 v9, v250, v250
    v_add_f32 v10, v10, v251
    v_fmac_f32 v11, v251, v251
    v_add_f32 v8, v8, v252
    v_fmac_f32 v9, v252, v252
    v_add_f32 v10, v10, v253
    v_fmac_f32 v11, v253, v253
    v_add_f32 v8, v8, v254
    v_fmac_f32 v9, v254, v254
    v_add_f32 v10, v10, v255
    v_fmac_f32 v11, v255, v255
    v_add_f32 v8, v8, v10
    v_add_f32 v9, v9, v11
    s_nop 1
    v_permlane32_swap_b32 v8, v9
    v_add_f32 v8, v8, v9
    v_mov_b32 v9, v8
    s_nop 1
    v_permlane16_swap_b32 v8, v9
    v_add_f32 v8, v8, v9
    s_nop 1
    v_add_f32_dpp v8, v8, v8 row_ror:8 row_mask:0xf bank_mask:0xf
    v_mul_f32 v8, 0x3b000000, v8
    v_mov_b32 v9, v8
    s_nop 1
    v_permlane32_swap_b32 v8, v9
    v_fma_f32 v9, -v8, v8, v9
    v_max_f32 v9, 0, v9
    v_add_f32 v9, 0x3727c5ac, v9
    v_rsq_f32 v9, v9
    v_sub_f32 v192, v192, v8
    v_sub_f32 v193, v193, v8
    v_sub_f32 v194, v194, v8
    v_sub_f32 v195, v195, v8
    v_sub_f32 v196, v196, v8
    v_sub_f32 v197, v197, v8
    v_sub_f32 v198, v198, v8
    v_sub_f32 v199, v199, v8
    v_mul_f32 v192, v192, v9
    v_mul_f32 v193, v193, v9
    v_mul_f32 v194, v194, v9
    v_mul_f32 v195, v195, v9
    v_mul_f32 v196, v196, v9
    v_mul_f32 v197, v197, v9
    v_mul_f32 v198, v198, v9
    v_mul_f32 v199, v199, v9
    v_cvt_pk_bf16_f32 v160, v192, v193
    v_cvt_pk_bf16_f32 v161, v194, v195
    v_cvt_pk_bf16_f32 v162, v196, v197
    v_cvt_pk_bf16_f32 v163, v198, v199
    v_min_u32 v160, -2, v160
    global_store_dwordx4 v120, v[160:163], s[36:37] offset:-4096 sc1
    v_sub_f32 v200, v200, v8
    v_sub_f32 v201, v201, v8
    v_sub_f32 v202, v202, v8
    v_sub_f32 v203, v203, v8
    v_sub_f32 v204, v204, v8
    v_sub_f32 v205, v205, v8
    v_sub_f32 v206, v206, v8
    v_sub_f32 v207, v207, v8
    v_mul_f32 v200, v200, v9
    v_mul_f32 v201, v201, v9
    v_mul_f32 v202, v202, v9
    v_mul_f32 v203, v203, v9
    v_mul_f32 v204, v204, v9
    v_mul_f32 v205, v205, v9
    v_mul_f32 v206, v206, v9
    v_mul_f32 v207, v207, v9
    v_cvt_pk_bf16_f32 v164, v200, v201
    v_cvt_pk_bf16_f32 v165, v202, v203
    v_cvt_pk_bf16_f32 v166, v204, v205
    v_cvt_pk_bf16_f32 v167, v206, v207
    v_min_u32 v164, -2, v164
    global_store_dwordx4 v120, v[164:167], s[36:37] offset:0 sc1
    v_sub_f32 v208, v208, v8
    v_sub_f32 v209, v209, v8
    v_sub_f32 v210, v210, v8
    v_sub_f32 v211, v211, v8
    v_sub_f32 v212, v212, v8
    v_sub_f32 v213, v213, v8
    v_sub_f32 v214, v214, v8
    v_sub_f32 v215, v215, v8
    v_mul_f32 v208, v208, v9
    v_mul_f32 v209, v209, v9
    v_mul_f32 v210, v210, v9
    v_mul_f32 v211, v211, v9
    v_mul_f32 v212, v212, v9
    v_mul_f32 v213, v213, v9
    v_mul_f32 v214, v214, v9
    v_mul_f32 v215, v215, v9
    v_cvt_pk_bf16_f32 v168, v208, v209
    v_cvt_pk_bf16_f32 v169, v210, v211
    v_cvt_pk_bf16_f32 v170, v212, v213
    v_cvt_pk_bf16_f32 v171, v214, v215
    v_min_u32 v168, -2, v168
    global_store_dwordx4 v121, v[168:171], s[36:37] offset:-4096 sc1
    v_sub_f32 v216, v216, v8
    v_sub_f32 v217, v217, v8
    v_sub_f32 v218, v218, v8
    v_sub_f32 v219, v219, v8
    v_sub_f32 v220, v220, v8
    v_sub_f32 v221, v221, v8
    v_sub_f32 v222, v222, v8
    v_sub_f32 v223, v223, v8
    v_mul_f32 v216, v216, v9
    v_mul_f32 v217, v217, v9
    v_mul_f32 v218, v218, v9
    v_mul_f32 v219, v219, v9
    v_mul_f32 v220, v220, v9
    v_mul_f32 v221, v221, v9
    v_mul_f32 v222, v222, v9
    v_mul_f32 v223, v223, v9
    v_cvt_pk_bf16_f32 v172, v216, v217
    v_cvt_pk_bf16_f32 v173, v218, v219
    v_cvt_pk_bf16_f32 v174, v220, v221
    v_cvt_pk_bf16_f32 v175, v222, v223
    v_min_u32 v172, -2, v172
    global_store_dwordx4 v121, v[172:175], s[36:37] offset:0 sc1
    v_sub_f32 v224, v224, v8
    v_sub_f32 v225, v225, v8
    v_sub_f32 v226, v226, v8
    v_sub_f32 v227, v227, v8
    v_sub_f32 v228, v228, v8
    v_sub_f32 v229, v229, v8
    v_sub_f32 v230, v230, v8
    v_sub_f32 v231, v231, v8
    v_mul_f32 v224, v224, v9
    v_mul_f32 v225, v225, v9
    v_mul_f32 v226, v226, v9
    v_mul_f32 v227, v227, v9
    v_mul_f32 v228, v228, v9
    v_mul_f32 v229, v229, v9
    v_mul_f32 v230, v230, v9
    v_mul_f32 v231, v231, v9
    v_cvt_pk_bf16_f32 v176, v224, v225
    v_cvt_pk_bf16_f32 v177, v226, v227
    v_cvt_pk_bf16_f32 v178, v228, v229
    v_cvt_pk_bf16_f32 v179, v230, v231
    v_min_u32 v176, -2, v176
    global_store_dwordx4 v122, v[176:179], s[36:37] offset:-4096 sc1
    v_sub_f32 v232, v232, v8
    v_sub_f32 v233, v233, v8
    v_sub_f32 v234, v234, v8
    v_sub_f32 v235, v235, v8
    v_sub_f32 v236, v236, v8
    v_sub_f32 v237, v237, v8
    v_sub_f32 v238, v238, v8
    v_sub_f32 v239, v239, v8
    v_mul_f32 v232, v232, v9
    v_mul_f32 v233, v233, v9
    v_mul_f32 v234, v234, v9
    v_mul_f32 v235, v235, v9
    v_mul_f32 v236, v236, v9
    v_mul_f32 v237, v237, v9
    v_mul_f32 v238, v238, v9
    v_mul_f32 v239, v239, v9
    v_cvt_pk_bf16_f32 v180, v232, v233
    v_cvt_pk_bf16_f32 v181, v234, v235
    v_cvt_pk_bf16_f32 v182, v236, v237
    v_cvt_pk_bf16_f32 v183, v238, v239
    v_min_u32 v180, -2, v180
    global_store_dwordx4 v122, v[180:183], s[36:37] offset:0 sc1
    v_sub_f32 v240, v240, v8
    v_sub_f32 v241, v241, v8
    v_sub_f32 v242, v242, v8
    v_sub_f32 v243, v243, v8
    v_sub_f32 v244, v244, v8
    v_sub_f32 v245, v245, v8
    v_sub_f32 v246, v246, v8
    v_sub_f32 v247, v247, v8
    v_mul_f32 v240, v240, v9
    v_mul_f32 v241, v241, v9
    v_mul_f32 v242, v242, v9
    v_mul_f32 v243, v243, v9
    v_mul_f32 v244, v244, v9
    v_mul_f32 v245, v245, v9
    v_mul_f32 v246, v246, v9
    v_mul_f32 v247, v247, v9
    v_cvt_pk_bf16_f32 v184, v240, v241
    v_cvt_pk_bf16_f32 v185, v242, v243
    v_cvt_pk_bf16_f32 v186, v244, v245
    v_cvt_pk_bf16_f32 v187, v246, v247
    v_min_u32 v184, -2, v184
    global_store_dwordx4 v123, v[184:187], s[36:37] offset:-4096 sc1
    v_sub_f32 v248, v248, v8
    v_sub_f32 v249, v249, v8
    v_sub_f32 v250, v250, v8
    v_sub_f32 v251, v251, v8
    v_sub_f32 v252, v252, v8
    v_sub_f32 v253, v253, v8
    v_sub_f32 v254, v254, v8
    v_sub_f32 v255, v255, v8
    v_mul_f32 v248, v248, v9
    v_mul_f32 v249, v249, v9
    v_mul_f32 v250, v250, v9
    v_mul_f32 v251, v251, v9
    v_mul_f32 v252, v252, v9
    v_mul_f32 v253, v253, v9
    v_mul_f32 v254, v254, v9
    v_mul_f32 v255, v255, v9
    v_cvt_pk_bf16_f32 v188, v248, v249
    v_cvt_pk_bf16_f32 v189, v250, v251
    v_cvt_pk_bf16_f32 v190, v252, v253
    v_cvt_pk_bf16_f32 v191, v254, v255
    v_min_u32 v188, -2, v188
    global_store_dwordx4 v123, v[188:191], s[36:37] offset:0 sc1
    s_xor_b32 s14, s13, 1
    s_lshl_b32 s14, s14, 4
    s_add_u32 s14, s14, s11
    s_lshl_b32 s14, s14, 6
    s_add_u32 s14, s14, 335872
    v_mov_b32 v8, s14
    s_waitcnt vmcnt(0)
    s_barrier
    global_store_dword v8, v7, s[4:5] sc1
LN0_SK2:
    s_waitcnt vmcnt(0)
    s_barrier
    s_getreg_b32 s19, hwreg(HW_REG_XCC_ID)
    s_and_b32 s19, s19, 15
    s_lshl_b32 s14, s10, 8
    s_lshr_b32 s15, s2, 3
    s_lshl_b32 s15, s15, 3
    s_add_u32 s14, s14, s15
    s_add_u32 s14, s14, 331776
    s_cmp_lg_u32 s9, 0
    s_cbranch_scc1 XP_1
    v_mov_b32 v18, s14
    v_mov_b32 v16, s8
    v_mov_b32 v17, s19
    global_store_dwordx2 v18, v[16:17], s[4:5] sc1
XP_1:
    s_cmp_ge_u32 s11, 16
    s_cbranch_scc1 END
    s_cmp_eq_u32 s13, 0
    s_cbranch_scc1 RED_GO
    s_branch ROLE_QH
RED_RET:
    s_load_dwordx2 s[20:21], s[0:1], 0
    s_load_dwordx2 s[42:43], s[0:1], 80
    s_sub_u32 s13, s10, 6
    s_lshr_b32 s11, s2, 3
    s_sub_u32 s11, s11, 14
    v_lshrrev_b32 v1, 3, v0
    v_and_b32 v2, 7, v0
    v_lshlrev_b32 v3, 4, v2
    v_lshl_add_u32 v3, v1, 10, v3
    s_lshl_b32 s14, s9, 13
    v_add_u32 v48, s14, v3
    v_lshrrev_b32 v1, 2, v0
    v_and_b32 v2, 3, v0
    v_add_u32 v49, 32768, v48
    v_add_u32 v50, 65536, v48
    v_add_u32 v51, 98304, v48
    v_add_u32 v52, 131072, v48
    v_add_u32 v53, 163840, v48
    v_add_u32 v54, 196608, v48
    v_add_u32 v55, 229376, v48
    v_add_u32 v56, 262144, v48
    v_add_u32 v57, 294912, v48
    v_add_u32 v58, 327680, v48
    v_add_u32 v59, 360448, v48
    v_add_u32 v60, 393216, v48
    v_add_u32 v61, 425984, v48
    v_lshlrev_b32 v3, 4, v1
    v_lshl_add_u32 v3, v2, 10, v3
    s_lshl_b32 s14, s9, 8
    v_add_u32 v4, s14, v3
    v_min_u32 v3, 13, v1
    v_and_b32 v45, 3, v3
    v_lshlrev_b32 v3, 15, v3
    v_lshl_add_u32 v3, v45, 11, v3
    s_lshl_b32 s14, s9, 13
    s_add_u32 s14, s14, 1024
    v_add_u32 v5, s14, v3
    v_min_u32 v3, 13, v1
    v_add_u32 v3, s9, v3
    v_add_u32 v3, s11, v3
    v_and_b32 v3, 7, v3
    v_lshl_add_u32 v5, v3, 7, v5
    v_lshlrev_b32 v41, 5, v2
    v_lshrrev_b32 v3, 5, v0
    v_lshl_add_u32 v3, v3, 7, v41
    v_bfe_u32 v1, v0, 4, 1
    v_lshl_add_u32 v3, v1, 2, v3
    s_lshl_b32 s14, s9, 3
    v_add_u32 v40, s14, v3
    s_mov_b32 s44, 0x000f000f
    s_mov_b32 s45, 0x000f000f
    v_mov_b32 v36, -1
    v_mov_b32 v37, -1
    v_mov_b32 v38, -1
    v_mov_b32 v39, -1
    s_waitcnt lgkmcnt(0)
    s_lshl_b32 s14, s13, 10
    s_lshl_b32 s15, s11, 7
    s_add_u32 s14, s14, s15
    s_add_u32 s14, s14, 344064
    s_lshl_b32 s15, s13, 8
    s_lshl_b32 s16, s11, 4
    s_add_u32 s15, s15, s16
    s_lshl_b32 s16, s9, 2
    s_add_u32 s15, s15, s16
    s_add_u32 s15, s15, 341888
    s_cmp_lt_u32 s11, 8
    s_cselect_b32 s14, s14, s15
    s_add_u32 s46, s4, s14
    s_addc_u32 s47, s5, 0
    v_add_u32 v46, 6291456, v48
    v_mov_b32 v43, 0
    v_mov_b32 v7, s8
RED_GO:
    s_mul_i32 s14, s13, 6
    s_sub_u32 s54, 64, s14
    s_lshl_b32 s14, s14, 3
    s_sub_u32 s55, 536, s14
    s_mul_i32 s14, s13, 63488
    s_add_u32 s14, s14, 395264
    v_mov_b32 v17, s14
    s_mov_b32 s12, 0
POLL_2:
    global_load_dword v16, v17, s[4:5] offset:0 sc1
    s_add_u32 s12, s12, 1
    s_mov_b32 s17, 30
    s_cmp_gt_u32 s12, 20000
    s_cbranch_scc1 TIMEOUT
    s_waitcnt vmcnt(0)
    v_cmp_ne_u32 vcc, s8, v16
    s_cbranch_vccnz POLL_2
    v_and_b32 v17, 31, v0
    v_max_u32 v17, 14, v17
    v_and_or_b32 v17, v0, 32, v17
    v_lshlrev_b32 v17, 3, v17
    v_add_u32 v17, 333312, v17
    s_mov_b32 s12, 0
POLL_3:
    global_load_dword v16, v17, s[4:5] offset:0 sc1
    s_add_u32 s12, s12, 1
    s_mov_b32 s17, 17
    s_cmp_gt_u32 s12, 20000
    s_cbranch_scc1 TIMEOUT
    s_waitcnt vmcnt(0)
    v_cmp_ne_u32 vcc, s8, v16
    s_cbranch_vccnz POLL_3
    s_lshl_b32 s14, s10, 8
    s_add_u32 s14, s14, 331776
    v_med3_u32 v18, 0, v0, 29
    v_lshlrev_b32 v18, 3, v18
    v_add_u32 v18, s14, v18
    s_mov_b32 s12, 0
XT_4:
    global_load_dwordx2 v[16:17], v18, s[4:5] sc1
    s_add_u32 s12, s12, 1
    s_mov_b32 s17, 12
    s_cmp_gt_u32 s12, 20000
    s_cbranch_scc1 TIMEOUT
    s_waitcnt vmcnt(0)
    v_cmp_ne_u32 vcc, s8, v16
    s_cbranch_vccnz XT_4
    v_cmp_ne_u32 vcc, s19, v17
    s_cmp_eq_u64 vcc, 0
    s_cselect_b32 s18, 1, 0
    s_cmp_ge_u32 s11, 8
    s_cbranch_scc1 RED_FFN
    s_lshl_b32 s14, s13, 5
    s_add_u32 s14, s14, 332416
    v_bfe_u32 v16, v0, 2, 2
    v_and_b32 v18, 3, v0
    v_lshlrev_b32 v18, 3, v18
    v_lshl_add_u32 v18, v16, 8, v18
    v_bfe_u32 v16, v0, 4, 1
    v_lshl_add_u32 v18, v16, 6, v18
    v_add_u32 v18, s14, v18
    s_mov_b32 s12, 0
XT_5:
    global_load_dwordx2 v[16:17], v18, s[4:5] sc1
    s_add_u32 s12, s12, 1
    s_mov_b32 s17, 15
    s_cmp_gt_u32 s12, 20000
    s_cbranch_scc1 TIMEOUT
    s_waitcnt vmcnt(0)
    v_cmp_ne_u32 vcc, s8, v16
    s_cbranch_vccnz XT_5
    s_lshl_b32 s14, s13, 22
    s_add_u32 s15, s14, 12582912
    s_add_u32 s22, s4, s15
    s_addc_u32 s23, s5, 0
    s_add_u32 s15, s14, 6291456
    s_add_u32 s24, s4, s15
    s_addc_u32 s25, s5, 0
    s_mul_i32 s14, s13, 1048576
    s_add_u32 s15, s14, 161480704
    s_add_u32 s26, s4, s15
    s_addc_u32 s27, s5, 0
    s_lshl_b32 s32, s11, 0
    s_mov_b32 s33, 8
    s_lshl_b32 s14, s13, 8
    s_add_u32 s14, s14, 342016
    s_add_u32 s50, s4, s14
    s_addc_u32 s51, s5, 0
    v_min_u32 v47, 31, v0
    v_lshlrev_b32 v47, 2, v47
    v_lshrrev_b32 v1, 3, v0
    v_lshlrev_b32 v1, 15, v1
    v_bfe_u32 v2, v0, 2, 1
    v_lshl_add_u32 v1, v2, 12, v1
    s_lshl_b32 s14, s9, 13
    s_add_u32 s14, s14, 3072
    v_add_u32 v5, s14, v1
    s_cmp_eq_u32 s13, 0
    s_cbranch_scc1 RED_W0
    s_add_u32 s20, s4, 0xe00000
    s_addc_u32 s21, s5, 0
RED_W1:
    s_cmp_eq_u32 s18, 0
    s_cbranch_scc1 RED_WS1
    s_lshr_b32 s14, s32, 3
    s_and_b32 s15, s32, 7
    s_lshl_b32 s15, s15, 7
    s_lshl_b32 s16, s14, 15
    s_add_u32 s16, s16, s15
    s_and_b32 s17, s16, 262143
    s_sub_i32 s52, s14, s54
    s_max_i32 s52, s52, 0
    s_lshl_b32 s52, s52, 15
    s_add_u32 s16, s16, s52
    s_add_u32 s38, s20, s16
    s_addc_u32 s39, s21, 0
    s_lshl_b32 s52, s14, 3
    s_sub_u32 s52, s52, 40
    s_bfe_u32 s29, s14, 0x10002
    s_and_b32 s16, s14, 3
    s_mul_i32 s16, s16, 262144
    s_add_u32 s16, s16, s15
    s_add_u32 s34, s26, s16
    s_addc_u32 s35, s27, 0
    s_lshr_b32 s14, s32, 3
    s_and_b32 s15, s32, 7
    s_lshl_b32 s15, s15, 7
    s_lshl_b32 s16, s14, 15
    s_add_u32 s16, s16, s15
    s_and_b32 s17, s16, 262143
    s_add_u32 s36, s24, s17
    s_addc_u32 s37, s25, 0
    s_add_u32 s40, s22, s17
    s_addc_u32 s41, s23, 0
    s_add_u32 s17, s16, 65536
    s_and_b32 s17, s17, 262143
    s_add_u32 s48, s24, s17
    s_addc_u32 s49, s25, 0
    s_mov_b32 s12, 0
    s_add_u32 s53, s32, s33
    v_mov_b32 v44, s53
    s_min_u32 s53, s53, 511
RED_6:
REDL_8:
    global_load_dwordx4 v[16:19], v48, s[38:39] offset:0 sc1
    global_load_dword v62, v47, s[50:51] sc1
    global_load_dwordx4 v[64:67], v48, s[34:35] offset:0 sc1
    global_load_dwordx4 v[68:71], v49, s[34:35] offset:0 sc1
    global_load_dwordx4 v[72:75], v50, s[34:35] offset:0 sc1
    global_load_dwordx4 v[76:79], v51, s[34:35] offset:0 sc1
    global_load_dwordx4 v[80:83], v52, s[34:35] offset:0 sc1
    global_load_dwordx4 v[84:87], v53, s[34:35] offset:0 sc1
    global_load_dwordx4 v[88:91], v54, s[34:35] offset:0 sc1
    global_load_dwordx4 v[92:95], v55, s[34:35] offset:0 sc1
    s_add_u32 s12, s12, 1
    s_mov_b32 s17, 2
    s_cmp_gt_u32 s12, 20000
    s_cbranch_scc1 TIMEOUT
    s_waitcnt vmcnt(8)
    v_cmp_gt_i32 s[14:15], s52, v62
    v_cmp_eq_u32 vcc, -1, v16
    s_or_b64 s[14:15], s[14:15], vcc
    v_lshlrev_b32 v24, 16, v16
    v_and_b32 v25, 0xffff0000, v16
    v_lshlrev_b32 v26, 16, v17
    v_and_b32 v27, 0xffff0000, v17
    v_lshlrev_b32 v28, 16, v18
    v_and_b32 v29, 0xffff0000, v18
    v_lshlrev_b32 v30, 16, v19
    v_and_b32 v31, 0xffff0000, v19
    s_waitcnt vmcnt(7)
    v_xor_b32 v42, s29, v64
    v_fma_mix_f32 v24, v64, 1.0, v24 op_sel_hi:[1,0,0]
    v_fma_mix_f32 v25, v64, 1.0, v25 op_sel:[1,0,0] op_sel_hi:[1,0,0]
    v_fma_mix_f32 v26, v65, 1.0, v26 op_sel_hi:[1,0,0]
    v_fma_mix_f32 v27, v65, 1.0, v27 op_sel:[1,0,0] op_sel_hi:[1,0,0]
    v_fma_mix_f32 v28, v66, 1.0, v28 op_sel_hi:[1,0,0]
    v_fma_mix_f32 v29, v66, 1.0, v29 op_sel:[1,0,0] op_sel_hi:[1,0,0]
    v_fma_mix_f32 v30, v67, 1.0, v30 op_sel_hi:[1,0,0]
    v_fma_mix_f32 v31, v67, 1.0, v31 op_sel:[1,0,0] op_sel_hi:[1,0,0]
    s_waitcnt vmcnt(6)
    v_bitop3_b32 v42, v42, v68, s29 bitop3:0xf6
    v_fma_mix_f32 v24, v68, 1.0, v24 op_sel_hi:[1,0,0]
    v_fma_mix_f32 v25, v68, 1.0, v25 op_sel:[1,0,0] op_sel_hi:[1,0,0]
    v_fma_mix_f32 v26, v69, 1.0, v26 op_sel_hi:[1,0,0]
    v_fma_mix_f32 v27, v69, 1.0, v27 op_sel:[1,0,0] op_sel_hi:[1,0,0]
    v_fma_mix_f32 v28, v70, 1.0, v28 op_sel_hi:[1,0,0]
    v_fma_mix_f32 v29, v70, 1.0, v29 op_sel:[1,0,0] op_sel_hi:[1,0,0]
    v_fma_mix_f32 v30, v71, 1.0, v30 op_sel_hi:[1,0,0]
    v_fma_mix_f32 v31, v71, 1.0, v31 op_sel:[1,0,0] op_sel_hi:[1,0,0]
    s_waitcnt vmcnt(5)
    v_bitop3_b32 v42, v42, v72, s29 bitop3:0xf6
    v_fma_mix_f32 v24, v72, 1.0, v24 op_sel_hi:[1,0,0]
    v_fma_mix_f32 v25, v72, 1.0, v25 op_sel:[1,0,0] op_sel_hi:[1,0,0]
    v_fma_mix_f32 v26, v73, 1.0, v26 op_sel_hi:[1,0,0]
    v_fma_mix_f32 v27, v73, 1.0, v27 op_sel:[1,0,0] op_sel_hi:[1,0,0]
    v_fma_mix_f32 v28, v74, 1.0, v28 op_sel_hi:[1,0,0]
    v_fma_mix_f32 v29, v74, 1.0, v29 op_sel:[1,0,0] op_sel_hi:[1,0,0]
    v_fma_mix_f32 v30, v75, 1.0, v30 op_sel_hi:[1,0,0]
    v_fma_mix_f32 v31, v75, 1.0, v31 op_sel:[1,0,0] op_sel_hi:[1,0,0]
    s_waitcnt vmcnt(4)
    v_bitop3_b32 v42, v42, v76, s29 bitop3:0xf6
    v_fma_mix_f32 v24, v76, 1.0, v24 op_sel_hi:[1,0,0]
    v_fma_mix_f32 v25, v76, 1.0, v25 op_sel:[1,0,0] op_sel_hi:[1,0,0]
    v_fma_mix_f32 v26, v77, 1.0, v26 op_sel_hi:[1,0,0]
    v_fma_mix_f32 v27, v77, 1.0, v27 op_sel:[1,0,0] op_sel_hi:[1,0,0]
    v_fma_mix_f32 v28, v78, 1.0, v28 op_sel_hi:[1,0,0]
    v_fma_mix_f32 v29, v78, 1.0, v29 op_sel:[1,0,0] op_sel_hi:[1,0,0]
    v_fma_mix_f32 v30, v79, 1.0, v30 op_sel_hi:[1,0,0]
    v_fma_mix_f32 v31, v79, 1.0, v31 op_sel:[1,0,0] op_sel_hi:[1,0,0]
    s_waitcnt vmcnt(3)
    v_bitop3_b32 v42, v42, v80, s29 bitop3:0xf6
    v_fma_mix_f32 v24, v80, 1.0, v24 op_sel_hi:[1,0,0]
    v_fma_mix_f32 v25, v80, 1.0, v25 op_sel:[1,0,0] op_sel_hi:[1,0,0]
    v_fma_mix_f32 v26, v81, 1.0, v26 op_sel_hi:[1,0,0]
    v_fma_mix_f32 v27, v81, 1.0, v27 op_sel:[1,0,0] op_sel_hi:[1,0,0]
    v_fma_mix_f32 v28, v82, 1.0, v28 op_sel_hi:[1,0,0]
    v_fma_mix_f32 v29, v82, 1.0, v29 op_sel:[1,0,0] op_sel_hi:[1,0,0]
    v_fma_mix_f32 v30, v83, 1.0, v30 op_sel_hi:[1,0,0]
    v_fma_mix_f32 v31, v83, 1.0, v31 op_sel:[1,0,0] op_sel_hi:[1,0,0]
    s_waitcnt vmcnt(2)
    v_bitop3_b32 v42, v42, v84, s29 bitop3:0xf6
    v_fma_mix_f32 v24, v84, 1.0, v24 op_sel_hi:[1,0,0]
    v_fma_mix_f32 v25, v84, 1.0, v25 op_sel:[1,0,0] op_sel_hi:[1,0,0]
    v_fma_mix_f32 v26, v85, 1.0, v26 op_sel_hi:[1,0,0]
    v_fma_mix_f32 v27, v85, 1.0, v27 op_sel:[1,0,0] op_sel_hi:[1,0,0]
    v_fma_mix_f32 v28, v86, 1.0, v28 op_sel_hi:[1,0,0]
    v_fma_mix_f32 v29, v86, 1.0, v29 op_sel:[1,0,0] op_sel_hi:[1,0,0]
    v_fma_mix_f32 v30, v87, 1.0, v30 op_sel_hi:[1,0,0]
    v_fma_mix_f32 v31, v87, 1.0, v31 op_sel:[1,0,0] op_sel_hi:[1,0,0]
    s_waitcnt vmcnt(1)
    v_bitop3_b32 v42, v42, v88, s29 bitop3:0xf6
    v_fma_mix_f32 v24, v88, 1.0, v24 op_sel_hi:[1,0,0]
    v_fma_mix_f32 v25, v88, 1.0, v25 op_sel:[1,0,0] op_sel_hi:[1,0,0]
    v_fma_mix_f32 v26, v89, 1.0, v26 op_sel_hi:[1,0,0]
    v_fma_mix_f32 v27, v89, 1.0, v27 op_sel:[1,0,0] op_sel_hi:[1,0,0]
    v_fma_mix_f32 v28, v90, 1.0, v28 op_sel_hi:[1,0,0]
    v_fma_mix_f32 v29, v90, 1.0, v29 op_sel:[1,0,0] op_sel_hi:[1,0,0]
    v_fma_mix_f32 v30, v91, 1.0, v30 op_sel_hi:[1,0,0]
    v_fma_mix_f32 v31, v91, 1.0, v31 op_sel:[1,0,0] op_sel_hi:[1,0,0]
    s_waitcnt vmcnt(0)
    v_bitop3_b32 v42, v42, v92, s29 bitop3:0xf6
    v_and_b32 v42, 1, v42
    v_cmp_ne_u32 vcc, 0, v42
    s_or_b64 vcc, vcc, s[14:15]
    s_cbranch_scc1 REDL_8
    v_fma_mix_f32 v24, v92, 1.0, v24 op_sel_hi:[1,0,0]
    v_fma_mix_f32 v25, v92, 1.0, v25 op_sel:[1,0,0] op_sel_hi:[1,0,0]
    v_fma_mix_f32 v26, v93, 1.0, v26 op_sel_hi:[1,0,0]
    v_fma_mix_f32 v27, v93, 1.0, v27 op_sel:[1,0,0] op_sel_hi:[1,0,0]
    v_fma_mix_f32 v28, v94, 1.0, v28 op_sel_hi:[1,0,0]
    v_fma_mix_f32 v29, v94, 1.0, v29 op_sel:[1,0,0] op_sel_hi:[1,0,0]
    v_fma_mix_f32 v30, v95, 1.0, v30 op_sel_hi:[1,0,0]
    v_fma_mix_f32 v31, v95, 1.0, v31 op_sel:[1,0,0] op_sel_hi:[1,0,0]
    v_cvt_pk_bf16_f32 v32, v24, v25
    v_cvt_pk_bf16_f32 v33, v26, v27
    v_cvt_pk_bf16_f32 v34, v28, v29
    v_cvt_pk_bf16_f32 v35, v30, v31
    global_store_dwordx4 v48, v[32:35], s[40:41] offset:0
    v_lshlrev_b32 v24, 16, v32
    v_and_b32 v25, 0xffff0000, v32
    v_lshlrev_b32 v26, 16, v33
    v_and_b32 v27, 0xffff0000, v33
    v_lshlrev_b32 v28, 16, v34
    v_and_b32 v29, 0xffff0000, v34
    v_lshlrev_b32 v30, 16, v35
    v_and_b32 v31, 0xffff0000, v35
    v_pk_add_f32 v[8:9], v[24:25], v[26:27]
    v_pk_mul_f32 v[10:11], v[24:25], v[24:25]
    v_pk_add_f32 v[12:13], v[28:29], v[30:31]
    v_pk_fma_f32 v[10:11], v[26:27], v[26:27], v[10:11]
    v_pk_add_f32 v[8:9], v[8:9], v[12:13]
    v_pk_fma_f32 v[10:11], v[28:29], v[28:29], v[10:11]
    v_add_f32 v8, v8, v9
    v_pk_fma_f32 v[10:11], v[30:31], v[30:31], v[10:11]
    v_add_f32 v9, v10, v11
    s_nop 1
    v_permlane32_swap_b32 v8, v9
    v_add_f32 v8, v8, v9
    s_nop 1
    v_add_f32_dpp v8, v8, v8 row_ror:8 row_mask:0xf bank_mask:0xf
    s_nop 1
    v_add_f32_dpp v8, v8, v8 row_ror:4 row_mask:0xf bank_mask:0xf
    s_mov_b64 exec, s[44:45]
    ds_write_b32 v40, v8 offset:0
    s_mov_b64 exec, -1
    s_waitcnt lgkmcnt(0)
    s_barrier
    ds_read_b128 v[96:99], v41 offset:0
    ds_read_b128 v[100:103], v41 offset:16
    ds_read_b128 v[104:107], v41 offset:128
    ds_read_b128 v[108:111], v41 offset:144
    v_xor_b32 v40, 256, v40
    v_xor_b32 v41, 256, v41
    s_waitcnt lgkmcnt(2)
    v_pk_add_f32 v[96:97], v[96:97], v[98:99]
    v_pk_add_f32 v[100:101], v[100:101], v[102:103]
    v_pk_add_f32 v[96:97], v[96:97], v[100:101]
    v_add_f32 v96, v96, v97
    v_mul_f32 v8, 0x3b000000, v96
    s_waitcnt lgkmcnt(0)
    v_pk_add_f32 v[104:105], v[104:105], v[106:107]
    v_pk_add_f32 v[108:109], v[108:109], v[110:111]
    v_pk_add_f32 v[104:105], v[104:105], v[108:109]
    v_add_f32 v104, v104, v105
    v_mul_f32 v9, 0x3b000000, v104
    v_fma_f32 v9, -v8, v8, v9
    v_max_f32 v9, 0, v9
    v_add_f32 v9, 0x3727c5ac, v9
    v_rsq_f32 v9, v9
    s_nop 0
    v_pk_add_f32 v[24:25], v[24:25], v[8:9] op_sel_hi:[1,0] neg_lo:[0,1] neg_hi:[0,1]
    v_pk_add_f32 v[26:27], v[26:27], v[8:9] op_sel_hi:[1,0] neg_lo:[0,1] neg_hi:[0,1]
    v_pk_add_f32 v[28:29], v[28:29], v[8:9] op_sel_hi:[1,0] neg_lo:[0,1] neg_hi:[0,1]
    v_pk_add_f32 v[30:31], v[30:31], v[8:9] op_sel_hi:[1,0] neg_lo:[0,1] neg_hi:[0,1]
    v_pk_mul_f32 v[24:25], v[24:25], v[8:9] op_sel:[0,1]
    v_pk_mul_f32 v[26:27], v[26:27], v[8:9] op_sel:[0,1]
    v_pk_mul_f32 v[28:29], v[28:29], v[8:9] op_sel:[0,1]
    v_pk_mul_f32 v[30:31], v[30:31], v[8:9] op_sel:[0,1]
    v_cvt_pk_bf16_f32 v112, v24, v25
    v_cvt_pk_bf16_f32 v113, v26, v27
    v_cvt_pk_bf16_f32 v114, v28, v29
    v_cvt_pk_bf16_f32 v115, v30, v31
    v_min_u32 v112, -2, v112
    s_waitcnt vmcnt(0)
    global_store_dwordx4 v48, v[112:115], s[36:37] offset:0
    s_cmp_lt_u32 s32, 1000
    s_cbranch_scc1 RED_6_M
    s_waitcnt vmcnt(0)
    s_branch RED_6_N
RED_6_M:
    global_store_dwordx4 v48, v[36:39], s[48:49] offset:0
RED_6_N:
    s_cmp_lg_u32 s9, 0
    s_cbranch_scc1 RED_6_P
    global_store_dword v43, v44, s[46:47] sc1
RED_6_P:
    s_add_u32 s32, s32, s33
    s_cmp_ge_u32 s32, s55
    s_cbranch_scc1 REDE_7
    s_lshr_b32 s14, s32, 3
    s_and_b32 s15, s32, 7
    s_lshl_b32 s15, s15, 7
    s_lshl_b32 s16, s14, 15
    s_add_u32 s16, s16, s15
    s_and_b32 s17, s16, 262143
    s_sub_i32 s52, s14, s54
    s_max_i32 s52, s52, 0
    s_lshl_b32 s52, s52, 15
    s_add_u32 s16, s16, s52
    s_add_u32 s38, s20, s16
    s_addc_u32 s39, s21, 0
    s_lshl_b32 s52, s14, 3
    s_sub_u32 s52, s52, 40
    s_bfe_u32 s29, s14, 0x10002
    s_and_b32 s16, s14, 3
    s_mul_i32 s16, s16, 262144
    s_add_u32 s16, s16, s15
    s_add_u32 s34, s26, s16
    s_addc_u32 s35, s27, 0
    s_lshr_b32 s14, s32, 3
    s_and_b32 s15, s32, 7
    s_lshl_b32 s15, s15, 7
    s_lshl_b32 s16, s14, 15
    s_add_u32 s16, s16, s15
    s_and_b32 s17, s16, 262143
    s_add_u32 s36, s24, s17
    s_addc_u32 s37, s25, 0
    s_add_u32 s40, s22, s17
    s_addc_u32 s41, s23, 0
    s_add_u32 s17, s16, 65536
    s_and_b32 s17, s17, 262143
    s_add_u32 s48, s24, s17
    s_addc_u32 s49, s25, 0
    s_mov_b32 s12, 0
    s_add_u32 s53, s32, s33
    v_mov_b32 v44, s53
    s_min_u32 s53, s53, 511
    s_branch RED_6
REDE_7:
    s_endpgm
RED_WS1:
    s_lshr_b32 s14, s32, 3
    s_and_b32 s15, s32, 7
    s_lshl_b32 s15, s15, 7
    s_lshl_b32 s16, s14, 15
    s_add_u32 s16, s16, s15
    s_and_b32 s17, s16, 262143
    s_sub_i32 s52, s14, s54
    s_max_i32 s52, s52, 0
    s_lshl_b32 s52, s52, 15
    s_add_u32 s16, s16, s52
    s_add_u32 s38, s20, s16
    s_addc_u32 s39, s21, 0
    s_lshl_b32 s52, s14, 3
    s_sub_u32 s52, s52, 40
    s_bfe_u32 s29, s14, 0x10002
    s_and_b32 s16, s14, 3
    s_mul_i32 s16, s16, 262144
    s_add_u32 s16, s16, s15
    s_add_u32 s34, s26, s16
    s_addc_u32 s35, s27, 0
    s_lshr_b32 s14, s32, 3
    s_and_b32 s15, s32, 7
    s_lshl_b32 s15, s15, 7
    s_lshl_b32 s16, s14, 15
    s_add_u32 s16, s16, s15
    s_and_b32 s17, s16, 262143
    s_add_u32 s36, s24, s17
    s_addc_u32 s37, s25, 0
    s_add_u32 s40, s22, s17
    s_addc_u32 s41, s23, 0
    s_add_u32 s17, s16, 65536
    s_and_b32 s17, s17, 262143
    s_add_u32 s48, s24, s17
    s_addc_u32 s49, s25, 0
    s_mov_b32 s12, 0
    s_add_u32 s53, s32, s33
    v_mov_b32 v44, s53
    s_min_u32 s53, s53, 511
RED_9:
REDL_11:
    global_load_dwordx4 v[16:19], v48, s[38:39] offset:0 sc1
    global_load_dword v62, v47, s[50:51] sc1
    global_load_dwordx4 v[64:67], v48, s[34:35] offset:0 sc1
    global_load_dwordx4 v[68:71], v49, s[34:35] offset:0 sc1
    global_load_dwordx4 v[72:75], v50, s[34:35] offset:0 sc1
    global_load_dwordx4 v[76:79], v51, s[34:35] offset:0 sc1
    global_load_dwordx4 v[80:83], v52, s[34:35] offset:0 sc1
    global_load_dwordx4 v[84:87], v53, s[34:35] offset:0 sc1
    global_load_dwordx4 v[88:91], v54, s[34:35] offset:0 sc1
    global_load_dwordx4 v[92:95], v55, s[34:35] offset:0 sc1
    s_add_u32 s12, s12, 1
    s_mov_b32 s17, 2
    s_cmp_gt_u32 s12, 20000
    s_cbranch_scc1 TIMEOUT
    s_waitcnt vmcnt(8)
    v_cmp_gt_i32 s[14:15], s52, v62
    v_cmp_eq_u32 vcc, -1, v16
    s_or_b64 s[14:15], s[14:15], vcc
    v_lshlrev_b32 v24, 16, v16
    v_and_b32 v25, 0xffff0000, v16
    v_lshlrev_b32 v26, 16, v17
    v_and_b32 v27, 0xffff0000, v17
    v_lshlrev_b32 v28, 16, v18
    v_and_b32 v29, 0xffff0000, v18
    v_lshlrev_b32 v30, 16, v19
    v_and_b32 v31, 0xffff0000, v19
    s_waitcnt vmcnt(7)
    v_xor_b32 v42, s29, v64
    v_fma_mix_f32 v24, v64, 1.0, v24 op_sel_hi:[1,0,0]
    v_fma_mix_f32 v25, v64, 1.0, v25 op_sel:[1,0,0] op_sel_hi:[1,0,0]
    v_fma_mix_f32 v26, v65, 1.0, v26 op_sel_hi:[1,0,0]
    v_fma_mix_f32 v27, v65, 1.0, v27 op_sel:[1,0,0] op_sel_hi:[1,0,0]
    v_fma_mix_f32 v28, v66, 1.0, v28 op_sel_hi:[1,0,0]
    v_fma_mix_f32 v29, v66, 1.0, v29 op_sel:[1,0,0] op_sel_hi:[1,0,0]
    v_fma_mix_f32 v30, v67, 1.0, v30 op_sel_hi:[1,0,0]
    v_fma_mix_f32 v31, v67, 1.0, v31 op_sel:[1,0,0] op_sel_hi:[1,0,0]
    s_waitcnt vmcnt(6)
    v_bitop3_b32 v42, v42, v68, s29 bitop3:0xf6
    v_fma_mix_f32 v24, v68, 1.0, v24 op_sel_hi:[1,0,0]
    v_fma_mix_f32 v25, v68, 1.0, v25 op_sel:[1,0,0] op_sel_hi:[1,0,0]
    v_fma_mix_f32 v26, v69, 1.0, v26 op_sel_hi:[1,0,0]
    v_fma_mix_f32 v27, v69, 1.0, v27 op_sel:[1,0,0] op_sel_hi:[1,0,0]
    v_fma_mix_f32 v28, v70, 1.0, v28 op_sel_hi:[1,0,0]
    v_fma_mix_f32 v29, v70, 1.0, v29 op_sel:[1,0,0] op_sel_hi:[1,0,0]
    v_fma_mix_f32 v30, v71, 1.0, v30 op_sel_hi:[1,0,0]
    v_fma_mix_f32 v31, v71, 1.0, v31 op_sel:[1,0,0] op_sel_hi:[1,0,0]
    s_waitcnt vmcnt(5)
    v_bitop3_b32 v42, v42, v72, s29 bitop3:0xf6
    v_fma_mix_f32 v24, v72, 1.0, v24 op_sel_hi:[1,0,0]
    v_fma_mix_f32 v25, v72, 1.0, v25 op_sel:[1,0,0] op_sel_hi:[1,0,0]
    v_fma_mix_f32 v26, v73, 1.0, v26 op_sel_hi:[1,0,0]
    v_fma_mix_f32 v27, v73, 1.0, v27 op_sel:[1,0,0] op_sel_hi:[1,0,0]
    v_fma_mix_f32 v28, v74, 1.0, v28 op_sel_hi:[1,0,0]
    v_fma_mix_f32 v29, v74, 1.0, v29 op_sel:[1,0,0] op_sel_hi:[1,0,0]
    v_fma_mix_f32 v30, v75, 1.0, v30 op_sel_hi:[1,0,0]
    v_fma_mix_f32 v31, v75, 1.0, v31 op_sel:[1,0,0] op_sel_hi:[1,0,0]
    s_waitcnt vmcnt(4)
    v_bitop3_b32 v42, v42, v76, s29 bitop3:0xf6
    v_fma_mix_f32 v24, v76, 1.0, v24 op_sel_hi:[1,0,0]
    v_fma_mix_f32 v25, v76, 1.0, v25 op_sel:[1,0,0] op_sel_hi:[1,0,0]
    v_fma_mix_f32 v26, v77, 1.0, v26 op_sel_hi:[1,0,0]
    v_fma_mix_f32 v27, v77, 1.0, v27 op_sel:[1,0,0] op_sel_hi:[1,0,0]
    v_fma_mix_f32 v28, v78, 1.0, v28 op_sel_hi:[1,0,0]
    v_fma_mix_f32 v29, v78, 1.0, v29 op_sel:[1,0,0] op_sel_hi:[1,0,0]
    v_fma_mix_f32 v30, v79, 1.0, v30 op_sel_hi:[1,0,0]
    v_fma_mix_f32 v31, v79, 1.0, v31 op_sel:[1,0,0] op_sel_hi:[1,0,0]
    s_waitcnt vmcnt(3)
    v_bitop3_b32 v42, v42, v80, s29 bitop3:0xf6
    v_fma_mix_f32 v24, v80, 1.0, v24 op_sel_hi:[1,0,0]
    v_fma_mix_f32 v25, v80, 1.0, v25 op_sel:[1,0,0] op_sel_hi:[1,0,0]
    v_fma_mix_f32 v26, v81, 1.0, v26 op_sel_hi:[1,0,0]
    v_fma_mix_f32 v27, v81, 1.0, v27 op_sel:[1,0,0] op_sel_hi:[1,0,0]
    v_fma_mix_f32 v28, v82, 1.0, v28 op_sel_hi:[1,0,0]
    v_fma_mix_f32 v29, v82, 1.0, v29 op_sel:[1,0,0] op_sel_hi:[1,0,0]
    v_fma_mix_f32 v30, v83, 1.0, v30 op_sel_hi:[1,0,0]
    v_fma_mix_f32 v31, v83, 1.0, v31 op_sel:[1,0,0] op_sel_hi:[1,0,0]
    s_waitcnt vmcnt(2)
    v_bitop3_b32 v42, v42, v84, s29 bitop3:0xf6
    v_fma_mix_f32 v24, v84, 1.0, v24 op_sel_hi:[1,0,0]
    v_fma_mix_f32 v25, v84, 1.0, v25 op_sel:[1,0,0] op_sel_hi:[1,0,0]
    v_fma_mix_f32 v26, v85, 1.0, v26 op_sel_hi:[1,0,0]
    v_fma_mix_f32 v27, v85, 1.0, v27 op_sel:[1,0,0] op_sel_hi:[1,0,0]
    v_fma_mix_f32 v28, v86, 1.0, v28 op_sel_hi:[1,0,0]
    v_fma_mix_f32 v29, v86, 1.0, v29 op_sel:[1,0,0] op_sel_hi:[1,0,0]
    v_fma_mix_f32 v30, v87, 1.0, v30 op_sel_hi:[1,0,0]
    v_fma_mix_f32 v31, v87, 1.0, v31 op_sel:[1,0,0] op_sel_hi:[1,0,0]
    s_waitcnt vmcnt(1)
    v_bitop3_b32 v42, v42, v88, s29 bitop3:0xf6
    v_fma_mix_f32 v24, v88, 1.0, v24 op_sel_hi:[1,0,0]
    v_fma_mix_f32 v25, v88, 1.0, v25 op_sel:[1,0,0] op_sel_hi:[1,0,0]
    v_fma_mix_f32 v26, v89, 1.0, v26 op_sel_hi:[1,0,0]
    v_fma_mix_f32 v27, v89, 1.0, v27 op_sel:[1,0,0] op_sel_hi:[1,0,0]
    v_fma_mix_f32 v28, v90, 1.0, v28 op_sel_hi:[1,0,0]
    v_fma_mix_f32 v29, v90, 1.0, v29 op_sel:[1,0,0] op_sel_hi:[1,0,0]
    v_fma_mix_f32 v30, v91, 1.0, v30 op_sel_hi:[1,0,0]
    v_fma_mix_f32 v31, v91, 1.0, v31 op_sel:[1,0,0] op_sel_hi:[1,0,0]
    s_waitcnt vmcnt(0)
    v_bitop3_b32 v42, v42, v92, s29 bitop3:0xf6
    v_and_b32 v42, 1, v42
    v_cmp_ne_u32 vcc, 0, v42
    s_or_b64 vcc, vcc, s[14:15]
    s_cbranch_scc1 REDL_11
    v_fma_mix_f32 v24, v92, 1.0, v24 op_sel_hi:[1,0,0]
    v_fma_mix_f32 v25, v92, 1.0, v25 op_sel:[1,0,0] op_sel_hi:[1,0,0]
    v_fma_mix_f32 v26, v93, 1.0, v26 op_sel_hi:[1,0,0]
    v_fma_mix_f32 v27, v93, 1.0, v27 op_sel:[1,0,0] op_sel_hi:[1,0,0]
    v_fma_mix_f32 v28, v94, 1.0, v28 op_sel_hi:[1,0,0]
    v_fma_mix_f32 v29, v94, 1.0, v29 op_sel:[1,0,0] op_sel_hi:[1,0,0]
    v_fma_mix_f32 v30, v95, 1.0, v30 op_sel_hi:[1,0,0]
    v_fma_mix_f32 v31, v95, 1.0, v31 op_sel:[1,0,0] op_sel_hi:[1,0,0]
    v_cvt_pk_bf16_f32 v32, v24, v25
    v_cvt_pk_bf16_f32 v33, v26, v27
    v_cvt_pk_bf16_f32 v34, v28, v29
    v_cvt_pk_bf16_f32 v35, v30, v31
    global_store_dwordx4 v48, v[32:35], s[40:41] offset:0 sc1
    v_lshlrev_b32 v24, 16, v32
    v_and_b32 v25, 0xffff0000, v32
    v_lshlrev_b32 v26, 16, v33
    v_and_b32 v27, 0xffff0000, v33
    v_lshlrev_b32 v28, 16, v34
    v_and_b32 v29, 0xffff0000, v34
    v_lshlrev_b32 v30, 16, v35
    v_and_b32 v31, 0xffff0000, v35
    v_pk_add_f32 v[8:9], v[24:25], v[26:27]
    v_pk_mul_f32 v[10:11], v[24:25], v[24:25]
    v_pk_add_f32 v[12:13], v[28:29], v[30:31]
    v_pk_fma_f32 v[10:11], v[26:27], v[26:27], v[10:11]
    v_pk_add_f32 v[8:9], v[8:9], v[12:13]
    v_pk_fma_f32 v[10:11], v[28:29], v[28:29], v[10:11]
    v_add_f32 v8, v8, v9
    v_pk_fma_f32 v[10:11], v[30:31], v[30:31], v[10:11]
    v_add_f32 v9, v10, v11
    s_nop 1
    v_permlane32_swap_b32 v8, v9
    v_add_f32 v8, v8, v9
    s_nop 1
    v_add_f32_dpp v8, v8, v8 row_ror:8 row_mask:0xf bank_mask:0xf
    s_nop 1
    v_add_f32_dpp v8, v8, v8 row_ror:4 row_mask:0xf bank_mask:0xf
    s_mov_b64 exec, s[44:45]
    ds_write_b32 v40, v8 offset:0
    s_mov_b64 exec, -1
    s_waitcnt lgkmcnt(0)
    s_barrier
    ds_read_b128 v[96:99], v41 offset:0
    ds_read_b128 v[100:103], v41 offset:16
    ds_read_b128 v[104:107], v41 offset:128
    ds_read_b128 v[108:111], v41 offset:144
    v_xor_b32 v40, 256, v40
    v_xor_b32 v41, 256, v41
    s_waitcnt lgkmcnt(2)
    v_pk_add_f32 v[96:97], v[96:97], v[98:99]
    v_pk_add_f32 v[100:101], v[100:101], v[102:103]
    v_pk_add_f32 v[96:97], v[96:97], v[100:101]
    v_add_f32 v96, v96, v97
    v_mul_f32 v8, 0x3b000000, v96
    s_waitcnt lgkmcnt(0)
    v_pk_add_f32 v[104:105], v[104:105], v[106:107]
    v_pk_add_f32 v[108:109], v[108:109], v[110:111]
    v_pk_add_f32 v[104:105], v[104:105], v[108:109]
    v_add_f32 v104, v104, v105
    v_mul_f32 v9, 0x3b000000, v104
    v_fma_f32 v9, -v8, v8, v9
    v_max_f32 v9, 0, v9
    v_add_f32 v9, 0x3727c5ac, v9
    v_rsq_f32 v9, v9
    s_nop 0
    v_pk_add_f32 v[24:25], v[24:25], v[8:9] op_sel_hi:[1,0] neg_lo:[0,1] neg_hi:[0,1]
    v_pk_add_f32 v[26:27], v[26:27], v[8:9] op_sel_hi:[1,0] neg_lo:[0,1] neg_hi:[0,1]
    v_pk_add_f32 v[28:29], v[28:29], v[8:9] op_sel_hi:[1,0] neg_lo:[0,1] neg_hi:[0,1]
    v_pk_add_f32 v[30:31], v[30:31], v[8:9] op_sel_hi:[1,0] neg_lo:[0,1] neg_hi:[0,1]
    v_pk_mul_f32 v[24:25], v[24:25], v[8:9] op_sel:[0,1]
    v_pk_mul_f32 v[26:27], v[26:27], v[8:9] op_sel:[0,1]
    v_pk_mul_f32 v[28:29], v[28:29], v[8:9] op_sel:[0,1]
    v_pk_mul_f32 v[30:31], v[30:31], v[8:9] op_sel:[0,1]
    v_cvt_pk_bf16_f32 v112, v24, v25
    v_cvt_pk_bf16_f32 v113, v26, v27
    v_cvt_pk_bf16_f32 v114, v28, v29
    v_cvt_pk_bf16_f32 v115, v30, v31
    v_min_u32 v112, -2, v112
    s_waitcnt vmcnt(0)
    global_store_dwordx4 v48, v[112:115], s[36:37] offset:0 sc1
    s_cmp_lt_u32 s32, 1000
    s_cbranch_scc1 RED_9_M
    s_waitcnt vmcnt(0)
    s_branch RED_9_N
RED_9_M:
    global_store_dwordx4 v48, v[36:39], s[48:49] offset:0 sc1
RED_9_N:
    s_cmp_lg_u32 s9, 0
    s_cbranch_scc1 RED_9_P
    global_store_dword v43, v44, s[46:47] sc1
RED_9_P:
    s_add_u32 s32, s32, s33
    s_cmp_ge_u32 s32, s55
    s_cbranch_scc1 REDE_10
    s_lshr_b32 s14, s32, 3
    s_and_b32 s15, s32, 7
    s_lshl_b32 s15, s15, 7
    s_lshl_b32 s16, s14, 15
    s_add_u32 s16, s16, s15
    s_and_b32 s17, s16, 262143
    s_sub_i32 s52, s14, s54
    s_max_i32 s52, s52, 0
    s_lshl_b32 s52, s52, 15
    s_add_u32 s16, s16, s52
    s_add_u32 s38, s20, s16
    s_addc_u32 s39, s21, 0
    s_lshl_b32 s52, s14, 3
    s_sub_u32 s52, s52, 40
    s_bfe_u32 s29, s14, 0x10002
    s_and_b32 s16, s14, 3
    s_mul_i32 s16, s16, 262144
    s_add_u32 s16, s16, s15
    s_add_u32 s34, s26, s16
    s_addc_u32 s35, s27, 0
    s_lshr_b32 s14, s32, 3
    s_and_b32 s15, s32, 7
    s_lshl_b32 s15, s15, 7
    s_lshl_b32 s16, s14, 15
    s_add_u32 s16, s16, s15
    s_and_b32 s17, s16, 262143
    s_add_u32 s36, s24, s17
    s_addc_u32 s37, s25, 0
    s_add_u32 s40, s22, s17
    s_addc_u32 s41, s23, 0
    s_add_u32 s17, s16, 65536
    s_and_b32 s17, s17, 262143
    s_add_u32 s48, s24, s17
    s_addc_u32 s49, s25, 0
    s_mov_b32 s12, 0
    s_add_u32 s53, s32, s33
    v_mov_b32 v44, s53
    s_min_u32 s53, s53, 511
    s_branch RED_9
REDE_10:
    s_endpgm
RED_W0:
    s_cmp_eq_u32 s18, 0
    s_cbranch_scc1 RED_WS0
    s_lshr_b32 s14, s32, 3
    s_and_b32 s15, s32, 7
    s_lshl_b32 s15, s15, 7
    s_lshl_b32 s16, s14, 15
    s_add_u32 s16, s16, s15
    s_and_b32 s17, s16, 262143
    s_lshl_b32 s52, s14, 3
    s_sub_u32 s52, s52, 40
    s_lshl_b32 s16, s32, 12
    s_add_u32 s16, s16, 2048
    s_add_u32 s38, s20, s16
    s_addc_u32 s39, s21, 0
    s_bfe_u32 s29, s14, 0x10002
    s_and_b32 s16, s14, 3
    s_mul_i32 s16, s16, 262144
    s_add_u32 s16, s16, s15
    s_add_u32 s34, s26, s16
    s_addc_u32 s35, s27, 0
    s_lshr_b32 s14, s32, 3
    s_and_b32 s15, s32, 7
    s_lshl_b32 s15, s15, 7
    s_lshl_b32 s16, s14, 15
    s_add_u32 s16, s16, s15
    s_and_b32 s17, s16, 262143
    s_add_u32 s36, s24, s17
    s_addc_u32 s37, s25, 0
    s_add_u32 s40, s22, s17
    s_addc_u32 s41, s23, 0
    s_add_u32 s17, s16, 65536
    s_and_b32 s17, s17, 262143
    s_add_u32 s48, s24, s17
    s_addc_u32 s49, s25, 0
    s_mov_b32 s12, 0
    s_add_u32 s53, s32, s33
    v_mov_b32 v44, s53
    s_min_u32 s53, s53, 511
RED_12:
    global_load_dwordx4 v[16:19], v4, s[38:39] offset:-2048
REDL_14:
    global_load_dword v62, v47, s[50:51] sc1
    global_load_dwordx4 v[64:67], v48, s[34:35] offset:0 sc1
    global_load_dwordx4 v[68:71], v49, s[34:35] offset:0 sc1
    global_load_dwordx4 v[72:75], v50, s[34:35] offset:0 sc1
    global_load_dwordx4 v[76:79], v51, s[34:35] offset:0 sc1
    global_load_dwordx4 v[80:83], v52, s[34:35] offset:0 sc1
    global_load_dwordx4 v[84:87], v53, s[34:35] offset:0 sc1
    global_load_dwordx4 v[88:91], v54, s[34:35] offset:0 sc1
    global_load_dwordx4 v[92:95], v55, s[34:35] offset:0 sc1
    s_add_u32 s12, s12, 1
    s_mov_b32 s17, 2
    s_cmp_gt_u32 s12, 20000
    s_cbranch_scc1 TIMEOUT
    s_waitcnt vmcnt(8)
    v_cmp_gt_i32 s[14:15], s52, v62
    v_lshlrev_b32 v24, 16, v16
    v_and_b32 v25, 0xffff0000, v16
    v_lshlrev_b32 v26, 16, v17
    v_and_b32 v27, 0xffff0000, v17
    v_lshlrev_b32 v28, 16, v18
    v_and_b32 v29, 0xffff0000, v18
    v_lshlrev_b32 v30, 16, v19
    v_and_b32 v31, 0xffff0000, v19
    s_waitcnt vmcnt(7)
    v_xor_b32 v42, s29, v64
    v_fma_mix_f32 v24, v64, 1.0, v24 op_sel_hi:[1,0,0]
    v_fma_mix_f32 v25, v64, 1.0, v25 op_sel:[1,0,0] op_sel_hi:[1,0,0]
    v_fma_mix_f32 v26, v65, 1.0, v26 op_sel_hi:[1,0,0]
    v_fma_mix_f32 v27, v65, 1.0, v27 op_sel:[1,0,0] op_sel_hi:[1,0,0]
    v_fma_mix_f32 v28, v66, 1.0, v28 op_sel_hi:[1,0,0]
    v_fma_mix_f32 v29, v66, 1.0, v29 op_sel:[1,0,0] op_sel_hi:[1,0,0]
    v_fma_mix_f32 v30, v67, 1.0, v30 op_sel_hi:[1,0,0]
    v_fma_mix_f32 v31, v67, 1.0, v31 op_sel:[1,0,0] op_sel_hi:[1,0,0]
    s_waitcnt vmcnt(6)
    v_bitop3_b32 v42, v42, v68, s29 bitop3:0xf6
    v_fma_mix_f32 v24, v68, 1.0, v24 op_sel_hi:[1,0,0]
    v_fma_mix_f32 v25, v68, 1.0, v25 op_sel:[1,0,0] op_sel_hi:[1,0,0]
    v_fma_mix_f32 v26, v69, 1.0, v26 op_sel_hi:[1,0,0]
    v_fma_mix_f32 v27, v69, 1.0, v27 op_sel:[1,0,0] op_sel_hi:[1,0,0]
    v_fma_mix_f32 v28, v70, 1.0, v28 op_sel_hi:[1,0,0]
    v_fma_mix_f32 v29, v70, 1.0, v29 op_sel:[1,0,0] op_sel_hi:[1,0,0]
    v_fma_mix_f32 v30, v71, 1.0, v30 op_sel_hi:[1,0,0]
    v_fma_mix_f32 v31, v71, 1.0, v31 op_sel:[1,0,0] op_sel_hi:[1,0,0]
    s_waitcnt vmcnt(5)
    v_bitop3_b32 v42, v42, v72, s29 bitop3:0xf6
    v_fma_mix_f32 v24, v72, 1.0, v24 op_sel_hi:[1,0,0]
    v_fma_mix_f32 v25, v72, 1.0, v25 op_sel:[1,0,0] op_sel_hi:[1,0,0]
    v_fma_mix_f32 v26, v73, 1.0, v26 op_sel_hi:[1,0,0]
    v_fma_mix_f32 v27, v73, 1.0, v27 op_sel:[1,0,0] op_sel_hi:[1,0,0]
    v_fma_mix_f32 v28, v74, 1.0, v28 op_sel_hi:[1,0,0]
    v_fma_mix_f32 v29, v74, 1.0, v29 op_sel:[1,0,0] op_sel_hi:[1,0,0]
    v_fma_mix_f32 v30, v75, 1.0, v30 op_sel_hi:[1,0,0]
    v_fma_mix_f32 v31, v75, 1.0, v31 op_sel:[1,0,0] op_sel_hi:[1,0,0]
    s_waitcnt vmcnt(4)
    v_bitop3_b32 v42, v42, v76, s29 bitop3:0xf6
    v_fma_mix_f32 v24, v76, 1.0, v24 op_sel_hi:[1,0,0]
    v_fma_mix_f32 v25, v76, 1.0, v25 op_sel:[1,0,0] op_sel_hi:[1,0,0]
    v_fma_mix_f32 v26, v77, 1.0, v26 op_sel_hi:[1,0,0]
    v_fma_mix_f32 v27, v77, 1.0, v27 op_sel:[1,0,0] op_sel_hi:[1,0,0]
    v_fma_mix_f32 v28, v78, 1.0, v28 op_sel_hi:[1,0,0]
    v_fma_mix_f32 v29, v78, 1.0, v29 op_sel:[1,0,0] op_sel_hi:[1,0,0]
    v_fma_mix_f32 v30, v79, 1.0, v30 op_sel_hi:[1,0,0]
    v_fma_mix_f32 v31, v79, 1.0, v31 op_sel:[1,0,0] op_sel_hi:[1,0,0]
    s_waitcnt vmcnt(3)
    v_bitop3_b32 v42, v42, v80, s29 bitop3:0xf6
    v_fma_mix_f32 v24, v80, 1.0, v24 op_sel_hi:[1,0,0]
    v_fma_mix_f32 v25, v80, 1.0, v25 op_sel:[1,0,0] op_sel_hi:[1,0,0]
    v_fma_mix_f32 v26, v81, 1.0, v26 op_sel_hi:[1,0,0]
    v_fma_mix_f32 v27, v81, 1.0, v27 op_sel:[1,0,0] op_sel_hi:[1,0,0]
    v_fma_mix_f32 v28, v82, 1.0, v28 op_sel_hi:[1,0,0]
    v_fma_mix_f32 v29, v82, 1.0, v29 op_sel:[1,0,0] op_sel_hi:[1,0,0]
    v_fma_mix_f32 v30, v83, 1.0, v30 op_sel_hi:[1,0,0]
    v_fma_mix_f32 v31, v83, 1.0, v31 op_sel:[1,0,0] op_sel_hi:[1,0,0]
    s_waitcnt vmcnt(2)
    v_bitop3_b32 v42, v42, v84, s29 bitop3:0xf6
    v_fma_mix_f32 v24, v84, 1.0, v24 op_sel_hi:[1,0,0]
    v_fma_mix_f32 v25, v84, 1.0, v25 op_sel:[1,0,0] op_sel_hi:[1,0,0]
    v_fma_mix_f32 v26, v85, 1.0, v26 op_sel_hi:[1,0,0]
    v_fma_mix_f32 v27, v85, 1.0, v27 op_sel:[1,0,0] op_sel_hi:[1,0,0]
    v_fma_mix_f32 v28, v86, 1.0, v28 op_sel_hi:[1,0,0]
    v_fma_mix_f32 v29, v86, 1.0, v29 op_sel:[1,0,0] op_sel_hi:[1,0,0]
    v_fma_mix_f32 v30, v87, 1.0, v30 op_sel_hi:[1,0,0]
    v_fma_mix_f32 v31, v87, 1.0, v31 op_sel:[1,0,0] op_sel_hi:[1,0,0]
    s_waitcnt vmcnt(1)
    v_bitop3_b32 v42, v42, v88, s29 bitop3:0xf6
    v_fma_mix_f32 v24, v88, 1.0, v24 op_sel_hi:[1,0,0]
    v_fma_mix_f32 v25, v88, 1.0, v25 op_sel:[1,0,0] op_sel_hi:[1,0,0]
    v_fma_mix_f32 v26, v89, 1.0, v26 op_sel_hi:[1,0,0]
    v_fma_mix_f32 v27, v89, 1.0, v27 op_sel:[1,0,0] op_sel_hi:[1,0,0]
    v_fma_mix_f32 v28, v90, 1.0, v28 op_sel_hi:[1,0,0]
    v_fma_mix_f32 v29, v90, 1.0, v29 op_sel:[1,0,0] op_sel_hi:[1,0,0]
    v_fma_mix_f32 v30, v91, 1.0, v30 op_sel_hi:[1,0,0]
    v_fma_mix_f32 v31, v91, 1.0, v31 op_sel:[1,0,0] op_sel_hi:[1,0,0]
    s_waitcnt vmcnt(0)
    v_bitop3_b32 v42, v42, v92, s29 bitop3:0xf6
    v_and_b32 v42, 1, v42
    v_cmp_ne_u32 vcc, 0, v42
    s_or_b64 vcc, vcc, s[14:15]
    s_cbranch_scc1 REDL_14
    v_fma_mix_f32 v24, v92, 1.0, v24 op_sel_hi:[1,0,0]
    v_fma_mix_f32 v25, v92, 1.0, v25 op_sel:[1,0,0] op_sel_hi:[1,0,0]
    v_fma_mix_f32 v26, v93, 1.0, v26 op_sel_hi:[1,0,0]
    v_fma_mix_f32 v27, v93, 1.0, v27 op_sel:[1,0,0] op_sel_hi:[1,0,0]
    v_fma_mix_f32 v28, v94, 1.0, v28 op_sel_hi:[1,0,0]
    v_fma_mix_f32 v29, v94, 1.0, v29 op_sel:[1,0,0] op_sel_hi:[1,0,0]
    v_fma_mix_f32 v30, v95, 1.0, v30 op_sel_hi:[1,0,0]
    v_fma_mix_f32 v31, v95, 1.0, v31 op_sel:[1,0,0] op_sel_hi:[1,0,0]
    v_cvt_pk_bf16_f32 v32, v24, v25
    v_cvt_pk_bf16_f32 v33, v26, v27
    v_cvt_pk_bf16_f32 v34, v28, v29
    v_cvt_pk_bf16_f32 v35, v30, v31
    global_store_dwordx4 v48, v[32:35], s[40:41] offset:0
    v_lshlrev_b32 v24, 16, v32
    v_and_b32 v25, 0xffff0000, v32
    v_lshlrev_b32 v26, 16, v33
    v_and_b32 v27, 0xffff0000, v33
    v_lshlrev_b32 v28, 16, v34
    v_and_b32 v29, 0xffff0000, v34
    v_lshlrev_b32 v30, 16, v35
    v_and_b32 v31, 0xffff0000, v35
    v_pk_add_f32 v[8:9], v[24:25], v[26:27]
    v_pk_mul_f32 v[10:11], v[24:25], v[24:25]
    v_pk_add_f32 v[12:13], v[28:29], v[30:31]
    v_pk_fma_f32 v[10:11], v[26:27], v[26:27], v[10:11]
    v_pk_add_f32 v[8:9], v[8:9], v[12:13]
    v_pk_fma_f32 v[10:11], v[28:29], v[28:29], v[10:11]
    v_add_f32 v8, v8, v9
    v_pk_fma_f32 v[10:11], v[30:31], v[30:31], v[10:11]
    v_add_f32 v9, v10, v11
    s_nop 1
    v_permlane32_swap_b32 v8, v9
    v_add_f32 v8, v8, v9
    s_nop 1
    v_add_f32_dpp v8, v8, v8 row_ror:8 row_mask:0xf bank_mask:0xf
    s_nop 1
    v_add_f32_dpp v8, v8, v8 row_ror:4 row_mask:0xf bank_mask:0xf
    s_mov_b64 exec, s[44:45]
    ds_write_b32 v40, v8 offset:0
    s_mov_b64 exec, -1
    s_waitcnt lgkmcnt(0)
    s_barrier
    ds_read_b128 v[96:99], v41 offset:0
    ds_read_b128 v[100:103], v41 offset:16
    ds_read_b128 v[104:107], v41 offset:128
    ds_read_b128 v[108:111], v41 offset:144
    v_xor_b32 v40, 256, v40
    v_xor_b32 v41, 256, v41
    s_waitcnt lgkmcnt(2)
    v_pk_add_f32 v[96:97], v[96:97], v[98:99]
    v_pk_add_f32 v[100:101], v[100:101], v[102:103]
    v_pk_add_f32 v[96:97], v[96:97], v[100:101]
    v_add_f32 v96, v96, v97
    v_mul_f32 v8, 0x3b000000, v96
    s_waitcnt lgkmcnt(0)
    v_pk_add_f32 v[104:105], v[104:105], v[106:107]
    v_pk_add_f32 v[108:109], v[108:109], v[110:111]
    v_pk_add_f32 v[104:105], v[104:105], v[108:109]
    v_add_f32 v104, v104, v105
    v_mul_f32 v9, 0x3b000000, v104
    v_fma_f32 v9, -v8, v8, v9
    v_max_f32 v9, 0, v9
    v_add_f32 v9, 0x3727c5ac, v9
    v_rsq_f32 v9, v9
    s_nop 0
    v_pk_add_f32 v[24:25], v[24:25], v[8:9] op_sel_hi:[1,0] neg_lo:[0,1] neg_hi:[0,1]
    v_pk_add_f32 v[26:27], v[26:27], v[8:9] op_sel_hi:[1,0] neg_lo:[0,1] neg_hi:[0,1]
    v_pk_add_f32 v[28:29], v[28:29], v[8:9] op_sel_hi:[1,0] neg_lo:[0,1] neg_hi:[0,1]
    v_pk_add_f32 v[30:31], v[30:31], v[8:9] op_sel_hi:[1,0] neg_lo:[0,1] neg_hi:[0,1]
    v_pk_mul_f32 v[24:25], v[24:25], v[8:9] op_sel:[0,1]
    v_pk_mul_f32 v[26:27], v[26:27], v[8:9] op_sel:[0,1]
    v_pk_mul_f32 v[28:29], v[28:29], v[8:9] op_sel:[0,1]
    v_pk_mul_f32 v[30:31], v[30:31], v[8:9] op_sel:[0,1]
    v_cvt_pk_bf16_f32 v112, v24, v25
    v_cvt_pk_bf16_f32 v113, v26, v27
    v_cvt_pk_bf16_f32 v114, v28, v29
    v_cvt_pk_bf16_f32 v115, v30, v31
    v_min_u32 v112, -2, v112
    s_waitcnt vmcnt(0)
    global_store_dwordx4 v48, v[112:115], s[36:37] offset:0
    s_cmp_lt_u32 s32, 1000
    s_cbranch_scc1 RED_12_M
    s_waitcnt vmcnt(0)
    s_branch RED_12_N
RED_12_M:
    global_store_dwordx4 v48, v[36:39], s[48:49] offset:0
RED_12_N:
    s_cmp_lg_u32 s9, 0
    s_cbranch_scc1 RED_12_P
    global_store_dword v43, v44, s[46:47] sc1
RED_12_P:
    s_add_u32 s32, s32, s33
    s_cmp_ge_u32 s32, 512
    s_cbranch_scc1 REDE_13
    s_lshr_b32 s14, s32, 3
    s_and_b32 s15, s32, 7
    s_lshl_b32 s15, s15, 7
    s_lshl_b32 s16, s14, 15
    s_add_u32 s16, s16, s15
    s_and_b32 s17, s16, 262143
    s_lshl_b32 s52, s14, 3
    s_sub_u32 s52, s52, 40
    s_lshl_b32 s16, s32, 12
    s_add_u32 s16, s16, 2048
    s_add_u32 s38, s20, s16
    s_addc_u32 s39, s21, 0
    s_bfe_u32 s29, s14, 0x10002
    s_and_b32 s16, s14, 3
    s_mul_i32 s16, s16, 262144
    s_add_u32 s16, s16, s15
    s_add_u32 s34, s26, s16
    s_addc_u32 s35, s27, 0
    s_lshr_b32 s14, s32, 3
    s_and_b32 s15, s32, 7
    s_lshl_b32 s15, s15, 7
    s_lshl_b32 s16, s14, 15
    s_add_u32 s16, s16, s15
    s_and_b32 s17, s16, 262143
    s_add_u32 s36, s24, s17
    s_addc_u32 s37, s25, 0
    s_add_u32 s40, s22, s17
    s_addc_u32 s41, s23, 0
    s_add_u32 s17, s16, 65536
    s_and_b32 s17, s17, 262143
    s_add_u32 s48, s24, s17
    s_addc_u32 s49, s25, 0
    s_mov_b32 s12, 0
    s_add_u32 s53, s32, s33
    v_mov_b32 v44, s53
    s_min_u32 s53, s53, 511
    s_branch RED_12
REDE_13:
    s_branch RED_WX
RED_WS0:
    s_lshr_b32 s14, s32, 3
    s_and_b32 s15, s32, 7
    s_lshl_b32 s15, s15, 7
    s_lshl_b32 s16, s14, 15
    s_add_u32 s16, s16, s15
    s_and_b32 s17, s16, 262143
    s_lshl_b32 s52, s14, 3
    s_sub_u32 s52, s52, 40
    s_lshl_b32 s16, s32, 12
    s_add_u32 s16, s16, 2048
    s_add_u32 s38, s20, s16
    s_addc_u32 s39, s21, 0
    s_bfe_u32 s29, s14, 0x10002
    s_and_b32 s16, s14, 3
    s_mul_i32 s16, s16, 262144
    s_add_u32 s16, s16, s15
    s_add_u32 s34, s26, s16
    s_addc_u32 s35, s27, 0
    s_lshr_b32 s14, s32, 3
    s_and_b32 s15, s32, 7
    s_lshl_b32 s15, s15, 7
    s_lshl_b32 s16, s14, 15
    s_add_u32 s16, s16, s15
    s_and_b32 s17, s16, 262143
    s_add_u32 s36, s24, s17
    s_addc_u32 s37, s25, 0
    s_add_u32 s40, s22, s17
    s_addc_u32 s41, s23, 0
    s_add_u32 s17, s16, 65536
    s_and_b32 s17, s17, 262143
    s_add_u32 s48, s24, s17
    s_addc_u32 s49, s25, 0
    s_mov_b32 s12, 0
    s_add_u32 s53, s32, s33
    v_mov_b32 v44, s53
    s_min_u32 s53, s53, 511
RED_15:
    global_load_dwordx4 v[16:19], v4, s[38:39] offset:-2048
REDL_17:
    global_load_dword v62, v47, s[50:51] sc1
    global_load_dwordx4 v[64:67], v48, s[34:35] offset:0 sc1
    global_load_dwordx4 v[68:71], v49, s[34:35] offset:0 sc1
    global_load_dwordx4 v[72:75], v50, s[34:35] offset:0 sc1
    global_load_dwordx4 v[76:79], v51, s[34:35] offset:0 sc1
    global_load_dwordx4 v[80:83], v52, s[34:35] offset:0 sc1
    global_load_dwordx4 v[84:87], v53, s[34:35] offset:0 sc1
    global_load_dwordx4 v[88:91], v54, s[34:35] offset:0 sc1
    global_load_dwordx4 v[92:95], v55, s[34:35] offset:0 sc1
    s_add_u32 s12, s12, 1
    s_mov_b32 s17, 2
    s_cmp_gt_u32 s12, 20000
    s_cbranch_scc1 TIMEOUT
    s_waitcnt vmcnt(8)
    v_cmp_gt_i32 s[14:15], s52, v62
    v_lshlrev_b32 v24, 16, v16
    v_and_b32 v25, 0xffff0000, v16
    v_lshlrev_b32 v26, 16, v17
    v_and_b32 v27, 0xffff0000, v17
    v_lshlrev_b32 v28, 16, v18
    v_and_b32 v29, 0xffff0000, v18
    v_lshlrev_b32 v30, 16, v19
    v_and_b32 v31, 0xffff0000, v19
    s_waitcnt vmcnt(7)
    v_xor_b32 v42, s29, v64
    v_fma_mix_f32 v24, v64, 1.0, v24 op_sel_hi:[1,0,0]
    v_fma_mix_f32 v25, v64, 1.0, v25 op_sel:[1,0,0] op_sel_hi:[1,0,0]
    v_fma_mix_f32 v26, v65, 1.0, v26 op_sel_hi:[1,0,0]
    v_fma_mix_f32 v27, v65, 1.0, v27 op_sel:[1,0,0] op_sel_hi:[1,0,0]
    v_fma_mix_f32 v28, v66, 1.0, v28 op_sel_hi:[1,0,0]
    v_fma_mix_f32 v29, v66, 1.0, v29 op_sel:[1,0,0] op_sel_hi:[1,0,0]
    v_fma_mix_f32 v30, v67, 1.0, v30 op_sel_hi:[1,0,0]
    v_fma_mix_f32 v31, v67, 1.0, v31 op_sel:[1,0,0] op_sel_hi:[1,0,0]
    s_waitcnt vmcnt(6)
    v_bitop3_b32 v42, v42, v68, s29 bitop3:0xf6
    v_fma_mix_f32 v24, v68, 1.0, v24 op_sel_hi:[1,0,0]
    v_fma_mix_f32 v25, v68, 1.0, v25 op_sel:[1,0,0] op_sel_hi:[1,0,0]
    v_fma_mix_f32 v26, v69, 1.0, v26 op_sel_hi:[1,0,0]
    v_fma_mix_f32 v27, v69, 1.0, v27 op_sel:[1,0,0] op_sel_hi:[1,0,0]
    v_fma_mix_f32 v28, v70, 1.0, v28 op_sel_hi:[1,0,0]
    v_fma_mix_f32 v29, v70, 1.0, v29 op_sel:[1,0,0] op_sel_hi:[1,0,0]
    v_fma_mix_f32 v30, v71, 1.0, v30 op_sel_hi:[1,0,0]
    v_fma_mix_f32 v31, v71, 1.0, v31 op_sel:[1,0,0] op_sel_hi:[1,0,0]
    s_waitcnt vmcnt(5)
    v_bitop3_b32 v42, v42, v72, s29 bitop3:0xf6
    v_fma_mix_f32 v24, v72, 1.0, v24 op_sel_hi:[1,0,0]
    v_fma_mix_f32 v25, v72, 1.0, v25 op_sel:[1,0,0] op_sel_hi:[1,0,0]
    v_fma_mix_f32 v26, v73, 1.0, v26 op_sel_hi:[1,0,0]
    v_fma_mix_f32 v27, v73, 1.0, v27 op_sel:[1,0,0] op_sel_hi:[1,0,0]
    v_fma_mix_f32 v28, v74, 1.0, v28 op_sel_hi:[1,0,0]
    v_fma_mix_f32 v29, v74, 1.0, v29 op_sel:[1,0,0] op_sel_hi:[1,0,0]
    v_fma_mix_f32 v30, v75, 1.0, v30 op_sel_hi:[1,0,0]
    v_fma_mix_f32 v31, v75, 1.0, v31 op_sel:[1,0,0] op_sel_hi:[1,0,0]
    s_waitcnt vmcnt(4)
    v_bitop3_b32 v42, v42, v76, s29 bitop3:0xf6
    v_fma_mix_f32 v24, v76, 1.0, v24 op_sel_hi:[1,0,0]
    v_fma_mix_f32 v25, v76, 1.0, v25 op_sel:[1,0,0] op_sel_hi:[1,0,0]
    v_fma_mix_f32 v26, v77, 1.0, v26 op_sel_hi:[1,0,0]
    v_fma_mix_f32 v27, v77, 1.0, v27 op_sel:[1,0,0] op_sel_hi:[1,0,0]
    v_fma_mix_f32 v28, v78, 1.0, v28 op_sel_hi:[1,0,0]
    v_fma_mix_f32 v29, v78, 1.0, v29 op_sel:[1,0,0] op_sel_hi:[1,0,0]
    v_fma_mix_f32 v30, v79, 1.0, v30 op_sel_hi:[1,0,0]
    v_fma_mix_f32 v31, v79, 1.0, v31 op_sel:[1,0,0] op_sel_hi:[1,0,0]
    s_waitcnt vmcnt(3)
    v_bitop3_b32 v42, v42, v80, s29 bitop3:0xf6
    v_fma_mix_f32 v24, v80, 1.0, v24 op_sel_hi:[1,0,0]
    v_fma_mix_f32 v25, v80, 1.0, v25 op_sel:[1,0,0] op_sel_hi:[1,0,0]
    v_fma_mix_f32 v26, v81, 1.0, v26 op_sel_hi:[1,0,0]
    v_fma_mix_f32 v27, v81, 1.0, v27 op_sel:[1,0,0] op_sel_hi:[1,0,0]
    v_fma_mix_f32 v28, v82, 1.0, v28 op_sel_hi:[1,0,0]
    v_fma_mix_f32 v29, v82, 1.0, v29 op_sel:[1,0,0] op_sel_hi:[1,0,0]
    v_fma_mix_f32 v30, v83, 1.0, v30 op_sel_hi:[1,0,0]
    v_fma_mix_f32 v31, v83, 1.0, v31 op_sel:[1,0,0] op_sel_hi:[1,0,0]
    s_waitcnt vmcnt(2)
    v_bitop3_b32 v42, v42, v84, s29 bitop3:0xf6
    v_fma_mix_f32 v24, v84, 1.0, v24 op_sel_hi:[1,0,0]
    v_fma_mix_f32 v25, v84, 1.0, v25 op_sel:[1,0,0] op_sel_hi:[1,0,0]
    v_fma_mix_f32 v26, v85, 1.0, v26 op_sel_hi:[1,0,0]
    v_fma_mix_f32 v27, v85, 1.0, v27 op_sel:[1,0,0] op_sel_hi:[1,0,0]
    v_fma_mix_f32 v28, v86, 1.0, v28 op_sel_hi:[1,0,0]
    v_fma_mix_f32 v29, v86, 1.0, v29 op_sel:[1,0,0] op_sel_hi:[1,0,0]
    v_fma_mix_f32 v30, v87, 1.0, v30 op_sel_hi:[1,0,0]
    v_fma_mix_f32 v31, v87, 1.0, v31 op_sel:[1,0,0] op_sel_hi:[1,0,0]
    s_waitcnt vmcnt(1)
    v_bitop3_b32 v42, v42, v88, s29 bitop3:0xf6
    v_fma_mix_f32 v24, v88, 1.0, v24 op_sel_hi:[1,0,0]
    v_fma_mix_f32 v25, v88, 1.0, v25 op_sel:[1,0,0] op_sel_hi:[1,0,0]
    v_fma_mix_f32 v26, v89, 1.0, v26 op_sel_hi:[1,0,0]
    v_fma_mix_f32 v27, v89, 1.0, v27 op_sel:[1,0,0] op_sel_hi:[1,0,0]
    v_fma_mix_f32 v28, v90, 1.0, v28 op_sel_hi:[1,0,0]
    v_fma_mix_f32 v29, v90, 1.0, v29 op_sel:[1,0,0] op_sel_hi:[1,0,0]
    v_fma_mix_f32 v30, v91, 1.0, v30 op_sel_hi:[1,0,0]
    v_fma_mix_f32 v31, v91, 1.0, v31 op_sel:[1,0,0] op_sel_hi:[1,0,0]
    s_waitcnt vmcnt(0)
    v_bitop3_b32 v42, v42, v92, s29 bitop3:0xf6
    v_and_b32 v42, 1, v42
    v_cmp_ne_u32 vcc, 0, v42
    s_or_b64 vcc, vcc, s[14:15]
    s_cbranch_scc1 REDL_17
    v_fma_mix_f32 v24, v92, 1.0, v24 op_sel_hi:[1,0,0]
    v_fma_mix_f32 v25, v92, 1.0, v25 op_sel:[1,0,0] op_sel_hi:[1,0,0]
    v_fma_mix_f32 v26, v93, 1.0, v26 op_sel_hi:[1,0,0]
    v_fma_mix_f32 v27, v93, 1.0, v27 op_sel:[1,0,0] op_sel_hi:[1,0,0]
    v_fma_mix_f32 v28, v94, 1.0, v28 op_sel_hi:[1,0,0]
    v_fma_mix_f32 v29, v94, 1.0, v29 op_sel:[1,0,0] op_sel_hi:[1,0,0]
    v_fma_mix_f32 v30, v95, 1.0, v30 op_sel_hi:[1,0,0]
    v_fma_mix_f32 v31, v95, 1.0, v31 op_sel:[1,0,0] op_sel_hi:[1,0,0]
    v_cvt_pk_bf16_f32 v32, v24, v25
    v_cvt_pk_bf16_f32 v33, v26, v27
    v_cvt_pk_bf16_f32 v34, v28, v29
    v_cvt_pk_bf16_f32 v35, v30, v31
    global_store_dwordx4 v48, v[32:35], s[40:41] offset:0 sc1
    v_lshlrev_b32 v24, 16, v32
    v_and_b32 v25, 0xffff0000, v32
    v_lshlrev_b32 v26, 16, v33
    v_and_b32 v27, 0xffff0000, v33
    v_lshlrev_b32 v28, 16, v34
    v_and_b32 v29, 0xffff0000, v34
    v_lshlrev_b32 v30, 16, v35
    v_and_b32 v31, 0xffff0000, v35
    v_pk_add_f32 v[8:9], v[24:25], v[26:27]
    v_pk_mul_f32 v[10:11], v[24:25], v[24:25]
    v_pk_add_f32 v[12:13], v[28:29], v[30:31]
    v_pk_fma_f32 v[10:11], v[26:27], v[26:27], v[10:11]
    v_pk_add_f32 v[8:9], v[8:9], v[12:13]
    v_pk_fma_f32 v[10:11], v[28:29], v[28:29], v[10:11]
    v_add_f32 v8, v8, v9
    v_pk_fma_f32 v[10:11], v[30:31], v[30:31], v[10:11]
    v_add_f32 v9, v10, v11
    s_nop 1
    v_permlane32_swap_b32 v8, v9
    v_add_f32 v8, v8, v9
    s_nop 1
    v_add_f32_dpp v8, v8, v8 row_ror:8 row_mask:0xf bank_mask:0xf
    s_nop 1
    v_add_f32_dpp v8, v8, v8 row_ror:4 row_mask:0xf bank_mask:0xf
    s_mov_b64 exec, s[44:45]
    ds_write_b32 v40, v8 offset:0
    s_mov_b64 exec, -1
    s_waitcnt lgkmcnt(0)
    s_barrier
    ds_read_b128 v[96:99], v41 offset:0
    ds_read_b128 v[100:103], v41 offset:16
    ds_read_b128 v[104:107], v41 offset:128
    ds_read_b128 v[108:111], v41 offset:144
    v_xor_b32 v40, 256, v40
    v_xor_b32 v41, 256, v41
    s_waitcnt lgkmcnt(2)
    v_pk_add_f32 v[96:97], v[96:97], v[98:99]
    v_pk_add_f32 v[100:101], v[100:101], v[102:103]
    v_pk_add_f32 v[96:97], v[96:97], v[100:101]
    v_add_f32 v96, v96, v97
    v_mul_f32 v8, 0x3b000000, v96
    s_waitcnt lgkmcnt(0)
    v_pk_add_f32 v[104:105], v[104:105], v[106:107]
    v_pk_add_f32 v[108:109], v[108:109], v[110:111]
    v_pk_add_f32 v[104:105], v[104:105], v[108:109]
    v_add_f32 v104, v104, v105
    v_mul_f32 v9, 0x3b000000, v104
    v_fma_f32 v9, -v8, v8, v9
    v_max_f32 v9, 0, v9
    v_add_f32 v9, 0x3727c5ac, v9
    v_rsq_f32 v9, v9
    s_nop 0
    v_pk_add_f32 v[24:25], v[24:25], v[8:9] op_sel_hi:[1,0] neg_lo:[0,1] neg_hi:[0,1]
    v_pk_add_f32 v[26:27], v[26:27], v[8:9] op_sel_hi:[1,0] neg_lo:[0,1] neg_hi:[0,1]
    v_pk_add_f32 v[28:29], v[28:29], v[8:9] op_sel_hi:[1,0] neg_lo:[0,1] neg_hi:[0,1]
    v_pk_add_f32 v[30:31], v[30:31], v[8:9] op_sel_hi:[1,0] neg_lo:[0,1] neg_hi:[0,1]
    v_pk_mul_f32 v[24:25], v[24:25], v[8:9] op_sel:[0,1]
    v_pk_mul_f32 v[26:27], v[26:27], v[8:9] op_sel:[0,1]
    v_pk_mul_f32 v[28:29], v[28:29], v[8:9] op_sel:[0,1]
    v_pk_mul_f32 v[30:31], v[30:31], v[8:9] op_sel:[0,1]
    v_cvt_pk_bf16_f32 v112, v24, v25
    v_cvt_pk_bf16_f32 v113, v26, v27
    v_cvt_pk_bf16_f32 v114, v28, v29
    v_cvt_pk_bf16_f32 v115, v30, v31
    v_min_u32 v112, -2, v112
    s_waitcnt vmcnt(0)
    global_store_dwordx4 v48, v[112:115], s[36:37] offset:0 sc1
    s_cmp_lt_u32 s32, 1000
    s_cbranch_scc1 RED_15_M
    s_waitcnt vmcnt(0)
    s_branch RED_15_N
RED_15_M:
    global_store_dwordx4 v48, v[36:39], s[48:49] offset:0 sc1
RED_15_N:
    s_cmp_lg_u32 s9, 0
    s_cbranch_scc1 RED_15_P
    global_store_dword v43, v44, s[46:47] sc1
RED_15_P:
    s_add_u32 s32, s32, s33
    s_cmp_ge_u32 s32, 512
    s_cbranch_scc1 REDE_16
    s_lshr_b32 s14, s32, 3
    s_and_b32 s15, s32, 7
    s_lshl_b32 s15, s15, 7
    s_lshl_b32 s16, s14, 15
    s_add_u32 s16, s16, s15
    s_and_b32 s17, s16, 262143
    s_lshl_b32 s52, s14, 3
    s_sub_u32 s52, s52, 40
    s_lshl_b32 s16, s32, 12
    s_add_u32 s16, s16, 2048
    s_add_u32 s38, s20, s16
    s_addc_u32 s39, s21, 0
    s_bfe_u32 s29, s14, 0x10002
    s_and_b32 s16, s14, 3
    s_mul_i32 s16, s16, 262144
    s_add_u32 s16, s16, s15
    s_add_u32 s34, s26, s16
    s_addc_u32 s35, s27, 0
    s_lshr_b32 s14, s32, 3
    s_and_b32 s15, s32, 7
    s_lshl_b32 s15, s15, 7
    s_lshl_b32 s16, s14, 15
    s_add_u32 s16, s16, s15
    s_and_b32 s17, s16, 262143
    s_add_u32 s36, s24, s17
    s_addc_u32 s37, s25, 0
    s_add_u32 s40, s22, s17
    s_addc_u32 s41, s23, 0
    s_add_u32 s17, s16, 65536
    s_and_b32 s17, s17, 262143
    s_add_u32 s48, s24, s17
    s_addc_u32 s49, s25, 0
    s_mov_b32 s12, 0
    s_add_u32 s53, s32, s33
    v_mov_b32 v44, s53
    s_min_u32 s53, s53, 511
    s_branch RED_15
REDE_16:
    s_branch RED_WX
RED_WX:
    s_add_u32 s20, s4, 0xdd8000
    s_addc_u32 s21, s5, 0
    s_branch RED_W1
RED_FFN:
    s_lshl_b32 s14, s13, 22
    s_add_u32 s15, s14, 12582912
    s_add_u32 s20, s4, s15
    s_addc_u32 s21, s5, 0
    s_mul_i32 s14, s13, 2097152
    s_add_u32 s15, s14, 163577856
    s_add_u32 s26, s4, s15
    s_addc_u32 s27, s5, 0
    s_sub_u32 s32, s11, 8
    s_mov_b32 s33, 8
    s_and_b32 s14, s32, 7
    s_lshl_b32 s14, s14, 7
    s_add_u32 s38, s20, s14
    s_addc_u32 s39, s21, 0
    s_sub_u32 s34, s38, 6291456
    s_subb_u32 s35, s39, 0
    global_load_dword v46, v48, s[38:39] sc1
    global_load_dword v46, v48, s[34:35] sc1
    global_load_dword v46, v49, s[38:39] sc1
    global_load_dword v46, v49, s[34:35] sc1
    global_load_dword v46, v50, s[38:39] sc1
    global_load_dword v46, v50, s[34:35] sc1
    global_load_dword v46, v51, s[38:39] sc1
    global_load_dword v46, v51, s[34:35] sc1
    global_load_dword v46, v52, s[38:39] sc1
    global_load_dword v46, v52, s[34:35] sc1
    global_load_dword v46, v53, s[38:39] sc1
    global_load_dword v46, v53, s[34:35] sc1
    global_load_dword v46, v54, s[38:39] sc1
    global_load_dword v46, v54, s[34:35] sc1
    global_load_dword v46, v55, s[38:39] sc1
    global_load_dword v46, v55, s[34:35] sc1
    s_cmp_eq_u32 s13, 1
    s_cbranch_scc1 RED_F1
    s_add_u32 s22, s4, 0xe00000
    s_addc_u32 s23, s5, 0
    s_add_u32 s24, s4, 0x800000
    s_addc_u32 s25, s5, 0
    s_lshr_b32 s14, s32, 3
    s_and_b32 s15, s32, 7
    s_lshl_b32 s15, s15, 7
    s_lshl_b32 s16, s14, 15
    s_add_u32 s16, s16, s15
    s_and_b32 s17, s16, 262143
    s_add_u32 s38, s20, s17
    s_addc_u32 s39, s21, 0
    s_bfe_u32 s29, s14, 0x10002
    s_and_b32 s16, s14, 3
    s_mul_i32 s16, s16, 458752
    s_add_u32 s30, s26, s16
    s_addc_u32 s31, s27, 0
    s_add_u32 s16, s16, s15
    s_add_u32 s34, s26, s16
    s_addc_u32 s35, s27, 0
    s_lshr_b32 s14, s32, 3
    s_and_b32 s15, s32, 7
    s_lshl_b32 s15, s15, 7
    s_lshl_b32 s16, s14, 15
    s_add_u32 s16, s16, s15
    s_and_b32 s17, s16, 262143
    s_add_u32 s36, s24, s16
    s_addc_u32 s37, s25, 0
    s_add_u32 s40, s22, s16
    s_addc_u32 s41, s23, 0
    s_mov_b32 s12, 0
    s_add_u32 s53, s32, s33
    v_mov_b32 v44, s53
    s_min_u32 s53, s53, 511
REDL_20:
    global_load_dword v63, v5, s[30:31] sc1
    s_add_u32 s12, s12, 1
    s_mov_b32 s17, 3
    s_cmp_gt_u32 s12, 20000
    s_cbranch_scc1 TIMEOUT
    s_waitcnt vmcnt(0)
RED_18:
    v_xor_b32 v63, s29, v63
    v_and_b32 v63, 1, v63
    v_cmp_ne_u32 vcc, 0, v63
    s_cbranch_vccnz REDL_20
    global_load_dwordx4 v[16:19], v48, s[38:39] offset:0 sc1
    global_load_dwordx4 v[64:67], v48, s[34:35] offset:0 sc1
    global_load_dwordx4 v[68:71], v49, s[34:35] offset:0 sc1
    global_load_dwordx4 v[72:75], v50, s[34:35] offset:0 sc1
    global_load_dwordx4 v[76:79], v51, s[34:35] offset:0 sc1
    global_load_dwordx4 v[80:83], v52, s[34:35] offset:0 sc1
    global_load_dwordx4 v[84:87], v53, s[34:35] offset:0 sc1
    global_load_dwordx4 v[88:91], v54, s[34:35] offset:0 sc1
    global_load_dwordx4 v[92:95], v55, s[34:35] offset:0 sc1
    global_load_dwordx4 v[96:99], v56, s[34:35] offset:0 sc1
    global_load_dwordx4 v[100:103], v57, s[34:35] offset:0 sc1
    global_load_dwordx4 v[104:107], v58, s[34:35] offset:0 sc1
    global_load_dwordx4 v[108:111], v59, s[34:35] offset:0 sc1
    global_load_dwordx4 v[112:115], v60, s[34:35] offset:0 sc1
    global_load_dwordx4 v[116:119], v61, s[34:35] offset:0 sc1
    s_waitcnt vmcnt(14)
    v_lshlrev_b32 v24, 16, v16
    v_and_b32 v25, 0xffff0000, v16
    v_lshlrev_b32 v26, 16, v17
    v_and_b32 v27, 0xffff0000, v17
    v_lshlrev_b32 v28, 16, v18
    v_and_b32 v29, 0xffff0000, v18
    v_lshlrev_b32 v30, 16, v19
    v_and_b32 v31, 0xffff0000, v19
    s_waitcnt vmcnt(13)
    v_fma_mix_f32 v24, v64, 1.0, v24 op_sel_hi:[1,0,0]
    v_fma_mix_f32 v25, v64, 1.0, v25 op_sel:[1,0,0] op_sel_hi:[1,0,0]
    v_fma_mix_f32 v26, v65, 1.0, v26 op_sel_hi:[1,0,0]
    v_fma_mix_f32 v27, v65, 1.0, v27 op_sel:[1,0,0] op_sel_hi:[1,0,0]
    v_fma_mix_f32 v28, v66, 1.0, v28 op_sel_hi:[1,0,0]
    v_fma_mix_f32 v29, v66, 1.0, v29 op_sel:[1,0,0] op_sel_hi:[1,0,0]
    v_fma_mix_f32 v30, v67, 1.0, v30 op_sel_hi:[1,0,0]
    v_fma_mix_f32 v31, v67, 1.0, v31 op_sel:[1,0,0] op_sel_hi:[1,0,0]
    v_xor_b32 v42, s29, v64
    s_waitcnt vmcnt(12)
    v_fma_mix_f32 v24, v68, 1.0, v24 op_sel_hi:[1,0,0]
    v_fma_mix_f32 v25, v68, 1.0, v25 op_sel:[1,0,0] op_sel_hi:[1,0,0]
    v_fma_mix_f32 v26, v69, 1.0, v26 op_sel_hi:[1,0,0]
    v_fma_mix_f32 v27, v69, 1.0, v27 op_sel:[1,0,0] op_sel_hi:[1,0,0]
    v_fma_mix_f32 v28, v70, 1.0, v28 op_sel_hi:[1,0,0]
    v_fma_mix_f32 v29, v70, 1.0, v29 op_sel:[1,0,0] op_sel_hi:[1,0,0]
    v_fma_mix_f32 v30, v71, 1.0, v30 op_sel_hi:[1,0,0]
    v_fma_mix_f32 v31, v71, 1.0, v31 op_sel:[1,0,0] op_sel_hi:[1,0,0]
    v_bitop3_b32 v42, v42, v68, s29 bitop3:0xf6
    s_waitcnt vmcnt(11)
    v_fma_mix_f32 v24, v72, 1.0, v24 op_sel_hi:[1,0,0]
    v_fma_mix_f32 v25, v72, 1.0, v25 op_sel:[1,0,0] op_sel_hi:[1,0,0]
    v_fma_mix_f32 v26, v73, 1.0, v26 op_sel_hi:[1,0,0]
    v_fma_mix_f32 v27, v73, 1.0, v27 op_sel:[1,0,0] op_sel_hi:[1,0,0]
    v_fma_mix_f32 v28, v74, 1.0, v28 op_sel_hi:[1,0,0]
    v_fma_mix_f32 v29, v74, 1.0, v29 op_sel:[1,0,0] op_sel_hi:[1,0,0]
    v_fma_mix_f32 v30, v75, 1.0, v30 op_sel_hi:[1,0,0]
    v_fma_mix_f32 v31, v75, 1.0, v31 op_sel:[1,0,0] op_sel_hi:[1,0,0]
    v_bitop3_b32 v42, v42, v72, s29 bitop3:0xf6
    s_waitcnt vmcnt(10)
    v_fma_mix_f32 v24, v76, 1.0, v24 op_sel_hi:[1,0,0]
    v_fma_mix_f32 v25, v76, 1.0, v25 op_sel:[1,0,0] op_sel_hi:[1,0,0]
    v_fma_mix_f32 v26, v77, 1.0, v26 op_sel_hi:[1,0,0]
    v_fma_mix_f32 v27, v77, 1.0, v27 op_sel:[1,0,0] op_sel_hi:[1,0,0]
    v_fma_mix_f32 v28, v78, 1.0, v28 op_sel_hi:[1,0,0]
    v_fma_mix_f32 v29, v78, 1.0, v29 op_sel:[1,0,0] op_sel_hi:[1,0,0]
    v_fma_mix_f32 v30, v79, 1.0, v30 op_sel_hi:[1,0,0]
    v_fma_mix_f32 v31, v79, 1.0, v31 op_sel:[1,0,0] op_sel_hi:[1,0,0]
    v_bitop3_b32 v42, v42, v76, s29 bitop3:0xf6
    s_waitcnt vmcnt(9)
    v_fma_mix_f32 v24, v80, 1.0, v24 op_sel_hi:[1,0,0]
    v_fma_mix_f32 v25, v80, 1.0, v25 op_sel:[1,0,0] op_sel_hi:[1,0,0]
    v_fma_mix_f32 v26, v81, 1.0, v26 op_sel_hi:[1,0,0]
    v_fma_mix_f32 v27, v81, 1.0, v27 op_sel:[1,0,0] op_sel_hi:[1,0,0]
    v_fma_mix_f32 v28, v82, 1.0, v28 op_sel_hi:[1,0,0]
    v_fma_mix_f32 v29, v82, 1.0, v29 op_sel:[1,0,0] op_sel_hi:[1,0,0]
    v_fma_mix_f32 v30, v83, 1.0, v30 op_sel_hi:[1,0,0]
    v_fma_mix_f32 v31, v83, 1.0, v31 op_sel:[1,0,0] op_sel_hi:[1,0,0]
    v_bitop3_b32 v42, v42, v80, s29 bitop3:0xf6
    s_waitcnt vmcnt(8)
    v_fma_mix_f32 v24, v84, 1.0, v24 op_sel_hi:[1,0,0]
    v_fma_mix_f32 v25, v84, 1.0, v25 op_sel:[1,0,0] op_sel_hi:[1,0,0]
    v_fma_mix_f32 v26, v85, 1.0, v26 op_sel_hi:[1,0,0]
    v_fma_mix_f32 v27, v85, 1.0, v27 op_sel:[1,0,0] op_sel_hi:[1,0,0]
    v_fma_mix_f32 v28, v86, 1.0, v28 op_sel_hi:[1,0,0]
    v_fma_mix_f32 v29, v86, 1.0, v29 op_sel:[1,0,0] op_sel_hi:[1,0,0]
    v_fma_mix_f32 v30, v87, 1.0, v30 op_sel_hi:[1,0,0]
    v_fma_mix_f32 v31, v87, 1.0, v31 op_sel:[1,0,0] op_sel_hi:[1,0,0]
    v_bitop3_b32 v42, v42, v84, s29 bitop3:0xf6
    s_waitcnt vmcnt(7)
    v_fma_mix_f32 v24, v88, 1.0, v24 op_sel_hi:[1,0,0]
    v_fma_mix_f32 v25, v88, 1.0, v25 op_sel:[1,0,0] op_sel_hi:[1,0,0]
    v_fma_mix_f32 v26, v89, 1.0, v26 op_sel_hi:[1,0,0]
    v_fma_mix_f32 v27, v89, 1.0, v27 op_sel:[1,0,0] op_sel_hi:[1,0,0]
    v_fma_mix_f32 v28, v90, 1.0, v28 op_sel_hi:[1,0,0]
    v_fma_mix_f32 v29, v90, 1.0, v29 op_sel:[1,0,0] op_sel_hi:[1,0,0]
    v_fma_mix_f32 v30, v91, 1.0, v30 op_sel_hi:[1,0,0]
    v_fma_mix_f32 v31, v91, 1.0, v31 op_sel:[1,0,0] op_sel_hi:[1,0,0]
    v_bitop3_b32 v42, v42, v88, s29 bitop3:0xf6
    s_waitcnt vmcnt(6)
    v_fma_mix_f32 v24, v92, 1.0, v24 op_sel_hi:[1,0,0]
    v_fma_mix_f32 v25, v92, 1.0, v25 op_sel:[1,0,0] op_sel_hi:[1,0,0]
    v_fma_mix_f32 v26, v93, 1.0, v26 op_sel_hi:[1,0,0]
    v_fma_mix_f32 v27, v93, 1.0, v27 op_sel:[1,0,0] op_sel_hi:[1,0,0]
    v_fma_mix_f32 v28, v94, 1.0, v28 op_sel_hi:[1,0,0]
    v_fma_mix_f32 v29, v94, 1.0, v29 op_sel:[1,0,0] op_sel_hi:[1,0,0]
    v_fma_mix_f32 v30, v95, 1.0, v30 op_sel_hi:[1,0,0]
    v_fma_mix_f32 v31, v95, 1.0, v31 op_sel:[1,0,0] op_sel_hi:[1,0,0]
    v_bitop3_b32 v42, v42, v92, s29 bitop3:0xf6
    s_waitcnt vmcnt(5)
    v_fma_mix_f32 v24, v96, 1.0, v24 op_sel_hi:[1,0,0]
    v_fma_mix_f32 v25, v96, 1.0, v25 op_sel:[1,0,0] op_sel_hi:[1,0,0]
    v_fma_mix_f32 v26, v97, 1.0, v26 op_sel_hi:[1,0,0]
    v_fma_mix_f32 v27, v97, 1.0, v27 op_sel:[1,0,0] op_sel_hi:[1,0,0]
    v_fma_mix_f32 v28, v98, 1.0, v28 op_sel_hi:[1,0,0]
    v_fma_mix_f32 v29, v98, 1.0, v29 op_sel:[1,0,0] op_sel_hi:[1,0,0]
    v_fma_mix_f32 v30, v99, 1.0, v30 op_sel_hi:[1,0,0]
    v_fma_mix_f32 v31, v99, 1.0, v31 op_sel:[1,0,0] op_sel_hi:[1,0,0]
    v_bitop3_b32 v42, v42, v96, s29 bitop3:0xf6
    s_waitcnt vmcnt(4)
    v_fma_mix_f32 v24, v100, 1.0, v24 op_sel_hi:[1,0,0]
    v_fma_mix_f32 v25, v100, 1.0, v25 op_sel:[1,0,0] op_sel_hi:[1,0,0]
    v_fma_mix_f32 v26, v101, 1.0, v26 op_sel_hi:[1,0,0]
    v_fma_mix_f32 v27, v101, 1.0, v27 op_sel:[1,0,0] op_sel_hi:[1,0,0]
    v_fma_mix_f32 v28, v102, 1.0, v28 op_sel_hi:[1,0,0]
    v_fma_mix_f32 v29, v102, 1.0, v29 op_sel:[1,0,0] op_sel_hi:[1,0,0]
    v_fma_mix_f32 v30, v103, 1.0, v30 op_sel_hi:[1,0,0]
    v_fma_mix_f32 v31, v103, 1.0, v31 op_sel:[1,0,0] op_sel_hi:[1,0,0]
    v_bitop3_b32 v42, v42, v100, s29 bitop3:0xf6
    s_waitcnt vmcnt(3)
    v_fma_mix_f32 v24, v104, 1.0, v24 op_sel_hi:[1,0,0]
    v_fma_mix_f32 v25, v104, 1.0, v25 op_sel:[1,0,0] op_sel_hi:[1,0,0]
    v_fma_mix_f32 v26, v105, 1.0, v26 op_sel_hi:[1,0,0]
    v_fma_mix_f32 v27, v105, 1.0, v27 op_sel:[1,0,0] op_sel_hi:[1,0,0]
    v_fma_mix_f32 v28, v106, 1.0, v28 op_sel_hi:[1,0,0]
    v_fma_mix_f32 v29, v106, 1.0, v29 op_sel:[1,0,0] op_sel_hi:[1,0,0]
    v_fma_mix_f32 v30, v107, 1.0, v30 op_sel_hi:[1,0,0]
    v_fma_mix_f32 v31, v107, 1.0, v31 op_sel:[1,0,0] op_sel_hi:[1,0,0]
    v_bitop3_b32 v42, v42, v104, s29 bitop3:0xf6
    s_waitcnt vmcnt(2)
    v_fma_mix_f32 v24, v108, 1.0, v24 op_sel_hi:[1,0,0]
    v_fma_mix_f32 v25, v108, 1.0, v25 op_sel:[1,0,0] op_sel_hi:[1,0,0]
    v_fma_mix_f32 v26, v109, 1.0, v26 op_sel_hi:[1,0,0]
    v_fma_mix_f32 v27, v109, 1.0, v27 op_sel:[1,0,0] op_sel_hi:[1,0,0]
    v_fma_mix_f32 v28, v110, 1.0, v28 op_sel_hi:[1,0,0]
    v_fma_mix_f32 v29, v110, 1.0, v29 op_sel:[1,0,0] op_sel_hi:[1,0,0]
    v_fma_mix_f32 v30, v111, 1.0, v30 op_sel_hi:[1,0,0]
    v_fma_mix_f32 v31, v111, 1.0, v31 op_sel:[1,0,0] op_sel_hi:[1,0,0]
    v_bitop3_b32 v42, v42, v108, s29 bitop3:0xf6
    s_waitcnt vmcnt(1)
    v_fma_mix_f32 v24, v112, 1.0, v24 op_sel_hi:[1,0,0]
    v_fma_mix_f32 v25, v112, 1.0, v25 op_sel:[1,0,0] op_sel_hi:[1,0,0]
    v_fma_mix_f32 v26, v113, 1.0, v26 op_sel_hi:[1,0,0]
    v_fma_mix_f32 v27, v113, 1.0, v27 op_sel:[1,0,0] op_sel_hi:[1,0,0]
    v_fma_mix_f32 v28, v114, 1.0, v28 op_sel_hi:[1,0,0]
    v_fma_mix_f32 v29, v114, 1.0, v29 op_sel:[1,0,0] op_sel_hi:[1,0,0]
    v_fma_mix_f32 v30, v115, 1.0, v30 op_sel_hi:[1,0,0]
    v_fma_mix_f32 v31, v115, 1.0, v31 op_sel:[1,0,0] op_sel_hi:[1,0,0]
    v_bitop3_b32 v42, v42, v112, s29 bitop3:0xf6
    s_waitcnt vmcnt(0)
    v_fma_mix_f32 v24, v116, 1.0, v24 op_sel_hi:[1,0,0]
    v_fma_mix_f32 v25, v116, 1.0, v25 op_sel:[1,0,0] op_sel_hi:[1,0,0]
    v_fma_mix_f32 v26, v117, 1.0, v26 op_sel_hi:[1,0,0]
    v_fma_mix_f32 v27, v117, 1.0, v27 op_sel:[1,0,0] op_sel_hi:[1,0,0]
    v_fma_mix_f32 v28, v118, 1.0, v28 op_sel_hi:[1,0,0]
    v_fma_mix_f32 v29, v118, 1.0, v29 op_sel:[1,0,0] op_sel_hi:[1,0,0]
    v_fma_mix_f32 v30, v119, 1.0, v30 op_sel_hi:[1,0,0]
    v_fma_mix_f32 v31, v119, 1.0, v31 op_sel:[1,0,0] op_sel_hi:[1,0,0]
    v_bitop3_b32 v42, v42, v116, s29 bitop3:0xf6
    v_and_b32 v42, 1, v42
    v_cmp_ne_u32 vcc, 0, v42
    s_cbranch_vccnz REDL_20
    s_lshr_b32 s14, s53, 3
    s_and_b32 s15, s53, 7
    s_lshl_b32 s15, s15, 7
    s_lshl_b32 s16, s14, 15
    s_add_u32 s16, s16, s15
    s_and_b32 s17, s16, 262143
    s_add_u32 s38, s20, s17
    s_addc_u32 s39, s21, 0
    s_bfe_u32 s29, s14, 0x10002
    s_and_b32 s16, s14, 3
    s_mul_i32 s16, s16, 458752
    s_add_u32 s30, s26, s16
    s_addc_u32 s31, s27, 0
    s_add_u32 s16, s16, s15
    s_add_u32 s34, s26, s16
    s_addc_u32 s35, s27, 0
    global_load_dword v63, v5, s[30:31] sc1
    v_cvt_pk_bf16_f32 v32, v24, v25
    v_cvt_pk_bf16_f32 v33, v26, v27
    v_cvt_pk_bf16_f32 v34, v28, v29
    v_cvt_pk_bf16_f32 v35, v30, v31
    v_min_u32 v32, -2, v32
    global_store_dwordx4 v48, v[32:35], s[40:41] offset:0 sc1
    v_lshlrev_b32 v24, 16, v32
    v_and_b32 v25, 0xffff0000, v32
    v_lshlrev_b32 v26, 16, v33
    v_and_b32 v27, 0xffff0000, v33
    v_lshlrev_b32 v28, 16, v34
    v_and_b32 v29, 0xffff0000, v34
    v_lshlrev_b32 v30, 16, v35
    v_and_b32 v31, 0xffff0000, v35
    v_pk_add_f32 v[8:9], v[24:25], v[26:27]
    v_pk_mul_f32 v[10:11], v[24:25], v[24:25]
    v_pk_add_f32 v[12:13], v[28:29], v[30:31]
    v_pk_fma_f32 v[10:11], v[26:27], v[26:27], v[10:11]
    v_pk_add_f32 v[8:9], v[8:9], v[12:13]
    v_pk_fma_f32 v[10:11], v[28:29], v[28:29], v[10:11]
    v_add_f32 v8, v8, v9
    v_pk_fma_f32 v[10:11], v[30:31], v[30:31], v[10:11]
    v_add_f32 v9, v10, v11
    s_nop 1
    v_permlane32_swap_b32 v8, v9
    v_add_f32 v8, v8, v9
    s_nop 1
    v_add_f32_dpp v8, v8, v8 row_ror:8 row_mask:0xf bank_mask:0xf
    s_nop 1
    v_add_f32_dpp v8, v8, v8 row_ror:4 row_mask:0xf bank_mask:0xf
    s_mov_b64 exec, s[44:45]
    ds_write_b32 v40, v8 offset:0
    s_mov_b64 exec, -1
    s_waitcnt lgkmcnt(0)
    s_barrier
    ds_read_b128 v[64:67], v41 offset:0
    ds_read_b128 v[68:71], v41 offset:16
    ds_read_b128 v[72:75], v41 offset:128
    ds_read_b128 v[76:79], v41 offset:144
    v_xor_b32 v40, 256, v40
    v_xor_b32 v41, 256, v41
    s_waitcnt lgkmcnt(2)
    v_pk_add_f32 v[64:65], v[64:65], v[66:67]
    v_pk_add_f32 v[68:69], v[68:69], v[70:71]
    v_pk_add_f32 v[64:65], v[64:65], v[68:69]
    v_add_f32 v64, v64, v65
    v_mul_f32 v8, 0x3b000000, v64
    s_waitcnt lgkmcnt(0)
    v_pk_add_f32 v[72:73], v[72:73], v[74:75]
    v_pk_add_f32 v[76:77], v[76:77], v[78:79]
    v_pk_add_f32 v[72:73], v[72:73], v[76:77]
    v_add_f32 v72, v72, v73
    v_mul_f32 v9, 0x3b000000, v72
    v_fma_f32 v9, -v8, v8, v9
    v_max_f32 v9, 0, v9
    v_add_f32 v9, 0x3727c5ac, v9
    v_rsq_f32 v9, v9
    s_nop 0
    v_pk_add_f32 v[24:25], v[24:25], v[8:9] op_sel_hi:[1,0] neg_lo:[0,1] neg_hi:[0,1]
    v_pk_add_f32 v[26:27], v[26:27], v[8:9] op_sel_hi:[1,0] neg_lo:[0,1] neg_hi:[0,1]
    v_pk_add_f32 v[28:29], v[28:29], v[8:9] op_sel_hi:[1,0] neg_lo:[0,1] neg_hi:[0,1]
    v_pk_add_f32 v[30:31], v[30:31], v[8:9] op_sel_hi:[1,0] neg_lo:[0,1] neg_hi:[0,1]
    v_pk_mul_f32 v[24:25], v[24:25], v[8:9] op_sel:[0,1]
    v_pk_mul_f32 v[26:27], v[26:27], v[8:9] op_sel:[0,1]
    v_pk_mul_f32 v[28:29], v[28:29], v[8:9] op_sel:[0,1]
    v_pk_mul_f32 v[30:31], v[30:31], v[8:9] op_sel:[0,1]
    v_cvt_pk_bf16_f32 v16, v24, v25
    v_cvt_pk_bf16_f32 v17, v26, v27
    v_cvt_pk_bf16_f32 v18, v28, v29
    v_cvt_pk_bf16_f32 v19, v30, v31
    v_min_u32 v16, -2, v16
    global_store_dwordx4 v48, v[16:19], s[36:37] offset:0 sc1
    s_cmp_lt_u32 s32, 488
    s_cbranch_scc1 RED_18_M
    s_waitcnt vmcnt(0)
    s_branch RED_18_N
RED_18_M:
    global_store_dwordx4 v51, v[36:39], s[36:37] sc1
    global_store_dwordx4 v51, v[36:39], s[40:41] sc1
RED_18_N:
    s_cmp_eq_u32 s18, 0
    s_cbranch_scc1 LS_21
    global_store_dword v43, v44, s[46:47]
    s_branch LS_21_E
LS_21:
    global_store_dword v43, v44, s[46:47] sc1
LS_21_E:
    s_add_u32 s32, s32, s33
    s_cmp_ge_u32 s32, 512
    s_cbranch_scc1 REDE_19
    s_lshr_b32 s14, s32, 3
    s_and_b32 s15, s32, 7
    s_lshl_b32 s15, s15, 7
    s_lshl_b32 s16, s14, 15
    s_add_u32 s16, s16, s15
    s_and_b32 s17, s16, 262143
    s_add_u32 s36, s24, s16
    s_addc_u32 s37, s25, 0
    s_add_u32 s40, s22, s16
    s_addc_u32 s41, s23, 0
    s_mov_b32 s12, 0
    s_add_u32 s53, s32, s33
    v_mov_b32 v44, s53
    s_min_u32 s53, s53, 511
    s_waitcnt vmcnt(5)
    s_branch RED_18
REDE_19:
    s_waitcnt vmcnt(5)
    s_sub_u32 s42, s42, 163840
    s_subb_u32 s43, s43, 0
RED_F1:
    s_mov_b64 s[22:23], s[42:43]
    s_lshr_b32 s14, s32, 3
    s_and_b32 s15, s32, 7
    s_lshl_b32 s15, s15, 7
    s_lshl_b32 s16, s14, 15
    s_add_u32 s16, s16, s15
    s_and_b32 s17, s16, 262143
    s_add_u32 s38, s20, s17
    s_addc_u32 s39, s21, 0
    s_bfe_u32 s29, s14, 0x10002
    s_and_b32 s16, s14, 3
    s_mul_i32 s16, s16, 458752
    s_add_u32 s30, s26, s16
    s_addc_u32 s31, s27, 0
    s_add_u32 s16, s16, s15
    s_add_u32 s34, s26, s16
    s_addc_u32 s35, s27, 0
    s_lshr_b32 s14, s32, 3
    s_and_b32 s15, s32, 7
    s_lshl_b32 s15, s15, 7
    s_lshl_b32 s16, s14, 15
    s_add_u32 s16, s16, s15
    s_and_b32 s17, s16, 262143
    s_lshl_b32 s16, s32, 12
    s_sub_i32 s17, s14, s54
    s_max_i32 s17, s17, 0
    s_lshl_b32 s17, s17, 15
    s_add_u32 s16, s16, s17
    s_add_u32 s40, s22, s16
    s_addc_u32 s41, s23, 0
    s_mov_b32 s12, 0
    s_add_u32 s53, s32, s33
    v_mov_b32 v44, s53
    s_min_u32 s53, s53, 535
REDL_24:
    global_load_dword v63, v5, s[30:31] sc1
    s_add_u32 s12, s12, 1
    s_mov_b32 s17, 3
    s_cmp_gt_u32 s12, 20000
    s_cbranch_scc1 TIMEOUT
    s_waitcnt vmcnt(0)
RED_22:
    v_xor_b32 v63, s29, v63
    v_and_b32 v63, 1, v63
    v_cmp_ne_u32 vcc, 0, v63
    s_cbranch_vccnz REDL_24
    global_load_dwordx4 v[16:19], v48, s[38:39] offset:0 sc1
    global_load_dwordx4 v[64:67], v48, s[34:35] offset:0 sc1
    global_load_dwordx4 v[68:71], v49, s[34:35] offset:0 sc1
    global_load_dwordx4 v[72:75], v50, s[34:35] offset:0 sc1
    global_load_dwordx4 v[76:79], v51, s[34:35] offset:0 sc1
    global_load_dwordx4 v[80:83], v52, s[34:35] offset:0 sc1
    global_load_dwordx4 v[84:87], v53, s[34:35] offset:0 sc1
    global_load_dwordx4 v[88:91], v54, s[34:35] offset:0 sc1
    global_load_dwordx4 v[92:95], v55, s[34:35] offset:0 sc1
    global_load_dwordx4 v[96:99], v56, s[34:35] offset:0 sc1
    global_load_dwordx4 v[100:103], v57, s[34:35] offset:0 sc1
    global_load_dwordx4 v[104:107], v58, s[34:35] offset:0 sc1
    global_load_dwordx4 v[108:111], v59, s[34:35] offset:0 sc1
    global_load_dwordx4 v[112:115], v60, s[34:35] offset:0 sc1
    global_load_dwordx4 v[116:119], v61, s[34:35] offset:0 sc1
    s_waitcnt vmcnt(14)
    v_lshlrev_b32 v24, 16, v16
    v_and_b32 v25, 0xffff0000, v16
    v_lshlrev_b32 v26, 16, v17
    v_and_b32 v27, 0xffff0000, v17
    v_lshlrev_b32 v28, 16, v18
    v_and_b32 v29, 0xffff0000, v18
    v_lshlrev_b32 v30, 16, v19
    v_and_b32 v31, 0xffff0000, v19
    s_waitcnt vmcnt(13)
    v_fma_mix_f32 v24, v64, 1.0, v24 op_sel_hi:[1,0,0]
    v_fma_mix_f32 v25, v64, 1.0, v25 op_sel:[1,0,0] op_sel_hi:[1,0,0]
    v_fma_mix_f32 v26, v65, 1.0, v26 op_sel_hi:[1,0,0]
    v_fma_mix_f32 v27, v65, 1.0, v27 op_sel:[1,0,0] op_sel_hi:[1,0,0]
    v_fma_mix_f32 v28, v66, 1.0, v28 op_sel_hi:[1,0,0]
    v_fma_mix_f32 v29, v66, 1.0, v29 op_sel:[1,0,0] op_sel_hi:[1,0,0]
    v_fma_mix_f32 v30, v67, 1.0, v30 op_sel_hi:[1,0,0]
    v_fma_mix_f32 v31, v67, 1.0, v31 op_sel:[1,0,0] op_sel_hi:[1,0,0]
    v_xor_b32 v42, s29, v64
    s_waitcnt vmcnt(12)
    v_fma_mix_f32 v24, v68, 1.0, v24 op_sel_hi:[1,0,0]
    v_fma_mix_f32 v25, v68, 1.0, v25 op_sel:[1,0,0] op_sel_hi:[1,0,0]
    v_fma_mix_f32 v26, v69, 1.0, v26 op_sel_hi:[1,0,0]
    v_fma_mix_f32 v27, v69, 1.0, v27 op_sel:[1,0,0] op_sel_hi:[1,0,0]
    v_fma_mix_f32 v28, v70, 1.0, v28 op_sel_hi:[1,0,0]
    v_fma_mix_f32 v29, v70, 1.0, v29 op_sel:[1,0,0] op_sel_hi:[1,0,0]
    v_fma_mix_f32 v30, v71, 1.0, v30 op_sel_hi:[1,0,0]
    v_fma_mix_f32 v31, v71, 1.0, v31 op_sel:[1,0,0] op_sel_hi:[1,0,0]
    v_bitop3_b32 v42, v42, v68, s29 bitop3:0xf6
    s_waitcnt vmcnt(11)
    v_fma_mix_f32 v24, v72, 1.0, v24 op_sel_hi:[1,0,0]
    v_fma_mix_f32 v25, v72, 1.0, v25 op_sel:[1,0,0] op_sel_hi:[1,0,0]
    v_fma_mix_f32 v26, v73, 1.0, v26 op_sel_hi:[1,0,0]
    v_fma_mix_f32 v27, v73, 1.0, v27 op_sel:[1,0,0] op_sel_hi:[1,0,0]
    v_fma_mix_f32 v28, v74, 1.0, v28 op_sel_hi:[1,0,0]
    v_fma_mix_f32 v29, v74, 1.0, v29 op_sel:[1,0,0] op_sel_hi:[1,0,0]
    v_fma_mix_f32 v30, v75, 1.0, v30 op_sel_hi:[1,0,0]
    v_fma_mix_f32 v31, v75, 1.0, v31 op_sel:[1,0,0] op_sel_hi:[1,0,0]
    v_bitop3_b32 v42, v42, v72, s29 bitop3:0xf6
    s_waitcnt vmcnt(10)
    v_fma_mix_f32 v24, v76, 1.0, v24 op_sel_hi:[1,0,0]
    v_fma_mix_f32 v25, v76, 1.0, v25 op_sel:[1,0,0] op_sel_hi:[1,0,0]
    v_fma_mix_f32 v26, v77, 1.0, v26 op_sel_hi:[1,0,0]
    v_fma_mix_f32 v27, v77, 1.0, v27 op_sel:[1,0,0] op_sel_hi:[1,0,0]
    v_fma_mix_f32 v28, v78, 1.0, v28 op_sel_hi:[1,0,0]
    v_fma_mix_f32 v29, v78, 1.0, v29 op_sel:[1,0,0] op_sel_hi:[1,0,0]
    v_fma_mix_f32 v30, v79, 1.0, v30 op_sel_hi:[1,0,0]
    v_fma_mix_f32 v31, v79, 1.0, v31 op_sel:[1,0,0] op_sel_hi:[1,0,0]
    v_bitop3_b32 v42, v42, v76, s29 bitop3:0xf6
    s_waitcnt vmcnt(9)
    v_fma_mix_f32 v24, v80, 1.0, v24 op_sel_hi:[1,0,0]
    v_fma_mix_f32 v25, v80, 1.0, v25 op_sel:[1,0,0] op_sel_hi:[1,0,0]
    v_fma_mix_f32 v26, v81, 1.0, v26 op_sel_hi:[1,0,0]
    v_fma_mix_f32 v27, v81, 1.0, v27 op_sel:[1,0,0] op_sel_hi:[1,0,0]
    v_fma_mix_f32 v28, v82, 1.0, v28 op_sel_hi:[1,0,0]
    v_fma_mix_f32 v29, v82, 1.0, v29 op_sel:[1,0,0] op_sel_hi:[1,0,0]
    v_fma_mix_f32 v30, v83, 1.0, v30 op_sel_hi:[1,0,0]
    v_fma_mix_f32 v31, v83, 1.0, v31 op_sel:[1,0,0] op_sel_hi:[1,0,0]
    v_bitop3_b32 v42, v42, v80, s29 bitop3:0xf6
    s_waitcnt vmcnt(8)
    v_fma_mix_f32 v24, v84, 1.0, v24 op_sel_hi:[1,0,0]
    v_fma_mix_f32 v25, v84, 1.0, v25 op_sel:[1,0,0] op_sel_hi:[1,0,0]
    v_fma_mix_f32 v26, v85, 1.0, v26 op_sel_hi:[1,0,0]
    v_fma_mix_f32 v27, v85, 1.0, v27 op_sel:[1,0,0] op_sel_hi:[1,0,0]
    v_fma_mix_f32 v28, v86, 1.0, v28 op_sel_hi:[1,0,0]
    v_fma_mix_f32 v29, v86, 1.0, v29 op_sel:[1,0,0] op_sel_hi:[1,0,0]
    v_fma_mix_f32 v30, v87, 1.0, v30 op_sel_hi:[1,0,0]
    v_fma_mix_f32 v31, v87, 1.0, v31 op_sel:[1,0,0] op_sel_hi:[1,0,0]
    v_bitop3_b32 v42, v42, v84, s29 bitop3:0xf6
    s_waitcnt vmcnt(7)
    v_fma_mix_f32 v24, v88, 1.0, v24 op_sel_hi:[1,0,0]
    v_fma_mix_f32 v25, v88, 1.0, v25 op_sel:[1,0,0] op_sel_hi:[1,0,0]
    v_fma_mix_f32 v26, v89, 1.0, v26 op_sel_hi:[1,0,0]
    v_fma_mix_f32 v27, v89, 1.0, v27 op_sel:[1,0,0] op_sel_hi:[1,0,0]
    v_fma_mix_f32 v28, v90, 1.0, v28 op_sel_hi:[1,0,0]
    v_fma_mix_f32 v29, v90, 1.0, v29 op_sel:[1,0,0] op_sel_hi:[1,0,0]
    v_fma_mix_f32 v30, v91, 1.0, v30 op_sel_hi:[1,0,0]
    v_fma_mix_f32 v31, v91, 1.0, v31 op_sel:[1,0,0] op_sel_hi:[1,0,0]
    v_bitop3_b32 v42, v42, v88, s29 bitop3:0xf6
    s_waitcnt vmcnt(6)
    v_fma_mix_f32 v24, v92, 1.0, v24 op_sel_hi:[1,0,0]
    v_fma_mix_f32 v25, v92, 1.0, v25 op_sel:[1,0,0] op_sel_hi:[1,0,0]
    v_fma_mix_f32 v26, v93, 1.0, v26 op_sel_hi:[1,0,0]
    v_fma_mix_f32 v27, v93, 1.0, v27 op_sel:[1,0,0] op_sel_hi:[1,0,0]
    v_fma_mix_f32 v28, v94, 1.0, v28 op_sel_hi:[1,0,0]
    v_fma_mix_f32 v29, v94, 1.0, v29 op_sel:[1,0,0] op_sel_hi:[1,0,0]
    v_fma_mix_f32 v30, v95, 1.0, v30 op_sel_hi:[1,0,0]
    v_fma_mix_f32 v31, v95, 1.0, v31 op_sel:[1,0,0] op_sel_hi:[1,0,0]
    v_bitop3_b32 v42, v42, v92, s29 bitop3:0xf6
    s_waitcnt vmcnt(5)
    v_fma_mix_f32 v24, v96, 1.0, v24 op_sel_hi:[1,0,0]
    v_fma_mix_f32 v25, v96, 1.0, v25 op_sel:[1,0,0] op_sel_hi:[1,0,0]
    v_fma_mix_f32 v26, v97, 1.0, v26 op_sel_hi:[1,0,0]
    v_fma_mix_f32 v27, v97, 1.0, v27 op_sel:[1,0,0] op_sel_hi:[1,0,0]
    v_fma_mix_f32 v28, v98, 1.0, v28 op_sel_hi:[1,0,0]
    v_fma_mix_f32 v29, v98, 1.0, v29 op_sel:[1,0,0] op_sel_hi:[1,0,0]
    v_fma_mix_f32 v30, v99, 1.0, v30 op_sel_hi:[1,0,0]
    v_fma_mix_f32 v31, v99, 1.0, v31 op_sel:[1,0,0] op_sel_hi:[1,0,0]
    v_bitop3_b32 v42, v42, v96, s29 bitop3:0xf6
    s_waitcnt vmcnt(4)
    v_fma_mix_f32 v24, v100, 1.0, v24 op_sel_hi:[1,0,0]
    v_fma_mix_f32 v25, v100, 1.0, v25 op_sel:[1,0,0] op_sel_hi:[1,0,0]
    v_fma_mix_f32 v26, v101, 1.0, v26 op_sel_hi:[1,0,0]
    v_fma_mix_f32 v27, v101, 1.0, v27 op_sel:[1,0,0] op_sel_hi:[1,0,0]
    v_fma_mix_f32 v28, v102, 1.0, v28 op_sel_hi:[1,0,0]
    v_fma_mix_f32 v29, v102, 1.0, v29 op_sel:[1,0,0] op_sel_hi:[1,0,0]
    v_fma_mix_f32 v30, v103, 1.0, v30 op_sel_hi:[1,0,0]
    v_fma_mix_f32 v31, v103, 1.0, v31 op_sel:[1,0,0] op_sel_hi:[1,0,0]
    v_bitop3_b32 v42, v42, v100, s29 bitop3:0xf6
    s_waitcnt vmcnt(3)
    v_fma_mix_f32 v24, v104, 1.0, v24 op_sel_hi:[1,0,0]
    v_fma_mix_f32 v25, v104, 1.0, v25 op_sel:[1,0,0] op_sel_hi:[1,0,0]
    v_fma_mix_f32 v26, v105, 1.0, v26 op_sel_hi:[1,0,0]
    v_fma_mix_f32 v27, v105, 1.0, v27 op_sel:[1,0,0] op_sel_hi:[1,0,0]
    v_fma_mix_f32 v28, v106, 1.0, v28 op_sel_hi:[1,0,0]
    v_fma_mix_f32 v29, v106, 1.0, v29 op_sel:[1,0,0] op_sel_hi:[1,0,0]
    v_fma_mix_f32 v30, v107, 1.0, v30 op_sel_hi:[1,0,0]
    v_fma_mix_f32 v31, v107, 1.0, v31 op_sel:[1,0,0] op_sel_hi:[1,0,0]
    v_bitop3_b32 v42, v42, v104, s29 bitop3:0xf6
    s_waitcnt vmcnt(2)
    v_fma_mix_f32 v24, v108, 1.0, v24 op_sel_hi:[1,0,0]
    v_fma_mix_f32 v25, v108, 1.0, v25 op_sel:[1,0,0] op_sel_hi:[1,0,0]
    v_fma_mix_f32 v26, v109, 1.0, v26 op_sel_hi:[1,0,0]
    v_fma_mix_f32 v27, v109, 1.0, v27 op_sel:[1,0,0] op_sel_hi:[1,0,0]
    v_fma_mix_f32 v28, v110, 1.0, v28 op_sel_hi:[1,0,0]
    v_fma_mix_f32 v29, v110, 1.0, v29 op_sel:[1,0,0] op_sel_hi:[1,0,0]
    v_fma_mix_f32 v30, v111, 1.0, v30 op_sel_hi:[1,0,0]
    v_fma_mix_f32 v31, v111, 1.0, v31 op_sel:[1,0,0] op_sel_hi:[1,0,0]
    v_bitop3_b32 v42, v42, v108, s29 bitop3:0xf6
    s_waitcnt vmcnt(1)
    v_fma_mix_f32 v24, v112, 1.0, v24 op_sel_hi:[1,0,0]
    v_fma_mix_f32 v25, v112, 1.0, v25 op_sel:[1,0,0] op_sel_hi:[1,0,0]
    v_fma_mix_f32 v26, v113, 1.0, v26 op_sel_hi:[1,0,0]
    v_fma_mix_f32 v27, v113, 1.0, v27 op_sel:[1,0,0] op_sel_hi:[1,0,0]
    v_fma_mix_f32 v28, v114, 1.0, v28 op_sel_hi:[1,0,0]
    v_fma_mix_f32 v29, v114, 1.0, v29 op_sel:[1,0,0] op_sel_hi:[1,0,0]
    v_fma_mix_f32 v30, v115, 1.0, v30 op_sel_hi:[1,0,0]
    v_fma_mix_f32 v31, v115, 1.0, v31 op_sel:[1,0,0] op_sel_hi:[1,0,0]
    v_bitop3_b32 v42, v42, v112, s29 bitop3:0xf6
    s_waitcnt vmcnt(0)
    v_fma_mix_f32 v24, v116, 1.0, v24 op_sel_hi:[1,0,0]
    v_fma_mix_f32 v25, v116, 1.0, v25 op_sel:[1,0,0] op_sel_hi:[1,0,0]
    v_fma_mix_f32 v26, v117, 1.0, v26 op_sel_hi:[1,0,0]
    v_fma_mix_f32 v27, v117, 1.0, v27 op_sel:[1,0,0] op_sel_hi:[1,0,0]
    v_fma_mix_f32 v28, v118, 1.0, v28 op_sel_hi:[1,0,0]
    v_fma_mix_f32 v29, v118, 1.0, v29 op_sel:[1,0,0] op_sel_hi:[1,0,0]
    v_fma_mix_f32 v30, v119, 1.0, v30 op_sel_hi:[1,0,0]
    v_fma_mix_f32 v31, v119, 1.0, v31 op_sel:[1,0,0] op_sel_hi:[1,0,0]
    v_bitop3_b32 v42, v42, v116, s29 bitop3:0xf6
    v_and_b32 v42, 1, v42
    v_cmp_ne_u32 vcc, 0, v42
    s_cbranch_vccnz REDL_24
    s_lshr_b32 s14, s53, 3
    s_and_b32 s15, s53, 7
    s_lshl_b32 s15, s15, 7
    s_lshl_b32 s16, s14, 15
    s_add_u32 s16, s16, s15
    s_and_b32 s17, s16, 262143
    s_add_u32 s38, s20, s17
    s_addc_u32 s39, s21, 0
    s_bfe_u32 s29, s14, 0x10002
    s_and_b32 s16, s14, 3
    s_mul_i32 s16, s16, 458752
    s_add_u32 s30, s26, s16
    s_addc_u32 s31, s27, 0
    s_add_u32 s16, s16, s15
    s_add_u32 s34, s26, s16
    s_addc_u32 s35, s27, 0
    global_load_dword v63, v5, s[30:31] sc1
    v_cvt_pk_bf16_f32 v32, v24, v25
    v_cvt_pk_bf16_f32 v33, v26, v27
    v_cvt_pk_bf16_f32 v34, v28, v29
    v_cvt_pk_bf16_f32 v35, v30, v31
    global_store_dwordx4 v4, v[32:35], s[40:41] offset:0
    s_cmp_eq_u32 s18, 0
    s_cbranch_scc1 LS_25
    global_store_dword v43, v44, s[46:47]
    s_branch LS_25_E
LS_25:
    global_store_dword v43, v44, s[46:47] sc1
LS_25_E:
    s_add_u32 s32, s32, s33
    s_cmp_ge_u32 s32, s55
    s_cbranch_scc1 REDE_23
    s_lshr_b32 s14, s32, 3
    s_and_b32 s15, s32, 7
    s_lshl_b32 s15, s15, 7
    s_lshl_b32 s16, s14, 15
    s_add_u32 s16, s16, s15
    s_and_b32 s17, s16, 262143
    s_lshl_b32 s16, s32, 12
    s_sub_i32 s17, s14, s54
    s_max_i32 s17, s17, 0
    s_lshl_b32 s17, s17, 15
    s_add_u32 s16, s16, s17
    s_add_u32 s40, s22, s16
    s_addc_u32 s41, s23, 0
    s_mov_b32 s12, 0
    s_add_u32 s53, s32, s33
    v_mov_b32 v44, s53
    s_min_u32 s53, s53, 535
    s_waitcnt vmcnt(2)
    s_branch RED_22
REDE_23:
    s_waitcnt vmcnt(2)
    s_cmp_lg_u32 s32, 495
    s_cbranch_scc1 END
    v_mov_b32 v8, 0
    global_store_dword v8, v7, s[4:5] sc1
    s_endpgm
ROLE_QKV:
    s_load_dwordx4 s[20:23], s[0:1], 16
    s_load_dwordx2 s[24:25], s[0:1], 32
    s_and_b32 s14, s11, 1
    s_lshr_b32 s11, s11, 1
    s_lshl_b32 s15, s10, 3
    s_add_u32 s11, s11, s15
    s_sub_u32 s11, s11, 16
    s_add_u32 s10, s14, 2
    s_lshl_b32 s15, s11, 1
    s_add_u32 s15, s15, s14
    s_lshl_b32 s15, s15, 7
    s_add_u32 s52, s15, 360448
    s_mov_b32 s32, 0xd5ab5400
    s_mov_b32 s33, 0xfeaaaaaa
    s_mov_b32 s56, 10
    s_lshl_b32 s26, s9, 13
    s_mul_i32 s36, s11, 2129920
    s_add_u32 s36, s36, 18874368
    s_lshl_b32 s37, s11, 5
    s_add_u32 s37, s37, 393216
    v_lshrrev_b32 v10, 4, v0
    v_lshlrev_b32 v11, 2, v10
    v_and_b32 v20, 15, v0
    v_xor_b32 v20, v20, v11
    v_lshlrev_b32 v20, 4, v20
    v_mul_u32_u24 v10, 8192, v10
    v_add_u32 v20, v20, v10
    s_lshl_b32 s14, s9, 18
    s_lshl_b32 s15, s11, 8
    s_add_u32 s14, s14, s15
    v_add_u32 v20, s14, v20
    v_bfe_u32 v10, v0, 2, 2
    v_mul_u32_u24 v21, 320, v10
    v_bfe_u32 v10, v0, 4, 1
    v_lshl_add_u32 v21, v10, 5, v21
    v_and_b32 v10, 3, v0
    v_lshl_add_u32 v21, v10, 3, v21
    v_lshrrev_b32 v10, 5, v0
    v_mul_u32_u24 v10, 2048, v10
    v_add_u32 v21, v21, v10
    s_lshl_b32 s14, s9, 6
    v_xor_b32 v21, s14, v21
    v_add_u32 v22, 0x10000, v21
    v_add_u32 v23, 0x20000, v21
    s_waitcnt lgkmcnt(0)
    s_cmp_eq_u32 s10, 3
    s_cselect_b64 s[30:31], s[24:25], s[22:23]
    s_cselect_b64 s[24:25], s[22:23], s[24:25]
    s_mov_b64 s[22:23], s[30:31]
    s_and_b32 s30, s10, 1
    s_lshl_b32 s30, s30, 2
    s_add_u32 s30, s30, s9
    v_mov_b32 v9, 0
    global_load_dword v9, v9, s[4:5] sc1
    s_add_u32 s42, s22, 0x0
    s_addc_u32 s43, s23, 0
    s_add_u32 m0, s26, 0
    s_nop 0
    global_load_lds_dwordx4 v20, s[42:43]
    s_add_u32 s42, s22, 0x8000
    s_addc_u32 s43, s23, 0
    s_add_u32 m0, s26, 1024
    s_nop 0
    global_load_lds_dwordx4 v20, s[42:43]
    s_add_u32 s42, s22, 0x10000
    s_addc_u32 s43, s23, 0
    s_add_u32 m0, s26, 2048
    s_nop 0
    global_load_lds_dwordx4 v20, s[42:43]
    s_add_u32 s42, s22, 0x18000
    s_addc_u32 s43, s23, 0
    s_add_u32 m0, s26, 3072
    s_nop 0
    global_load_lds_dwordx4 v20, s[42:43]
    s_add_u32 s42, s22, 0x20000
    s_addc_u32 s43, s23, 0
    s_add_u32 m0, s26, 4096
    s_nop 0
    global_load_lds_dwordx4 v20, s[42:43]
    s_add_u32 s42, s22, 0x28000
    s_addc_u32 s43, s23, 0
    s_add_u32 m0, s26, 5120
    s_nop 0
    global_load_lds_dwordx4 v20, s[42:43]
    s_add_u32 s42, s22, 0x30000
    s_addc_u32 s43, s23, 0
    s_add_u32 m0, s26, 6144
    s_nop 0
    global_load_lds_dwordx4 v20, s[42:43]
    s_add_u32 s42, s22, 0x38000
    s_addc_u32 s43, s23, 0
    s_add_u32 m0, s26, 7168
    s_nop 0
    global_load_lds_dwordx4 v20, s[42:43]
    s_add_u32 s42, s22, 0x100000
    s_addc_u32 s43, s23, 0
    s_add_u32 m0, s26, 32768
    s_nop 0
    global_load_lds_dwordx4 v20, s[42:43]
    s_add_u32 s42, s22, 0x108000
    s_addc_u32 s43, s23, 0
    s_add_u32 m0, s26, 33792
    s_nop 0
    global_load_lds_dwordx4 v20, s[42:43]
    s_add_u32 s42, s22, 0x110000
    s_addc_u32 s43, s23, 0
    s_add_u32 m0, s26, 34816
    s_nop 0
    global_load_lds_dwordx4 v20, s[42:43]
    s_add_u32 s42, s22, 0x118000
    s_addc_u32 s43, s23, 0
    s_add_u32 m0, s26, 35840
    s_nop 0
    global_load_lds_dwordx4 v20, s[42:43]
    s_add_u32 s42, s22, 0x120000
    s_addc_u32 s43, s23, 0
    s_add_u32 m0, s26, 36864
    s_nop 0
    global_load_lds_dwordx4 v20, s[42:43]
    s_add_u32 s42, s22, 0x128000
    s_addc_u32 s43, s23, 0
    s_add_u32 m0, s26, 37888
    s_nop 0
    global_load_lds_dwordx4 v20, s[42:43]
    s_add_u32 s42, s22, 0x130000
    s_addc_u32 s43, s23, 0
    s_add_u32 m0, s26, 38912
    s_nop 0
    global_load_lds_dwordx4 v20, s[42:43]
    s_add_u32 s42, s22, 0x138000
    s_addc_u32 s43, s23, 0
    s_add_u32 m0, s26, 39936
    s_nop 0
    global_load_lds_dwordx4 v20, s[42:43]
    s_add_u32 s42, s22, 0x200000
    s_addc_u32 s43, s23, 0
    s_add_u32 m0, s26, 65536
    s_nop 0
    global_load_lds_dwordx4 v20, s[42:43]
    s_add_u32 s42, s22, 0x208000
    s_addc_u32 s43, s23, 0
    s_add_u32 m0, s26, 66560
    s_nop 0
    global_load_lds_dwordx4 v20, s[42:43]
    s_add_u32 s42, s22, 0x210000
    s_addc_u32 s43, s23, 0
    s_add_u32 m0, s26, 67584
    s_nop 0
    global_load_lds_dwordx4 v20, s[42:43]
    s_add_u32 s42, s22, 0x218000
    s_addc_u32 s43, s23, 0
    s_add_u32 m0, s26, 68608
    s_nop 0
    global_load_lds_dwordx4 v20, s[42:43]
    s_add_u32 s42, s22, 0x220000
    s_addc_u32 s43, s23, 0
    s_add_u32 m0, s26, 69632
    s_nop 0
    global_load_lds_dwordx4 v20, s[42:43]
    s_add_u32 s42, s22, 0x228000
    s_addc_u32 s43, s23, 0
    s_add_u32 m0, s26, 70656
    s_nop 0
    global_load_lds_dwordx4 v20, s[42:43]
    s_add_u32 s42, s22, 0x230000
    s_addc_u32 s43, s23, 0
    s_add_u32 m0, s26, 71680
    s_nop 0
    global_load_lds_dwordx4 v20, s[42:43]
    s_add_u32 s42, s22, 0x238000
    s_addc_u32 s43, s23, 0
    s_add_u32 m0, s26, 72704
    s_nop 0
    global_load_lds_dwordx4 v20, s[42:43]
    s_add_u32 s42, s22, 0x300000
    s_addc_u32 s43, s23, 0
    s_add_u32 m0, s26, 98304
    s_nop 0
    global_load_lds_dwordx4 v20, s[42:43]
    s_add_u32 s42, s22, 0x308000
    s_addc_u32 s43, s23, 0
    s_add_u32 m0, s26, 99328
    s_nop 0
    global_load_lds_dwordx4 v20, s[42:43]
    s_add_u32 s42, s22, 0x310000
    s_addc_u32 s43, s23, 0
    s_add_u32 m0, s26, 100352
    s_nop 0
    global_load_lds_dwordx4 v20, s[42:43]
    s_add_u32 s42, s22, 0x318000
    s_addc_u32 s43, s23, 0
    s_add_u32 m0, s26, 101376
    s_nop 0
    global_load_lds_dwordx4 v20, s[42:43]
    s_add_u32 s42, s22, 0x320000
    s_addc_u32 s43, s23, 0
    s_add_u32 m0, s26, 102400
    s_nop 0
    global_load_lds_dwordx4 v20, s[42:43]
    s_add_u32 s42, s22, 0x328000
    s_addc_u32 s43, s23, 0
    s_add_u32 m0, s26, 103424
    s_nop 0
    global_load_lds_dwordx4 v20, s[42:43]
    s_add_u32 s42, s22, 0x330000
    s_addc_u32 s43, s23, 0
    s_add_u32 m0, s26, 104448
    s_nop 0
    global_load_lds_dwordx4 v20, s[42:43]
    s_add_u32 s42, s22, 0x338000
    s_addc_u32 s43, s23, 0
    s_add_u32 m0, s26, 105472
    s_nop 0
    global_load_lds_dwordx4 v20, s[42:43]
    s_add_u32 s42, s24, 0x0
    s_addc_u32 s43, s25, 0
    s_add_u32 m0, s26, 131072
    s_nop 0
    global_load_lds_dwordx4 v20, s[42:43]
    s_add_u32 s42, s24, 0x8000
    s_addc_u32 s43, s25, 0
    s_add_u32 m0, s26, 132096
    s_nop 0
    global_load_lds_dwordx4 v20, s[42:43]
    s_add_u32 s42, s24, 0x10000
    s_addc_u32 s43, s25, 0
    s_add_u32 m0, s26, 133120
    s_nop 0
    global_load_lds_dwordx4 v20, s[42:43]
    s_add_u32 s42, s24, 0x18000
    s_addc_u32 s43, s25, 0
    s_add_u32 m0, s26, 134144
    s_nop 0
    global_load_lds_dwordx4 v20, s[42:43]
    s_add_u32 s42, s24, 0x20000
    s_addc_u32 s43, s25, 0
    s_add_u32 m0, s26, 135168
    s_nop 0
    global_load_lds_dwordx4 v20, s[42:43]
    s_add_u32 s42, s24, 0x28000
    s_addc_u32 s43, s25, 0
    s_add_u32 m0, s26, 136192
    s_nop 0
    global_load_lds_dwordx4 v20, s[42:43]
    s_add_u32 s42, s24, 0x30000
    s_addc_u32 s43, s25, 0
    s_add_u32 m0, s26, 137216
    s_nop 0
    global_load_lds_dwordx4 v20, s[42:43]
    s_add_u32 s42, s24, 0x38000
    s_addc_u32 s43, s25, 0
    s_add_u32 m0, s26, 138240
    s_nop 0
    global_load_lds_dwordx4 v20, s[42:43]
    v_lshlrev_b32 v1, 4, v0
    s_add_u32 s29, s26, 65536
    s_add_u32 s14, s9, 0
    s_and_b32 s14, s14, 3
    s_lshl_b32 s15, s14, 13
    s_add_u32 s15, s15, 65536
    v_add_u32 v2, s15, v1
    s_add_u32 s14, s9, 1
    s_and_b32 s14, s14, 3
    s_lshl_b32 s15, s14, 13
    s_add_u32 s15, s15, 65536
    v_add_u32 v3, s15, v1
    s_add_u32 s14, s9, 2
    s_and_b32 s14, s14, 3
    s_lshl_b32 s15, s14, 13
    s_add_u32 s15, s15, 65536
    v_add_u32 v4, s15, v1
    s_add_u32 s14, s9, 3
    s_and_b32 s14, s14, 3
    s_lshl_b32 s15, s14, 13
    s_add_u32 s15, s15, 65536
    v_add_u32 v5, s15, v1
    s_lshl_b32 s14, s9, 11
    v_add_u32 v6, s14, v1
    s_lshl_b32 s14, s9, 2
    v_mov_b32 v7, s14
    s_add_u32 s52, s52, s14
    s_mov_b32 s27, 0
    s_lshl_b32 s14, s2, 7
    s_add_u32 s14, s14, 32768
    v_add_u32 v8, s14, v7
    s_add_u32 s40, s4, s14
    s_addc_u32 s41, s5, 0
    s_lshl_b32 s14, s9, 10
    s_add_u32 s14, s14, 24576
    v_add_u32 v14, s14, v1
    v_bfe_u32 v10, v0, 2, 3
    v_lshlrev_b32 v1, 7, v10
    v_lshrrev_b32 v10, 5, v0
    v_lshl_add_u32 v1, v10, 6, v1
    v_and_b32 v10, 3, v0
    v_lshl_add_u32 v1, v10, 4, v1
    v_mov_b32 v16, -1
    v_mov_b32 v17, -1
    v_mov_b32 v18, -1
    v_mov_b32 v19, -1
    s_bfm_b64 s[14:15], s27, 0
    s_and_b64 s[14:15], s[14:15], s[32:33]
    s_bcnt1_i32_b64 s14, s[14:15]
    s_sub_u32 s15, s27, s14
    s_add_u32 s14, s14, 32
    s_bitcmp1_b64 s[32:33], s27
    s_cselect_b32 s14, s14, s15
    s_min_u32 s14, s14, 63
    s_lshl_b32 s14, s14, 1
    s_add_u32 s14, s14, s10
    s_sub_u32 s28, s14, 2
    s_and_b32 s14, s28, 64
    s_add_u32 s14, s14, s28
    s_lshl_b32 s15, s14, 15
    s_add_u32 s15, s15, s26
    s_add_u32 s15, s15, 4194304
    s_add_u32 s34, s4, s15
    s_addc_u32 s35, s5, 0
    s_add_u32 s38, s34, 0x1000
    s_addc_u32 s39, s35, 0
    v_and_b32 v13, 31, v0
    v_lshlrev_b32 v13, 6, v13
    v_add_u32 v13, 335872, v13
    s_and_b32 s14, s2, 7
    s_lshl_b32 s14, s14, 8
    s_lshr_b32 s15, s2, 6
    s_lshl_b32 s15, s15, 6
    s_add_u32 s14, s14, s15
    s_add_u32 s14, s14, 333952
    v_and_b32 v50, 56, v0
    v_add_u32 v50, s14, v50
    s_getreg_b32 s19, hwreg(HW_REG_XCC_ID)
    s_and_b32 s19, s19, 15
    s_waitcnt vmcnt(40)
    v_readfirstlane_b32 s8, v9
    s_add_u32 s8, s8, 1
    s_nop 0
    v_mov_b32 v9, s8
    s_lshl_b32 s53, s8, 7
    s_add_u32 s53, s53, 1
    s_waitcnt vmcnt(32)
    s_barrier
    s_cmp_lg_u32 s30, 0
    s_cbranch_scc1 QKR_27
    ds_read_b64_tr_b16 a[0:1], v21 offset:0
    ds_read_b64_tr_b16 a[2:3], v21 offset:1024
    ds_read_b64_tr_b16 a[4:5], v21 offset:4096
    ds_read_b64_tr_b16 a[6:7], v21 offset:5120
    ds_read_b64_tr_b16 a[8:9], v21 offset:8192
    ds_read_b64_tr_b16 a[10:11], v21 offset:9216
    ds_read_b64_tr_b16 a[12:13], v21 offset:12288
    ds_read_b64_tr_b16 a[14:15], v21 offset:13312
    ds_read_b64_tr_b16 a[16:17], v21 offset:16384
    ds_read_b64_tr_b16 a[18:19], v21 offset:17408
    ds_read_b64_tr_b16 a[20:21], v21 offset:20480
    ds_read_b64_tr_b16 a[22:23], v21 offset:21504
    ds_read_b64_tr_b16 a[24:25], v21 offset:24576
    ds_read_b64_tr_b16 a[26:27], v21 offset:25600
    ds_read_b64_tr_b16 a[28:29], v21 offset:28672
    ds_read_b64_tr_b16 a[30:31], v21 offset:29696
    s_branch QKR_26
QKR_27:
    s_cmp_lg_u32 s30, 1
    s_cbranch_scc1 QKR_28
    ds_read_b64_tr_b16 a[96:97], v21 offset:0
    ds_read_b64_tr_b16 a[98:99], v21 offset:1024
    ds_read_b64_tr_b16 a[100:101], v21 offset:4096
    ds_read_b64_tr_b16 a[102:103], v21 offset:5120
    ds_read_b64_tr_b16 a[104:105], v21 offset:8192
    ds_read_b64_tr_b16 a[106:107], v21 offset:9216
    ds_read_b64_tr_b16 a[108:109], v21 offset:12288
    ds_read_b64_tr_b16 a[110:111], v21 offset:13312
    ds_read_b64_tr_b16 a[112:113], v21 offset:16384
    ds_read_b64_tr_b16 a[114:115], v21 offset:17408
    ds_read_b64_tr_b16 a[116:117], v21 offset:20480
    ds_read_b64_tr_b16 a[118:119], v21 offset:21504
    ds_read_b64_tr_b16 a[120:121], v21 offset:24576
    ds_read_b64_tr_b16 a[122:123], v21 offset:25600
    ds_read_b64_tr_b16 a[124:125], v21 offset:28672
    ds_read_b64_tr_b16 a[126:127], v21 offset:29696
    s_branch QKR_26
QKR_28:
    s_cmp_lg_u32 s30, 2
    s_cbranch_scc1 QKR_29
    ds_read_b64_tr_b16 a[64:65], v21 offset:0
    ds_read_b64_tr_b16 a[66:67], v21 offset:1024
    ds_read_b64_tr_b16 a[68:69], v21 offset:4096
    ds_read_b64_tr_b16 a[70:71], v21 offset:5120
    ds_read_b64_tr_b16 a[72:73], v21 offset:8192
    ds_read_b64_tr_b16 a[74:75], v21 offset:9216
    ds_read_b64_tr_b16 a[76:77], v21 offset:12288
    ds_read_b64_tr_b16 a[78:79], v21 offset:13312
    ds_read_b64_tr_b16 a[80:81], v21 offset:16384
    ds_read_b64_tr_b16 a[82:83], v21 offset:17408
    ds_read_b64_tr_b16 a[84:85], v21 offset:20480
    ds_read_b64_tr_b16 a[86:87], v21 offset:21504
    ds_read_b64_tr_b16 a[88:89], v21 offset:24576
    ds_read_b64_tr_b16 a[90:91], v21 offset:25600
    ds_read_b64_tr_b16 a[92:93], v21 offset:28672
    ds_read_b64_tr_b16 a[94:95], v21 offset:29696
    s_branch QKR_26
QKR_29:
    s_cmp_lg_u32 s30, 3
    s_cbranch_scc1 QKR_30
    ds_read_b64_tr_b16 a[32:33], v21 offset:0
    ds_read_b64_tr_b16 a[34:35], v21 offset:1024
    ds_read_b64_tr_b16 a[36:37], v21 offset:4096
    ds_read_b64_tr_b16 a[38:39], v21 offset:5120
    ds_read_b64_tr_b16 a[40:41], v21 offset:8192
    ds_read_b64_tr_b16 a[42:43], v21 offset:9216
    ds_read_b64_tr_b16 a[44:45], v21 offset:12288
    ds_read_b64_tr_b16 a[46:47], v21 offset:13312
    ds_read_b64_tr_b16 a[48:49], v21 offset:16384
    ds_read_b64_tr_b16 a[50:51], v21 offset:17408
    ds_read_b64_tr_b16 a[52:53], v21 offset:20480
    ds_read_b64_tr_b16 a[54:55], v21 offset:21504
    ds_read_b64_tr_b16 a[56:57], v21 offset:24576
    ds_read_b64_tr_b16 a[58:59], v21 offset:25600
    ds_read_b64_tr_b16 a[60:61], v21 offset:28672
    ds_read_b64_tr_b16 a[62:63], v21 offset:29696
    s_branch QKR_26
QKR_30:
    s_cmp_lg_u32 s30, 4
    s_cbranch_scc1 QKR_31
    ds_read_b64_tr_b16 a[128:129], v21 offset:0
    ds_read_b64_tr_b16 a[130:131], v21 offset:1024
    ds_read_b64_tr_b16 a[132:133], v21 offset:4096
    ds_read_b64_tr_b16 a[134:135], v21 offset:5120
    ds_read_b64_tr_b16 a[136:137], v21 offset:8192
    ds_read_b64_tr_b16 a[138:139], v21 offset:9216
    ds_read_b64_tr_b16 a[140:141], v21 offset:12288
    ds_read_b64_tr_b16 a[142:143], v21 offset:13312
    ds_read_b64_tr_b16 a[144:145], v21 offset:16384
    ds_read_b64_tr_b16 a[146:147], v21 offset:17408
    ds_read_b64_tr_b16 a[148:149], v21 offset:20480
    ds_read_b64_tr_b16 a[150:151], v21 offset:21504
    ds_read_b64_tr_b16 a[152:153], v21 offset:24576
    ds_read_b64_tr_b16 a[154:155], v21 offset:25600
    ds_read_b64_tr_b16 a[156:157], v21 offset:28672
    ds_read_b64_tr_b16 a[158:159], v21 offset:29696
    s_branch QKR_26
QKR_31:
    s_cmp_lg_u32 s30, 5
    s_cbranch_scc1 QKR_32
    ds_read_b64_tr_b16 a[224:225], v21 offset:0
    ds_read_b64_tr_b16 a[226:227], v21 offset:1024
    ds_read_b64_tr_b16 a[228:229], v21 offset:4096
    ds_read_b64_tr_b16 a[230:231], v21 offset:5120
    ds_read_b64_tr_b16 a[232:233], v21 offset:8192
    ds_read_b64_tr_b16 a[234:235], v21 offset:9216
    ds_read_b64_tr_b16 a[236:237], v21 offset:12288
    ds_read_b64_tr_b16 a[238:239], v21 offset:13312
    ds_read_b64_tr_b16 a[240:241], v21 offset:16384
    ds_read_b64_tr_b16 a[242:243], v21 offset:17408
    ds_read_b64_tr_b16 a[244:245], v21 offset:20480
    ds_read_b64_tr_b16 a[246:247], v21 offset:21504
    ds_read_b64_tr_b16 a[248:249], v21 offset:24576
    ds_read_b64_tr_b16 a[250:251], v21 offset:25600
    ds_read_b64_tr_b16 a[252:253], v21 offset:28672
    ds_read_b64_tr_b16 a[254:255], v21 offset:29696
    s_branch QKR_26
QKR_32:
    s_cmp_lg_u32 s30, 6
    s_cbranch_scc1 QKR_33
    ds_read_b64_tr_b16 a[192:193], v21 offset:0
    ds_read_b64_tr_b16 a[194:195], v21 offset:1024
    ds_read_b64_tr_b16 a[196:197], v21 offset:4096
    ds_read_b64_tr_b16 a[198:199], v21 offset:5120
    ds_read_b64_tr_b16 a[200:201], v21 offset:8192
    ds_read_b64_tr_b16 a[202:203], v21 offset:9216
    ds_read_b64_tr_b16 a[204:205], v21 offset:12288
    ds_read_b64_tr_b16 a[206:207], v21 offset:13312
    ds_read_b64_tr_b16 a[208:209], v21 offset:16384
    ds_read_b64_tr_b16 a[210:211], v21 offset:17408
    ds_read_b64_tr_b16 a[212:213], v21 offset:20480
    ds_read_b64_tr_b16 a[214:215], v21 offset:21504
    ds_read_b64_tr_b16 a[216:217], v21 offset:24576
    ds_read_b64_tr_b16 a[218:219], v21 offset:25600
    ds_read_b64_tr_b16 a[220:221], v21 offset:28672
    ds_read_b64_tr_b16 a[222:223], v21 offset:29696
    s_branch QKR_26
QKR_33:
    ds_read_b64_tr_b16 a[160:161], v21 offset:0
    ds_read_b64_tr_b16 a[162:163], v21 offset:1024
    ds_read_b64_tr_b16 a[164:165], v21 offset:4096
    ds_read_b64_tr_b16 a[166:167], v21 offset:5120
    ds_read_b64_tr_b16 a[168:169], v21 offset:8192
    ds_read_b64_tr_b16 a[170:171], v21 offset:9216
    ds_read_b64_tr_b16 a[172:173], v21 offset:12288
    ds_read_b64_tr_b16 a[174:175], v21 offset:13312
    ds_read_b64_tr_b16 a[176:177], v21 offset:16384
    ds_read_b64_tr_b16 a[178:179], v21 offset:17408
    ds_read_b64_tr_b16 a[180:181], v21 offset:20480
    ds_read_b64_tr_b16 a[182:183], v21 offset:21504
    ds_read_b64_tr_b16 a[184:185], v21 offset:24576
    ds_read_b64_tr_b16 a[186:187], v21 offset:25600
    ds_read_b64_tr_b16 a[188:189], v21 offset:28672
    ds_read_b64_tr_b16 a[190:191], v21 offset:29696
QKR_26:
    s_waitcnt lgkmcnt(0)
    s_barrier
    s_add_u32 s42, s24, 0x100000
    s_addc_u32 s43, s25, 0
    s_add_u32 m0, s26, 0
    s_nop 0
    global_load_lds_dwordx4 v20, s[42:43]
    s_add_u32 s42, s24, 0x108000
    s_addc_u32 s43, s25, 0
    s_add_u32 m0, s26, 1024
    s_nop 0
    global_load_lds_dwordx4 v20, s[42:43]
    s_add_u32 s42, s24, 0x110000
    s_addc_u32 s43, s25, 0
    s_add_u32 m0, s26, 2048
    s_nop 0
    global_load_lds_dwordx4 v20, s[42:43]
    s_add_u32 s42, s24, 0x118000
    s_addc_u32 s43, s25, 0
    s_add_u32 m0, s26, 3072
    s_nop 0
    global_load_lds_dwordx4 v20, s[42:43]
    s_add_u32 s42, s24, 0x120000
    s_addc_u32 s43, s25, 0
    s_add_u32 m0, s26, 4096
    s_nop 0
    global_load_lds_dwordx4 v20, s[42:43]
    s_add_u32 s42, s24, 0x128000
    s_addc_u32 s43, s25, 0
    s_add_u32 m0, s26, 5120
    s_nop 0
    global_load_lds_dwordx4 v20, s[42:43]
    s_add_u32 s42, s24, 0x130000
    s_addc_u32 s43, s25, 0
    s_add_u32 m0, s26, 6144
    s_nop 0
    global_load_lds_dwordx4 v20, s[42:43]
    s_add_u32 s42, s24, 0x138000
    s_addc_u32 s43, s25, 0
    s_add_u32 m0, s26, 7168
    s_nop 0
    global_load_lds_dwordx4 v20, s[42:43]
    s_waitcnt vmcnt(32)
    s_barrier
    s_cmp_lg_u32 s30, 0
    s_cbranch_scc1 QKR_36
    ds_read_b64_tr_b16 a[32:33], v21 offset:32768
    ds_read_b64_tr_b16 a[34:35], v21 offset:33792
    ds_read_b64_tr_b16 a[36:37], v21 offset:36864
    ds_read_b64_tr_b16 a[38:39], v21 offset:37888
    ds_read_b64_tr_b16 a[40:41], v21 offset:40960
    ds_read_b64_tr_b16 a[42:43], v21 offset:41984
    ds_read_b64_tr_b16 a[44:45], v21 offset:45056
    ds_read_b64_tr_b16 a[46:47], v21 offset:46080
    ds_read_b64_tr_b16 a[48:49], v21 offset:49152
    ds_read_b64_tr_b16 a[50:51], v21 offset:50176
    ds_read_b64_tr_b16 a[52:53], v21 offset:53248
    ds_read_b64_tr_b16 a[54:55], v21 offset:54272
    ds_read_b64_tr_b16 a[56:57], v21 offset:57344
    ds_read_b64_tr_b16 a[58:59], v21 offset:58368
    ds_read_b64_tr_b16 a[60:61], v21 offset:61440
    ds_read_b64_tr_b16 a[62:63], v21 offset:62464
    s_branch QKR_35
QKR_36:
    s_cmp_lg_u32 s30, 1
    s_cbranch_scc1 QKR_37
    ds_read_b64_tr_b16 a[0:1], v21 offset:32768
    ds_read_b64_tr_b16 a[2:3], v21 offset:33792
    ds_read_b64_tr_b16 a[4:5], v21 offset:36864
    ds_read_b64_tr_b16 a[6:7], v21 offset:37888
    ds_read_b64_tr_b16 a[8:9], v21 offset:40960
    ds_read_b64_tr_b16 a[10:11], v21 offset:41984
    ds_read_b64_tr_b16 a[12:13], v21 offset:45056
    ds_read_b64_tr_b16 a[14:15], v21 offset:46080
    ds_read_b64_tr_b16 a[16:17], v21 offset:49152
    ds_read_b64_tr_b16 a[18:19], v21 offset:50176
    ds_read_b64_tr_b16 a[20:21], v21 offset:53248
    ds_read_b64_tr_b16 a[22:23], v21 offset:54272
    ds_read_b64_tr_b16 a[24:25], v21 offset:57344
    ds_read_b64_tr_b16 a[26:27], v21 offset:58368
    ds_read_b64_tr_b16 a[28:29], v21 offset:61440
    ds_read_b64_tr_b16 a[30:31], v21 offset:62464
    s_branch QKR_35
QKR_37:
    s_cmp_lg_u32 s30, 2
    s_cbranch_scc1 QKR_38
    ds_read_b64_tr_b16 a[96:97], v21 offset:32768
    ds_read_b64_tr_b16 a[98:99], v21 offset:33792
    ds_read_b64_tr_b16 a[100:101], v21 offset:36864
    ds_read_b64_tr_b16 a[102:103], v21 offset:37888
    ds_read_b64_tr_b16 a[104:105], v21 offset:40960
    ds_read_b64_tr_b16 a[106:107], v21 offset:41984
    ds_read_b64_tr_b16 a[108:109], v21 offset:45056
    ds_read_b64_tr_b16 a[110:111], v21 offset:46080
    ds_read_b64_tr_b16 a[112:113], v21 offset:49152
    ds_read_b64_tr_b16 a[114:115], v21 offset:50176
    ds_read_b64_tr_b16 a[116:117], v21 offset:53248
    ds_read_b64_tr_b16 a[118:119], v21 offset:54272
    ds_read_b64_tr_b16 a[120:121], v21 offset:57344
    ds_read_b64_tr_b16 a[122:123], v21 offset:58368
    ds_read_b64_tr_b16 a[124:125], v21 offset:61440
    ds_read_b64_tr_b16 a[126:127], v21 offset:62464
    s_branch QKR_35
QKR_38:
    s_cmp_lg_u32 s30, 3
    s_cbranch_scc1 QKR_39
    ds_read_b64_tr_b16 a[64:65], v21 offset:32768
    ds_read_b64_tr_b16 a[66:67], v21 offset:33792
    ds_read_b64_tr_b16 a[68:69], v21 offset:36864
    ds_read_b64_tr_b16 a[70:71], v21 offset:37888
    ds_read_b64_tr_b16 a[72:73], v21 offset:40960
    ds_read_b64_tr_b16 a[74:75], v21 offset:41984
    ds_read_b64_tr_b16 a[76:77], v21 offset:45056
    ds_read_b64_tr_b16 a[78:79], v21 offset:46080
    ds_read_b64_tr_b16 a[80:81], v21 offset:49152
    ds_read_b64_tr_b16 a[82:83], v21 offset:50176
    ds_read_b64_tr_b16 a[84:85], v21 offset:53248
    ds_read_b64_tr_b16 a[86:87], v21 offset:54272
    ds_read_b64_tr_b16 a[88:89], v21 offset:57344
    ds_read_b64_tr_b16 a[90:91], v21 offset:58368
    ds_read_b64_tr_b16 a[92:93], v21 offset:61440
    ds_read_b64_tr_b16 a[94:95], v21 offset:62464
    s_branch QKR_35
QKR_39:
    s_cmp_lg_u32 s30, 4
    s_cbranch_scc1 QKR_40
    ds_read_b64_tr_b16 a[160:161], v21 offset:32768
    ds_read_b64_tr_b16 a[162:163], v21 offset:33792
    ds_read_b64_tr_b16 a[164:165], v21 offset:36864
    ds_read_b64_tr_b16 a[166:167], v21 offset:37888
    ds_read_b64_tr_b16 a[168:169], v21 offset:40960
    ds_read_b64_tr_b16 a[170:171], v21 offset:41984
    ds_read_b64_tr_b16 a[172:173], v21 offset:45056
    ds_read_b64_tr_b16 a[174:175], v21 offset:46080
    ds_read_b64_tr_b16 a[176:177], v21 offset:49152
    ds_read_b64_tr_b16 a[178:179], v21 offset:50176
    ds_read_b64_tr_b16 a[180:181], v21 offset:53248
    ds_read_b64_tr_b16 a[182:183], v21 offset:54272
    ds_read_b64_tr_b16 a[184:185], v21 offset:57344
    ds_read_b64_tr_b16 a[186:187], v21 offset:58368
    ds_read_b64_tr_b16 a[188:189], v21 offset:61440
    ds_read_b64_tr_b16 a[190:191], v21 offset:62464
    s_branch QKR_35
QKR_40:
    s_cmp_lg_u32 s30, 5
    s_cbranch_scc1 QKR_41
    ds_read_b64_tr_b16 a[128:129], v21 offset:32768
    ds_read_b64_tr_b16 a[130:131], v21 offset:33792
    ds_read_b64_tr_b16 a[132:133], v21 offset:36864
    ds_read_b64_tr_b16 a[134:135], v21 offset:37888
    ds_read_b64_tr_b16 a[136:137], v21 offset:40960
    ds_read_b64_tr_b16 a[138:139], v21 offset:41984
    ds_read_b64_tr_b16 a[140:141], v21 offset:45056
    ds_read_b64_tr_b16 a[142:143], v21 offset:46080
    ds_read_b64_tr_b16 a[144:145], v21 offset:49152
    ds_read_b64_tr_b16 a[146:147], v21 offset:50176
    ds_read_b64_tr_b16 a[148:149], v21 offset:53248
    ds_read_b64_tr_b16 a[150:151], v21 offset:54272
    ds_read_b64_tr_b16 a[152:153], v21 offset:57344
    ds_read_b64_tr_b16 a[154:155], v21 offset:58368
    ds_read_b64_tr_b16 a[156:157], v21 offset:61440
    ds_read_b64_tr_b16 a[158:159], v21 offset:62464
    s_branch QKR_35
QKR_41:
    s_cmp_lg_u32 s30, 6
    s_cbranch_scc1 QKR_42
    ds_read_b64_tr_b16 a[224:225], v21 offset:32768
    ds_read_b64_tr_b16 a[226:227], v21 offset:33792
    ds_read_b64_tr_b16 a[228:229], v21 offset:36864
    ds_read_b64_tr_b16 a[230:231], v21 offset:37888
    ds_read_b64_tr_b16 a[232:233], v21 offset:40960
    ds_read_b64_tr_b16 a[234:235], v21 offset:41984
    ds_read_b64_tr_b16 a[236:237], v21 offset:45056
    ds_read_b64_tr_b16 a[238:239], v21 offset:46080
    ds_read_b64_tr_b16 a[240:241], v21 offset:49152
    ds_read_b64_tr_b16 a[242:243], v21 offset:50176
    ds_read_b64_tr_b16 a[244:245], v21 offset:53248
    ds_read_b64_tr_b16 a[246:247], v21 offset:54272
    ds_read_b64_tr_b16 a[248:249], v21 offset:57344
    ds_read_b64_tr_b16 a[250:251], v21 offset:58368
    ds_read_b64_tr_b16 a[252:253], v21 offset:61440
    ds_read_b64_tr_b16 a[254:255], v21 offset:62464
    s_branch QKR_35
QKR_42:
    ds_read_b64_tr_b16 a[192:193], v21 offset:32768
    ds_read_b64_tr_b16 a[194:195], v21 offset:33792
    ds_read_b64_tr_b16 a[196:197], v21 offset:36864
    ds_read_b64_tr_b16 a[198:199], v21 offset:37888
    ds_read_b64_tr_b16 a[200:201], v21 offset:40960
    ds_read_b64_tr_b16 a[202:203], v21 offset:41984
    ds_read_b64_tr_b16 a[204:205], v21 offset:45056
    ds_read_b64_tr_b16 a[206:207], v21 offset:46080
    ds_read_b64_tr_b16 a[208:209], v21 offset:49152
    ds_read_b64_tr_b16 a[210:211], v21 offset:50176
    ds_read_b64_tr_b16 a[212:213], v21 offset:53248
    ds_read_b64_tr_b16 a[214:215], v21 offset:54272
    ds_read_b64_tr_b16 a[216:217], v21 offset:57344
    ds_read_b64_tr_b16 a[218:219], v21 offset:58368
    ds_read_b64_tr_b16 a[220:221], v21 offset:61440
    ds_read_b64_tr_b16 a[222:223], v21 offset:62464
QKR_35:
    s_waitcnt lgkmcnt(0)
    s_barrier
    s_add_u32 s42, s24, 0x200000
    s_addc_u32 s43, s25, 0
    s_add_u32 m0, s26, 32768
    s_nop 0
    global_load_lds_dwordx4 v20, s[42:43]
    s_add_u32 s42, s24, 0x208000
    s_addc_u32 s43, s25, 0
    s_add_u32 m0, s26, 33792
    s_nop 0
    global_load_lds_dwordx4 v20, s[42:43]
    s_add_u32 s42, s24, 0x210000
    s_addc_u32 s43, s25, 0
    s_add_u32 m0, s26, 34816
    s_nop 0
    global_load_lds_dwordx4 v20, s[42:43]
    s_add_u32 s42, s24, 0x218000
    s_addc_u32 s43, s25, 0
    s_add_u32 m0, s26, 35840
    s_nop 0
    global_load_lds_dwordx4 v20, s[42:43]
    s_add_u32 s42, s24, 0x220000
    s_addc_u32 s43, s25, 0
    s_add_u32 m0, s26, 36864
    s_nop 0
    global_load_lds_dwordx4 v20, s[42:43]
    s_add_u32 s42, s24, 0x228000
    s_addc_u32 s43, s25, 0
    s_add_u32 m0, s26, 37888
    s_nop 0
    global_load_lds_dwordx4 v20, s[42:43]
    s_add_u32 s42, s24, 0x230000
    s_addc_u32 s43, s25, 0
    s_add_u32 m0, s26, 38912
    s_nop 0
    global_load_lds_dwordx4 v20, s[42:43]
    s_add_u32 s42, s24, 0x238000
    s_addc_u32 s43, s25, 0
    s_add_u32 m0, s26, 39936
    s_nop 0
    global_load_lds_dwordx4 v20, s[42:43]
    s_waitcnt vmcnt(32)
    s_barrier
    s_cmp_lg_u32 s30, 0
    s_cbranch_scc1 QKR_45
    ds_read_b64_tr_b16 a[64:65], v22 offset:0
    ds_read_b64_tr_b16 a[66:67], v22 offset:1024
    ds_read_b64_tr_b16 a[68:69], v22 offset:4096
    ds_read_b64_tr_b16 a[70:71], v22 offset:5120
    ds_read_b64_tr_b16 a[72:73], v22 offset:8192
    ds_read_b64_tr_b16 a[74:75], v22 offset:9216
    ds_read_b64_tr_b16 a[76:77], v22 offset:12288
    ds_read_b64_tr_b16 a[78:79], v22 offset:13312
    ds_read_b64_tr_b16 a[80:81], v22 offset:16384
    ds_read_b64_tr_b16 a[82:83], v22 offset:17408
    ds_read_b64_tr_b16 a[84:85], v22 offset:20480
    ds_read_b64_tr_b16 a[86:87], v22 offset:21504
    ds_read_b64_tr_b16 a[88:89], v22 offset:24576
    ds_read_b64_tr_b16 a[90:91], v22 offset:25600
    ds_read_b64_tr_b16 a[92:93], v22 offset:28672
    ds_read_b64_tr_b16 a[94:95], v22 offset:29696
    s_branch QKR_44
QKR_45:
    s_cmp_lg_u32 s30, 1
    s_cbranch_scc1 QKR_46
    ds_read_b64_tr_b16 a[32:33], v22 offset:0
    ds_read_b64_tr_b16 a[34:35], v22 offset:1024
    ds_read_b64_tr_b16 a[36:37], v22 offset:4096
    ds_read_b64_tr_b16 a[38:39], v22 offset:5120
    ds_read_b64_tr_b16 a[40:41], v22 offset:8192
    ds_read_b64_tr_b16 a[42:43], v22 offset:9216
    ds_read_b64_tr_b16 a[44:45], v22 offset:12288
    ds_read_b64_tr_b16 a[46:47], v22 offset:13312
    ds_read_b64_tr_b16 a[48:49], v22 offset:16384
    ds_read_b64_tr_b16 a[50:51], v22 offset:17408
    ds_read_b64_tr_b16 a[52:53], v22 offset:20480
    ds_read_b64_tr_b16 a[54:55], v22 offset:21504
    ds_read_b64_tr_b16 a[56:57], v22 offset:24576
    ds_read_b64_tr_b16 a[58:59], v22 offset:25600
    ds_read_b64_tr_b16 a[60:61], v22 offset:28672
    ds_read_b64_tr_b16 a[62:63], v22 offset:29696
    s_branch QKR_44
QKR_46:
    s_cmp_lg_u32 s30, 2
    s_cbranch_scc1 QKR_47
    ds_read_b64_tr_b16 a[0:1], v22 offset:0
    ds_read_b64_tr_b16 a[2:3], v22 offset:1024
    ds_read_b64_tr_b16 a[4:5], v22 offset:4096
    ds_read_b64_tr_b16 a[6:7], v22 offset:5120
    ds_read_b64_tr_b16 a[8:9], v22 offset:8192
    ds_read_b64_tr_b16 a[10:11], v22 offset:9216
    ds_read_b64_tr_b16 a[12:13], v22 offset:12288
    ds_read_b64_tr_b16 a[14:15], v22 offset:13312
    ds_read_b64_tr_b16 a[16:17], v22 offset:16384
    ds_read_b64_tr_b16 a[18:19], v22 offset:17408
    ds_read_b64_tr_b16 a[20:21], v22 offset:20480
    ds_read_b64_tr_b16 a[22:23], v22 offset:21504
    ds_read_b64_tr_b16 a[24:25], v22 offset:24576
    ds_read_b64_tr_b16 a[26:27], v22 offset:25600
    ds_read_b64_tr_b16 a[28:29], v22 offset:28672
    ds_read_b64_tr_b16 a[30:31], v22 offset:29696
    s_branch QKR_44
QKR_47:
    s_cmp_lg_u32 s30, 3
    s_cbranch_scc1 QKR_48
    ds_read_b64_tr_b16 a[96:97], v22 offset:0
    ds_read_b64_tr_b16 a[98:99], v22 offset:1024
    ds_read_b64_tr_b16 a[100:101], v22 offset:4096
    ds_read_b64_tr_b16 a[102:103], v22 offset:5120
    ds_read_b64_tr_b16 a[104:105], v22 offset:8192
    ds_read_b64_tr_b16 a[106:107], v22 offset:9216
    ds_read_b64_tr_b16 a[108:109], v22 offset:12288
    ds_read_b64_tr_b16 a[110:111], v22 offset:13312
    ds_read_b64_tr_b16 a[112:113], v22 offset:16384
    ds_read_b64_tr_b16 a[114:115], v22 offset:17408
    ds_read_b64_tr_b16 a[116:117], v22 offset:20480
    ds_read_b64_tr_b16 a[118:119], v22 offset:21504
    ds_read_b64_tr_b16 a[120:121], v22 offset:24576
    ds_read_b64_tr_b16 a[122:123], v22 offset:25600
    ds_read_b64_tr_b16 a[124:125], v22 offset:28672
    ds_read_b64_tr_b16 a[126:127], v22 offset:29696
    s_branch QKR_44
QKR_48:
    s_cmp_lg_u32 s30, 4
    s_cbranch_scc1 QKR_49
    ds_read_b64_tr_b16 a[192:193], v22 offset:0
    ds_read_b64_tr_b16 a[194:195], v22 offset:1024
    ds_read_b64_tr_b16 a[196:197], v22 offset:4096
    ds_read_b64_tr_b16 a[198:199], v22 offset:5120
    ds_read_b64_tr_b16 a[200:201], v22 offset:8192
    ds_read_b64_tr_b16 a[202:203], v22 offset:9216
    ds_read_b64_tr_b16 a[204:205], v22 offset:12288
    ds_read_b64_tr_b16 a[206:207], v22 offset:13312
    ds_read_b64_tr_b16 a[208:209], v22 offset:16384
    ds_read_b64_tr_b16 a[210:211], v22 offset:17408
    ds_read_b64_tr_b16 a[212:213], v22 offset:20480
    ds_read_b64_tr_b16 a[214:215], v22 offset:21504
    ds_read_b64_tr_b16 a[216:217], v22 offset:24576
    ds_read_b64_tr_b16 a[218:219], v22 offset:25600
    ds_read_b64_tr_b16 a[220:221], v22 offset:28672
    ds_read_b64_tr_b16 a[222:223], v22 offset:29696
    s_branch QKR_44
QKR_49:
    s_cmp_lg_u32 s30, 5
    s_cbranch_scc1 QKR_50
    ds_read_b64_tr_b16 a[160:161], v22 offset:0
    ds_read_b64_tr_b16 a[162:163], v22 offset:1024
    ds_read_b64_tr_b16 a[164:165], v22 offset:4096
    ds_read_b64_tr_b16 a[166:167], v22 offset:5120
    ds_read_b64_tr_b16 a[168:169], v22 offset:8192
    ds_read_b64_tr_b16 a[170:171], v22 offset:9216
    ds_read_b64_tr_b16 a[172:173], v22 offset:12288
    ds_read_b64_tr_b16 a[174:175], v22 offset:13312
    ds_read_b64_tr_b16 a[176:177], v22 offset:16384
    ds_read_b64_tr_b16 a[178:179], v22 offset:17408
    ds_read_b64_tr_b16 a[180:181], v22 offset:20480
    ds_read_b64_tr_b16 a[182:183], v22 offset:21504
    ds_read_b64_tr_b16 a[184:185], v22 offset:24576
    ds_read_b64_tr_b16 a[186:187], v22 offset:25600
    ds_read_b64_tr_b16 a[188:189], v22 offset:28672
    ds_read_b64_tr_b16 a[190:191], v22 offset:29696
    s_branch QKR_44
QKR_50:
    s_cmp_lg_u32 s30, 6
    s_cbranch_scc1 QKR_51
    ds_read_b64_tr_b16 a[128:129], v22 offset:0
    ds_read_b64_tr_b16 a[130:131], v22 offset:1024
    ds_read_b64_tr_b16 a[132:133], v22 offset:4096
    ds_read_b64_tr_b16 a[134:135], v22 offset:5120
    ds_read_b64_tr_b16 a[136:137], v22 offset:8192
    ds_read_b64_tr_b16 a[138:139], v22 offset:9216
    ds_read_b64_tr_b16 a[140:141], v22 offset:12288
    ds_read_b64_tr_b16 a[142:143], v22 offset:13312
    ds_read_b64_tr_b16 a[144:145], v22 offset:16384
    ds_read_b64_tr_b16 a[146:147], v22 offset:17408
    ds_read_b64_tr_b16 a[148:149], v22 offset:20480
    ds_read_b64_tr_b16 a[150:151], v22 offset:21504
    ds_read_b64_tr_b16 a[152:153], v22 offset:24576
    ds_read_b64_tr_b16 a[154:155], v22 offset:25600
    ds_read_b64_tr_b16 a[156:157], v22 offset:28672
    ds_read_b64_tr_b16 a[158:159], v22 offset:29696
    s_branch QKR_44
QKR_51:
    ds_read_b64_tr_b16 a[224:225], v22 offset:0
    ds_read_b64_tr_b16 a[226:227], v22 offset:1024
    ds_read_b64_tr_b16 a[228:229], v22 offset:4096
    ds_read_b64_tr_b16 a[230:231], v22 offset:5120
    ds_read_b64_tr_b16 a[232:233], v22 offset:8192
    ds_read_b64_tr_b16 a[234:235], v22 offset:9216
    ds_read_b64_tr_b16 a[236:237], v22 offset:12288
    ds_read_b64_tr_b16 a[238:239], v22 offset:13312
    ds_read_b64_tr_b16 a[240:241], v22 offset:16384
    ds_read_b64_tr_b16 a[242:243], v22 offset:17408
    ds_read_b64_tr_b16 a[244:245], v22 offset:20480
    ds_read_b64_tr_b16 a[246:247], v22 offset:21504
    ds_read_b64_tr_b16 a[248:249], v22 offset:24576
    ds_read_b64_tr_b16 a[250:251], v22 offset:25600
    ds_read_b64_tr_b16 a[252:253], v22 offset:28672
    ds_read_b64_tr_b16 a[254:255], v22 offset:29696
QKR_44:
    s_waitcnt lgkmcnt(0)
    s_barrier
    s_add_u32 s42, s24, 0x300000
    s_addc_u32 s43, s25, 0
    s_add_u32 m0, s26, 65536
    s_nop 0
    global_load_lds_dwordx4 v20, s[42:43]
    s_add_u32 s42, s24, 0x308000
    s_addc_u32 s43, s25, 0
    s_add_u32 m0, s26, 66560
    s_nop 0
    global_load_lds_dwordx4 v20, s[42:43]
    s_add_u32 s42, s24, 0x310000
    s_addc_u32 s43, s25, 0
    s_add_u32 m0, s26, 67584
    s_nop 0
    global_load_lds_dwordx4 v20, s[42:43]
    s_add_u32 s42, s24, 0x318000
    s_addc_u32 s43, s25, 0
    s_add_u32 m0, s26, 68608
    s_nop 0
    global_load_lds_dwordx4 v20, s[42:43]
    s_add_u32 s42, s24, 0x320000
    s_addc_u32 s43, s25, 0
    s_add_u32 m0, s26, 69632
    s_nop 0
    global_load_lds_dwordx4 v20, s[42:43]
    s_add_u32 s42, s24, 0x328000
    s_addc_u32 s43, s25, 0
    s_add_u32 m0, s26, 70656
    s_nop 0
    global_load_lds_dwordx4 v20, s[42:43]
    s_add_u32 s42, s24, 0x330000
    s_addc_u32 s43, s25, 0
    s_add_u32 m0, s26, 71680
    s_nop 0
    global_load_lds_dwordx4 v20, s[42:43]
    s_add_u32 s42, s24, 0x338000
    s_addc_u32 s43, s25, 0
    s_add_u32 m0, s26, 72704
    s_nop 0
    global_load_lds_dwordx4 v20, s[42:43]
    s_waitcnt vmcnt(32)
    s_barrier
    s_cmp_lg_u32 s30, 0
    s_cbranch_scc1 QKR_54
    ds_read_b64_tr_b16 a[96:97], v22 offset:32768
    ds_read_b64_tr_b16 a[98:99], v22 offset:33792
    ds_read_b64_tr_b16 a[100:101], v22 offset:36864
    ds_read_b64_tr_b16 a[102:103], v22 offset:37888
    ds_read_b64_tr_b16 a[104:105], v22 offset:40960
    ds_read_b64_tr_b16 a[106:107], v22 offset:41984
    ds_read_b64_tr_b16 a[108:109], v22 offset:45056
    ds_read_b64_tr_b16 a[110:111], v22 offset:46080
    ds_read_b64_tr_b16 a[112:113], v22 offset:49152
    ds_read_b64_tr_b16 a[114:115], v22 offset:50176
    ds_read_b64_tr_b16 a[116:117], v22 offset:53248
    ds_read_b64_tr_b16 a[118:119], v22 offset:54272
    ds_read_b64_tr_b16 a[120:121], v22 offset:57344
    ds_read_b64_tr_b16 a[122:123], v22 offset:58368
    ds_read_b64_tr_b16 a[124:125], v22 offset:61440
    ds_read_b64_tr_b16 a[126:127], v22 offset:62464
    s_branch QKR_53
QKR_54:
    s_cmp_lg_u32 s30, 1
    s_cbranch_scc1 QKR_55
    ds_read_b64_tr_b16 a[64:65], v22 offset:32768
    ds_read_b64_tr_b16 a[66:67], v22 offset:33792
    ds_read_b64_tr_b16 a[68:69], v22 offset:36864
    ds_read_b64_tr_b16 a[70:71], v22 offset:37888
    ds_read_b64_tr_b16 a[72:73], v22 offset:40960
    ds_read_b64_tr_b16 a[74:75], v22 offset:41984
    ds_read_b64_tr_b16 a[76:77], v22 offset:45056
    ds_read_b64_tr_b16 a[78:79], v22 offset:46080
    ds_read_b64_tr_b16 a[80:81], v22 offset:49152
    ds_read_b64_tr_b16 a[82:83], v22 offset:50176
    ds_read_b64_tr_b16 a[84:85], v22 offset:53248
    ds_read_b64_tr_b16 a[86:87], v22 offset:54272
    ds_read_b64_tr_b16 a[88:89], v22 offset:57344
    ds_read_b64_tr_b16 a[90:91], v22 offset:58368
    ds_read_b64_tr_b16 a[92:93], v22 offset:61440
    ds_read_b64_tr_b16 a[94:95], v22 offset:62464
    s_branch QKR_53
QKR_55:
    s_cmp_lg_u32 s30, 2
    s_cbranch_scc1 QKR_56
    ds_read_b64_tr_b16 a[32:33], v22 offset:32768
    ds_read_b64_tr_b16 a[34:35], v22 offset:33792
    ds_read_b64_tr_b16 a[36:37], v22 offset:36864
    ds_read_b64_tr_b16 a[38:39], v22 offset:37888
    ds_read_b64_tr_b16 a[40:41], v22 offset:40960
    ds_read_b64_tr_b16 a[42:43], v22 offset:41984
    ds_read_b64_tr_b16 a[44:45], v22 offset:45056
    ds_read_b64_tr_b16 a[46:47], v22 offset:46080
    ds_read_b64_tr_b16 a[48:49], v22 offset:49152
    ds_read_b64_tr_b16 a[50:51], v22 offset:50176
    ds_read_b64_tr_b16 a[52:53], v22 offset:53248
    ds_read_b64_tr_b16 a[54:55], v22 offset:54272
    ds_read_b64_tr_b16 a[56:57], v22 offset:57344
    ds_read_b64_tr_b16 a[58:59], v22 offset:58368
    ds_read_b64_tr_b16 a[60:61], v22 offset:61440
    ds_read_b64_tr_b16 a[62:63], v22 offset:62464
    s_branch QKR_53
QKR_56:
    s_cmp_lg_u32 s30, 3
    s_cbranch_scc1 QKR_57
    ds_read_b64_tr_b16 a[0:1], v22 offset:32768
    ds_read_b64_tr_b16 a[2:3], v22 offset:33792
    ds_read_b64_tr_b16 a[4:5], v22 offset:36864
    ds_read_b64_tr_b16 a[6:7], v22 offset:37888
    ds_read_b64_tr_b16 a[8:9], v22 offset:40960
    ds_read_b64_tr_b16 a[10:11], v22 offset:41984
    ds_read_b64_tr_b16 a[12:13], v22 offset:45056
    ds_read_b64_tr_b16 a[14:15], v22 offset:46080
    ds_read_b64_tr_b16 a[16:17], v22 offset:49152
    ds_read_b64_tr_b16 a[18:19], v22 offset:50176
    ds_read_b64_tr_b16 a[20:21], v22 offset:53248
    ds_read_b64_tr_b16 a[22:23], v22 offset:54272
    ds_read_b64_tr_b16 a[24:25], v22 offset:57344
    ds_read_b64_tr_b16 a[26:27], v22 offset:58368
    ds_read_b64_tr_b16 a[28:29], v22 offset:61440
    ds_read_b64_tr_b16 a[30:31], v22 offset:62464
    s_branch QKR_53
QKR_57:
    s_cmp_lg_u32 s30, 4
    s_cbranch_scc1 QKR_58
    ds_read_b64_tr_b16 a[224:225], v22 offset:32768
    ds_read_b64_tr_b16 a[226:227], v22 offset:33792
    ds_read_b64_tr_b16 a[228:229], v22 offset:36864
    ds_read_b64_tr_b16 a[230:231], v22 offset:37888
    ds_read_b64_tr_b16 a[232:233], v22 offset:40960
    ds_read_b64_tr_b16 a[234:235], v22 offset:41984
    ds_read_b64_tr_b16 a[236:237], v22 offset:45056
    ds_read_b64_tr_b16 a[238:239], v22 offset:46080
    ds_read_b64_tr_b16 a[240:241], v22 offset:49152
    ds_read_b64_tr_b16 a[242:243], v22 offset:50176
    ds_read_b64_tr_b16 a[244:245], v22 offset:53248
    ds_read_b64_tr_b16 a[246:247], v22 offset:54272
    ds_read_b64_tr_b16 a[248:249], v22 offset:57344
    ds_read_b64_tr_b16 a[250:251], v22 offset:58368
    ds_read_b64_tr_b16 a[252:253], v22 offset:61440
    ds_read_b64_tr_b16 a[254:255], v22 offset:62464
    s_branch QKR_53
QKR_58:
    s_cmp_lg_u32 s30, 5
    s_cbranch_scc1 QKR_59
    ds_read_b64_tr_b16 a[192:193], v22 offset:32768
    ds_read_b64_tr_b16 a[194:195], v22 offset:33792
    ds_read_b64_tr_b16 a[196:197], v22 offset:36864
    ds_read_b64_tr_b16 a[198:199], v22 offset:37888
    ds_read_b64_tr_b16 a[200:201], v22 offset:40960
    ds_read_b64_tr_b16 a[202:203], v22 offset:41984
    ds_read_b64_tr_b16 a[204:205], v22 offset:45056
    ds_read_b64_tr_b16 a[206:207], v22 offset:46080
    ds_read_b64_tr_b16 a[208:209], v22 offset:49152
    ds_read_b64_tr_b16 a[210:211], v22 offset:50176
    ds_read_b64_tr_b16 a[212:213], v22 offset:53248
    ds_read_b64_tr_b16 a[214:215], v22 offset:54272
    ds_read_b64_tr_b16 a[216:217], v22 offset:57344
    ds_read_b64_tr_b16 a[218:219], v22 offset:58368
    ds_read_b64_tr_b16 a[220:221], v22 offset:61440
    ds_read_b64_tr_b16 a[222:223], v22 offset:62464
    s_branch QKR_53
QKR_59:
    s_cmp_lg_u32 s30, 6
    s_cbranch_scc1 QKR_60
    ds_read_b64_tr_b16 a[160:161], v22 offset:32768
    ds_read_b64_tr_b16 a[162:163], v22 offset:33792
    ds_read_b64_tr_b16 a[164:165], v22 offset:36864
    ds_read_b64_tr_b16 a[166:167], v22 offset:37888
    ds_read_b64_tr_b16 a[168:169], v22 offset:40960
    ds_read_b64_tr_b16 a[170:171], v22 offset:41984
    ds_read_b64_tr_b16 a[172:173], v22 offset:45056
    ds_read_b64_tr_b16 a[174:175], v22 offset:46080
    ds_read_b64_tr_b16 a[176:177], v22 offset:49152
    ds_read_b64_tr_b16 a[178:179], v22 offset:50176
    ds_read_b64_tr_b16 a[180:181], v22 offset:53248
    ds_read_b64_tr_b16 a[182:183], v22 offset:54272
    ds_read_b64_tr_b16 a[184:185], v22 offset:57344
    ds_read_b64_tr_b16 a[186:187], v22 offset:58368
    ds_read_b64_tr_b16 a[188:189], v22 offset:61440
    ds_read_b64_tr_b16 a[190:191], v22 offset:62464
    s_branch QKR_53
QKR_60:
    ds_read_b64_tr_b16 a[128:129], v22 offset:32768
    ds_read_b64_tr_b16 a[130:131], v22 offset:33792
    ds_read_b64_tr_b16 a[132:133], v22 offset:36864
    ds_read_b64_tr_b16 a[134:135], v22 offset:37888
    ds_read_b64_tr_b16 a[136:137], v22 offset:40960
    ds_read_b64_tr_b16 a[138:139], v22 offset:41984
    ds_read_b64_tr_b16 a[140:141], v22 offset:45056
    ds_read_b64_tr_b16 a[142:143], v22 offset:46080
    ds_read_b64_tr_b16 a[144:145], v22 offset:49152
    ds_read_b64_tr_b16 a[146:147], v22 offset:50176
    ds_read_b64_tr_b16 a[148:149], v22 offset:53248
    ds_read_b64_tr_b16 a[150:151], v22 offset:54272
    ds_read_b64_tr_b16 a[152:153], v22 offset:57344
    ds_read_b64_tr_b16 a[154:155], v22 offset:58368
    ds_read_b64_tr_b16 a[156:157], v22 offset:61440
    ds_read_b64_tr_b16 a[158:159], v22 offset:62464
QKR_53:
    s_waitcnt lgkmcnt(0)
    s_barrier
    s_add_u32 s42, s20, 0x0
    s_addc_u32 s43, s21, 0
    s_add_u32 m0, s26, 98304
    s_nop 0
    global_load_lds_dwordx4 v20, s[42:43]
    s_add_u32 s42, s20, 0x8000
    s_addc_u32 s43, s21, 0
    s_add_u32 m0, s26, 99328
    s_nop 0
    global_load_lds_dwordx4 v20, s[42:43]
    s_add_u32 s42, s20, 0x10000
    s_addc_u32 s43, s21, 0
    s_add_u32 m0, s26, 100352
    s_nop 0
    global_load_lds_dwordx4 v20, s[42:43]
    s_add_u32 s42, s20, 0x18000
    s_addc_u32 s43, s21, 0
    s_add_u32 m0, s26, 101376
    s_nop 0
    global_load_lds_dwordx4 v20, s[42:43]
    s_add_u32 s42, s20, 0x20000
    s_addc_u32 s43, s21, 0
    s_add_u32 m0, s26, 102400
    s_nop 0
    global_load_lds_dwordx4 v20, s[42:43]
    s_add_u32 s42, s20, 0x28000
    s_addc_u32 s43, s21, 0
    s_add_u32 m0, s26, 103424
    s_nop 0
    global_load_lds_dwordx4 v20, s[42:43]
    s_add_u32 s42, s20, 0x30000
    s_addc_u32 s43, s21, 0
    s_add_u32 m0, s26, 104448
    s_nop 0
    global_load_lds_dwordx4 v20, s[42:43]
    s_add_u32 s42, s20, 0x38000
    s_addc_u32 s43, s21, 0
    s_add_u32 m0, s26, 105472
    s_nop 0
    global_load_lds_dwordx4 v20, s[42:43]
    s_waitcnt vmcnt(32)
    s_barrier
    s_cmp_lg_u32 s30, 0
    s_cbranch_scc1 QKR_63
    ds_read_b64_tr_b16 a[128:129], v23 offset:0
    ds_read_b64_tr_b16 a[130:131], v23 offset:1024
    ds_read_b64_tr_b16 a[132:133], v23 offset:4096
    ds_read_b64_tr_b16 a[134:135], v23 offset:5120
    ds_read_b64_tr_b16 a[136:137], v23 offset:8192
    ds_read_b64_tr_b16 a[138:139], v23 offset:9216
    ds_read_b64_tr_b16 a[140:141], v23 offset:12288
    ds_read_b64_tr_b16 a[142:143], v23 offset:13312
    ds_read_b64_tr_b16 a[144:145], v23 offset:16384
    ds_read_b64_tr_b16 a[146:147], v23 offset:17408
    ds_read_b64_tr_b16 a[148:149], v23 offset:20480
    ds_read_b64_tr_b16 a[150:151], v23 offset:21504
    ds_read_b64_tr_b16 a[152:153], v23 offset:24576
    ds_read_b64_tr_b16 a[154:155], v23 offset:25600
    ds_read_b64_tr_b16 a[156:157], v23 offset:28672
    ds_read_b64_tr_b16 a[158:159], v23 offset:29696
    s_branch QKR_62
QKR_63:
    s_cmp_lg_u32 s30, 1
    s_cbranch_scc1 QKR_64
    ds_read_b64_tr_b16 a[224:225], v23 offset:0
    ds_read_b64_tr_b16 a[226:227], v23 offset:1024
    ds_read_b64_tr_b16 a[228:229], v23 offset:4096
    ds_read_b64_tr_b16 a[230:231], v23 offset:5120
    ds_read_b64_tr_b16 a[232:233], v23 offset:8192
    ds_read_b64_tr_b16 a[234:235], v23 offset:9216
    ds_read_b64_tr_b16 a[236:237], v23 offset:12288
    ds_read_b64_tr_b16 a[238:239], v23 offset:13312
    ds_read_b64_tr_b16 a[240:241], v23 offset:16384
    ds_read_b64_tr_b16 a[242:243], v23 offset:17408
    ds_read_b64_tr_b16 a[244:245], v23 offset:20480
    ds_read_b64_tr_b16 a[246:247], v23 offset:21504
    ds_read_b64_tr_b16 a[248:249], v23 offset:24576
    ds_read_b64_tr_b16 a[250:251], v23 offset:25600
    ds_read_b64_tr_b16 a[252:253], v23 offset:28672
    ds_read_b64_tr_b16 a[254:255], v23 offset:29696
    s_branch QKR_62
QKR_64:
    s_cmp_lg_u32 s30, 2
    s_cbranch_scc1 QKR_65
    ds_read_b64_tr_b16 a[192:193], v23 offset:0
    ds_read_b64_tr_b16 a[194:195], v23 offset:1024
    ds_read_b64_tr_b16 a[196:197], v23 offset:4096
    ds_read_b64_tr_b16 a[198:199], v23 offset:5120
    ds_read_b64_tr_b16 a[200:201], v23 offset:8192
    ds_read_b64_tr_b16 a[202:203], v23 offset:9216
    ds_read_b64_tr_b16 a[204:205], v23 offset:12288
    ds_read_b64_tr_b16 a[206:207], v23 offset:13312
    ds_read_b64_tr_b16 a[208:209], v23 offset:16384
    ds_read_b64_tr_b16 a[210:211], v23 offset:17408
    ds_read_b64_tr_b16 a[212:213], v23 offset:20480
    ds_read_b64_tr_b16 a[214:215], v23 offset:21504
    ds_read_b64_tr_b16 a[216:217], v23 offset:24576
    ds_read_b64_tr_b16 a[218:219], v23 offset:25600
    ds_read_b64_tr_b16 a[220:221], v23 offset:28672
    ds_read_b64_tr_b16 a[222:223], v23 offset:29696
    s_branch QKR_62
QKR_65:
    s_cmp_lg_u32 s30, 3
    s_cbranch_scc1 QKR_66
    ds_read_b64_tr_b16 a[160:161], v23 offset:0
    ds_read_b64_tr_b16 a[162:163], v23 offset:1024
    ds_read_b64_tr_b16 a[164:165], v23 offset:4096
    ds_read_b64_tr_b16 a[166:167], v23 offset:5120
    ds_read_b64_tr_b16 a[168:169], v23 offset:8192
    ds_read_b64_tr_b16 a[170:171], v23 offset:9216
    ds_read_b64_tr_b16 a[172:173], v23 offset:12288
    ds_read_b64_tr_b16 a[174:175], v23 offset:13312
    ds_read_b64_tr_b16 a[176:177], v23 offset:16384
    ds_read_b64_tr_b16 a[178:179], v23 offset:17408
    ds_read_b64_tr_b16 a[180:181], v23 offset:20480
    ds_read_b64_tr_b16 a[182:183], v23 offset:21504
    ds_read_b64_tr_b16 a[184:185], v23 offset:24576
    ds_read_b64_tr_b16 a[186:187], v23 offset:25600
    ds_read_b64_tr_b16 a[188:189], v23 offset:28672
    ds_read_b64_tr_b16 a[190:191], v23 offset:29696
    s_branch QKR_62
QKR_66:
    s_cmp_lg_u32 s30, 4
    s_cbranch_scc1 QKR_67
    ds_read_b64_tr_b16 a[0:1], v23 offset:0
    ds_read_b64_tr_b16 a[2:3], v23 offset:1024
    ds_read_b64_tr_b16 a[4:5], v23 offset:4096
    ds_read_b64_tr_b16 a[6:7], v23 offset:5120
    ds_read_b64_tr_b16 a[8:9], v23 offset:8192
    ds_read_b64_tr_b16 a[10:11], v23 offset:9216
    ds_read_b64_tr_b16 a[12:13], v23 offset:12288
    ds_read_b64_tr_b16 a[14:15], v23 offset:13312
    ds_read_b64_tr_b16 a[16:17], v23 offset:16384
    ds_read_b64_tr_b16 a[18:19], v23 offset:17408
    ds_read_b64_tr_b16 a[20:21], v23 offset:20480
    ds_read_b64_tr_b16 a[22:23], v23 offset:21504
    ds_read_b64_tr_b16 a[24:25], v23 offset:24576
    ds_read_b64_tr_b16 a[26:27], v23 offset:25600
    ds_read_b64_tr_b16 a[28:29], v23 offset:28672
    ds_read_b64_tr_b16 a[30:31], v23 offset:29696
    s_branch QKR_62
QKR_67:
    s_cmp_lg_u32 s30, 5
    s_cbranch_scc1 QKR_68
    ds_read_b64_tr_b16 a[96:97], v23 offset:0
    ds_read_b64_tr_b16 a[98:99], v23 offset:1024
    ds_read_b64_tr_b16 a[100:101], v23 offset:4096
    ds_read_b64_tr_b16 a[102:103], v23 offset:5120
    ds_read_b64_tr_b16 a[104:105], v23 offset:8192
    ds_read_b64_tr_b16 a[106:107], v23 offset:9216
    ds_read_b64_tr_b16 a[108:109], v23 offset:12288
    ds_read_b64_tr_b16 a[110:111], v23 offset:13312
    ds_read_b64_tr_b16 a[112:113], v23 offset:16384
    ds_read_b64_tr_b16 a[114:115], v23 offset:17408
    ds_read_b64_tr_b16 a[116:117], v23 offset:20480
    ds_read_b64_tr_b16 a[118:119], v23 offset:21504
    ds_read_b64_tr_b16 a[120:121], v23 offset:24576
    ds_read_b64_tr_b16 a[122:123], v23 offset:25600
    ds_read_b64_tr_b16 a[124:125], v23 offset:28672
    ds_read_b64_tr_b16 a[126:127], v23 offset:29696
    s_branch QKR_62
QKR_68:
    s_cmp_lg_u32 s30, 6
    s_cbranch_scc1 QKR_69
    ds_read_b64_tr_b16 a[64:65], v23 offset:0
    ds_read_b64_tr_b16 a[66:67], v23 offset:1024
    ds_read_b64_tr_b16 a[68:69], v23 offset:4096
    ds_read_b64_tr_b16 a[70:71], v23 offset:5120
    ds_read_b64_tr_b16 a[72:73], v23 offset:8192
    ds_read_b64_tr_b16 a[74:75], v23 offset:9216
    ds_read_b64_tr_b16 a[76:77], v23 offset:12288
    ds_read_b64_tr_b16 a[78:79], v23 offset:13312
    ds_read_b64_tr_b16 a[80:81], v23 offset:16384
    ds_read_b64_tr_b16 a[82:83], v23 offset:17408
    ds_read_b64_tr_b16 a[84:85], v23 offset:20480
    ds_read_b64_tr_b16 a[86:87], v23 offset:21504
    ds_read_b64_tr_b16 a[88:89], v23 offset:24576
    ds_read_b64_tr_b16 a[90:91], v23 offset:25600
    ds_read_b64_tr_b16 a[92:93], v23 offset:28672
    ds_read_b64_tr_b16 a[94:95], v23 offset:29696
    s_branch QKR_62
QKR_69:
    ds_read_b64_tr_b16 a[32:33], v23 offset:0
    ds_read_b64_tr_b16 a[34:35], v23 offset:1024
    ds_read_b64_tr_b16 a[36:37], v23 offset:4096
    ds_read_b64_tr_b16 a[38:39], v23 offset:5120
    ds_read_b64_tr_b16 a[40:41], v23 offset:8192
    ds_read_b64_tr_b16 a[42:43], v23 offset:9216
    ds_read_b64_tr_b16 a[44:45], v23 offset:12288
    ds_read_b64_tr_b16 a[46:47], v23 offset:13312
    ds_read_b64_tr_b16 a[48:49], v23 offset:16384
    ds_read_b64_tr_b16 a[50:51], v23 offset:17408
    ds_read_b64_tr_b16 a[52:53], v23 offset:20480
    ds_read_b64_tr_b16 a[54:55], v23 offset:21504
    ds_read_b64_tr_b16 a[56:57], v23 offset:24576
    ds_read_b64_tr_b16 a[58:59], v23 offset:25600
    ds_read_b64_tr_b16 a[60:61], v23 offset:28672
    ds_read_b64_tr_b16 a[62:63], v23 offset:29696
QKR_62:
    s_waitcnt lgkmcnt(0)
    s_barrier
    s_add_u32 s42, s20, 0x100000
    s_addc_u32 s43, s21, 0
    s_add_u32 m0, s26, 131072
    s_nop 0
    global_load_lds_dwordx4 v20, s[42:43]
    s_add_u32 s42, s20, 0x108000
    s_addc_u32 s43, s21, 0
    s_add_u32 m0, s26, 132096
    s_nop 0
    global_load_lds_dwordx4 v20, s[42:43]
    s_add_u32 s42, s20, 0x110000
    s_addc_u32 s43, s21, 0
    s_add_u32 m0, s26, 133120
    s_nop 0
    global_load_lds_dwordx4 v20, s[42:43]
    s_add_u32 s42, s20, 0x118000
    s_addc_u32 s43, s21, 0
    s_add_u32 m0, s26, 134144
    s_nop 0
    global_load_lds_dwordx4 v20, s[42:43]
    s_add_u32 s42, s20, 0x120000
    s_addc_u32 s43, s21, 0
    s_add_u32 m0, s26, 135168
    s_nop 0
    global_load_lds_dwordx4 v20, s[42:43]
    s_add_u32 s42, s20, 0x128000
    s_addc_u32 s43, s21, 0
    s_add_u32 m0, s26, 136192
    s_nop 0
    global_load_lds_dwordx4 v20, s[42:43]
    s_add_u32 s42, s20, 0x130000
    s_addc_u32 s43, s21, 0
    s_add_u32 m0, s26, 137216
    s_nop 0
    global_load_lds_dwordx4 v20, s[42:43]
    s_add_u32 s42, s20, 0x138000
    s_addc_u32 s43, s21, 0
    s_add_u32 m0, s26, 138240
    s_nop 0
    global_load_lds_dwordx4 v20, s[42:43]
    global_load_dword v12, v13, s[4:5] sc1
    global_load_dwordx2 v[48:49], v50, s[4:5] sc1
    s_waitcnt vmcnt(34)
    s_barrier
    s_cmp_lg_u32 s30, 0
    s_cbranch_scc1 QKR_72
    ds_read_b64_tr_b16 a[160:161], v21 offset:0
    ds_read_b64_tr_b16 a[162:163], v21 offset:1024
    ds_read_b64_tr_b16 a[164:165], v21 offset:4096
    ds_read_b64_tr_b16 a[166:167], v21 offset:5120
    ds_read_b64_tr_b16 a[168:169], v21 offset:8192
    ds_read_b64_tr_b16 a[170:171], v21 offset:9216
    ds_read_b64_tr_b16 a[172:173], v21 offset:12288
    ds_read_b64_tr_b16 a[174:175], v21 offset:13312
    ds_read_b64_tr_b16 a[176:177], v21 offset:16384
    ds_read_b64_tr_b16 a[178:179], v21 offset:17408
    ds_read_b64_tr_b16 a[180:181], v21 offset:20480
    ds_read_b64_tr_b16 a[182:183], v21 offset:21504
    ds_read_b64_tr_b16 a[184:185], v21 offset:24576
    ds_read_b64_tr_b16 a[186:187], v21 offset:25600
    ds_read_b64_tr_b16 a[188:189], v21 offset:28672
    ds_read_b64_tr_b16 a[190:191], v21 offset:29696
    s_branch QKR_71
QKR_72:
    s_cmp_lg_u32 s30, 1
    s_cbranch_scc1 QKR_73
    ds_read_b64_tr_b16 a[128:129], v21 offset:0
    ds_read_b64_tr_b16 a[130:131], v21 offset:1024
    ds_read_b64_tr_b16 a[132:133], v21 offset:4096
    ds_read_b64_tr_b16 a[134:135], v21 offset:5120
    ds_read_b64_tr_b16 a[136:137], v21 offset:8192
    ds_read_b64_tr_b16 a[138:139], v21 offset:9216
    ds_read_b64_tr_b16 a[140:141], v21 offset:12288
    ds_read_b64_tr_b16 a[142:143], v21 offset:13312
    ds_read_b64_tr_b16 a[144:145], v21 offset:16384
    ds_read_b64_tr_b16 a[146:147], v21 offset:17408
    ds_read_b64_tr_b16 a[148:149], v21 offset:20480
    ds_read_b64_tr_b16 a[150:151], v21 offset:21504
    ds_read_b64_tr_b16 a[152:153], v21 offset:24576
    ds_read_b64_tr_b16 a[154:155], v21 offset:25600
    ds_read_b64_tr_b16 a[156:157], v21 offset:28672
    ds_read_b64_tr_b16 a[158:159], v21 offset:29696
    s_branch QKR_71
QKR_73:
    s_cmp_lg_u32 s30, 2
    s_cbranch_scc1 QKR_74
    ds_read_b64_tr_b16 a[224:225], v21 offset:0
    ds_read_b64_tr_b16 a[226:227], v21 offset:1024
    ds_read_b64_tr_b16 a[228:229], v21 offset:4096
    ds_read_b64_tr_b16 a[230:231], v21 offset:5120
    ds_read_b64_tr_b16 a[232:233], v21 offset:8192
    ds_read_b64_tr_b16 a[234:235], v21 offset:9216
    ds_read_b64_tr_b16 a[236:237], v21 offset:12288
    ds_read_b64_tr_b16 a[238:239], v21 offset:13312
    ds_read_b64_tr_b16 a[240:241], v21 offset:16384
    ds_read_b64_tr_b16 a[242:243], v21 offset:17408
    ds_read_b64_tr_b16 a[244:245], v21 offset:20480
    ds_read_b64_tr_b16 a[246:247], v21 offset:21504
    ds_read_b64_tr_b16 a[248:249], v21 offset:24576
    ds_read_b64_tr_b16 a[250:251], v21 offset:25600
    ds_read_b64_tr_b16 a[252:253], v21 offset:28672
    ds_read_b64_tr_b16 a[254:255], v21 offset:29696
    s_branch QKR_71
QKR_74:
    s_cmp_lg_u32 s30, 3
    s_cbranch_scc1 QKR_75
    ds_read_b64_tr_b16 a[192:193], v21 offset:0
    ds_read_b64_tr_b16 a[194:195], v21 offset:1024
    ds_read_b64_tr_b16 a[196:197], v21 offset:4096
    ds_read_b64_tr_b16 a[198:199], v21 offset:5120
    ds_read_b64_tr_b16 a[200:201], v21 offset:8192
    ds_read_b64_tr_b16 a[202:203], v21 offset:9216
    ds_read_b64_tr_b16 a[204:205], v21 offset:12288
    ds_read_b64_tr_b16 a[206:207], v21 offset:13312
    ds_read_b64_tr_b16 a[208:209], v21 offset:16384
    ds_read_b64_tr_b16 a[210:211], v21 offset:17408
    ds_read_b64_tr_b16 a[212:213], v21 offset:20480
    ds_read_b64_tr_b16 a[214:215], v21 offset:21504
    ds_read_b64_tr_b16 a[216:217], v21 offset:24576
    ds_read_b64_tr_b16 a[218:219], v21 offset:25600
    ds_read_b64_tr_b16 a[220:221], v21 offset:28672
    ds_read_b64_tr_b16 a[222:223], v21 offset:29696
    s_branch QKR_71
QKR_75:
    s_cmp_lg_u32 s30, 4
    s_cbranch_scc1 QKR_76
    ds_read_b64_tr_b16 a[32:33], v21 offset:0
    ds_read_b64_tr_b16 a[34:35], v21 offset:1024
    ds_read_b64_tr_b16 a[36:37], v21 offset:4096
    ds_read_b64_tr_b16 a[38:39], v21 offset:5120
    ds_read_b64_tr_b16 a[40:41], v21 offset:8192
    ds_read_b64_tr_b16 a[42:43], v21 offset:9216
    ds_read_b64_tr_b16 a[44:45], v21 offset:12288
    ds_read_b64_tr_b16 a[46:47], v21 offset:13312
    ds_read_b64_tr_b16 a[48:49], v21 offset:16384
    ds_read_b64_tr_b16 a[50:51], v21 offset:17408
    ds_read_b64_tr_b16 a[52:53], v21 offset:20480
    ds_read_b64_tr_b16 a[54:55], v21 offset:21504
    ds_read_b64_tr_b16 a[56:57], v21 offset:24576
    ds_read_b64_tr_b16 a[58:59], v21 offset:25600
    ds_read_b64_tr_b16 a[60:61], v21 offset:28672
    ds_read_b64_tr_b16 a[62:63], v21 offset:29696
    s_branch QKR_71
QKR_76:
    s_cmp_lg_u32 s30, 5
    s_cbranch_scc1 QKR_77
    ds_read_b64_tr_b16 a[0:1], v21 offset:0
    ds_read_b64_tr_b16 a[2:3], v21 offset:1024
    ds_read_b64_tr_b16 a[4:5], v21 offset:4096
    ds_read_b64_tr_b16 a[6:7], v21 offset:5120
    ds_read_b64_tr_b16 a[8:9], v21 offset:8192
    ds_read_b64_tr_b16 a[10:11], v21 offset:9216
    ds_read_b64_tr_b16 a[12:13], v21 offset:12288
    ds_read_b64_tr_b16 a[14:15], v21 offset:13312
    ds_read_b64_tr_b16 a[16:17], v21 offset:16384
    ds_read_b64_tr_b16 a[18:19], v21 offset:17408
    ds_read_b64_tr_b16 a[20:21], v21 offset:20480
    ds_read_b64_tr_b16 a[22:23], v21 offset:21504
    ds_read_b64_tr_b16 a[24:25], v21 offset:24576
    ds_read_b64_tr_b16 a[26:27], v21 offset:25600
    ds_read_b64_tr_b16 a[28:29], v21 offset:28672
    ds_read_b64_tr_b16 a[30:31], v21 offset:29696
    s_branch QKR_71
QKR_77:
    s_cmp_lg_u32 s30, 6
    s_cbranch_scc1 QKR_78
    ds_read_b64_tr_b16 a[96:97], v21 offset:0
    ds_read_b64_tr_b16 a[98:99], v21 offset:1024
    ds_read_b64_tr_b16 a[100:101], v21 offset:4096
    ds_read_b64_tr_b16 a[102:103], v21 offset:5120
    ds_read_b64_tr_b16 a[104:105], v21 offset:8192
    ds_read_b64_tr_b16 a[106:107], v21 offset:9216
    ds_read_b64_tr_b16 a[108:109], v21 offset:12288
    ds_read_b64_tr_b16 a[110:111], v21 offset:13312
    ds_read_b64_tr_b16 a[112:113], v21 offset:16384
    ds_read_b64_tr_b16 a[114:115], v21 offset:17408
    ds_read_b64_tr_b16 a[116:117], v21 offset:20480
    ds_read_b64_tr_b16 a[118:119], v21 offset:21504
    ds_read_b64_tr_b16 a[120:121], v21 offset:24576
    ds_read_b64_tr_b16 a[122:123], v21 offset:25600
    ds_read_b64_tr_b16 a[124:125], v21 offset:28672
    ds_read_b64_tr_b16 a[126:127], v21 offset:29696
    s_branch QKR_71
QKR_78:
    ds_read_b64_tr_b16 a[64:65], v21 offset:0
    ds_read_b64_tr_b16 a[66:67], v21 offset:1024
    ds_read_b64_tr_b16 a[68:69], v21 offset:4096
    ds_read_b64_tr_b16 a[70:71], v21 offset:5120
    ds_read_b64_tr_b16 a[72:73], v21 offset:8192
    ds_read_b64_tr_b16 a[74:75], v21 offset:9216
    ds_read_b64_tr_b16 a[76:77], v21 offset:12288
    ds_read_b64_tr_b16 a[78:79], v21 offset:13312
    ds_read_b64_tr_b16 a[80:81], v21 offset:16384
    ds_read_b64_tr_b16 a[82:83], v21 offset:17408
    ds_read_b64_tr_b16 a[84:85], v21 offset:20480
    ds_read_b64_tr_b16 a[86:87], v21 offset:21504
    ds_read_b64_tr_b16 a[88:89], v21 offset:24576
    ds_read_b64_tr_b16 a[90:91], v21 offset:25600
    ds_read_b64_tr_b16 a[92:93], v21 offset:28672
    ds_read_b64_tr_b16 a[94:95], v21 offset:29696
QKR_71:
    s_waitcnt lgkmcnt(0)
    s_barrier
    s_add_u32 s42, s20, 0x200000
    s_addc_u32 s43, s21, 0
    s_add_u32 m0, s26, 0
    s_nop 0
    global_load_lds_dwordx4 v20, s[42:43]
    s_add_u32 s42, s20, 0x208000
    s_addc_u32 s43, s21, 0
    s_add_u32 m0, s26, 1024
    s_nop 0
    global_load_lds_dwordx4 v20, s[42:43]
    s_add_u32 s42, s20, 0x210000
    s_addc_u32 s43, s21, 0
    s_add_u32 m0, s26, 2048
    s_nop 0
    global_load_lds_dwordx4 v20, s[42:43]
    s_add_u32 s42, s20, 0x218000
    s_addc_u32 s43, s21, 0
    s_add_u32 m0, s26, 3072
    s_nop 0
    global_load_lds_dwordx4 v20, s[42:43]
    s_add_u32 s42, s20, 0x220000
    s_addc_u32 s43, s21, 0
    s_add_u32 m0, s26, 4096
    s_nop 0
    global_load_lds_dwordx4 v20, s[42:43]
    s_add_u32 s42, s20, 0x228000
    s_addc_u32 s43, s21, 0
    s_add_u32 m0, s26, 5120
    s_nop 0
    global_load_lds_dwordx4 v20, s[42:43]
    s_add_u32 s42, s20, 0x230000
    s_addc_u32 s43, s21, 0
    s_add_u32 m0, s26, 6144
    s_nop 0
    global_load_lds_dwordx4 v20, s[42:43]
    s_add_u32 s42, s20, 0x238000
    s_addc_u32 s43, s21, 0
    s_add_u32 m0, s26, 7168
    s_nop 0
    global_load_lds_dwordx4 v20, s[42:43]
    s_waitcnt vmcnt(34)
    s_barrier
    s_cmp_lg_u32 s30, 0
    s_cbranch_scc1 QKR_81
    ds_read_b64_tr_b16 a[192:193], v21 offset:32768
    ds_read_b64_tr_b16 a[194:195], v21 offset:33792
    ds_read_b64_tr_b16 a[196:197], v21 offset:36864
    ds_read_b64_tr_b16 a[198:199], v21 offset:37888
    ds_read_b64_tr_b16 a[200:201], v21 offset:40960
    ds_read_b64_tr_b16 a[202:203], v21 offset:41984
    ds_read_b64_tr_b16 a[204:205], v21 offset:45056
    ds_read_b64_tr_b16 a[206:207], v21 offset:46080
    ds_read_b64_tr_b16 a[208:209], v21 offset:49152
    ds_read_b64_tr_b16 a[210:211], v21 offset:50176
    ds_read_b64_tr_b16 a[212:213], v21 offset:53248
    ds_read_b64_tr_b16 a[214:215], v21 offset:54272
    ds_read_b64_tr_b16 a[216:217], v21 offset:57344
    ds_read_b64_tr_b16 a[218:219], v21 offset:58368
    ds_read_b64_tr_b16 a[220:221], v21 offset:61440
    ds_read_b64_tr_b16 a[222:223], v21 offset:62464
    s_branch QKR_80
QKR_81:
    s_cmp_lg_u32 s30, 1
    s_cbranch_scc1 QKR_82
    ds_read_b64_tr_b16 a[160:161], v21 offset:32768
    ds_read_b64_tr_b16 a[162:163], v21 offset:33792
    ds_read_b64_tr_b16 a[164:165], v21 offset:36864
    ds_read_b64_tr_b16 a[166:167], v21 offset:37888
    ds_read_b64_tr_b16 a[168:169], v21 offset:40960
    ds_read_b64_tr_b16 a[170:171], v21 offset:41984
    ds_read_b64_tr_b16 a[172:173], v21 offset:45056
    ds_read_b64_tr_b16 a[174:175], v21 offset:46080
    ds_read_b64_tr_b16 a[176:177], v21 offset:49152
    ds_read_b64_tr_b16 a[178:179], v21 offset:50176
    ds_read_b64_tr_b16 a[180:181], v21 offset:53248
    ds_read_b64_tr_b16 a[182:183], v21 offset:54272
    ds_read_b64_tr_b16 a[184:185], v21 offset:57344
    ds_read_b64_tr_b16 a[186:187], v21 offset:58368
    ds_read_b64_tr_b16 a[188:189], v21 offset:61440
    ds_read_b64_tr_b16 a[190:191], v21 offset:62464
    s_branch QKR_80
QKR_82:
    s_cmp_lg_u32 s30, 2
    s_cbranch_scc1 QKR_83
    ds_read_b64_tr_b16 a[128:129], v21 offset:32768
    ds_read_b64_tr_b16 a[130:131], v21 offset:33792
    ds_read_b64_tr_b16 a[132:133], v21 offset:36864
    ds_read_b64_tr_b16 a[134:135], v21 offset:37888
    ds_read_b64_tr_b16 a[136:137], v21 offset:40960
    ds_read_b64_tr_b16 a[138:139], v21 offset:41984
    ds_read_b64_tr_b16 a[140:141], v21 offset:45056
    ds_read_b64_tr_b16 a[142:143], v21 offset:46080
    ds_read_b64_tr_b16 a[144:145], v21 offset:49152
    ds_read_b64_tr_b16 a[146:147], v21 offset:50176
    ds_read_b64_tr_b16 a[148:149], v21 offset:53248
    ds_read_b64_tr_b16 a[150:151], v21 offset:54272
    ds_read_b64_tr_b16 a[152:153], v21 offset:57344
    ds_read_b64_tr_b16 a[154:155], v21 offset:58368
    ds_read_b64_tr_b16 a[156:157], v21 offset:61440
    ds_read_b64_tr_b16 a[158:159], v21 offset:62464
    s_branch QKR_80
QKR_83:
    s_cmp_lg_u32 s30, 3
    s_cbranch_scc1 QKR_84
    ds_read_b64_tr_b16 a[224:225], v21 offset:32768
    ds_read_b64_tr_b16 a[226:227], v21 offset:33792
    ds_read_b64_tr_b16 a[228:229], v21 offset:36864
    ds_read_b64_tr_b16 a[230:231], v21 offset:37888
    ds_read_b64_tr_b16 a[232:233], v21 offset:40960
    ds_read_b64_tr_b16 a[234:235], v21 offset:41984
    ds_read_b64_tr_b16 a[236:237], v21 offset:45056
    ds_read_b64_tr_b16 a[238:239], v21 offset:46080
    ds_read_b64_tr_b16 a[240:241], v21 offset:49152
    ds_read_b64_tr_b16 a[242:243], v21 offset:50176
    ds_read_b64_tr_b16 a[244:245], v21 offset:53248
    ds_read_b64_tr_b16 a[246:247], v21 offset:54272
    ds_read_b64_tr_b16 a[248:249], v21 offset:57344
    ds_read_b64_tr_b16 a[250:251], v21 offset:58368
    ds_read_b64_tr_b16 a[252:253], v21 offset:61440
    ds_read_b64_tr_b16 a[254:255], v21 offset:62464
    s_branch QKR_80
QKR_84:
    s_cmp_lg_u32 s30, 4
    s_cbranch_scc1 QKR_85
    ds_read_b64_tr_b16 a[64:65], v21 offset:32768
    ds_read_b64_tr_b16 a[66:67], v21 offset:33792
    ds_read_b64_tr_b16 a[68:69], v21 offset:36864
    ds_read_b64_tr_b16 a[70:71], v21 offset:37888
    ds_read_b64_tr_b16 a[72:73], v21 offset:40960
    ds_read_b64_tr_b16 a[74:75], v21 offset:41984
    ds_read_b64_tr_b16 a[76:77], v21 offset:45056
    ds_read_b64_tr_b16 a[78:79], v21 offset:46080
    ds_read_b64_tr_b16 a[80:81], v21 offset:49152
    ds_read_b64_tr_b16 a[82:83], v21 offset:50176
    ds_read_b64_tr_b16 a[84:85], v21 offset:53248
    ds_read_b64_tr_b16 a[86:87], v21 offset:54272
    ds_read_b64_tr_b16 a[88:89], v21 offset:57344
    ds_read_b64_tr_b16 a[90:91], v21 offset:58368
    ds_read_b64_tr_b16 a[92:93], v21 offset:61440
    ds_read_b64_tr_b16 a[94:95], v21 offset:62464
    s_branch QKR_80
QKR_85:
    s_cmp_lg_u32 s30, 5
    s_cbranch_scc1 QKR_86
    ds_read_b64_tr_b16 a[32:33], v21 offset:32768
    ds_read_b64_tr_b16 a[34:35], v21 offset:33792
    ds_read_b64_tr_b16 a[36:37], v21 offset:36864
    ds_read_b64_tr_b16 a[38:39], v21 offset:37888
    ds_read_b64_tr_b16 a[40:41], v21 offset:40960
    ds_read_b64_tr_b16 a[42:43], v21 offset:41984
    ds_read_b64_tr_b16 a[44:45], v21 offset:45056
    ds_read_b64_tr_b16 a[46:47], v21 offset:46080
    ds_read_b64_tr_b16 a[48:49], v21 offset:49152
    ds_read_b64_tr_b16 a[50:51], v21 offset:50176
    ds_read_b64_tr_b16 a[52:53], v21 offset:53248
    ds_read_b64_tr_b16 a[54:55], v21 offset:54272
    ds_read_b64_tr_b16 a[56:57], v21 offset:57344
    ds_read_b64_tr_b16 a[58:59], v21 offset:58368
    ds_read_b64_tr_b16 a[60:61], v21 offset:61440
    ds_read_b64_tr_b16 a[62:63], v21 offset:62464
    s_branch QKR_80
QKR_86:
    s_cmp_lg_u32 s30, 6
    s_cbranch_scc1 QKR_87
    ds_read_b64_tr_b16 a[0:1], v21 offset:32768
    ds_read_b64_tr_b16 a[2:3], v21 offset:33792
    ds_read_b64_tr_b16 a[4:5], v21 offset:36864
    ds_read_b64_tr_b16 a[6:7], v21 offset:37888
    ds_read_b64_tr_b16 a[8:9], v21 offset:40960
    ds_read_b64_tr_b16 a[10:11], v21 offset:41984
    ds_read_b64_tr_b16 a[12:13], v21 offset:45056
    ds_read_b64_tr_b16 a[14:15], v21 offset:46080
    ds_read_b64_tr_b16 a[16:17], v21 offset:49152
    ds_read_b64_tr_b16 a[18:19], v21 offset:50176
    ds_read_b64_tr_b16 a[20:21], v21 offset:53248
    ds_read_b64_tr_b16 a[22:23], v21 offset:54272
    ds_read_b64_tr_b16 a[24:25], v21 offset:57344
    ds_read_b64_tr_b16 a[26:27], v21 offset:58368
    ds_read_b64_tr_b16 a[28:29], v21 offset:61440
    ds_read_b64_tr_b16 a[30:31], v21 offset:62464
    s_branch QKR_80
QKR_87:
    ds_read_b64_tr_b16 a[96:97], v21 offset:32768
    ds_read_b64_tr_b16 a[98:99], v21 offset:33792
    ds_read_b64_tr_b16 a[100:101], v21 offset:36864
    ds_read_b64_tr_b16 a[102:103], v21 offset:37888
    ds_read_b64_tr_b16 a[104:105], v21 offset:40960
    ds_read_b64_tr_b16 a[106:107], v21 offset:41984
    ds_read_b64_tr_b16 a[108:109], v21 offset:45056
    ds_read_b64_tr_b16 a[110:111], v21 offset:46080
    ds_read_b64_tr_b16 a[112:113], v21 offset:49152
    ds_read_b64_tr_b16 a[114:115], v21 offset:50176
    ds_read_b64_tr_b16 a[116:117], v21 offset:53248
    ds_read_b64_tr_b16 a[118:119], v21 offset:54272
    ds_read_b64_tr_b16 a[120:121], v21 offset:57344
    ds_read_b64_tr_b16 a[122:123], v21 offset:58368
    ds_read_b64_tr_b16 a[124:125], v21 offset:61440
    ds_read_b64_tr_b16 a[126:127], v21 offset:62464
QKR_80:
    s_waitcnt lgkmcnt(0)
    s_barrier
    s_add_u32 s42, s20, 0x300000
    s_addc_u32 s43, s21, 0
    s_add_u32 m0, s26, 32768
    s_nop 0
    global_load_lds_dwordx4 v20, s[42:43]
    s_add_u32 s42, s20, 0x308000
    s_addc_u32 s43, s21, 0
    s_add_u32 m0, s26, 33792
    s_nop 0
    global_load_lds_dwordx4 v20, s[42:43]
    s_add_u32 s42, s20, 0x310000
    s_addc_u32 s43, s21, 0
    s_add_u32 m0, s26, 34816
    s_nop 0
    global_load_lds_dwordx4 v20, s[42:43]
    s_add_u32 s42, s20, 0x318000
    s_addc_u32 s43, s21, 0
    s_add_u32 m0, s26, 35840
    s_nop 0
    global_load_lds_dwordx4 v20, s[42:43]
    s_add_u32 s42, s20, 0x320000
    s_addc_u32 s43, s21, 0
    s_add_u32 m0, s26, 36864
    s_nop 0
    global_load_lds_dwordx4 v20, s[42:43]
    s_add_u32 s42, s20, 0x328000
    s_addc_u32 s43, s21, 0
    s_add_u32 m0, s26, 37888
    s_nop 0
    global_load_lds_dwordx4 v20, s[42:43]
    s_add_u32 s42, s20, 0x330000
    s_addc_u32 s43, s21, 0
    s_add_u32 m0, s26, 38912
    s_nop 0
    global_load_lds_dwordx4 v20, s[42:43]
    s_add_u32 s42, s20, 0x338000
    s_addc_u32 s43, s21, 0
    s_add_u32 m0, s26, 39936
    s_nop 0
    global_load_lds_dwordx4 v20, s[42:43]
    s_waitcnt vmcnt(34)
    s_barrier
    s_cmp_lg_u32 s30, 0
    s_cbranch_scc1 QKR_90
    ds_read_b64_tr_b16 a[224:225], v22 offset:0
    ds_read_b64_tr_b16 a[226:227], v22 offset:1024
    ds_read_b64_tr_b16 a[228:229], v22 offset:4096
    ds_read_b64_tr_b16 a[230:231], v22 offset:5120
    ds_read_b64_tr_b16 a[232:233], v22 offset:8192
    ds_read_b64_tr_b16 a[234:235], v22 offset:9216
    ds_read_b64_tr_b16 a[236:237], v22 offset:12288
    ds_read_b64_tr_b16 a[238:239], v22 offset:13312
    ds_read_b64_tr_b16 a[240:241], v22 offset:16384
    ds_read_b64_tr_b16 a[242:243], v22 offset:17408
    ds_read_b64_tr_b16 a[244:245], v22 offset:20480
    ds_read_b64_tr_b16 a[246:247], v22 offset:21504
    ds_read_b64_tr_b16 a[248:249], v22 offset:24576
    ds_read_b64_tr_b16 a[250:251], v22 offset:25600
    ds_read_b64_tr_b16 a[252:253], v22 offset:28672
    ds_read_b64_tr_b16 a[254:255], v22 offset:29696
    s_branch QKR_89
QKR_90:
    s_cmp_lg_u32 s30, 1
    s_cbranch_scc1 QKR_91
    ds_read_b64_tr_b16 a[192:193], v22 offset:0
    ds_read_b64_tr_b16 a[194:195], v22 offset:1024
    ds_read_b64_tr_b16 a[196:197], v22 offset:4096
    ds_read_b64_tr_b16 a[198:199], v22 offset:5120
    ds_read_b64_tr_b16 a[200:201], v22 offset:8192
    ds_read_b64_tr_b16 a[202:203], v22 offset:9216
    ds_read_b64_tr_b16 a[204:205], v22 offset:12288
    ds_read_b64_tr_b16 a[206:207], v22 offset:13312
    ds_read_b64_tr_b16 a[208:209], v22 offset:16384
    ds_read_b64_tr_b16 a[210:211], v22 offset:17408
    ds_read_b64_tr_b16 a[212:213], v22 offset:20480
    ds_read_b64_tr_b16 a[214:215], v22 offset:21504
    ds_read_b64_tr_b16 a[216:217], v22 offset:24576
    ds_read_b64_tr_b16 a[218:219], v22 offset:25600
    ds_read_b64_tr_b16 a[220:221], v22 offset:28672
    ds_read_b64_tr_b16 a[222:223], v22 offset:29696
    s_branch QKR_89
QKR_91:
    s_cmp_lg_u32 s30, 2
    s_cbranch_scc1 QKR_92
    ds_read_b64_tr_b16 a[160:161], v22 offset:0
    ds_read_b64_tr_b16 a[162:163], v22 offset:1024
    ds_read_b64_tr_b16 a[164:165], v22 offset:4096
    ds_read_b64_tr_b16 a[166:167], v22 offset:5120
    ds_read_b64_tr_b16 a[168:169], v22 offset:8192
    ds_read_b64_tr_b16 a[170:171], v22 offset:9216
    ds_read_b64_tr_b16 a[172:173], v22 offset:12288
    ds_read_b64_tr_b16 a[174:175], v22 offset:13312
    ds_read_b64_tr_b16 a[176:177], v22 offset:16384
    ds_read_b64_tr_b16 a[178:179], v22 offset:17408
    ds_read_b64_tr_b16 a[180:181], v22 offset:20480
    ds_read_b64_tr_b16 a[182:183], v22 offset:21504
    ds_read_b64_tr_b16 a[184:185], v22 offset:24576
    ds_read_b64_tr_b16 a[186:187], v22 offset:25600
    ds_read_b64_tr_b16 a[188:189], v22 offset:28672
    ds_read_b64_tr_b16 a[190:191], v22 offset:29696
    s_branch QKR_89
QKR_92:
    s_cmp_lg_u32 s30, 3
    s_cbranch_scc1 QKR_93
    ds_read_b64_tr_b16 a[128:129], v22 offset:0
    ds_read_b64_tr_b16 a[130:131], v22 offset:1024
    ds_read_b64_tr_b16 a[132:133], v22 offset:4096
    ds_read_b64_tr_b16 a[134:135], v22 offset:5120
    ds_read_b64_tr_b16 a[136:137], v22 offset:8192
    ds_read_b64_tr_b16 a[138:139], v22 offset:9216
    ds_read_b64_tr_b16 a[140:141], v22 offset:12288
    ds_read_b64_tr_b16 a[142:143], v22 offset:13312
    ds_read_b64_tr_b16 a[144:145], v22 offset:16384
    ds_read_b64_tr_b16 a[146:147], v22 offset:17408
    ds_read_b64_tr_b16 a[148:149], v22 offset:20480
    ds_read_b64_tr_b16 a[150:151], v22 offset:21504
    ds_read_b64_tr_b16 a[152:153], v22 offset:24576
    ds_read_b64_tr_b16 a[154:155], v22 offset:25600
    ds_read_b64_tr_b16 a[156:157], v22 offset:28672
    ds_read_b64_tr_b16 a[158:159], v22 offset:29696
    s_branch QKR_89
QKR_93:
    s_cmp_lg_u32 s30, 4
    s_cbranch_scc1 QKR_94
    ds_read_b64_tr_b16 a[96:97], v22 offset:0
    ds_read_b64_tr_b16 a[98:99], v22 offset:1024
    ds_read_b64_tr_b16 a[100:101], v22 offset:4096
    ds_read_b64_tr_b16 a[102:103], v22 offset:5120
    ds_read_b64_tr_b16 a[104:105], v22 offset:8192
    ds_read_b64_tr_b16 a[106:107], v22 offset:9216
    ds_read_b64_tr_b16 a[108:109], v22 offset:12288
    ds_read_b64_tr_b16 a[110:111], v22 offset:13312
    ds_read_b64_tr_b16 a[112:113], v22 offset:16384
    ds_read_b64_tr_b16 a[114:115], v22 offset:17408
    ds_read_b64_tr_b16 a[116:117], v22 offset:20480
    ds_read_b64_tr_b16 a[118:119], v22 offset:21504
    ds_read_b64_tr_b16 a[120:121], v22 offset:24576
    ds_read_b64_tr_b16 a[122:123], v22 offset:25600
    ds_read_b64_tr_b16 a[124:125], v22 offset:28672
    ds_read_b64_tr_b16 a[126:127], v22 offset:29696
    s_branch QKR_89
QKR_94:
    s_cmp_lg_u32 s30, 5
    s_cbranch_scc1 QKR_95
    ds_read_b64_tr_b16 a[64:65], v22 offset:0
    ds_read_b64_tr_b16 a[66:67], v22 offset:1024
    ds_read_b64_tr_b16 a[68:69], v22 offset:4096
    ds_read_b64_tr_b16 a[70:71], v22 offset:5120
    ds_read_b64_tr_b16 a[72:73], v22 offset:8192
    ds_read_b64_tr_b16 a[74:75], v22 offset:9216
    ds_read_b64_tr_b16 a[76:77], v22 offset:12288
    ds_read_b64_tr_b16 a[78:79], v22 offset:13312
    ds_read_b64_tr_b16 a[80:81], v22 offset:16384
    ds_read_b64_tr_b16 a[82:83], v22 offset:17408
    ds_read_b64_tr_b16 a[84:85], v22 offset:20480
    ds_read_b64_tr_b16 a[86:87], v22 offset:21504
    ds_read_b64_tr_b16 a[88:89], v22 offset:24576
    ds_read_b64_tr_b16 a[90:91], v22 offset:25600
    ds_read_b64_tr_b16 a[92:93], v22 offset:28672
    ds_read_b64_tr_b16 a[94:95], v22 offset:29696
    s_branch QKR_89
QKR_95:
    s_cmp_lg_u32 s30, 6
    s_cbranch_scc1 QKR_96
    ds_read_b64_tr_b16 a[32:33], v22 offset:0
    ds_read_b64_tr_b16 a[34:35], v22 offset:1024
    ds_read_b64_tr_b16 a[36:37], v22 offset:4096
    ds_read_b64_tr_b16 a[38:39], v22 offset:5120
    ds_read_b64_tr_b16 a[40:41], v22 offset:8192
    ds_read_b64_tr_b16 a[42:43], v22 offset:9216
    ds_read_b64_tr_b16 a[44:45], v22 offset:12288
    ds_read_b64_tr_b16 a[46:47], v22 offset:13312
    ds_read_b64_tr_b16 a[48:49], v22 offset:16384
    ds_read_b64_tr_b16 a[50:51], v22 offset:17408
    ds_read_b64_tr_b16 a[52:53], v22 offset:20480
    ds_read_b64_tr_b16 a[54:55], v22 offset:21504
    ds_read_b64_tr_b16 a[56:57], v22 offset:24576
    ds_read_b64_tr_b16 a[58:59], v22 offset:25600
    ds_read_b64_tr_b16 a[60:61], v22 offset:28672
    ds_read_b64_tr_b16 a[62:63], v22 offset:29696
    s_branch QKR_89
QKR_96:
    ds_read_b64_tr_b16 a[0:1], v22 offset:0
    ds_read_b64_tr_b16 a[2:3], v22 offset:1024
    ds_read_b64_tr_b16 a[4:5], v22 offset:4096
    ds_read_b64_tr_b16 a[6:7], v22 offset:5120
    ds_read_b64_tr_b16 a[8:9], v22 offset:8192
    ds_read_b64_tr_b16 a[10:11], v22 offset:9216
    ds_read_b64_tr_b16 a[12:13], v22 offset:12288
    ds_read_b64_tr_b16 a[14:15], v22 offset:13312
    ds_read_b64_tr_b16 a[16:17], v22 offset:16384
    ds_read_b64_tr_b16 a[18:19], v22 offset:17408
    ds_read_b64_tr_b16 a[20:21], v22 offset:20480
    ds_read_b64_tr_b16 a[22:23], v22 offset:21504
    ds_read_b64_tr_b16 a[24:25], v22 offset:24576
    ds_read_b64_tr_b16 a[26:27], v22 offset:25600
    ds_read_b64_tr_b16 a[28:29], v22 offset:28672
    ds_read_b64_tr_b16 a[30:31], v22 offset:29696
QKR_89:
    s_waitcnt vmcnt(26)
    s_barrier
    s_cmp_lg_u32 s9, 0
    s_cbranch_scc1 QKR_99
    ds_read_b64_tr_b16 v[128:129], v22 offset:32768
    ds_read_b64_tr_b16 v[130:131], v22 offset:33792
    ds_read_b64_tr_b16 v[132:133], v22 offset:36864
    ds_read_b64_tr_b16 v[134:135], v22 offset:37888
    ds_read_b64_tr_b16 v[136:137], v22 offset:40960
    ds_read_b64_tr_b16 v[138:139], v22 offset:41984
    ds_read_b64_tr_b16 v[140:141], v22 offset:45056
    ds_read_b64_tr_b16 v[142:143], v22 offset:46080
    ds_read_b64_tr_b16 v[144:145], v22 offset:49152
    ds_read_b64_tr_b16 v[146:147], v22 offset:50176
    ds_read_b64_tr_b16 v[148:149], v22 offset:53248
    ds_read_b64_tr_b16 v[150:151], v22 offset:54272
    ds_read_b64_tr_b16 v[152:153], v22 offset:57344
    ds_read_b64_tr_b16 v[154:155], v22 offset:58368
    ds_read_b64_tr_b16 v[156:157], v22 offset:61440
    ds_read_b64_tr_b16 v[158:159], v22 offset:62464
    s_branch QKR_98
QKR_99:
    s_cmp_lg_u32 s9, 1
    s_cbranch_scc1 QKR_100
    ds_read_b64_tr_b16 v[224:225], v22 offset:32768
    ds_read_b64_tr_b16 v[226:227], v22 offset:33792
    ds_read_b64_tr_b16 v[228:229], v22 offset:36864
    ds_read_b64_tr_b16 v[230:231], v22 offset:37888
    ds_read_b64_tr_b16 v[232:233], v22 offset:40960
    ds_read_b64_tr_b16 v[234:235], v22 offset:41984
    ds_read_b64_tr_b16 v[236:237], v22 offset:45056
    ds_read_b64_tr_b16 v[238:239], v22 offset:46080
    ds_read_b64_tr_b16 v[240:241], v22 offset:49152
    ds_read_b64_tr_b16 v[242:243], v22 offset:50176
    ds_read_b64_tr_b16 v[244:245], v22 offset:53248
    ds_read_b64_tr_b16 v[246:247], v22 offset:54272
    ds_read_b64_tr_b16 v[248:249], v22 offset:57344
    ds_read_b64_tr_b16 v[250:251], v22 offset:58368
    ds_read_b64_tr_b16 v[252:253], v22 offset:61440
    ds_read_b64_tr_b16 v[254:255], v22 offset:62464
    s_branch QKR_98
QKR_100:
    s_cmp_lg_u32 s9, 2
    s_cbranch_scc1 QKR_101
    ds_read_b64_tr_b16 v[192:193], v22 offset:32768
    ds_read_b64_tr_b16 v[194:195], v22 offset:33792
    ds_read_b64_tr_b16 v[196:197], v22 offset:36864
    ds_read_b64_tr_b16 v[198:199], v22 offset:37888
    ds_read_b64_tr_b16 v[200:201], v22 offset:40960
    ds_read_b64_tr_b16 v[202:203], v22 offset:41984
    ds_read_b64_tr_b16 v[204:205], v22 offset:45056
    ds_read_b64_tr_b16 v[206:207], v22 offset:46080
    ds_read_b64_tr_b16 v[208:209], v22 offset:49152
    ds_read_b64_tr_b16 v[210:211], v22 offset:50176
    ds_read_b64_tr_b16 v[212:213], v22 offset:53248
    ds_read_b64_tr_b16 v[214:215], v22 offset:54272
    ds_read_b64_tr_b16 v[216:217], v22 offset:57344
    ds_read_b64_tr_b16 v[218:219], v22 offset:58368
    ds_read_b64_tr_b16 v[220:221], v22 offset:61440
    ds_read_b64_tr_b16 v[222:223], v22 offset:62464
    s_branch QKR_98
QKR_101:
    ds_read_b64_tr_b16 v[160:161], v22 offset:32768
    ds_read_b64_tr_b16 v[162:163], v22 offset:33792
    ds_read_b64_tr_b16 v[164:165], v22 offset:36864
    ds_read_b64_tr_b16 v[166:167], v22 offset:37888
    ds_read_b64_tr_b16 v[168:169], v22 offset:40960
    ds_read_b64_tr_b16 v[170:171], v22 offset:41984
    ds_read_b64_tr_b16 v[172:173], v22 offset:45056
    ds_read_b64_tr_b16 v[174:175], v22 offset:46080
    ds_read_b64_tr_b16 v[176:177], v22 offset:49152
    ds_read_b64_tr_b16 v[178:179], v22 offset:50176
    ds_read_b64_tr_b16 v[180:181], v22 offset:53248
    ds_read_b64_tr_b16 v[182:183], v22 offset:54272
    ds_read_b64_tr_b16 v[184:185], v22 offset:57344
    ds_read_b64_tr_b16 v[186:187], v22 offset:58368
    ds_read_b64_tr_b16 v[188:189], v22 offset:61440
    ds_read_b64_tr_b16 v[190:191], v22 offset:62464
QKR_98:
    s_waitcnt lgkmcnt(0)
    s_waitcnt vmcnt(18)
    s_barrier
    s_cmp_lg_u32 s9, 0
    s_cbranch_scc1 QKR_104
    ds_read_b64_tr_b16 v[160:161], v23 offset:0
    ds_read_b64_tr_b16 v[162:163], v23 offset:1024
    ds_read_b64_tr_b16 v[164:165], v23 offset:4096
    ds_read_b64_tr_b16 v[166:167], v23 offset:5120
    ds_read_b64_tr_b16 v[168:169], v23 offset:8192
    ds_read_b64_tr_b16 v[170:171], v23 offset:9216
    ds_read_b64_tr_b16 v[172:173], v23 offset:12288
    ds_read_b64_tr_b16 v[174:175], v23 offset:13312
    ds_read_b64_tr_b16 v[176:177], v23 offset:16384
    ds_read_b64_tr_b16 v[178:179], v23 offset:17408
    ds_read_b64_tr_b16 v[180:181], v23 offset:20480
    ds_read_b64_tr_b16 v[182:183], v23 offset:21504
    ds_read_b64_tr_b16 v[184:185], v23 offset:24576
    ds_read_b64_tr_b16 v[186:187], v23 offset:25600
    ds_read_b64_tr_b16 v[188:189], v23 offset:28672
    ds_read_b64_tr_b16 v[190:191], v23 offset:29696
    s_branch QKR_103
QKR_104:
    s_cmp_lg_u32 s9, 1
    s_cbranch_scc1 QKR_105
    ds_read_b64_tr_b16 v[128:129], v23 offset:0
    ds_read_b64_tr_b16 v[130:131], v23 offset:1024
    ds_read_b64_tr_b16 v[132:133], v23 offset:4096
    ds_read_b64_tr_b16 v[134:135], v23 offset:5120
    ds_read_b64_tr_b16 v[136:137], v23 offset:8192
    ds_read_b64_tr_b16 v[138:139], v23 offset:9216
    ds_read_b64_tr_b16 v[140:141], v23 offset:12288
    ds_read_b64_tr_b16 v[142:143], v23 offset:13312
    ds_read_b64_tr_b16 v[144:145], v23 offset:16384
    ds_read_b64_tr_b16 v[146:147], v23 offset:17408
    ds_read_b64_tr_b16 v[148:149], v23 offset:20480
    ds_read_b64_tr_b16 v[150:151], v23 offset:21504
    ds_read_b64_tr_b16 v[152:153], v23 offset:24576
    ds_read_b64_tr_b16 v[154:155], v23 offset:25600
    ds_read_b64_tr_b16 v[156:157], v23 offset:28672
    ds_read_b64_tr_b16 v[158:159], v23 offset:29696
    s_branch QKR_103
QKR_105:
    s_cmp_lg_u32 s9, 2
    s_cbranch_scc1 QKR_106
    ds_read_b64_tr_b16 v[224:225], v23 offset:0
    ds_read_b64_tr_b16 v[226:227], v23 offset:1024
    ds_read_b64_tr_b16 v[228:229], v23 offset:4096
    ds_read_b64_tr_b16 v[230:231], v23 offset:5120
    ds_read_b64_tr_b16 v[232:233], v23 offset:8192
    ds_read_b64_tr_b16 v[234:235], v23 offset:9216
    ds_read_b64_tr_b16 v[236:237], v23 offset:12288
    ds_read_b64_tr_b16 v[238:239], v23 offset:13312
    ds_read_b64_tr_b16 v[240:241], v23 offset:16384
    ds_read_b64_tr_b16 v[242:243], v23 offset:17408
    ds_read_b64_tr_b16 v[244:245], v23 offset:20480
    ds_read_b64_tr_b16 v[246:247], v23 offset:21504
    ds_read_b64_tr_b16 v[248:249], v23 offset:24576
    ds_read_b64_tr_b16 v[250:251], v23 offset:25600
    ds_read_b64_tr_b16 v[252:253], v23 offset:28672
    ds_read_b64_tr_b16 v[254:255], v23 offset:29696
    s_branch QKR_103
QKR_106:
    ds_read_b64_tr_b16 v[192:193], v23 offset:0
    ds_read_b64_tr_b16 v[194:195], v23 offset:1024
    ds_read_b64_tr_b16 v[196:197], v23 offset:4096
    ds_read_b64_tr_b16 v[198:199], v23 offset:5120
    ds_read_b64_tr_b16 v[200:201], v23 offset:8192
    ds_read_b64_tr_b16 v[202:203], v23 offset:9216
    ds_read_b64_tr_b16 v[204:205], v23 offset:12288
    ds_read_b64_tr_b16 v[206:207], v23 offset:13312
    ds_read_b64_tr_b16 v[208:209], v23 offset:16384
    ds_read_b64_tr_b16 v[210:211], v23 offset:17408
    ds_read_b64_tr_b16 v[212:213], v23 offset:20480
    ds_read_b64_tr_b16 v[214:215], v23 offset:21504
    ds_read_b64_tr_b16 v[216:217], v23 offset:24576
    ds_read_b64_tr_b16 v[218:219], v23 offset:25600
    ds_read_b64_tr_b16 v[220:221], v23 offset:28672
    ds_read_b64_tr_b16 v[222:223], v23 offset:29696
QKR_103:
    s_waitcnt vmcnt(8)
    s_barrier
    s_cmp_lg_u32 s9, 0
    s_cbranch_scc1 QKR_109
    ds_read_b64_tr_b16 v[192:193], v21 offset:0
    ds_read_b64_tr_b16 v[194:195], v21 offset:1024
    ds_read_b64_tr_b16 v[196:197], v21 offset:4096
    ds_read_b64_tr_b16 v[198:199], v21 offset:5120
    ds_read_b64_tr_b16 v[200:201], v21 offset:8192
    ds_read_b64_tr_b16 v[202:203], v21 offset:9216
    ds_read_b64_tr_b16 v[204:205], v21 offset:12288
    ds_read_b64_tr_b16 v[206:207], v21 offset:13312
    ds_read_b64_tr_b16 v[208:209], v21 offset:16384
    ds_read_b64_tr_b16 v[210:211], v21 offset:17408
    ds_read_b64_tr_b16 v[212:213], v21 offset:20480
    ds_read_b64_tr_b16 v[214:215], v21 offset:21504
    ds_read_b64_tr_b16 v[216:217], v21 offset:24576
    ds_read_b64_tr_b16 v[218:219], v21 offset:25600
    ds_read_b64_tr_b16 v[220:221], v21 offset:28672
    ds_read_b64_tr_b16 v[222:223], v21 offset:29696
    s_branch QKR_108
QKR_109:
    s_cmp_lg_u32 s9, 1
    s_cbranch_scc1 QKR_110
    ds_read_b64_tr_b16 v[160:161], v21 offset:0
    ds_read_b64_tr_b16 v[162:163], v21 offset:1024
    ds_read_b64_tr_b16 v[164:165], v21 offset:4096
    ds_read_b64_tr_b16 v[166:167], v21 offset:5120
    ds_read_b64_tr_b16 v[168:169], v21 offset:8192
    ds_read_b64_tr_b16 v[170:171], v21 offset:9216
    ds_read_b64_tr_b16 v[172:173], v21 offset:12288
    ds_read_b64_tr_b16 v[174:175], v21 offset:13312
    ds_read_b64_tr_b16 v[176:177], v21 offset:16384
    ds_read_b64_tr_b16 v[178:179], v21 offset:17408
    ds_read_b64_tr_b16 v[180:181], v21 offset:20480
    ds_read_b64_tr_b16 v[182:183], v21 offset:21504
    ds_read_b64_tr_b16 v[184:185], v21 offset:24576
    ds_read_b64_tr_b16 v[186:187], v21 offset:25600
    ds_read_b64_tr_b16 v[188:189], v21 offset:28672
    ds_read_b64_tr_b16 v[190:191], v21 offset:29696
    s_branch QKR_108
QKR_110:
    s_cmp_lg_u32 s9, 2
    s_cbranch_scc1 QKR_111
    ds_read_b64_tr_b16 v[128:129], v21 offset:0
    ds_read_b64_tr_b16 v[130:131], v21 offset:1024
    ds_read_b64_tr_b16 v[132:133], v21 offset:4096
    ds_read_b64_tr_b16 v[134:135], v21 offset:5120
    ds_read_b64_tr_b16 v[136:137], v21 offset:8192
    ds_read_b64_tr_b16 v[138:139], v21 offset:9216
    ds_read_b64_tr_b16 v[140:141], v21 offset:12288
    ds_read_b64_tr_b16 v[142:143], v21 offset:13312
    ds_read_b64_tr_b16 v[144:145], v21 offset:16384
    ds_read_b64_tr_b16 v[146:147], v21 offset:17408
    ds_read_b64_tr_b16 v[148:149], v21 offset:20480
    ds_read_b64_tr_b16 v[150:151], v21 offset:21504
    ds_read_b64_tr_b16 v[152:153], v21 offset:24576
    ds_read_b64_tr_b16 v[154:155], v21 offset:25600
    ds_read_b64_tr_b16 v[156:157], v21 offset:28672
    ds_read_b64_tr_b16 v[158:159], v21 offset:29696
    s_branch QKR_108
QKR_111:
    ds_read_b64_tr_b16 v[224:225], v21 offset:0
    ds_read_b64_tr_b16 v[226:227], v21 offset:1024
    ds_read_b64_tr_b16 v[228:229], v21 offset:4096
    ds_read_b64_tr_b16 v[230:231], v21 offset:5120
    ds_read_b64_tr_b16 v[232:233], v21 offset:8192
    ds_read_b64_tr_b16 v[234:235], v21 offset:9216
    ds_read_b64_tr_b16 v[236:237], v21 offset:12288
    ds_read_b64_tr_b16 v[238:239], v21 offset:13312
    ds_read_b64_tr_b16 v[240:241], v21 offset:16384
    ds_read_b64_tr_b16 v[242:243], v21 offset:17408
    ds_read_b64_tr_b16 v[244:245], v21 offset:20480
    ds_read_b64_tr_b16 v[246:247], v21 offset:21504
    ds_read_b64_tr_b16 v[248:249], v21 offset:24576
    ds_read_b64_tr_b16 v[250:251], v21 offset:25600
    ds_read_b64_tr_b16 v[252:253], v21 offset:28672
    ds_read_b64_tr_b16 v[254:255], v21 offset:29696
QKR_108:
    v_cmp_ne_u32 s[50:51], s8, v12
    v_xor_b32 v48, s8, v48
    v_xor_b32 v49, s19, v49
    v_or_b32 v48, v48, v49
    v_cmp_ne_u32 vcc, 0, v48
    s_cmp_eq_u64 vcc, 0
    s_cselect_b32 s18, 1, 0
    s_mov_b32 m0, s29
    s_nop 0
    global_load_lds_dwordx4 v1, s[34:35] offset:0 sc1
    global_load_lds_dwordx4 v1, s[34:35] offset:1024 sc1
    global_load_lds_dwordx4 v1, s[34:35] offset:2048 sc1
    global_load_lds_dwordx4 v1, s[34:35] offset:3072 sc1
    s_add_u32 m0, s29, 4096
    s_nop 0
    global_load_lds_dwordx4 v1, s[38:39] offset:0 sc1
    global_load_lds_dwordx4 v1, s[38:39] offset:1024 sc1
    global_load_lds_dwordx4 v1, s[38:39] offset:2048 sc1
    global_load_lds_dwordx4 v1, s[38:39] offset:3072 sc1
    s_waitcnt vmcnt(8)
    s_barrier
    s_cmp_lg_u32 s9, 0
    s_cbranch_scc1 QKR_114
    ds_read_b64_tr_b16 v[224:225], v21 offset:32768
    ds_read_b64_tr_b16 v[226:227], v21 offset:33792
    ds_read_b64_tr_b16 v[228:229], v21 offset:36864
    ds_read_b64_tr_b16 v[230:231], v21 offset:37888
    ds_read_b64_tr_b16 v[232:233], v21 offset:40960
    ds_read_b64_tr_b16 v[234:235], v21 offset:41984
    ds_read_b64_tr_b16 v[236:237], v21 offset:45056
    ds_read_b64_tr_b16 v[238:239], v21 offset:46080
    ds_read_b64_tr_b16 v[240:241], v21 offset:49152
    ds_read_b64_tr_b16 v[242:243], v21 offset:50176
    ds_read_b64_tr_b16 v[244:245], v21 offset:53248
    ds_read_b64_tr_b16 v[246:247], v21 offset:54272
    ds_read_b64_tr_b16 v[248:249], v21 offset:57344
    ds_read_b64_tr_b16 v[250:251], v21 offset:58368
    ds_read_b64_tr_b16 v[252:253], v21 offset:61440
    ds_read_b64_tr_b16 v[254:255], v21 offset:62464
    s_branch QKR_113
QKR_114:
    s_cmp_lg_u32 s9, 1
    s_cbranch_scc1 QKR_115
    ds_read_b64_tr_b16 v[192:193], v21 offset:32768
    ds_read_b64_tr_b16 v[194:195], v21 offset:33792
    ds_read_b64_tr_b16 v[196:197], v21 offset:36864
    ds_read_b64_tr_b16 v[198:199], v21 offset:37888
    ds_read_b64_tr_b16 v[200:201], v21 offset:40960
    ds_read_b64_tr_b16 v[202:203], v21 offset:41984
    ds_read_b64_tr_b16 v[204:205], v21 offset:45056
    ds_read_b64_tr_b16 v[206:207], v21 offset:46080
    ds_read_b64_tr_b16 v[208:209], v21 offset:49152
    ds_read_b64_tr_b16 v[210:211], v21 offset:50176
    ds_read_b64_tr_b16 v[212:213], v21 offset:53248
    ds_read_b64_tr_b16 v[214:215], v21 offset:54272
    ds_read_b64_tr_b16 v[216:217], v21 offset:57344
    ds_read_b64_tr_b16 v[218:219], v21 offset:58368
    ds_read_b64_tr_b16 v[220:221], v21 offset:61440
    ds_read_b64_tr_b16 v[222:223], v21 offset:62464
    s_branch QKR_113
QKR_115:
    s_cmp_lg_u32 s9, 2
    s_cbranch_scc1 QKR_116
    ds_read_b64_tr_b16 v[160:161], v21 offset:32768
    ds_read_b64_tr_b16 v[162:163], v21 offset:33792
    ds_read_b64_tr_b16 v[164:165], v21 offset:36864
    ds_read_b64_tr_b16 v[166:167], v21 offset:37888
    ds_read_b64_tr_b16 v[168:169], v21 offset:40960
    ds_read_b64_tr_b16 v[170:171], v21 offset:41984
    ds_read_b64_tr_b16 v[172:173], v21 offset:45056
    ds_read_b64_tr_b16 v[174:175], v21 offset:46080
    ds_read_b64_tr_b16 v[176:177], v21 offset:49152
    ds_read_b64_tr_b16 v[178:179], v21 offset:50176
    ds_read_b64_tr_b16 v[180:181], v21 offset:53248
    ds_read_b64_tr_b16 v[182:183], v21 offset:54272
    ds_read_b64_tr_b16 v[184:185], v21 offset:57344
    ds_read_b64_tr_b16 v[186:187], v21 offset:58368
    ds_read_b64_tr_b16 v[188:189], v21 offset:61440
    ds_read_b64_tr_b16 v[190:191], v21 offset:62464
    s_branch QKR_113
QKR_116:
    ds_read_b64_tr_b16 v[128:129], v21 offset:32768
    ds_read_b64_tr_b16 v[130:131], v21 offset:33792
    ds_read_b64_tr_b16 v[132:133], v21 offset:36864
    ds_read_b64_tr_b16 v[134:135], v21 offset:37888
    ds_read_b64_tr_b16 v[136:137], v21 offset:40960
    ds_read_b64_tr_b16 v[138:139], v21 offset:41984
    ds_read_b64_tr_b16 v[140:141], v21 offset:45056
    ds_read_b64_tr_b16 v[142:143], v21 offset:46080
    ds_read_b64_tr_b16 v[144:145], v21 offset:49152
    ds_read_b64_tr_b16 v[146:147], v21 offset:50176
    ds_read_b64_tr_b16 v[148:149], v21 offset:53248
    ds_read_b64_tr_b16 v[150:151], v21 offset:54272
    ds_read_b64_tr_b16 v[152:153], v21 offset:57344
    ds_read_b64_tr_b16 v[154:155], v21 offset:58368
    ds_read_b64_tr_b16 v[156:157], v21 offset:61440
    ds_read_b64_tr_b16 v[158:159], v21 offset:62464
QKR_113:
    s_waitcnt lgkmcnt(0)
    s_barrier
    s_mov_b32 s12, 0
    s_cmp_eq_u64 s[50:51], 0
    s_cbranch_scc1 QK_GO
QK_XA:
    global_load_dword v12, v13, s[4:5] sc1
    s_add_u32 s12, s12, 1
    s_mov_b32 s17, 18
    s_cmp_gt_u32 s12, 20000
    s_cbranch_scc1 TIMEOUT
    s_waitcnt vmcnt(0)
    v_cmp_ne_u32 vcc, s8, v12
    s_cbranch_vccnz QK_XA
QK_SPIN0:
    s_mov_b32 s12, 0
QK_SPIN:
    global_load_dword v15, v1, s[34:35] sc1
    s_add_u32 s12, s12, 1
    s_mov_b32 s17, 4
    s_cmp_gt_u32 s12, 20000
    s_cbranch_scc1 TIMEOUT
    s_waitcnt vmcnt(0)
    v_cmp_eq_u32 vcc, -1, v15
    s_cbranch_vccnz QK_SPIN
    s_mov_b32 m0, s29
    s_nop 0
    global_load_lds_dwordx4 v1, s[34:35] offset:0 sc1
    global_load_lds_dwordx4 v1, s[34:35] offset:1024 sc1
    global_load_lds_dwordx4 v1, s[34:35] offset:2048 sc1
    global_load_lds_dwordx4 v1, s[34:35] offset:3072 sc1
    s_add_u32 m0, s29, 4096
    s_nop 0
    global_load_lds_dwordx4 v1, s[38:39] offset:0 sc1
    global_load_lds_dwordx4 v1, s[38:39] offset:1024 sc1
    global_load_lds_dwordx4 v1, s[38:39] offset:2048 sc1
    global_load_lds_dwordx4 v1, s[38:39] offset:3072 sc1
QK_GO:
    s_waitcnt vmcnt(0)
QK_GO2:
    ds_read_b128 v[48:51], v2 offset:0
    ds_read_b128 v[52:55], v2 offset:1024
    ds_read_b128 v[56:59], v2 offset:2048
    ds_read_b128 v[60:63], v2 offset:3072
    ds_read_b128 v[64:67], v2 offset:4096
    ds_read_b128 v[68:71], v2 offset:5120
    ds_read_b128 v[72:75], v2 offset:6144
    ds_read_b128 v[76:79], v2 offset:7168
QK_H0:
    s_waitcnt lgkmcnt(7)
    v_mfma_f32_32x32x16_bf16 v[80:95], a[0:3], v[48:51], 0
    s_waitcnt lgkmcnt(6)
    v_mfma_f32_32x32x16_bf16 v[80:95], a[4:7], v[52:55], v[80:95]
    v_max_u32 v15, v48, v52
    s_waitcnt lgkmcnt(5)
    v_mfma_f32_32x32x16_bf16 v[80:95], a[8:11], v[56:59], v[80:95]
    s_waitcnt lgkmcnt(4)
    v_mfma_f32_32x32x16_bf16 v[80:95], a[12:15], v[60:63], v[80:95]
    v_max3_u32 v15, v15, v56, v60
    s_waitcnt lgkmcnt(3)
    v_mfma_f32_32x32x16_bf16 v[80:95], a[16:19], v[64:67], v[80:95]
    s_waitcnt lgkmcnt(2)
    v_mfma_f32_32x32x16_bf16 v[80:95], a[20:23], v[68:71], v[80:95]
    v_max3_u32 v15, v15, v64, v68
    s_waitcnt lgkmcnt(1)
    v_mfma_f32_32x32x16_bf16 v[80:95], a[24:27], v[72:75], v[80:95]
    s_waitcnt lgkmcnt(0)
    v_mfma_f32_32x32x16_bf16 v[80:95], a[28:31], v[76:79], v[80:95]
    v_max3_u32 v15, v15, v72, v76
    v_cmp_eq_u32 vcc, -1, v15
    v_mfma_f32_32x32x16_bf16 v[96:111], v[48:51], a[128:131], 0
    s_cbranch_vccnz QK_SPIN
    s_barrier
    v_mfma_f32_32x32x16_bf16 v[96:111], v[52:55], a[132:135], v[96:111]
    ds_read_b128 v[20:23], v3 offset:0
    s_branch QK_J
QK_HQ:
    s_waitcnt lgkmcnt(7)
    v_mfma_f32_32x32x16_bf16 v[80:95], a[0:3], v[48:51], 0
    s_waitcnt lgkmcnt(6)
    v_mfma_f32_32x32x16_bf16 v[80:95], a[4:7], v[52:55], v[80:95]
    v_cvt_pk_bf16_f32 v112, v112, v120
    v_cvt_pk_bf16_f32 v113, v113, v121
    v_cvt_pk_bf16_f32 v114, v114, v122
    v_cvt_pk_bf16_f32 v115, v115, v123
    v_max_u32 v15, v48, v52
    s_waitcnt lgkmcnt(5)
    v_mfma_f32_32x32x16_bf16 v[80:95], a[8:11], v[56:59], v[80:95]
    global_store_dwordx4 v6, v[112:115], s[42:43] offset:0 sc1
    s_waitcnt lgkmcnt(4)
    v_mfma_f32_32x32x16_bf16 v[80:95], a[12:15], v[60:63], v[80:95]
    v_cvt_pk_bf16_f32 v116, v116, v124
    v_cvt_pk_bf16_f32 v117, v117, v125
    v_max3_u32 v15, v15, v56, v60
    s_waitcnt lgkmcnt(3)
    v_mfma_f32_32x32x16_bf16 v[80:95], a[16:19], v[64:67], v[80:95]
    v_cvt_pk_bf16_f32 v118, v118, v126
    v_cvt_pk_bf16_f32 v119, v119, v127
    s_waitcnt lgkmcnt(2)
    v_mfma_f32_32x32x16_bf16 v[80:95], a[20:23], v[68:71], v[80:95]
    v_max3_u32 v15, v15, v64, v68
    s_waitcnt lgkmcnt(1)
    v_mfma_f32_32x32x16_bf16 v[80:95], a[24:27], v[72:75], v[80:95]
    global_store_dwordx4 v6, v[116:119], s[42:43] offset:1024 sc1
    s_waitcnt lgkmcnt(0)
    v_mfma_f32_32x32x16_bf16 v[80:95], a[28:31], v[76:79], v[80:95]
    v_max3_u32 v15, v15, v72, v76
    v_cmp_eq_u32 vcc, -1, v15
    v_mfma_f32_32x32x16_bf16 v[96:111], v[48:51], a[128:131], 0
    s_cbranch_vccnz QK_FQ2
    s_barrier
    v_mfma_f32_32x32x16_bf16 v[96:111], v[52:55], a[132:135], v[96:111]
    ds_read_b128 v[20:23], v3 offset:0
    s_waitcnt vmcnt(2)
    global_store_dword v7, v9, s[40:41] sc1
QK_J:
    v_mfma_f32_32x32x16_bf16 v[96:111], v[56:59], a[136:139], v[96:111]
    ds_read_b128 v[24:27], v3 offset:1024
    s_lshr_b32 s14, s28, 6
    s_mul_i32 s14, s14, 2016
    s_add_u32 s14, s14, s28
    s_mul_i32 s15, s14, 32768
    s_add_u32 s15, s15, s36
    v_mfma_f32_32x32x16_bf16 v[96:111], v[60:63], a[140:143], v[96:111]
    ds_read_b128 v[28:31], v3 offset:2048
    s_add_u32 s42, s4, s15
    s_addc_u32 s43, s5, 0
    s_add_u32 s44, s42, 0x2000
    s_addc_u32 s45, s43, 0
    v_mfma_f32_32x32x16_bf16 v[96:111], v[64:67], a[144:147], v[96:111]
    ds_read_b128 v[32:35], v3 offset:3072
    s_add_u32 s46, s42, 0x4000
    s_addc_u32 s47, s43, 0
    s_lshl_b32 s14, s28, 10
    s_add_u32 s14, s14, s37
    v_mfma_f32_32x32x16_bf16 v[96:111], v[68:71], a[148:151], v[96:111]
    ds_read_b128 v[36:39], v3 offset:4096
    s_add_u32 s48, s4, s14
    s_addc_u32 s49, s5, 0
    s_xor_b32 s29, s29, 0x8000
    s_add_u32 s27, s27, 1
    v_mfma_f32_32x32x16_bf16 v[96:111], v[72:75], a[152:155], v[96:111]
    ds_read_b128 v[40:43], v3 offset:5120
    s_and_b32 s14, s28, 64
    s_lshl_b32 s14, s14, 7
    s_add_u32 s54, s52, s14
    s_and_b32 s14, s28, 63
    s_add_u32 s55, s53, s14
    s_cmp_eq_u32 s27, s56
    s_cbranch_scc1 QK_XB
QK_XBR:
    v_mfma_f32_32x32x16_bf16 v[96:111], v[76:79], a[156:159], v[96:111]
    ds_read_b128 v[44:47], v3 offset:6144
    s_lshr_b32 s14, s28, 1
    s_min_u32 s14, s14, 32
    s_bitcmp1_b32 0xfff80000, s14
    s_cbranch_scc1 QK_KV
    s_waitcnt lgkmcnt(6)
    v_mfma_f32_32x32x16_bf16 v[80:95], a[32:35], v[20:23], v[80:95]
    s_bfm_b64 s[14:15], s27, 0
    s_and_b64 s[14:15], s[14:15], s[32:33]
    s_bcnt1_i32_b64 s14, s[14:15]
    s_sub_u32 s15, s27, s14
    v_mfma_f32_32x32x16_bf16 v[96:111], v[20:23], a[160:163], v[96:111]
    ds_read_b128 v[20:23], v3 offset:7168
    s_add_u32 s14, s14, 32
    s_bitcmp1_b64 s[32:33], s27
    s_cselect_b32 s14, s14, s15
    s_waitcnt lgkmcnt(6)
    v_mfma_f32_32x32x16_bf16 v[80:95], a[36:39], v[24:27], v[80:95]
    s_min_u32 s14, s14, 63
    s_lshl_b32 s14, s14, 1
    s_add_u32 s14, s14, s10
    s_sub_u32 s28, s14, 2
    global_store_dwordx4 v14, v[16:19], s[42:43] sc1
    v_mfma_f32_32x32x16_bf16 v[96:111], v[24:27], a[164:167], v[96:111]
    ds_read_b128 v[24:27], v4 offset:0
    s_and_b32 s14, s28, 64
    s_add_u32 s14, s14, s28
    s_lshl_b32 s15, s14, 15
    s_add_u32 s15, s15, s26
    s_waitcnt lgkmcnt(6)
    v_mfma_f32_32x32x16_bf16 v[80:95], a[40:43], v[28:31], v[80:95]
    s_add_u32 s15, s15, 4194304
    s_add_u32 s34, s4, s15
    s_addc_u32 s35, s5, 0
    s_add_u32 s38, s34, 0x1000
    s_addc_u32 s39, s35, 0
    v_mfma_f32_32x32x16_bf16 v[96:111], v[28:31], a[168:171], v[96:111]
    ds_read_b128 v[28:31], v4 offset:1024
    s_waitcnt lgkmcnt(6)
    v_mfma_f32_32x32x16_bf16 v[80:95], a[44:47], v[32:35], v[80:95]
    v_mfma_f32_32x32x16_bf16 v[96:111], v[32:35], a[172:175], v[96:111]
    ds_read_b128 v[32:35], v4 offset:2048
    s_waitcnt lgkmcnt(6)
    v_mfma_f32_32x32x16_bf16 v[80:95], a[48:51], v[36:39], v[80:95]
    v_mfma_f32_32x32x16_bf16 v[96:111], v[36:39], a[176:179], v[96:111]
    ds_read_b128 v[36:39], v4 offset:3072
    s_waitcnt lgkmcnt(6)
    v_mfma_f32_32x32x16_bf16 v[80:95], a[52:55], v[40:43], v[80:95]
    v_mfma_f32_32x32x16_bf16 v[96:111], v[40:43], a[180:183], v[96:111]
    ds_read_b128 v[40:43], v4 offset:4096
    s_waitcnt lgkmcnt(6)
    v_mfma_f32_32x32x16_bf16 v[80:95], a[56:59], v[44:47], v[80:95]
    v_mfma_f32_32x32x16_bf16 v[96:111], v[44:47], a[184:187], v[96:111]
    ds_read_b128 v[44:47], v4 offset:5120
    s_waitcnt lgkmcnt(6)
    v_mfma_f32_32x32x16_bf16 v[80:95], a[60:63], v[20:23], v[80:95]
    v_mfma_f32_32x32x16_bf16 v[96:111], v[20:23], a[188:191], v[96:111]
    ds_read_b128 v[20:23], v4 offset:6144
    s_waitcnt lgkmcnt(6)
    v_mfma_f32_32x32x16_bf16 v[80:95], a[64:67], v[24:27], v[80:95]
    v_mfma_f32_32x32x16_bf16 v[96:111], v[24:27], a[192:195], v[96:111]
    ds_read_b128 v[24:27], v4 offset:7168
    s_waitcnt lgkmcnt(6)
    v_mfma_f32_32x32x16_bf16 v[80:95], a[68:71], v[28:31], v[80:95]
    v_mfma_f32_32x32x16_bf16 v[96:111], v[28:31], a[196:199], v[96:111]
    ds_read_b128 v[28:31], v5 offset:0
    s_waitcnt lgkmcnt(6)
    v_mfma_f32_32x32x16_bf16 v[80:95], a[72:75], v[32:35], v[80:95]
    v_mfma_f32_32x32x16_bf16 v[96:111], v[32:35], a[200:203], v[96:111]
    ds_read_b128 v[32:35], v5 offset:1024
    s_waitcnt lgkmcnt(6)
    v_mfma_f32_32x32x16_bf16 v[80:95], a[76:79], v[36:39], v[80:95]
    v_mfma_f32_32x32x16_bf16 v[96:111], v[36:39], a[204:207], v[96:111]
    ds_read_b128 v[36:39], v5 offset:2048
    s_mov_b32 m0, s29
    s_waitcnt lgkmcnt(6)
    v_mfma_f32_32x32x16_bf16 v[80:95], a[80:83], v[40:43], v[80:95]
    global_load_lds_dwordx4 v1, s[34:35] offset:0 sc1
    v_mfma_f32_32x32x16_bf16 v[96:111], v[40:43], a[208:211], v[96:111]
    ds_read_b128 v[40:43], v5 offset:3072
    s_waitcnt lgkmcnt(6)
    v_mfma_f32_32x32x16_bf16 v[80:95], a[84:87], v[44:47], v[80:95]
    global_load_lds_dwordx4 v1, s[34:35] offset:1024 sc1
    v_mfma_f32_32x32x16_bf16 v[96:111], v[44:47], a[212:215], v[96:111]
    ds_read_b128 v[44:47], v5 offset:4096
    s_waitcnt lgkmcnt(6)
    v_mfma_f32_32x32x16_bf16 v[80:95], a[88:91], v[20:23], v[80:95]
    global_load_lds_dwordx4 v1, s[34:35] offset:2048 sc1
    v_mfma_f32_32x32x16_bf16 v[96:111], v[20:23], a[216:219], v[96:111]
    ds_read_b128 v[20:23], v5 offset:5120
    s_waitcnt lgkmcnt(6)
    v_mfma_f32_32x32x16_bf16 v[80:95], a[92:95], v[24:27], v[80:95]
    global_load_lds_dwordx4 v1, s[34:35] offset:3072 sc1
    v_mfma_f32_32x32x16_bf16 v[96:111], v[24:27], a[220:223], v[96:111]
    ds_read_b128 v[24:27], v5 offset:6144
    s_add_u32 m0, s29, 4096
    s_waitcnt lgkmcnt(6)
    v_mfma_f32_32x32x16_bf16 v[80:95], a[96:99], v[28:31], v[80:95]
    global_load_lds_dwordx4 v1, s[38:39] offset:0 sc1
    v_mfma_f32_32x32x16_bf16 v[96:111], v[28:31], a[224:227], v[96:111]
    ds_read_b128 v[28:31], v5 offset:7168
    s_waitcnt lgkmcnt(6)
    v_mfma_f32_32x32x16_bf16 v[80:95], a[100:103], v[32:35], v[80:95]
    global_load_lds_dwordx4 v1, s[38:39] offset:1024 sc1
    s_waitcnt lgkmcnt(5)
    v_mfma_f32_32x32x16_bf16 v[80:95], a[104:107], v[36:39], v[80:95]
    s_waitcnt lgkmcnt(4)
    v_mfma_f32_32x32x16_bf16 v[80:95], a[108:111], v[40:43], v[80:95]
    global_load_lds_dwordx4 v1, s[38:39] offset:2048 sc1
    s_waitcnt lgkmcnt(3)
    v_mfma_f32_32x32x16_bf16 v[80:95], a[112:115], v[44:47], v[80:95]
    s_waitcnt lgkmcnt(2)
    v_mfma_f32_32x32x16_bf16 v[80:95], a[116:119], v[20:23], v[80:95]
    global_load_lds_dwordx4 v1, s[38:39] offset:3072 sc1
    s_waitcnt lgkmcnt(1)
    v_mfma_f32_32x32x16_bf16 v[80:95], a[120:123], v[24:27], v[80:95]
    s_waitcnt vmcnt(8)
    s_cmp_eq_u32 s18, 0
    s_cbranch_scc1 PG_118
    global_store_dword v8, v12, s[4:5]
PG_118_R:
    s_waitcnt lgkmcnt(0)
    v_mfma_f32_32x32x16_bf16 v[80:95], a[124:127], v[28:31], v[80:95]
    global_store_dword v7, v9, s[40:41] sc1
    v_mfma_f32_32x32x16_bf16 v[96:111], v[32:35], a[228:231], v[96:111]
    ds_read_b128 v[32:35], v2 offset:0
    s_mov_b64 s[40:41], s[48:49]
    v_mov_b32 v8, s54
    v_mov_b32 v12, s55
    v_mfma_f32_32x32x16_bf16 v[96:111], v[36:39], a[232:235], v[96:111]
    ds_read_b128 v[36:39], v2 offset:1024
    v_cvt_pk_bf16_f32 v80, v80, v88
    v_cvt_pk_bf16_f32 v81, v81, v89
    v_cvt_pk_bf16_f32 v82, v82, v90
    v_cvt_pk_bf16_f32 v83, v83, v91
    v_mfma_f32_32x32x16_bf16 v[96:111], v[40:43], a[236:239], v[96:111]
    ds_read_b128 v[40:43], v2 offset:2048
    global_store_dwordx4 v6, v[80:83], s[44:45] offset:0 sc1
    v_cvt_pk_bf16_f32 v84, v84, v92
    v_cvt_pk_bf16_f32 v85, v85, v93
    v_cvt_pk_bf16_f32 v86, v86, v94
    v_cvt_pk_bf16_f32 v87, v87, v95
    v_mfma_f32_32x32x16_bf16 v[96:111], v[44:47], a[240:243], v[96:111]
    ds_read_b128 v[44:47], v2 offset:3072
    v_mfma_f32_32x32x16_bf16 v[96:111], v[20:23], a[244:247], v[96:111]
    ds_read_b128 v[20:23], v2 offset:4096
    v_mfma_f32_32x32x16_bf16 v[96:111], v[24:27], a[248:251], v[96:111]
    ds_read_b128 v[24:27], v2 offset:5120
    v_mfma_f32_32x32x16_bf16 v[96:111], v[28:31], a[252:255], v[96:111]
    ds_read_b128 v[28:31], v2 offset:6144
    global_store_dwordx4 v6, v[84:87], s[44:45] offset:1024 sc1
    s_waitcnt lgkmcnt(6)
    v_mfma_f32_32x32x16_bf16 v[112:127], v[128:131], v[32:35], 0
    ds_read_b128 v[32:35], v2 offset:7168
    s_waitcnt lgkmcnt(6)
    v_mfma_f32_32x32x16_bf16 v[112:127], v[132:135], v[36:39], v[112:127]
    ds_read_b128 v[36:39], v3 offset:0
    s_waitcnt lgkmcnt(6)
    v_mfma_f32_32x32x16_bf16 v[112:127], v[136:139], v[40:43], v[112:127]
    ds_read_b128 v[40:43], v3 offset:1024
    v_cvt_pk_bf16_f32 v96, v96, v97
    v_cvt_pk_bf16_f32 v97, v98, v99
    v_cvt_pk_bf16_f32 v98, v104, v105
    v_cvt_pk_bf16_f32 v99, v106, v107
    s_waitcnt lgkmcnt(6)
    v_mfma_f32_32x32x16_bf16 v[112:127], v[140:143], v[44:47], v[112:127]
    ds_read_b128 v[44:47], v3 offset:2048
    global_store_dwordx4 v6, v[96:99], s[46:47] offset:0 sc1
    v_cvt_pk_bf16_f32 v100, v100, v101
    v_cvt_pk_bf16_f32 v101, v102, v103
    v_cvt_pk_bf16_f32 v102, v108, v109
    v_cvt_pk_bf16_f32 v103, v110, v111
    s_waitcnt lgkmcnt(6)
    v_mfma_f32_32x32x16_bf16 v[112:127], v[144:147], v[20:23], v[112:127]
    ds_read_b128 v[20:23], v3 offset:3072
    s_waitcnt lgkmcnt(6)
    v_mfma_f32_32x32x16_bf16 v[112:127], v[148:151], v[24:27], v[112:127]
    ds_read_b128 v[24:27], v3 offset:4096
    s_waitcnt lgkmcnt(6)
    v_mfma_f32_32x32x16_bf16 v[112:127], v[152:155], v[28:31], v[112:127]
    ds_read_b128 v[28:31], v3 offset:5120
    s_waitcnt lgkmcnt(6)
    v_mfma_f32_32x32x16_bf16 v[112:127], v[156:159], v[32:35], v[112:127]
    ds_read_b128 v[32:35], v3 offset:6144
    global_store_dwordx4 v6, v[100:103], s[46:47] offset:1024 sc1
    s_waitcnt lgkmcnt(6)
    v_mfma_f32_32x32x16_bf16 v[112:127], v[160:163], v[36:39], v[112:127]
    ds_read_b128 v[36:39], v3 offset:7168
    s_waitcnt lgkmcnt(6)
    v_mfma_f32_32x32x16_bf16 v[112:127], v[164:167], v[40:43], v[112:127]
    ds_read_b128 v[40:43], v4 offset:0
    s_waitcnt lgkmcnt(6)
    v_mfma_f32_32x32x16_bf16 v[112:127], v[168:171], v[44:47], v[112:127]
    ds_read_b128 v[44:47], v4 offset:1024
    s_waitcnt lgkmcnt(6)
    v_mfma_f32_32x32x16_bf16 v[112:127], v[172:175], v[20:23], v[112:127]
    ds_read_b128 v[20:23], v4 offset:2048
    s_waitcnt lgkmcnt(6)
    v_mfma_f32_32x32x16_bf16 v[112:127], v[176:179], v[24:27], v[112:127]
    ds_read_b128 v[24:27], v4 offset:3072
    s_waitcnt lgkmcnt(6)
    v_mfma_f32_32x32x16_bf16 v[112:127], v[180:183], v[28:31], v[112:127]
    ds_read_b128 v[28:31], v4 offset:4096
    s_waitcnt lgkmcnt(6)
    v_mfma_f32_32x32x16_bf16 v[112:127], v[184:187], v[32:35], v[112:127]
    ds_read_b128 v[32:35], v4 offset:5120
    s_waitcnt lgkmcnt(6)
    v_mfma_f32_32x32x16_bf16 v[112:127], v[188:191], v[36:39], v[112:127]
    ds_read_b128 v[36:39], v4 offset:6144
    s_waitcnt lgkmcnt(6)
    v_mfma_f32_32x32x16_bf16 v[112:127], v[192:195], v[40:43], v[112:127]
    ds_read_b128 v[40:43], v4 offset:7168
    s_waitcnt lgkmcnt(6)
    v_mfma_f32_32x32x16_bf16 v[112:127], v[196:199], v[44:47], v[112:127]
    ds_read_b128 v[44:47], v5 offset:0
    s_waitcnt lgkmcnt(6)
    v_mfma_f32_32x32x16_bf16 v[112:127], v[200:203], v[20:23], v[112:127]
    ds_read_b128 v[20:23], v5 offset:1024
    s_waitcnt lgkmcnt(6)
    v_mfma_f32_32x32x16_bf16 v[112:127], v[204:207], v[24:27], v[112:127]
    ds_read_b128 v[24:27], v5 offset:2048
    s_waitcnt lgkmcnt(6)
    v_mfma_f32_32x32x16_bf16 v[112:127], v[208:211], v[28:31], v[112:127]
    ds_read_b128 v[28:31], v5 offset:3072
    s_waitcnt lgkmcnt(6)
    v_mfma_f32_32x32x16_bf16 v[112:127], v[212:215], v[32:35], v[112:127]
    ds_read_b128 v[32:35], v5 offset:4096
    s_waitcnt lgkmcnt(6)
    v_mfma_f32_32x32x16_bf16 v[112:127], v[216:219], v[36:39], v[112:127]
    ds_read_b128 v[36:39], v5 offset:5120
    s_waitcnt lgkmcnt(6)
    v_mfma_f32_32x32x16_bf16 v[112:127], v[220:223], v[40:43], v[112:127]
    ds_read_b128 v[40:43], v5 offset:6144
    s_waitcnt lgkmcnt(6)
    v_mfma_f32_32x32x16_bf16 v[112:127], v[224:227], v[44:47], v[112:127]
    ds_read_b128 v[44:47], v5 offset:7168
    s_waitcnt lgkmcnt(6)
    v_mfma_f32_32x32x16_bf16 v[112:127], v[228:231], v[20:23], v[112:127]
    s_waitcnt lgkmcnt(5)
    v_mfma_f32_32x32x16_bf16 v[112:127], v[232:235], v[24:27], v[112:127]
    s_waitcnt lgkmcnt(4)
    v_mfma_f32_32x32x16_bf16 v[112:127], v[236:239], v[28:31], v[112:127]
    v_xor_b32 v2, 0x8000, v2
    v_xor_b32 v3, 0x8000, v3
    v_xor_b32 v4, 0x8000, v4
    v_xor_b32 v5, 0x8000, v5
    s_waitcnt lgkmcnt(3)
    v_mfma_f32_32x32x16_bf16 v[112:127], v[240:243], v[32:35], v[112:127]
    s_waitcnt vmcnt(6)
    ds_read_b128 v[48:51], v2 offset:0
    ds_read_b128 v[52:55], v2 offset:1024
    s_waitcnt lgkmcnt(4)
    v_mfma_f32_32x32x16_bf16 v[112:127], v[244:247], v[36:39], v[112:127]
    ds_read_b128 v[56:59], v2 offset:2048
    ds_read_b128 v[60:63], v2 offset:3072
    s_waitcnt lgkmcnt(5)
    v_mfma_f32_32x32x16_bf16 v[112:127], v[248:251], v[40:43], v[112:127]
    ds_read_b128 v[64:67], v2 offset:4096
    ds_read_b128 v[68:71], v2 offset:5120
    s_waitcnt lgkmcnt(6)
    v_mfma_f32_32x32x16_bf16 v[112:127], v[252:255], v[44:47], v[112:127]
    ds_read_b128 v[72:75], v2 offset:6144
    ds_read_b128 v[76:79], v2 offset:7168
    s_cmp_ge_u32 s27, 64
    s_cbranch_scc0 QK_HQ
    s_nop 7
    v_cvt_pk_bf16_f32 v112, v112, v120
    v_cvt_pk_bf16_f32 v113, v113, v121
    v_cvt_pk_bf16_f32 v114, v114, v122
    v_cvt_pk_bf16_f32 v115, v115, v123
    global_store_dwordx4 v6, v[112:115], s[42:43] offset:0 sc1
    v_cvt_pk_bf16_f32 v116, v116, v124
    v_cvt_pk_bf16_f32 v117, v117, v125
    v_cvt_pk_bf16_f32 v118, v118, v126
    v_cvt_pk_bf16_f32 v119, v119, v127
    global_store_dwordx4 v6, v[116:119], s[42:43] offset:1024 sc1
    s_waitcnt lgkmcnt(0)
QK_FQ:
    s_waitcnt vmcnt(2)
    global_store_dword v7, v9, s[40:41] sc1
    s_waitcnt vmcnt(1)
    s_cmp_eq_u32 s18, 0
    s_cbranch_scc1 PG_119
    global_store_dword v8, v12, s[4:5]
PG_119_R:
    s_cmp_lt_u32 s27, 64
    s_cbranch_scc1 QK_SPIN0
    s_endpgm
QK_KV:
    s_waitcnt lgkmcnt(6)
    v_mfma_f32_32x32x16_bf16 v[80:95], a[32:35], v[20:23], v[80:95]
    s_bfm_b64 s[14:15], s27, 0
    s_and_b64 s[14:15], s[14:15], s[32:33]
    s_bcnt1_i32_b64 s14, s[14:15]
    s_sub_u32 s15, s27, s14
    v_mfma_f32_32x32x16_bf16 v[96:111], v[20:23], a[160:163], v[96:111]
    ds_read_b128 v[20:23], v3 offset:7168
    s_add_u32 s14, s14, 32
    s_bitcmp1_b64 s[32:33], s27
    s_cselect_b32 s14, s14, s15
    s_waitcnt lgkmcnt(6)
    v_mfma_f32_32x32x16_bf16 v[80:95], a[36:39], v[24:27], v[80:95]
    s_min_u32 s14, s14, 63
    s_lshl_b32 s14, s14, 1
    s_add_u32 s14, s14, s10
    s_sub_u32 s28, s14, 2
    global_store_dwordx4 v14, v[16:19], s[42:43] sc1
    v_mfma_f32_32x32x16_bf16 v[96:111], v[24:27], a[164:167], v[96:111]
    ds_read_b128 v[24:27], v4 offset:0
    s_and_b32 s14, s28, 64
    s_add_u32 s14, s14, s28
    s_lshl_b32 s15, s14, 15
    s_add_u32 s15, s15, s26
    s_waitcnt lgkmcnt(6)
    v_mfma_f32_32x32x16_bf16 v[80:95], a[40:43], v[28:31], v[80:95]
    s_add_u32 s15, s15, 4194304
    s_add_u32 s34, s4, s15
    s_addc_u32 s35, s5, 0
    s_add_u32 s38, s34, 0x1000
    s_addc_u32 s39, s35, 0
    v_mfma_f32_32x32x16_bf16 v[96:111], v[28:31], a[168:171], v[96:111]
    ds_read_b128 v[28:31], v4 offset:1024
    s_waitcnt lgkmcnt(6)
    v_mfma_f32_32x32x16_bf16 v[80:95], a[44:47], v[32:35], v[80:95]
    v_mfma_f32_32x32x16_bf16 v[96:111], v[32:35], a[172:175], v[96:111]
    ds_read_b128 v[32:35], v4 offset:2048
    s_waitcnt lgkmcnt(6)
    v_mfma_f32_32x32x16_bf16 v[80:95], a[48:51], v[36:39], v[80:95]
    v_mfma_f32_32x32x16_bf16 v[96:111], v[36:39], a[176:179], v[96:111]
    ds_read_b128 v[36:39], v4 offset:3072
    s_mov_b32 m0, s29
    s_waitcnt lgkmcnt(6)
    v_mfma_f32_32x32x16_bf16 v[80:95], a[52:55], v[40:43], v[80:95]
    global_load_lds_dwordx4 v1, s[34:35] offset:0 sc1
    v_mfma_f32_32x32x16_bf16 v[96:111], v[40:43], a[180:183], v[96:111]
    ds_read_b128 v[40:43], v4 offset:4096
    s_waitcnt lgkmcnt(6)
    v_mfma_f32_32x32x16_bf16 v[80:95], a[56:59], v[44:47], v[80:95]
    global_load_lds_dwordx4 v1, s[34:35] offset:1024 sc1
    v_mfma_f32_32x32x16_bf16 v[96:111], v[44:47], a[184:187], v[96:111]
    ds_read_b128 v[44:47], v4 offset:5120
    s_waitcnt lgkmcnt(6)
    v_mfma_f32_32x32x16_bf16 v[80:95], a[60:63], v[20:23], v[80:95]
    global_load_lds_dwordx4 v1, s[34:35] offset:2048 sc1
    v_mfma_f32_32x32x16_bf16 v[96:111], v[20:23], a[188:191], v[96:111]
    ds_read_b128 v[20:23], v4 offset:6144
    s_waitcnt lgkmcnt(6)
    v_mfma_f32_32x32x16_bf16 v[80:95], a[64:67], v[24:27], v[80:95]
    global_load_lds_dwordx4 v1, s[34:35] offset:3072 sc1
    v_mfma_f32_32x32x16_bf16 v[96:111], v[24:27], a[192:195], v[96:111]
    ds_read_b128 v[24:27], v4 offset:7168
    s_add_u32 m0, s29, 4096
    s_waitcnt lgkmcnt(6)
    v_mfma_f32_32x32x16_bf16 v[80:95], a[68:71], v[28:31], v[80:95]
    global_load_lds_dwordx4 v1, s[38:39] offset:0 sc1
    v_mfma_f32_32x32x16_bf16 v[96:111], v[28:31], a[196:199], v[96:111]
    ds_read_b128 v[28:31], v5 offset:0
    s_waitcnt lgkmcnt(6)
    v_mfma_f32_32x32x16_bf16 v[80:95], a[72:75], v[32:35], v[80:95]
    global_load_lds_dwordx4 v1, s[38:39] offset:1024 sc1
    v_mfma_f32_32x32x16_bf16 v[96:111], v[32:35], a[200:203], v[96:111]
    ds_read_b128 v[32:35], v5 offset:1024
    s_waitcnt lgkmcnt(6)
    v_mfma_f32_32x32x16_bf16 v[80:95], a[76:79], v[36:39], v[80:95]
    global_load_lds_dwordx4 v1, s[38:39] offset:2048 sc1
    v_mfma_f32_32x32x16_bf16 v[96:111], v[36:39], a[204:207], v[96:111]
    ds_read_b128 v[36:39], v5 offset:2048
    s_waitcnt lgkmcnt(6)
    v_mfma_f32_32x32x16_bf16 v[80:95], a[80:83], v[40:43], v[80:95]
    global_load_lds_dwordx4 v1, s[38:39] offset:3072 sc1
    v_mfma_f32_32x32x16_bf16 v[96:111], v[40:43], a[208:211], v[96:111]
    ds_read_b128 v[40:43], v5 offset:3072
    s_waitcnt lgkmcnt(6)
    v_mfma_f32_32x32x16_bf16 v[80:95], a[84:87], v[44:47], v[80:95]
    v_mfma_f32_32x32x16_bf16 v[96:111], v[44:47], a[212:215], v[96:111]
    ds_read_b128 v[44:47], v5 offset:4096
    s_waitcnt lgkmcnt(6)
    v_mfma_f32_32x32x16_bf16 v[80:95], a[88:91], v[20:23], v[80:95]
    v_mfma_f32_32x32x16_bf16 v[96:111], v[20:23], a[216:219], v[96:111]
    ds_read_b128 v[20:23], v5 offset:5120
    s_waitcnt lgkmcnt(6)
    v_mfma_f32_32x32x16_bf16 v[80:95], a[92:95], v[24:27], v[80:95]
    v_mfma_f32_32x32x16_bf16 v[96:111], v[24:27], a[220:223], v[96:111]
    ds_read_b128 v[24:27], v5 offset:6144
    s_waitcnt lgkmcnt(6)
    v_mfma_f32_32x32x16_bf16 v[80:95], a[96:99], v[28:31], v[80:95]
    v_mfma_f32_32x32x16_bf16 v[96:111], v[28:31], a[224:227], v[96:111]
    ds_read_b128 v[28:31], v5 offset:7168
    s_waitcnt lgkmcnt(6)
    v_mfma_f32_32x32x16_bf16 v[80:95], a[100:103], v[32:35], v[80:95]
    s_waitcnt lgkmcnt(5)
    v_mfma_f32_32x32x16_bf16 v[80:95], a[104:107], v[36:39], v[80:95]
    s_waitcnt lgkmcnt(4)
    v_mfma_f32_32x32x16_bf16 v[80:95], a[108:111], v[40:43], v[80:95]
    v_xor_b32 v2, 0x8000, v2
    v_xor_b32 v3, 0x8000, v3
    v_xor_b32 v4, 0x8000, v4
    v_xor_b32 v5, 0x8000, v5
    s_waitcnt lgkmcnt(3)
    v_mfma_f32_32x32x16_bf16 v[80:95], a[112:115], v[44:47], v[80:95]
    s_waitcnt lgkmcnt(2)
    v_mfma_f32_32x32x16_bf16 v[80:95], a[116:119], v[20:23], v[80:95]
    s_waitcnt lgkmcnt(1)
    v_mfma_f32_32x32x16_bf16 v[80:95], a[120:123], v[24:27], v[80:95]
    s_waitcnt vmcnt(8)
    s_cmp_eq_u32 s18, 0
    s_cbranch_scc1 PG_120
    global_store_dword v8, v12, s[4:5]
PG_120_R:
    s_waitcnt lgkmcnt(0)
    v_mfma_f32_32x32x16_bf16 v[80:95], a[124:127], v[28:31], v[80:95]
    global_store_dword v7, v9, s[40:41] sc1
    v_mfma_f32_32x32x16_bf16 v[96:111], v[32:35], a[228:231], v[96:111]
    s_mov_b64 s[40:41], s[48:49]
    v_mov_b32 v8, s54
    v_mov_b32 v12, s55
    v_mfma_f32_32x32x16_bf16 v[96:111], v[36:39], a[232:235], v[96:111]
    v_cvt_pk_bf16_f32 v80, v80, v88
    v_cvt_pk_bf16_f32 v81, v81, v89
    v_cvt_pk_bf16_f32 v82, v82, v90
    v_cvt_pk_bf16_f32 v83, v83, v91
    v_mfma_f32_32x32x16_bf16 v[96:111], v[40:43], a[236:239], v[96:111]
    global_store_dwordx4 v6, v[80:83], s[44:45] offset:0 sc1
    v_cvt_pk_bf16_f32 v84, v84, v92
    v_cvt_pk_bf16_f32 v85, v85, v93
    v_cvt_pk_bf16_f32 v86, v86, v94
    v_cvt_pk_bf16_f32 v87, v87, v95
    v_mfma_f32_32x32x16_bf16 v[96:111], v[44:47], a[240:243], v[96:111]
    s_waitcnt vmcnt(3)
    ds_read_b128 v[48:51], v2 offset:0
    ds_read_b128 v[52:55], v2 offset:1024
    v_mfma_f32_32x32x16_bf16 v[96:111], v[20:23], a[244:247], v[96:111]
    ds_read_b128 v[56:59], v2 offset:2048
    ds_read_b128 v[60:63], v2 offset:3072
    v_mfma_f32_32x32x16_bf16 v[96:111], v[24:27], a[248:251], v[96:111]
    ds_read_b128 v[64:67], v2 offset:4096
    ds_read_b128 v[68:71], v2 offset:5120
    v_mfma_f32_32x32x16_bf16 v[96:111], v[28:31], a[252:255], v[96:111]
    ds_read_b128 v[72:75], v2 offset:6144
    ds_read_b128 v[76:79], v2 offset:7168
    global_store_dwordx4 v6, v[84:87], s[44:45] offset:1024 sc1
QK_HV:
    s_waitcnt lgkmcnt(7)
    s_nop 0
    v_mfma_f32_32x32x16_bf16 v[80:95], a[0:3], v[48:51], 0
    s_waitcnt lgkmcnt(6)
    v_mfma_f32_32x32x16_bf16 v[80:95], a[4:7], v[52:55], v[80:95]
    v_cvt_pk_bf16_f32 v96, v96, v97
    v_cvt_pk_bf16_f32 v97, v98, v99
    v_cvt_pk_bf16_f32 v98, v104, v105
    v_cvt_pk_bf16_f32 v99, v106, v107
    v_max_u32 v15, v48, v52
    s_waitcnt lgkmcnt(5)
    v_mfma_f32_32x32x16_bf16 v[80:95], a[8:11], v[56:59], v[80:95]
    global_store_dwordx4 v6, v[96:99], s[46:47] offset:0 sc1
    s_waitcnt lgkmcnt(4)
    v_mfma_f32_32x32x16_bf16 v[80:95], a[12:15], v[60:63], v[80:95]
    v_cvt_pk_bf16_f32 v100, v100, v101
    v_cvt_pk_bf16_f32 v101, v102, v103
    v_max3_u32 v15, v15, v56, v60
    s_waitcnt lgkmcnt(3)
    v_mfma_f32_32x32x16_bf16 v[80:95], a[16:19], v[64:67], v[80:95]
    v_cvt_pk_bf16_f32 v102, v108, v109
    v_cvt_pk_bf16_f32 v103, v110, v111
    s_waitcnt lgkmcnt(2)
    v_mfma_f32_32x32x16_bf16 v[80:95], a[20:23], v[68:71], v[80:95]
    v_max3_u32 v15, v15, v64, v68
    s_waitcnt lgkmcnt(1)
    v_mfma_f32_32x32x16_bf16 v[80:95], a[24:27], v[72:75], v[80:95]
    global_store_dwordx4 v6, v[100:103], s[46:47] offset:1024 sc1
    s_waitcnt lgkmcnt(0)
    v_mfma_f32_32x32x16_bf16 v[80:95], a[28:31], v[76:79], v[80:95]
    v_max3_u32 v15, v15, v72, v76
    v_cmp_eq_u32 vcc, -1, v15
    v_mfma_f32_32x32x16_bf16 v[96:111], v[48:51], a[128:131], 0
    s_cbranch_vccnz QK_FV2
    s_barrier
    v_mfma_f32_32x32x16_bf16 v[96:111], v[52:55], a[132:135], v[96:111]
    ds_read_b128 v[20:23], v3 offset:0
    s_branch QK_J
QK_FV:
    s_waitcnt vmcnt(0)
    global_store_dword v7, v9, s[40:41] sc1
    s_cmp_eq_u32 s18, 0
    s_cbranch_scc1 PG_121
    global_store_dword v8, v12, s[4:5]
PG_121_R:
    s_branch QK_SPIN0
QK_FQ2:
    s_mov_b32 m0, s29
    s_nop 0
    global_load_lds_dwordx4 v1, s[34:35] offset:0 sc1
    global_load_lds_dwordx4 v1, s[34:35] offset:1024 sc1
    global_load_lds_dwordx4 v1, s[34:35] offset:2048 sc1
    global_load_lds_dwordx4 v1, s[34:35] offset:3072 sc1
    s_add_u32 m0, s29, 4096
    s_nop 0
    global_load_lds_dwordx4 v1, s[38:39] offset:0 sc1
    global_load_lds_dwordx4 v1, s[38:39] offset:1024 sc1
    global_load_lds_dwordx4 v1, s[38:39] offset:2048 sc1
    global_load_lds_dwordx4 v1, s[38:39] offset:3072 sc1
    s_mov_b32 s12, 0
    s_waitcnt vmcnt(10)
    global_store_dword v7, v9, s[40:41] sc1
    s_waitcnt vmcnt(9)
    s_cmp_eq_u32 s18, 0
    s_cbranch_scc1 PG_122
    global_store_dword v8, v12, s[4:5]
PG_122_R:
    s_waitcnt vmcnt(2)
    s_branch QK_GO2
QK_FV2:
    s_mov_b32 m0, s29
    s_nop 0
    global_load_lds_dwordx4 v1, s[34:35] offset:0 sc1
    global_load_lds_dwordx4 v1, s[34:35] offset:1024 sc1
    global_load_lds_dwordx4 v1, s[34:35] offset:2048 sc1
    global_load_lds_dwordx4 v1, s[34:35] offset:3072 sc1
    s_add_u32 m0, s29, 4096
    s_nop 0
    global_load_lds_dwordx4 v1, s[38:39] offset:0 sc1
    global_load_lds_dwordx4 v1, s[38:39] offset:1024 sc1
    global_load_lds_dwordx4 v1, s[38:39] offset:2048 sc1
    global_load_lds_dwordx4 v1, s[38:39] offset:3072 sc1
    s_mov_b32 s12, 0
    s_waitcnt vmcnt(8)
    global_store_dword v7, v9, s[40:41] sc1
    s_cmp_eq_u32 s18, 0
    s_cbranch_scc1 PG_123
    global_store_dword v8, v12, s[4:5]
PG_123_R:
    s_waitcnt vmcnt(2)
    s_branch QK_GO2
QK_XB:
    v_and_b32 v11, 31, v0
    v_max_u32 v11, 14, v11
    v_and_or_b32 v11, v0, 32, v11
    v_lshlrev_b32 v11, 3, v11
    v_add_u32 v11, 333312, v11
    s_mov_b32 s12, 0
POLL_124:
    global_load_dword v10, v11, s[4:5] offset:0 sc1
    s_add_u32 s12, s12, 1
    s_mov_b32 s17, 19
    s_cmp_gt_u32 s12, 20000
    s_cbranch_scc1 TIMEOUT
    s_waitcnt vmcnt(0)
    v_cmp_ne_u32 vcc, s8, v10
    s_cbranch_vccnz POLL_124
    s_branch QK_XBR
PG_118:
    global_store_dword v8, v12, s[4:5] sc1
    s_branch PG_118_R
PG_119:
    global_store_dword v8, v12, s[4:5] sc1
    s_branch PG_119_R
PG_120:
    global_store_dword v8, v12, s[4:5] sc1
    s_branch PG_120_R
PG_121:
    global_store_dword v8, v12, s[4:5] sc1
    s_branch PG_121_R
PG_122:
    global_store_dword v8, v12, s[4:5] sc1
    s_branch PG_122_R
PG_123:
    global_store_dword v8, v12, s[4:5] sc1
    s_branch PG_123_R
ROLE_QX:
    s_lshl_b32 s14, s13, 1
    s_add_u32 s11, s11, s14
    s_sub_u32 s11, s11, 16
    s_lshl_b32 s11, s11, 2
    s_mov_b32 s63, s11
    s_mov_b32 s62, 2048
    s_branch QH_IN
ROLE_QH:
    s_mov_b32 s62, 0
    s_mov_b32 s63, 0
QH_IN:
    s_load_dwordx2 s[22:23], s[0:1], 16
    s_lshl_b32 s52, s11, 7
    s_add_u32 s52, s52, 376832
    s_add_u32 s52, s52, s62
    s_lshl_b32 s11, s11, 1
    s_mov_b32 s32, 0x0
    s_mov_b32 s33, 0xffffffc0
    s_cmp_lg_u32 s62, 0
    s_cselect_b32 s32, 0x0, s32
    s_cselect_b32 s33, 0x0, s33
    s_lshl_b32 s26, s9, 13
    s_mul_i32 s36, s11, 2129920
    s_add_u32 s36, s36, 18874368
    s_lshl_b32 s37, s11, 5
    s_add_u32 s37, s37, 393216
    v_lshrrev_b32 v10, 4, v0
    v_lshlrev_b32 v11, 2, v10
    v_and_b32 v20, 15, v0
    v_xor_b32 v20, v20, v11
    v_lshlrev_b32 v20, 4, v20
    v_mul_u32_u24 v10, 8192, v10
    v_add_u32 v20, v20, v10
    s_lshl_b32 s14, s9, 18
    s_lshl_b32 s15, s11, 8
    s_add_u32 s14, s14, s15
    v_add_u32 v20, s14, v20
    v_bfe_u32 v10, v0, 2, 2
    v_mul_u32_u24 v21, 320, v10
    v_bfe_u32 v10, v0, 4, 1
    v_lshl_add_u32 v21, v10, 5, v21
    v_and_b32 v10, 3, v0
    v_lshl_add_u32 v21, v10, 3, v21
    v_lshrrev_b32 v10, 5, v0
    v_mul_u32_u24 v10, 2048, v10
    v_add_u32 v21, v21, v10
    s_lshl_b32 s14, s9, 6
    v_xor_b32 v21, s14, v21
    v_add_u32 v22, 0x10000, v21
    v_add_u32 v23, 0x20000, v21
    s_waitcnt lgkmcnt(0)
    s_add_u32 s24, s22, 0x100
    s_addc_u32 s25, s23, 0
    s_cmp_eq_u32 s13, 0
    s_cbranch_scc1 LS_125_E
    v_lshlrev_b32 v11, 4, v0
    v_add_u32 v11, 327680, v11
    s_mov_b32 s12, 0
LS_125:
    global_load_dword v10, v11, s[4:5] sc1
    s_add_u32 s12, s12, 1
    s_mov_b32 s17, 27
    s_cmp_gt_u32 s12, 20000
    s_cbranch_scc1 TIMEOUT
    s_waitcnt vmcnt(0)
    v_cmp_ne_u32 vcc, s8, v10
    s_cbranch_vccnz LS_125
LS_125_E:
    s_add_u32 s42, s22, 0x0
    s_addc_u32 s43, s23, 0
    s_add_u32 m0, s26, 0
    s_nop 0
    global_load_lds_dwordx4 v20, s[42:43]
    s_add_u32 s42, s22, 0x8000
    s_addc_u32 s43, s23, 0
    s_add_u32 m0, s26, 1024
    s_nop 0
    global_load_lds_dwordx4 v20, s[42:43]
    s_add_u32 s42, s22, 0x10000
    s_addc_u32 s43, s23, 0
    s_add_u32 m0, s26, 2048
    s_nop 0
    global_load_lds_dwordx4 v20, s[42:43]
    s_add_u32 s42, s22, 0x18000
    s_addc_u32 s43, s23, 0
    s_add_u32 m0, s26, 3072
    s_nop 0
    global_load_lds_dwordx4 v20, s[42:43]
    s_add_u32 s42, s22, 0x20000
    s_addc_u32 s43, s23, 0
    s_add_u32 m0, s26, 4096
    s_nop 0
    global_load_lds_dwordx4 v20, s[42:43]
    s_add_u32 s42, s22, 0x28000
    s_addc_u32 s43, s23, 0
    s_add_u32 m0, s26, 5120
    s_nop 0
    global_load_lds_dwordx4 v20, s[42:43]
    s_add_u32 s42, s22, 0x30000
    s_addc_u32 s43, s23, 0
    s_add_u32 m0, s26, 6144
    s_nop 0
    global_load_lds_dwordx4 v20, s[42:43]
    s_add_u32 s42, s22, 0x38000
    s_addc_u32 s43, s23, 0
    s_add_u32 m0, s26, 7168
    s_nop 0
    global_load_lds_dwordx4 v20, s[42:43]
    s_add_u32 s42, s22, 0x100000
    s_addc_u32 s43, s23, 0
    s_add_u32 m0, s26, 32768
    s_nop 0
    global_load_lds_dwordx4 v20, s[42:43]
    s_add_u32 s42, s22, 0x108000
    s_addc_u32 s43, s23, 0
    s_add_u32 m0, s26, 33792
    s_nop 0
    global_load_lds_dwordx4 v20, s[42:43]
    s_add_u32 s42, s22, 0x110000
    s_addc_u32 s43, s23, 0
    s_add_u32 m0, s26, 34816
    s_nop 0
    global_load_lds_dwordx4 v20, s[42:43]
    s_add_u32 s42, s22, 0x118000
    s_addc_u32 s43, s23, 0
    s_add_u32 m0, s26, 35840
    s_nop 0
    global_load_lds_dwordx4 v20, s[42:43]
    s_add_u32 s42, s22, 0x120000
    s_addc_u32 s43, s23, 0
    s_add_u32 m0, s26, 36864
    s_nop 0
    global_load_lds_dwordx4 v20, s[42:43]
    s_add_u32 s42, s22, 0x128000
    s_addc_u32 s43, s23, 0
    s_add_u32 m0, s26, 37888
    s_nop 0
    global_load_lds_dwordx4 v20, s[42:43]
    s_add_u32 s42, s22, 0x130000
    s_addc_u32 s43, s23, 0
    s_add_u32 m0, s26, 38912
    s_nop 0
    global_load_lds_dwordx4 v20, s[42:43]
    s_add_u32 s42, s22, 0x138000
    s_addc_u32 s43, s23, 0
    s_add_u32 m0, s26, 39936
    s_nop 0
    global_load_lds_dwordx4 v20, s[42:43]
    s_add_u32 s42, s22, 0x200000
    s_addc_u32 s43, s23, 0
    s_add_u32 m0, s26, 65536
    s_nop 0
    global_load_lds_dwordx4 v20, s[42:43]
    s_add_u32 s42, s22, 0x208000
    s_addc_u32 s43, s23, 0
    s_add_u32 m0, s26, 66560
    s_nop 0
    global_load_lds_dwordx4 v20, s[42:43]
    s_add_u32 s42, s22, 0x210000
    s_addc_u32 s43, s23, 0
    s_add_u32 m0, s26, 67584
    s_nop 0
    global_load_lds_dwordx4 v20, s[42:43]
    s_add_u32 s42, s22, 0x218000
    s_addc_u32 s43, s23, 0
    s_add_u32 m0, s26, 68608
    s_nop 0
    global_load_lds_dwordx4 v20, s[42:43]
    s_add_u32 s42, s22, 0x220000
    s_addc_u32 s43, s23, 0
    s_add_u32 m0, s26, 69632
    s_nop 0
    global_load_lds_dwordx4 v20, s[42:43]
    s_add_u32 s42, s22, 0x228000
    s_addc_u32 s43, s23, 0
    s_add_u32 m0, s26, 70656
    s_nop 0
    global_load_lds_dwordx4 v20, s[42:43]
    s_add_u32 s42, s22, 0x230000
    s_addc_u32 s43, s23, 0
    s_add_u32 m0, s26, 71680
    s_nop 0
    global_load_lds_dwordx4 v20, s[42:43]
    s_add_u32 s42, s22, 0x238000
    s_addc_u32 s43, s23, 0
    s_add_u32 m0, s26, 72704
    s_nop 0
    global_load_lds_dwordx4 v20, s[42:43]
    s_add_u32 s42, s22, 0x300000
    s_addc_u32 s43, s23, 0
    s_add_u32 m0, s26, 98304
    s_nop 0
    global_load_lds_dwordx4 v20, s[42:43]
    s_add_u32 s42, s22, 0x308000
    s_addc_u32 s43, s23, 0
    s_add_u32 m0, s26, 99328
    s_nop 0
    global_load_lds_dwordx4 v20, s[42:43]
    s_add_u32 s42, s22, 0x310000
    s_addc_u32 s43, s23, 0
    s_add_u32 m0, s26, 100352
    s_nop 0
    global_load_lds_dwordx4 v20, s[42:43]
    s_add_u32 s42, s22, 0x318000
    s_addc_u32 s43, s23, 0
    s_add_u32 m0, s26, 101376
    s_nop 0
    global_load_lds_dwordx4 v20, s[42:43]
    s_add_u32 s42, s22, 0x320000
    s_addc_u32 s43, s23, 0
    s_add_u32 m0, s26, 102400
    s_nop 0
    global_load_lds_dwordx4 v20, s[42:43]
    s_add_u32 s42, s22, 0x328000
    s_addc_u32 s43, s23, 0
    s_add_u32 m0, s26, 103424
    s_nop 0
    global_load_lds_dwordx4 v20, s[42:43]
    s_add_u32 s42, s22, 0x330000
    s_addc_u32 s43, s23, 0
    s_add_u32 m0, s26, 104448
    s_nop 0
    global_load_lds_dwordx4 v20, s[42:43]
    s_add_u32 s42, s22, 0x338000
    s_addc_u32 s43, s23, 0
    s_add_u32 m0, s26, 105472
    s_nop 0
    global_load_lds_dwordx4 v20, s[42:43]
    s_add_u32 s42, s24, 0x0
    s_addc_u32 s43, s25, 0
    s_add_u32 m0, s26, 131072
    s_nop 0
    global_load_lds_dwordx4 v20, s[42:43]
    s_add_u32 s42, s24, 0x8000
    s_addc_u32 s43, s25, 0
    s_add_u32 m0, s26, 132096
    s_nop 0
    global_load_lds_dwordx4 v20, s[42:43]
    s_add_u32 s42, s24, 0x10000
    s_addc_u32 s43, s25, 0
    s_add_u32 m0, s26, 133120
    s_nop 0
    global_load_lds_dwordx4 v20, s[42:43]
    s_add_u32 s42, s24, 0x18000
    s_addc_u32 s43, s25, 0
    s_add_u32 m0, s26, 134144
    s_nop 0
    global_load_lds_dwordx4 v20, s[42:43]
    s_add_u32 s42, s24, 0x20000
    s_addc_u32 s43, s25, 0
    s_add_u32 m0, s26, 135168
    s_nop 0
    global_load_lds_dwordx4 v20, s[42:43]
    s_add_u32 s42, s24, 0x28000
    s_addc_u32 s43, s25, 0
    s_add_u32 m0, s26, 136192
    s_nop 0
    global_load_lds_dwordx4 v20, s[42:43]
    s_add_u32 s42, s24, 0x30000
    s_addc_u32 s43, s25, 0
    s_add_u32 m0, s26, 137216
    s_nop 0
    global_load_lds_dwordx4 v20, s[42:43]
    s_add_u32 s42, s24, 0x38000
    s_addc_u32 s43, s25, 0
    s_add_u32 m0, s26, 138240
    s_nop 0
    global_load_lds_dwordx4 v20, s[42:43]
    v_lshlrev_b32 v1, 4, v0
    s_add_u32 s29, s26, 65536
    s_add_u32 s14, s9, 0
    s_and_b32 s14, s14, 3
    s_lshl_b32 s15, s14, 13
    s_add_u32 s15, s15, 65536
    v_add_u32 v2, s15, v1
    s_add_u32 s14, s9, 1
    s_and_b32 s14, s14, 3
    s_lshl_b32 s15, s14, 13
    s_add_u32 s15, s15, 65536
    v_add_u32 v3, s15, v1
    s_add_u32 s14, s9, 2
    s_and_b32 s14, s14, 3
    s_lshl_b32 s15, s14, 13
    s_add_u32 s15, s15, 65536
    v_add_u32 v4, s15, v1
    s_add_u32 s14, s9, 3
    s_and_b32 s14, s14, 3
    s_lshl_b32 s15, s14, 13
    s_add_u32 s15, s15, 65536
    v_add_u32 v5, s15, v1
    s_lshl_b32 s14, s9, 11
    v_add_u32 v6, s14, v1
    s_lshl_b32 s14, s9, 2
    v_mov_b32 v7, s14
    s_add_u32 s52, s52, s14
    s_bcnt0_i32_b64 s27, s[32:33]
    s_lshl_b32 s14, s2, 7
    s_add_u32 s14, s14, 32768
    v_add_u32 v8, s14, v7
    s_add_u32 s40, s4, s14
    s_addc_u32 s41, s5, 0
    s_lshl_b32 s14, s9, 10
    s_add_u32 s14, s14, 24576
    v_add_u32 v14, s14, v1
    v_bfe_u32 v10, v0, 2, 3
    v_lshlrev_b32 v1, 7, v10
    v_lshrrev_b32 v10, 5, v0
    v_lshl_add_u32 v1, v10, 6, v1
    v_and_b32 v10, 3, v0
    v_lshl_add_u32 v1, v10, 4, v1
    v_mov_b32 v16, -1
    v_mov_b32 v17, -1
    v_mov_b32 v18, -1
    v_mov_b32 v19, -1
    s_ff1_i32_b64 s14, s[32:33]
    s_min_u32 s28, s14, 63
    s_bitset0_b64 s[32:33], s28
    s_and_b32 s14, s28, 64
    s_add_u32 s14, s14, s28
    s_lshl_b32 s15, s14, 15
    s_add_u32 s15, s15, s26
    s_add_u32 s15, s15, 4194304
    s_add_u32 s34, s4, s15
    s_addc_u32 s35, s5, 0
    s_add_u32 s38, s34, 0x1000
    s_addc_u32 s39, s35, 0
    v_mov_b32 v9, s8
    s_lshl_b32 s53, s8, 7
    s_add_u32 s53, s53, 1
    s_waitcnt vmcnt(32)
    s_barrier
    s_cmp_lg_u32 s9, 0
    s_cbranch_scc1 QKR_127
    ds_read_b64_tr_b16 a[0:1], v21 offset:0
    ds_read_b64_tr_b16 a[2:3], v21 offset:1024
    ds_read_b64_tr_b16 a[4:5], v21 offset:4096
    ds_read_b64_tr_b16 a[6:7], v21 offset:5120
    ds_read_b64_tr_b16 a[8:9], v21 offset:8192
    ds_read_b64_tr_b16 a[10:11], v21 offset:9216
    ds_read_b64_tr_b16 a[12:13], v21 offset:12288
    ds_read_b64_tr_b16 a[14:15], v21 offset:13312
    ds_read_b64_tr_b16 a[16:17], v21 offset:16384
    ds_read_b64_tr_b16 a[18:19], v21 offset:17408
    ds_read_b64_tr_b16 a[20:21], v21 offset:20480
    ds_read_b64_tr_b16 a[22:23], v21 offset:21504
    ds_read_b64_tr_b16 a[24:25], v21 offset:24576
    ds_read_b64_tr_b16 a[26:27], v21 offset:25600
    ds_read_b64_tr_b16 a[28:29], v21 offset:28672
    ds_read_b64_tr_b16 a[30:31], v21 offset:29696
    s_branch QKR_126
QKR_127:
    s_cmp_lg_u32 s9, 1
    s_cbranch_scc1 QKR_128
    ds_read_b64_tr_b16 a[96:97], v21 offset:0
    ds_read_b64_tr_b16 a[98:99], v21 offset:1024
    ds_read_b64_tr_b16 a[100:101], v21 offset:4096
    ds_read_b64_tr_b16 a[102:103], v21 offset:5120
    ds_read_b64_tr_b16 a[104:105], v21 offset:8192
    ds_read_b64_tr_b16 a[106:107], v21 offset:9216
    ds_read_b64_tr_b16 a[108:109], v21 offset:12288
    ds_read_b64_tr_b16 a[110:111], v21 offset:13312
    ds_read_b64_tr_b16 a[112:113], v21 offset:16384
    ds_read_b64_tr_b16 a[114:115], v21 offset:17408
    ds_read_b64_tr_b16 a[116:117], v21 offset:20480
    ds_read_b64_tr_b16 a[118:119], v21 offset:21504
    ds_read_b64_tr_b16 a[120:121], v21 offset:24576
    ds_read_b64_tr_b16 a[122:123], v21 offset:25600
    ds_read_b64_tr_b16 a[124:125], v21 offset:28672
    ds_read_b64_tr_b16 a[126:127], v21 offset:29696
    s_branch QKR_126
QKR_128:
    s_cmp_lg_u32 s9, 2
    s_cbranch_scc1 QKR_129
    ds_read_b64_tr_b16 a[64:65], v21 offset:0
    ds_read_b64_tr_b16 a[66:67], v21 offset:1024
    ds_read_b64_tr_b16 a[68:69], v21 offset:4096
    ds_read_b64_tr_b16 a[70:71], v21 offset:5120
    ds_read_b64_tr_b16 a[72:73], v21 offset:8192
    ds_read_b64_tr_b16 a[74:75], v21 offset:9216
    ds_read_b64_tr_b16 a[76:77], v21 offset:12288
    ds_read_b64_tr_b16 a[78:79], v21 offset:13312
    ds_read_b64_tr_b16 a[80:81], v21 offset:16384
    ds_read_b64_tr_b16 a[82:83], v21 offset:17408
    ds_read_b64_tr_b16 a[84:85], v21 offset:20480
    ds_read_b64_tr_b16 a[86:87], v21 offset:21504
    ds_read_b64_tr_b16 a[88:89], v21 offset:24576
    ds_read_b64_tr_b16 a[90:91], v21 offset:25600
    ds_read_b64_tr_b16 a[92:93], v21 offset:28672
    ds_read_b64_tr_b16 a[94:95], v21 offset:29696
    s_branch QKR_126
QKR_129:
    ds_read_b64_tr_b16 a[32:33], v21 offset:0
    ds_read_b64_tr_b16 a[34:35], v21 offset:1024
    ds_read_b64_tr_b16 a[36:37], v21 offset:4096
    ds_read_b64_tr_b16 a[38:39], v21 offset:5120
    ds_read_b64_tr_b16 a[40:41], v21 offset:8192
    ds_read_b64_tr_b16 a[42:43], v21 offset:9216
    ds_read_b64_tr_b16 a[44:45], v21 offset:12288
    ds_read_b64_tr_b16 a[46:47], v21 offset:13312
    ds_read_b64_tr_b16 a[48:49], v21 offset:16384
    ds_read_b64_tr_b16 a[50:51], v21 offset:17408
    ds_read_b64_tr_b16 a[52:53], v21 offset:20480
    ds_read_b64_tr_b16 a[54:55], v21 offset:21504
    ds_read_b64_tr_b16 a[56:57], v21 offset:24576
    ds_read_b64_tr_b16 a[58:59], v21 offset:25600
    ds_read_b64_tr_b16 a[60:61], v21 offset:28672
    ds_read_b64_tr_b16 a[62:63], v21 offset:29696
QKR_126:
    s_waitcnt lgkmcnt(0)
    s_barrier
    s_add_u32 s42, s24, 0x100000
    s_addc_u32 s43, s25, 0
    s_add_u32 m0, s26, 0
    s_nop 0
    global_load_lds_dwordx4 v20, s[42:43]
    s_add_u32 s42, s24, 0x108000
    s_addc_u32 s43, s25, 0
    s_add_u32 m0, s26, 1024
    s_nop 0
    global_load_lds_dwordx4 v20, s[42:43]
    s_add_u32 s42, s24, 0x110000
    s_addc_u32 s43, s25, 0
    s_add_u32 m0, s26, 2048
    s_nop 0
    global_load_lds_dwordx4 v20, s[42:43]
    s_add_u32 s42, s24, 0x118000
    s_addc_u32 s43, s25, 0
    s_add_u32 m0, s26, 3072
    s_nop 0
    global_load_lds_dwordx4 v20, s[42:43]
    s_add_u32 s42, s24, 0x120000
    s_addc_u32 s43, s25, 0
    s_add_u32 m0, s26, 4096
    s_nop 0
    global_load_lds_dwordx4 v20, s[42:43]
    s_add_u32 s42, s24, 0x128000
    s_addc_u32 s43, s25, 0
    s_add_u32 m0, s26, 5120
    s_nop 0
    global_load_lds_dwordx4 v20, s[42:43]
    s_add_u32 s42, s24, 0x130000
    s_addc_u32 s43, s25, 0
    s_add_u32 m0, s26, 6144
    s_nop 0
    global_load_lds_dwordx4 v20, s[42:43]
    s_add_u32 s42, s24, 0x138000
    s_addc_u32 s43, s25, 0
    s_add_u32 m0, s26, 7168
    s_nop 0
    global_load_lds_dwordx4 v20, s[42:43]
    s_waitcnt vmcnt(32)
    s_barrier
    s_cmp_lg_u32 s9, 0
    s_cbranch_scc1 QKR_132
    ds_read_b64_tr_b16 a[32:33], v21 offset:32768
    ds_read_b64_tr_b16 a[34:35], v21 offset:33792
    ds_read_b64_tr_b16 a[36:37], v21 offset:36864
    ds_read_b64_tr_b16 a[38:39], v21 offset:37888
    ds_read_b64_tr_b16 a[40:41], v21 offset:40960
    ds_read_b64_tr_b16 a[42:43], v21 offset:41984
    ds_read_b64_tr_b16 a[44:45], v21 offset:45056
    ds_read_b64_tr_b16 a[46:47], v21 offset:46080
    ds_read_b64_tr_b16 a[48:49], v21 offset:49152
    ds_read_b64_tr_b16 a[50:51], v21 offset:50176
    ds_read_b64_tr_b16 a[52:53], v21 offset:53248
    ds_read_b64_tr_b16 a[54:55], v21 offset:54272
    ds_read_b64_tr_b16 a[56:57], v21 offset:57344
    ds_read_b64_tr_b16 a[58:59], v21 offset:58368
    ds_read_b64_tr_b16 a[60:61], v21 offset:61440
    ds_read_b64_tr_b16 a[62:63], v21 offset:62464
    s_branch QKR_131
QKR_132:
    s_cmp_lg_u32 s9, 1
    s_cbranch_scc1 QKR_133
    ds_read_b64_tr_b16 a[0:1], v21 offset:32768
    ds_read_b64_tr_b16 a[2:3], v21 offset:33792
    ds_read_b64_tr_b16 a[4:5], v21 offset:36864
    ds_read_b64_tr_b16 a[6:7], v21 offset:37888
    ds_read_b64_tr_b16 a[8:9], v21 offset:40960
    ds_read_b64_tr_b16 a[10:11], v21 offset:41984
    ds_read_b64_tr_b16 a[12:13], v21 offset:45056
    ds_read_b64_tr_b16 a[14:15], v21 offset:46080
    ds_read_b64_tr_b16 a[16:17], v21 offset:49152
    ds_read_b64_tr_b16 a[18:19], v21 offset:50176
    ds_read_b64_tr_b16 a[20:21], v21 offset:53248
    ds_read_b64_tr_b16 a[22:23], v21 offset:54272
    ds_read_b64_tr_b16 a[24:25], v21 offset:57344
    ds_read_b64_tr_b16 a[26:27], v21 offset:58368
    ds_read_b64_tr_b16 a[28:29], v21 offset:61440
    ds_read_b64_tr_b16 a[30:31], v21 offset:62464
    s_branch QKR_131
QKR_133:
    s_cmp_lg_u32 s9, 2
    s_cbranch_scc1 QKR_134
    ds_read_b64_tr_b16 a[96:97], v21 offset:32768
    ds_read_b64_tr_b16 a[98:99], v21 offset:33792
    ds_read_b64_tr_b16 a[100:101], v21 offset:36864
    ds_read_b64_tr_b16 a[102:103], v21 offset:37888
    ds_read_b64_tr_b16 a[104:105], v21 offset:40960
    ds_read_b64_tr_b16 a[106:107], v21 offset:41984
    ds_read_b64_tr_b16 a[108:109], v21 offset:45056
    ds_read_b64_tr_b16 a[110:111], v21 offset:46080
    ds_read_b64_tr_b16 a[112:113], v21 offset:49152
    ds_read_b64_tr_b16 a[114:115], v21 offset:50176
    ds_read_b64_tr_b16 a[116:117], v21 offset:53248
    ds_read_b64_tr_b16 a[118:119], v21 offset:54272
    ds_read_b64_tr_b16 a[120:121], v21 offset:57344
    ds_read_b64_tr_b16 a[122:123], v21 offset:58368
    ds_read_b64_tr_b16 a[124:125], v21 offset:61440
    ds_read_b64_tr_b16 a[126:127], v21 offset:62464
    s_branch QKR_131
QKR_134:
    ds_read_b64_tr_b16 a[64:65], v21 offset:32768
    ds_read_b64_tr_b16 a[66:67], v21 offset:33792
    ds_read_b64_tr_b16 a[68:69], v21 offset:36864
    ds_read_b64_tr_b16 a[70:71], v21 offset:37888
    ds_read_b64_tr_b16 a[72:73], v21 offset:40960
    ds_read_b64_tr_b16 a[74:75], v21 offset:41984
    ds_read_b64_tr_b16 a[76:77], v21 offset:45056
    ds_read_b64_tr_b16 a[78:79], v21 offset:46080
    ds_read_b64_tr_b16 a[80:81], v21 offset:49152
    ds_read_b64_tr_b16 a[82:83], v21 offset:50176
    ds_read_b64_tr_b16 a[84:85], v21 offset:53248
    ds_read_b64_tr_b16 a[86:87], v21 offset:54272
    ds_read_b64_tr_b16 a[88:89], v21 offset:57344
    ds_read_b64_tr_b16 a[90:91], v21 offset:58368
    ds_read_b64_tr_b16 a[92:93], v21 offset:61440
    ds_read_b64_tr_b16 a[94:95], v21 offset:62464
QKR_131:
    s_waitcnt lgkmcnt(0)
    s_barrier
    s_add_u32 s42, s24, 0x200000
    s_addc_u32 s43, s25, 0
    s_add_u32 m0, s26, 32768
    s_nop 0
    global_load_lds_dwordx4 v20, s[42:43]
    s_add_u32 s42, s24, 0x208000
    s_addc_u32 s43, s25, 0
    s_add_u32 m0, s26, 33792
    s_nop 0
    global_load_lds_dwordx4 v20, s[42:43]
    s_add_u32 s42, s24, 0x210000
    s_addc_u32 s43, s25, 0
    s_add_u32 m0, s26, 34816
    s_nop 0
    global_load_lds_dwordx4 v20, s[42:43]
    s_add_u32 s42, s24, 0x218000
    s_addc_u32 s43, s25, 0
    s_add_u32 m0, s26, 35840
    s_nop 0
    global_load_lds_dwordx4 v20, s[42:43]
    s_add_u32 s42, s24, 0x220000
    s_addc_u32 s43, s25, 0
    s_add_u32 m0, s26, 36864
    s_nop 0
    global_load_lds_dwordx4 v20, s[42:43]
    s_add_u32 s42, s24, 0x228000
    s_addc_u32 s43, s25, 0
    s_add_u32 m0, s26, 37888
    s_nop 0
    global_load_lds_dwordx4 v20, s[42:43]
    s_add_u32 s42, s24, 0x230000
    s_addc_u32 s43, s25, 0
    s_add_u32 m0, s26, 38912
    s_nop 0
    global_load_lds_dwordx4 v20, s[42:43]
    s_add_u32 s42, s24, 0x238000
    s_addc_u32 s43, s25, 0
    s_add_u32 m0, s26, 39936
    s_nop 0
    global_load_lds_dwordx4 v20, s[42:43]
    s_waitcnt vmcnt(32)
    s_barrier
    s_cmp_lg_u32 s9, 0
    s_cbranch_scc1 QKR_137
    ds_read_b64_tr_b16 a[64:65], v22 offset:0
    ds_read_b64_tr_b16 a[66:67], v22 offset:1024
    ds_read_b64_tr_b16 a[68:69], v22 offset:4096
    ds_read_b64_tr_b16 a[70:71], v22 offset:5120
    ds_read_b64_tr_b16 a[72:73], v22 offset:8192
    ds_read_b64_tr_b16 a[74:75], v22 offset:9216
    ds_read_b64_tr_b16 a[76:77], v22 offset:12288
    ds_read_b64_tr_b16 a[78:79], v22 offset:13312
    ds_read_b64_tr_b16 a[80:81], v22 offset:16384
    ds_read_b64_tr_b16 a[82:83], v22 offset:17408
    ds_read_b64_tr_b16 a[84:85], v22 offset:20480
    ds_read_b64_tr_b16 a[86:87], v22 offset:21504
    ds_read_b64_tr_b16 a[88:89], v22 offset:24576
    ds_read_b64_tr_b16 a[90:91], v22 offset:25600
    ds_read_b64_tr_b16 a[92:93], v22 offset:28672
    ds_read_b64_tr_b16 a[94:95], v22 offset:29696
    s_branch QKR_136
QKR_137:
    s_cmp_lg_u32 s9, 1
    s_cbranch_scc1 QKR_138
    ds_read_b64_tr_b16 a[32:33], v22 offset:0
    ds_read_b64_tr_b16 a[34:35], v22 offset:1024
    ds_read_b64_tr_b16 a[36:37], v22 offset:4096
    ds_read_b64_tr_b16 a[38:39], v22 offset:5120
    ds_read_b64_tr_b16 a[40:41], v22 offset:8192
    ds_read_b64_tr_b16 a[42:43], v22 offset:9216
    ds_read_b64_tr_b16 a[44:45], v22 offset:12288
    ds_read_b64_tr_b16 a[46:47], v22 offset:13312
    ds_read_b64_tr_b16 a[48:49], v22 offset:16384
    ds_read_b64_tr_b16 a[50:51], v22 offset:17408
    ds_read_b64_tr_b16 a[52:53], v22 offset:20480
    ds_read_b64_tr_b16 a[54:55], v22 offset:21504
    ds_read_b64_tr_b16 a[56:57], v22 offset:24576
    ds_read_b64_tr_b16 a[58:59], v22 offset:25600
    ds_read_b64_tr_b16 a[60:61], v22 offset:28672
    ds_read_b64_tr_b16 a[62:63], v22 offset:29696
    s_branch QKR_136
QKR_138:
    s_cmp_lg_u32 s9, 2
    s_cbranch_scc1 QKR_139
    ds_read_b64_tr_b16 a[0:1], v22 offset:0
    ds_read_b64_tr_b16 a[2:3], v22 offset:1024
    ds_read_b64_tr_b16 a[4:5], v22 offset:4096
    ds_read_b64_tr_b16 a[6:7], v22 offset:5120
    ds_read_b64_tr_b16 a[8:9], v22 offset:8192
    ds_read_b64_tr_b16 a[10:11], v22 offset:9216
    ds_read_b64_tr_b16 a[12:13], v22 offset:12288
    ds_read_b64_tr_b16 a[14:15], v22 offset:13312
    ds_read_b64_tr_b16 a[16:17], v22 offset:16384
    ds_read_b64_tr_b16 a[18:19], v22 offset:17408
    ds_read_b64_tr_b16 a[20:21], v22 offset:20480
    ds_read_b64_tr_b16 a[22:23], v22 offset:21504
    ds_read_b64_tr_b16 a[24:25], v22 offset:24576
    ds_read_b64_tr_b16 a[26:27], v22 offset:25600
    ds_read_b64_tr_b16 a[28:29], v22 offset:28672
    ds_read_b64_tr_b16 a[30:31], v22 offset:29696
    s_branch QKR_136
QKR_139:
    ds_read_b64_tr_b16 a[96:97], v22 offset:0
    ds_read_b64_tr_b16 a[98:99], v22 offset:1024
    ds_read_b64_tr_b16 a[100:101], v22 offset:4096
    ds_read_b64_tr_b16 a[102:103], v22 offset:5120
    ds_read_b64_tr_b16 a[104:105], v22 offset:8192
    ds_read_b64_tr_b16 a[106:107], v22 offset:9216
    ds_read_b64_tr_b16 a[108:109], v22 offset:12288
    ds_read_b64_tr_b16 a[110:111], v22 offset:13312
    ds_read_b64_tr_b16 a[112:113], v22 offset:16384
    ds_read_b64_tr_b16 a[114:115], v22 offset:17408
    ds_read_b64_tr_b16 a[116:117], v22 offset:20480
    ds_read_b64_tr_b16 a[118:119], v22 offset:21504
    ds_read_b64_tr_b16 a[120:121], v22 offset:24576
    ds_read_b64_tr_b16 a[122:123], v22 offset:25600
    ds_read_b64_tr_b16 a[124:125], v22 offset:28672
    ds_read_b64_tr_b16 a[126:127], v22 offset:29696
QKR_136:
    s_waitcnt lgkmcnt(0)
    s_barrier
    s_add_u32 s42, s24, 0x300000
    s_addc_u32 s43, s25, 0
    s_add_u32 m0, s26, 65536
    s_nop 0
    global_load_lds_dwordx4 v20, s[42:43]
    s_add_u32 s42, s24, 0x308000
    s_addc_u32 s43, s25, 0
    s_add_u32 m0, s26, 66560
    s_nop 0
    global_load_lds_dwordx4 v20, s[42:43]
    s_add_u32 s42, s24, 0x310000
    s_addc_u32 s43, s25, 0
    s_add_u32 m0, s26, 67584
    s_nop 0
    global_load_lds_dwordx4 v20, s[42:43]
    s_add_u32 s42, s24, 0x318000
    s_addc_u32 s43, s25, 0
    s_add_u32 m0, s26, 68608
    s_nop 0
    global_load_lds_dwordx4 v20, s[42:43]
    s_add_u32 s42, s24, 0x320000
    s_addc_u32 s43, s25, 0
    s_add_u32 m0, s26, 69632
    s_nop 0
    global_load_lds_dwordx4 v20, s[42:43]
    s_add_u32 s42, s24, 0x328000
    s_addc_u32 s43, s25, 0
    s_add_u32 m0, s26, 70656
    s_nop 0
    global_load_lds_dwordx4 v20, s[42:43]
    s_add_u32 s42, s24, 0x330000
    s_addc_u32 s43, s25, 0
    s_add_u32 m0, s26, 71680
    s_nop 0
    global_load_lds_dwordx4 v20, s[42:43]
    s_add_u32 s42, s24, 0x338000
    s_addc_u32 s43, s25, 0
    s_add_u32 m0, s26, 72704
    s_nop 0
    global_load_lds_dwordx4 v20, s[42:43]
    s_waitcnt vmcnt(32)
    s_barrier
    s_cmp_lg_u32 s9, 0
    s_cbranch_scc1 QKR_142
    ds_read_b64_tr_b16 a[96:97], v22 offset:32768
    ds_read_b64_tr_b16 a[98:99], v22 offset:33792
    ds_read_b64_tr_b16 a[100:101], v22 offset:36864
    ds_read_b64_tr_b16 a[102:103], v22 offset:37888
    ds_read_b64_tr_b16 a[104:105], v22 offset:40960
    ds_read_b64_tr_b16 a[106:107], v22 offset:41984
    ds_read_b64_tr_b16 a[108:109], v22 offset:45056
    ds_read_b64_tr_b16 a[110:111], v22 offset:46080
    ds_read_b64_tr_b16 a[112:113], v22 offset:49152
    ds_read_b64_tr_b16 a[114:115], v22 offset:50176
    ds_read_b64_tr_b16 a[116:117], v22 offset:53248
    ds_read_b64_tr_b16 a[118:119], v22 offset:54272
    ds_read_b64_tr_b16 a[120:121], v22 offset:57344
    ds_read_b64_tr_b16 a[122:123], v22 offset:58368
    ds_read_b64_tr_b16 a[124:125], v22 offset:61440
    ds_read_b64_tr_b16 a[126:127], v22 offset:62464
    s_branch QKR_141
QKR_142:
    s_cmp_lg_u32 s9, 1
    s_cbranch_scc1 QKR_143
    ds_read_b64_tr_b16 a[64:65], v22 offset:32768
    ds_read_b64_tr_b16 a[66:67], v22 offset:33792
    ds_read_b64_tr_b16 a[68:69], v22 offset:36864
    ds_read_b64_tr_b16 a[70:71], v22 offset:37888
    ds_read_b64_tr_b16 a[72:73], v22 offset:40960
    ds_read_b64_tr_b16 a[74:75], v22 offset:41984
    ds_read_b64_tr_b16 a[76:77], v22 offset:45056
    ds_read_b64_tr_b16 a[78:79], v22 offset:46080
    ds_read_b64_tr_b16 a[80:81], v22 offset:49152
    ds_read_b64_tr_b16 a[82:83], v22 offset:50176
    ds_read_b64_tr_b16 a[84:85], v22 offset:53248
    ds_read_b64_tr_b16 a[86:87], v22 offset:54272
    ds_read_b64_tr_b16 a[88:89], v22 offset:57344
    ds_read_b64_tr_b16 a[90:91], v22 offset:58368
    ds_read_b64_tr_b16 a[92:93], v22 offset:61440
    ds_read_b64_tr_b16 a[94:95], v22 offset:62464
    s_branch QKR_141
QKR_143:
    s_cmp_lg_u32 s9, 2
    s_cbranch_scc1 QKR_144
    ds_read_b64_tr_b16 a[32:33], v22 offset:32768
    ds_read_b64_tr_b16 a[34:35], v22 offset:33792
    ds_read_b64_tr_b16 a[36:37], v22 offset:36864
    ds_read_b64_tr_b16 a[38:39], v22 offset:37888
    ds_read_b64_tr_b16 a[40:41], v22 offset:40960
    ds_read_b64_tr_b16 a[42:43], v22 offset:41984
    ds_read_b64_tr_b16 a[44:45], v22 offset:45056
    ds_read_b64_tr_b16 a[46:47], v22 offset:46080
    ds_read_b64_tr_b16 a[48:49], v22 offset:49152
    ds_read_b64_tr_b16 a[50:51], v22 offset:50176
    ds_read_b64_tr_b16 a[52:53], v22 offset:53248
    ds_read_b64_tr_b16 a[54:55], v22 offset:54272
    ds_read_b64_tr_b16 a[56:57], v22 offset:57344
    ds_read_b64_tr_b16 a[58:59], v22 offset:58368
    ds_read_b64_tr_b16 a[60:61], v22 offset:61440
    ds_read_b64_tr_b16 a[62:63], v22 offset:62464
    s_branch QKR_141
QKR_144:
    ds_read_b64_tr_b16 a[0:1], v22 offset:32768
    ds_read_b64_tr_b16 a[2:3], v22 offset:33792
    ds_read_b64_tr_b16 a[4:5], v22 offset:36864
    ds_read_b64_tr_b16 a[6:7], v22 offset:37888
    ds_read_b64_tr_b16 a[8:9], v22 offset:40960
    ds_read_b64_tr_b16 a[10:11], v22 offset:41984
    ds_read_b64_tr_b16 a[12:13], v22 offset:45056
    ds_read_b64_tr_b16 a[14:15], v22 offset:46080
    ds_read_b64_tr_b16 a[16:17], v22 offset:49152
    ds_read_b64_tr_b16 a[18:19], v22 offset:50176
    ds_read_b64_tr_b16 a[20:21], v22 offset:53248
    ds_read_b64_tr_b16 a[22:23], v22 offset:54272
    ds_read_b64_tr_b16 a[24:25], v22 offset:57344
    ds_read_b64_tr_b16 a[26:27], v22 offset:58368
    ds_read_b64_tr_b16 a[28:29], v22 offset:61440
    ds_read_b64_tr_b16 a[30:31], v22 offset:62464
QKR_141:
    s_waitcnt vmcnt(24)
    s_barrier
    s_cmp_lg_u32 s9, 0
    s_cbranch_scc1 QKR_147
    ds_read_b64_tr_b16 a[128:129], v23 offset:0
    ds_read_b64_tr_b16 a[130:131], v23 offset:1024
    ds_read_b64_tr_b16 a[132:133], v23 offset:4096
    ds_read_b64_tr_b16 a[134:135], v23 offset:5120
    ds_read_b64_tr_b16 a[136:137], v23 offset:8192
    ds_read_b64_tr_b16 a[138:139], v23 offset:9216
    ds_read_b64_tr_b16 a[140:141], v23 offset:12288
    ds_read_b64_tr_b16 a[142:143], v23 offset:13312
    ds_read_b64_tr_b16 a[144:145], v23 offset:16384
    ds_read_b64_tr_b16 a[146:147], v23 offset:17408
    ds_read_b64_tr_b16 a[148:149], v23 offset:20480
    ds_read_b64_tr_b16 a[150:151], v23 offset:21504
    ds_read_b64_tr_b16 a[152:153], v23 offset:24576
    ds_read_b64_tr_b16 a[154:155], v23 offset:25600
    ds_read_b64_tr_b16 a[156:157], v23 offset:28672
    ds_read_b64_tr_b16 a[158:159], v23 offset:29696
    s_branch QKR_146
QKR_147:
    s_cmp_lg_u32 s9, 1
    s_cbranch_scc1 QKR_148
    ds_read_b64_tr_b16 a[224:225], v23 offset:0
    ds_read_b64_tr_b16 a[226:227], v23 offset:1024
    ds_read_b64_tr_b16 a[228:229], v23 offset:4096
    ds_read_b64_tr_b16 a[230:231], v23 offset:5120
    ds_read_b64_tr_b16 a[232:233], v23 offset:8192
    ds_read_b64_tr_b16 a[234:235], v23 offset:9216
    ds_read_b64_tr_b16 a[236:237], v23 offset:12288
    ds_read_b64_tr_b16 a[238:239], v23 offset:13312
    ds_read_b64_tr_b16 a[240:241], v23 offset:16384
    ds_read_b64_tr_b16 a[242:243], v23 offset:17408
    ds_read_b64_tr_b16 a[244:245], v23 offset:20480
    ds_read_b64_tr_b16 a[246:247], v23 offset:21504
    ds_read_b64_tr_b16 a[248:249], v23 offset:24576
    ds_read_b64_tr_b16 a[250:251], v23 offset:25600
    ds_read_b64_tr_b16 a[252:253], v23 offset:28672
    ds_read_b64_tr_b16 a[254:255], v23 offset:29696
    s_branch QKR_146
QKR_148:
    s_cmp_lg_u32 s9, 2
    s_cbranch_scc1 QKR_149
    ds_read_b64_tr_b16 a[192:193], v23 offset:0
    ds_read_b64_tr_b16 a[194:195], v23 offset:1024
    ds_read_b64_tr_b16 a[196:197], v23 offset:4096
    ds_read_b64_tr_b16 a[198:199], v23 offset:5120
    ds_read_b64_tr_b16 a[200:201], v23 offset:8192
    ds_read_b64_tr_b16 a[202:203], v23 offset:9216
    ds_read_b64_tr_b16 a[204:205], v23 offset:12288
    ds_read_b64_tr_b16 a[206:207], v23 offset:13312
    ds_read_b64_tr_b16 a[208:209], v23 offset:16384
    ds_read_b64_tr_b16 a[210:211], v23 offset:17408
    ds_read_b64_tr_b16 a[212:213], v23 offset:20480
    ds_read_b64_tr_b16 a[214:215], v23 offset:21504
    ds_read_b64_tr_b16 a[216:217], v23 offset:24576
    ds_read_b64_tr_b16 a[218:219], v23 offset:25600
    ds_read_b64_tr_b16 a[220:221], v23 offset:28672
    ds_read_b64_tr_b16 a[222:223], v23 offset:29696
    s_branch QKR_146
QKR_149:
    ds_read_b64_tr_b16 a[160:161], v23 offset:0
    ds_read_b64_tr_b16 a[162:163], v23 offset:1024
    ds_read_b64_tr_b16 a[164:165], v23 offset:4096
    ds_read_b64_tr_b16 a[166:167], v23 offset:5120
    ds_read_b64_tr_b16 a[168:169], v23 offset:8192
    ds_read_b64_tr_b16 a[170:171], v23 offset:9216
    ds_read_b64_tr_b16 a[172:173], v23 offset:12288
    ds_read_b64_tr_b16 a[174:175], v23 offset:13312
    ds_read_b64_tr_b16 a[176:177], v23 offset:16384
    ds_read_b64_tr_b16 a[178:179], v23 offset:17408
    ds_read_b64_tr_b16 a[180:181], v23 offset:20480
    ds_read_b64_tr_b16 a[182:183], v23 offset:21504
    ds_read_b64_tr_b16 a[184:185], v23 offset:24576
    ds_read_b64_tr_b16 a[186:187], v23 offset:25600
    ds_read_b64_tr_b16 a[188:189], v23 offset:28672
    ds_read_b64_tr_b16 a[190:191], v23 offset:29696
QKR_146:
    s_waitcnt vmcnt(16)
    s_barrier
    s_cmp_lg_u32 s9, 0
    s_cbranch_scc1 QKR_152
    ds_read_b64_tr_b16 a[160:161], v21 offset:0
    ds_read_b64_tr_b16 a[162:163], v21 offset:1024
    ds_read_b64_tr_b16 a[164:165], v21 offset:4096
    ds_read_b64_tr_b16 a[166:167], v21 offset:5120
    ds_read_b64_tr_b16 a[168:169], v21 offset:8192
    ds_read_b64_tr_b16 a[170:171], v21 offset:9216
    ds_read_b64_tr_b16 a[172:173], v21 offset:12288
    ds_read_b64_tr_b16 a[174:175], v21 offset:13312
    ds_read_b64_tr_b16 a[176:177], v21 offset:16384
    ds_read_b64_tr_b16 a[178:179], v21 offset:17408
    ds_read_b64_tr_b16 a[180:181], v21 offset:20480
    ds_read_b64_tr_b16 a[182:183], v21 offset:21504
    ds_read_b64_tr_b16 a[184:185], v21 offset:24576
    ds_read_b64_tr_b16 a[186:187], v21 offset:25600
    ds_read_b64_tr_b16 a[188:189], v21 offset:28672
    ds_read_b64_tr_b16 a[190:191], v21 offset:29696
    s_branch QKR_151
QKR_152:
    s_cmp_lg_u32 s9, 1
    s_cbranch_scc1 QKR_153
    ds_read_b64_tr_b16 a[128:129], v21 offset:0
    ds_read_b64_tr_b16 a[130:131], v21 offset:1024
    ds_read_b64_tr_b16 a[132:133], v21 offset:4096
    ds_read_b64_tr_b16 a[134:135], v21 offset:5120
    ds_read_b64_tr_b16 a[136:137], v21 offset:8192
    ds_read_b64_tr_b16 a[138:139], v21 offset:9216
    ds_read_b64_tr_b16 a[140:141], v21 offset:12288
    ds_read_b64_tr_b16 a[142:143], v21 offset:13312
    ds_read_b64_tr_b16 a[144:145], v21 offset:16384
    ds_read_b64_tr_b16 a[146:147], v21 offset:17408
    ds_read_b64_tr_b16 a[148:149], v21 offset:20480
    ds_read_b64_tr_b16 a[150:151], v21 offset:21504
    ds_read_b64_tr_b16 a[152:153], v21 offset:24576
    ds_read_b64_tr_b16 a[154:155], v21 offset:25600
    ds_read_b64_tr_b16 a[156:157], v21 offset:28672
    ds_read_b64_tr_b16 a[158:159], v21 offset:29696
    s_branch QKR_151
QKR_153:
    s_cmp_lg_u32 s9, 2
    s_cbranch_scc1 QKR_154
    ds_read_b64_tr_b16 a[224:225], v21 offset:0
    ds_read_b64_tr_b16 a[226:227], v21 offset:1024
    ds_read_b64_tr_b16 a[228:229], v21 offset:4096
    ds_read_b64_tr_b16 a[230:231], v21 offset:5120
    ds_read_b64_tr_b16 a[232:233], v21 offset:8192
    ds_read_b64_tr_b16 a[234:235], v21 offset:9216
    ds_read_b64_tr_b16 a[236:237], v21 offset:12288
    ds_read_b64_tr_b16 a[238:239], v21 offset:13312
    ds_read_b64_tr_b16 a[240:241], v21 offset:16384
    ds_read_b64_tr_b16 a[242:243], v21 offset:17408
    ds_read_b64_tr_b16 a[244:245], v21 offset:20480
    ds_read_b64_tr_b16 a[246:247], v21 offset:21504
    ds_read_b64_tr_b16 a[248:249], v21 offset:24576
    ds_read_b64_tr_b16 a[250:251], v21 offset:25600
    ds_read_b64_tr_b16 a[252:253], v21 offset:28672
    ds_read_b64_tr_b16 a[254:255], v21 offset:29696
    s_branch QKR_151
QKR_154:
    ds_read_b64_tr_b16 a[192:193], v21 offset:0
    ds_read_b64_tr_b16 a[194:195], v21 offset:1024
    ds_read_b64_tr_b16 a[196:197], v21 offset:4096
    ds_read_b64_tr_b16 a[198:199], v21 offset:5120
    ds_read_b64_tr_b16 a[200:201], v21 offset:8192
    ds_read_b64_tr_b16 a[202:203], v21 offset:9216
    ds_read_b64_tr_b16 a[204:205], v21 offset:12288
    ds_read_b64_tr_b16 a[206:207], v21 offset:13312
    ds_read_b64_tr_b16 a[208:209], v21 offset:16384
    ds_read_b64_tr_b16 a[210:211], v21 offset:17408
    ds_read_b64_tr_b16 a[212:213], v21 offset:20480
    ds_read_b64_tr_b16 a[214:215], v21 offset:21504
    ds_read_b64_tr_b16 a[216:217], v21 offset:24576
    ds_read_b64_tr_b16 a[218:219], v21 offset:25600
    ds_read_b64_tr_b16 a[220:221], v21 offset:28672
    ds_read_b64_tr_b16 a[222:223], v21 offset:29696
QKR_151:
    s_waitcnt vmcnt(8)
    s_barrier
    s_cmp_lg_u32 s9, 0
    s_cbranch_scc1 QKR_157
    ds_read_b64_tr_b16 a[192:193], v21 offset:32768
    ds_read_b64_tr_b16 a[194:195], v21 offset:33792
    ds_read_b64_tr_b16 a[196:197], v21 offset:36864
    ds_read_b64_tr_b16 a[198:199], v21 offset:37888
    ds_read_b64_tr_b16 a[200:201], v21 offset:40960
    ds_read_b64_tr_b16 a[202:203], v21 offset:41984
    ds_read_b64_tr_b16 a[204:205], v21 offset:45056
    ds_read_b64_tr_b16 a[206:207], v21 offset:46080
    ds_read_b64_tr_b16 a[208:209], v21 offset:49152
    ds_read_b64_tr_b16 a[210:211], v21 offset:50176
    ds_read_b64_tr_b16 a[212:213], v21 offset:53248
    ds_read_b64_tr_b16 a[214:215], v21 offset:54272
    ds_read_b64_tr_b16 a[216:217], v21 offset:57344
    ds_read_b64_tr_b16 a[218:219], v21 offset:58368
    ds_read_b64_tr_b16 a[220:221], v21 offset:61440
    ds_read_b64_tr_b16 a[222:223], v21 offset:62464
    s_branch QKR_156
QKR_157:
    s_cmp_lg_u32 s9, 1
    s_cbranch_scc1 QKR_158
    ds_read_b64_tr_b16 a[160:161], v21 offset:32768
    ds_read_b64_tr_b16 a[162:163], v21 offset:33792
    ds_read_b64_tr_b16 a[164:165], v21 offset:36864
    ds_read_b64_tr_b16 a[166:167], v21 offset:37888
    ds_read_b64_tr_b16 a[168:169], v21 offset:40960
    ds_read_b64_tr_b16 a[170:171], v21 offset:41984
    ds_read_b64_tr_b16 a[172:173], v21 offset:45056
    ds_read_b64_tr_b16 a[174:175], v21 offset:46080
    ds_read_b64_tr_b16 a[176:177], v21 offset:49152
    ds_read_b64_tr_b16 a[178:179], v21 offset:50176
    ds_read_b64_tr_b16 a[180:181], v21 offset:53248
    ds_read_b64_tr_b16 a[182:183], v21 offset:54272
    ds_read_b64_tr_b16 a[184:185], v21 offset:57344
    ds_read_b64_tr_b16 a[186:187], v21 offset:58368
    ds_read_b64_tr_b16 a[188:189], v21 offset:61440
    ds_read_b64_tr_b16 a[190:191], v21 offset:62464
    s_branch QKR_156
QKR_158:
    s_cmp_lg_u32 s9, 2
    s_cbranch_scc1 QKR_159
    ds_read_b64_tr_b16 a[128:129], v21 offset:32768
    ds_read_b64_tr_b16 a[130:131], v21 offset:33792
    ds_read_b64_tr_b16 a[132:133], v21 offset:36864
    ds_read_b64_tr_b16 a[134:135], v21 offset:37888
    ds_read_b64_tr_b16 a[136:137], v21 offset:40960
    ds_read_b64_tr_b16 a[138:139], v21 offset:41984
    ds_read_b64_tr_b16 a[140:141], v21 offset:45056
    ds_read_b64_tr_b16 a[142:143], v21 offset:46080
    ds_read_b64_tr_b16 a[144:145], v21 offset:49152
    ds_read_b64_tr_b16 a[146:147], v21 offset:50176
    ds_read_b64_tr_b16 a[148:149], v21 offset:53248
    ds_read_b64_tr_b16 a[150:151], v21 offset:54272
    ds_read_b64_tr_b16 a[152:153], v21 offset:57344
    ds_read_b64_tr_b16 a[154:155], v21 offset:58368
    ds_read_b64_tr_b16 a[156:157], v21 offset:61440
    ds_read_b64_tr_b16 a[158:159], v21 offset:62464
    s_branch QKR_156
QKR_159:
    ds_read_b64_tr_b16 a[224:225], v21 offset:32768
    ds_read_b64_tr_b16 a[226:227], v21 offset:33792
    ds_read_b64_tr_b16 a[228:229], v21 offset:36864
    ds_read_b64_tr_b16 a[230:231], v21 offset:37888
    ds_read_b64_tr_b16 a[232:233], v21 offset:40960
    ds_read_b64_tr_b16 a[234:235], v21 offset:41984
    ds_read_b64_tr_b16 a[236:237], v21 offset:45056
    ds_read_b64_tr_b16 a[238:239], v21 offset:46080
    ds_read_b64_tr_b16 a[240:241], v21 offset:49152
    ds_read_b64_tr_b16 a[242:243], v21 offset:50176
    ds_read_b64_tr_b16 a[244:245], v21 offset:53248
    ds_read_b64_tr_b16 a[246:247], v21 offset:54272
    ds_read_b64_tr_b16 a[248:249], v21 offset:57344
    ds_read_b64_tr_b16 a[250:251], v21 offset:58368
    ds_read_b64_tr_b16 a[252:253], v21 offset:61440
    ds_read_b64_tr_b16 a[254:255], v21 offset:62464
QKR_156:
    s_waitcnt vmcnt(0)
    s_barrier
    s_cmp_lg_u32 s9, 0
    s_cbranch_scc1 QKR_162
    ds_read_b64_tr_b16 a[224:225], v22 offset:0
    ds_read_b64_tr_b16 a[226:227], v22 offset:1024
    ds_read_b64_tr_b16 a[228:229], v22 offset:4096
    ds_read_b64_tr_b16 a[230:231], v22 offset:5120
    ds_read_b64_tr_b16 a[232:233], v22 offset:8192
    ds_read_b64_tr_b16 a[234:235], v22 offset:9216
    ds_read_b64_tr_b16 a[236:237], v22 offset:12288
    ds_read_b64_tr_b16 a[238:239], v22 offset:13312
    ds_read_b64_tr_b16 a[240:241], v22 offset:16384
    ds_read_b64_tr_b16 a[242:243], v22 offset:17408
    ds_read_b64_tr_b16 a[244:245], v22 offset:20480
    ds_read_b64_tr_b16 a[246:247], v22 offset:21504
    ds_read_b64_tr_b16 a[248:249], v22 offset:24576
    ds_read_b64_tr_b16 a[250:251], v22 offset:25600
    ds_read_b64_tr_b16 a[252:253], v22 offset:28672
    ds_read_b64_tr_b16 a[254:255], v22 offset:29696
    s_branch QKR_161
QKR_162:
    s_cmp_lg_u32 s9, 1
    s_cbranch_scc1 QKR_163
    ds_read_b64_tr_b16 a[192:193], v22 offset:0
    ds_read_b64_tr_b16 a[194:195], v22 offset:1024
    ds_read_b64_tr_b16 a[196:197], v22 offset:4096
    ds_read_b64_tr_b16 a[198:199], v22 offset:5120
    ds_read_b64_tr_b16 a[200:201], v22 offset:8192
    ds_read_b64_tr_b16 a[202:203], v22 offset:9216
    ds_read_b64_tr_b16 a[204:205], v22 offset:12288
    ds_read_b64_tr_b16 a[206:207], v22 offset:13312
    ds_read_b64_tr_b16 a[208:209], v22 offset:16384
    ds_read_b64_tr_b16 a[210:211], v22 offset:17408
    ds_read_b64_tr_b16 a[212:213], v22 offset:20480
    ds_read_b64_tr_b16 a[214:215], v22 offset:21504
    ds_read_b64_tr_b16 a[216:217], v22 offset:24576
    ds_read_b64_tr_b16 a[218:219], v22 offset:25600
    ds_read_b64_tr_b16 a[220:221], v22 offset:28672
    ds_read_b64_tr_b16 a[222:223], v22 offset:29696
    s_branch QKR_161
QKR_163:
    s_cmp_lg_u32 s9, 2
    s_cbranch_scc1 QKR_164
    ds_read_b64_tr_b16 a[160:161], v22 offset:0
    ds_read_b64_tr_b16 a[162:163], v22 offset:1024
    ds_read_b64_tr_b16 a[164:165], v22 offset:4096
    ds_read_b64_tr_b16 a[166:167], v22 offset:5120
    ds_read_b64_tr_b16 a[168:169], v22 offset:8192
    ds_read_b64_tr_b16 a[170:171], v22 offset:9216
    ds_read_b64_tr_b16 a[172:173], v22 offset:12288
    ds_read_b64_tr_b16 a[174:175], v22 offset:13312
    ds_read_b64_tr_b16 a[176:177], v22 offset:16384
    ds_read_b64_tr_b16 a[178:179], v22 offset:17408
    ds_read_b64_tr_b16 a[180:181], v22 offset:20480
    ds_read_b64_tr_b16 a[182:183], v22 offset:21504
    ds_read_b64_tr_b16 a[184:185], v22 offset:24576
    ds_read_b64_tr_b16 a[186:187], v22 offset:25600
    ds_read_b64_tr_b16 a[188:189], v22 offset:28672
    ds_read_b64_tr_b16 a[190:191], v22 offset:29696
    s_branch QKR_161
QKR_164:
    ds_read_b64_tr_b16 a[128:129], v22 offset:0
    ds_read_b64_tr_b16 a[130:131], v22 offset:1024
    ds_read_b64_tr_b16 a[132:133], v22 offset:4096
    ds_read_b64_tr_b16 a[134:135], v22 offset:5120
    ds_read_b64_tr_b16 a[136:137], v22 offset:8192
    ds_read_b64_tr_b16 a[138:139], v22 offset:9216
    ds_read_b64_tr_b16 a[140:141], v22 offset:12288
    ds_read_b64_tr_b16 a[142:143], v22 offset:13312
    ds_read_b64_tr_b16 a[144:145], v22 offset:16384
    ds_read_b64_tr_b16 a[146:147], v22 offset:17408
    ds_read_b64_tr_b16 a[148:149], v22 offset:20480
    ds_read_b64_tr_b16 a[150:151], v22 offset:21504
    ds_read_b64_tr_b16 a[152:153], v22 offset:24576
    ds_read_b64_tr_b16 a[154:155], v22 offset:25600
    ds_read_b64_tr_b16 a[156:157], v22 offset:28672
    ds_read_b64_tr_b16 a[158:159], v22 offset:29696
QKR_161:
    s_waitcnt lgkmcnt(0)
    s_barrier
    v_and_b32 v11, 31, v0
    v_max_u32 v11, 14, v11
    v_and_or_b32 v11, v0, 32, v11
    v_lshlrev_b32 v11, 3, v11
    v_add_u32 v11, 333312, v11
    s_mov_b32 s12, 0
POLL_166:
    global_load_dword v10, v11, s[4:5] offset:0 sc1
    s_add_u32 s12, s12, 1
    s_mov_b32 s17, 17
    s_cmp_gt_u32 s12, 20000
    s_cbranch_scc1 TIMEOUT
    s_waitcnt vmcnt(0)
    v_cmp_ne_u32 vcc, s8, v10
    s_cbranch_vccnz POLL_166
    s_mov_b32 m0, s29
    s_nop 0
    global_load_lds_dwordx4 v1, s[34:35] offset:0 sc1
    global_load_lds_dwordx4 v1, s[34:35] offset:1024 sc1
    global_load_lds_dwordx4 v1, s[34:35] offset:2048 sc1
    global_load_lds_dwordx4 v1, s[34:35] offset:3072 sc1
    s_add_u32 m0, s29, 4096
    s_nop 0
    global_load_lds_dwordx4 v1, s[38:39] offset:0 sc1
    global_load_lds_dwordx4 v1, s[38:39] offset:1024 sc1
    global_load_lds_dwordx4 v1, s[38:39] offset:2048 sc1
    global_load_lds_dwordx4 v1, s[38:39] offset:3072 sc1
    s_branch QH_GO
QH_SPIN0:
    s_mov_b32 s12, 0
QH_SPIN:
    global_load_dword v15, v1, s[34:35] sc1
    s_add_u32 s12, s12, 1
    s_mov_b32 s17, 4
    s_cmp_gt_u32 s12, 20000
    s_cbranch_scc1 TIMEOUT
    s_waitcnt vmcnt(0)
    v_cmp_eq_u32 vcc, -1, v15
    s_cbranch_vccnz QH_SPIN
    s_mov_b32 m0, s29
    s_nop 0
    global_load_lds_dwordx4 v1, s[34:35] offset:0 sc1
    global_load_lds_dwordx4 v1, s[34:35] offset:1024 sc1
    global_load_lds_dwordx4 v1, s[34:35] offset:2048 sc1
    global_load_lds_dwordx4 v1, s[34:35] offset:3072 sc1
    s_add_u32 m0, s29, 4096
    s_nop 0
    global_load_lds_dwordx4 v1, s[38:39] offset:0 sc1
    global_load_lds_dwordx4 v1, s[38:39] offset:1024 sc1
    global_load_lds_dwordx4 v1, s[38:39] offset:2048 sc1
    global_load_lds_dwordx4 v1, s[38:39] offset:3072 sc1
QH_GO:
    s_waitcnt vmcnt(0)
QH_GO2:
    ds_read_b128 v[48:51], v2 offset:0
    ds_read_b128 v[52:55], v2 offset:1024
    ds_read_b128 v[56:59], v2 offset:2048
    ds_read_b128 v[60:63], v2 offset:3072
    ds_read_b128 v[64:67], v2 offset:4096
    ds_read_b128 v[68:71], v2 offset:5120
    ds_read_b128 v[72:75], v2 offset:6144
    ds_read_b128 v[76:79], v2 offset:7168
QH_H0:
    s_waitcnt lgkmcnt(7)
    v_mfma_f32_32x32x16_bf16 v[80:95], a[0:3], v[48:51], 0
    s_waitcnt lgkmcnt(6)
    v_mfma_f32_32x32x16_bf16 v[80:95], a[4:7], v[52:55], v[80:95]
    v_max_u32 v15, v48, v52
    s_waitcnt lgkmcnt(5)
    v_mfma_f32_32x32x16_bf16 v[80:95], a[8:11], v[56:59], v[80:95]
    s_waitcnt lgkmcnt(4)
    v_mfma_f32_32x32x16_bf16 v[80:95], a[12:15], v[60:63], v[80:95]
    v_max3_u32 v15, v15, v56, v60
    s_waitcnt lgkmcnt(3)
    v_mfma_f32_32x32x16_bf16 v[80:95], a[16:19], v[64:67], v[80:95]
    s_waitcnt lgkmcnt(2)
    v_mfma_f32_32x32x16_bf16 v[80:95], a[20:23], v[68:71], v[80:95]
    v_max3_u32 v15, v15, v64, v68
    s_waitcnt lgkmcnt(1)
    v_mfma_f32_32x32x16_bf16 v[80:95], a[24:27], v[72:75], v[80:95]
    s_waitcnt lgkmcnt(0)
    v_mfma_f32_32x32x16_bf16 v[80:95], a[28:31], v[76:79], v[80:95]
    v_max3_u32 v15, v15, v72, v76
    v_cmp_eq_u32 vcc, -1, v15
    v_mfma_f32_32x32x16_bf16 v[96:111], a[128:131], v[48:51], 0
    s_cbranch_vccnz QH_SPIN
    s_barrier
    v_mfma_f32_32x32x16_bf16 v[96:111], a[132:135], v[52:55], v[96:111]
    ds_read_b128 v[20:23], v3 offset:0
    s_branch QH_J
QH_HV:
    s_waitcnt lgkmcnt(7)
    v_mfma_f32_32x32x16_bf16 v[80:95], a[0:3], v[48:51], 0
    s_waitcnt lgkmcnt(6)
    v_mfma_f32_32x32x16_bf16 v[80:95], a[4:7], v[52:55], v[80:95]
    v_cvt_pk_bf16_f32 v96, v96, v104
    v_cvt_pk_bf16_f32 v97, v97, v105
    v_cvt_pk_bf16_f32 v98, v98, v106
    v_cvt_pk_bf16_f32 v99, v99, v107
    v_max_u32 v15, v48, v52
    s_waitcnt lgkmcnt(5)
    v_mfma_f32_32x32x16_bf16 v[80:95], a[8:11], v[56:59], v[80:95]
    global_store_dwordx4 v6, v[96:99], s[46:47] offset:0 sc1
    s_waitcnt lgkmcnt(4)
    v_mfma_f32_32x32x16_bf16 v[80:95], a[12:15], v[60:63], v[80:95]
    v_cvt_pk_bf16_f32 v100, v100, v108
    v_cvt_pk_bf16_f32 v101, v101, v109
    v_max3_u32 v15, v15, v56, v60
    s_waitcnt lgkmcnt(3)
    v_mfma_f32_32x32x16_bf16 v[80:95], a[16:19], v[64:67], v[80:95]
    v_cvt_pk_bf16_f32 v102, v102, v110
    v_cvt_pk_bf16_f32 v103, v103, v111
    s_waitcnt lgkmcnt(2)
    v_mfma_f32_32x32x16_bf16 v[80:95], a[20:23], v[68:71], v[80:95]
    v_max3_u32 v15, v15, v64, v68
    s_waitcnt lgkmcnt(1)
    v_mfma_f32_32x32x16_bf16 v[80:95], a[24:27], v[72:75], v[80:95]
    global_store_dwordx4 v6, v[100:103], s[46:47] offset:1024 sc1
    s_waitcnt lgkmcnt(0)
    v_mfma_f32_32x32x16_bf16 v[80:95], a[28:31], v[76:79], v[80:95]
    v_max3_u32 v15, v15, v72, v76
    v_cmp_eq_u32 vcc, -1, v15
    v_mfma_f32_32x32x16_bf16 v[96:111], a[128:131], v[48:51], 0
    s_cbranch_vccnz QH_FV
    s_barrier
    v_mfma_f32_32x32x16_bf16 v[96:111], a[132:135], v[52:55], v[96:111]
    ds_read_b128 v[20:23], v3 offset:0
QH_J:
    v_mfma_f32_32x32x16_bf16 v[96:111], a[136:139], v[56:59], v[96:111]
    ds_read_b128 v[24:27], v3 offset:1024
    s_lshr_b32 s14, s28, 6
    s_mul_i32 s14, s14, 2016
    s_add_u32 s14, s14, s28
    s_mul_i32 s15, s14, 32768
    s_add_u32 s15, s15, s36
    v_mfma_f32_32x32x16_bf16 v[96:111], a[140:143], v[60:63], v[96:111]
    ds_read_b128 v[28:31], v3 offset:2048
    s_add_u32 s44, s4, s15
    s_addc_u32 s45, s5, 0
    s_add_u32 s46, s44, 0x208000
    s_addc_u32 s47, s45, 0
    v_mfma_f32_32x32x16_bf16 v[96:111], a[144:147], v[64:67], v[96:111]
    ds_read_b128 v[32:35], v3 offset:3072
    s_add_u32 s42, s44, 0x410000
    s_addc_u32 s43, s45, 0
    s_lshl_b32 s14, s28, 10
    s_add_u32 s14, s14, s37
    v_mfma_f32_32x32x16_bf16 v[96:111], a[148:151], v[68:71], v[96:111]
    ds_read_b128 v[36:39], v3 offset:4096
    s_add_u32 s48, s4, s14
    s_addc_u32 s49, s5, 0
    s_xor_b32 s29, s29, 0x8000
    s_add_u32 s27, s27, 1
    v_mfma_f32_32x32x16_bf16 v[96:111], a[152:155], v[72:75], v[96:111]
    ds_read_b128 v[40:43], v3 offset:5120
    s_and_b32 s14, s28, 64
    s_lshl_b32 s14, s14, 7
    s_add_u32 s54, s52, s14
    s_and_b32 s14, s28, 63
    s_add_u32 s55, s53, s14
    v_mfma_f32_32x32x16_bf16 v[96:111], a[156:159], v[76:79], v[96:111]
    ds_read_b128 v[44:47], v3 offset:6144
    s_waitcnt lgkmcnt(6)
    v_mfma_f32_32x32x16_bf16 v[80:95], a[32:35], v[20:23], v[80:95]
    s_ff1_i32_b64 s14, s[32:33]
    s_min_u32 s28, s14, 63
    s_bitset0_b64 s[32:33], s28
    v_mfma_f32_32x32x16_bf16 v[96:111], a[160:163], v[20:23], v[96:111]
    ds_read_b128 v[20:23], v3 offset:7168
    s_and_b32 s14, s28, 64
    s_add_u32 s14, s14, s28
    s_lshl_b32 s15, s14, 15
    s_add_u32 s15, s15, s26
    s_waitcnt lgkmcnt(6)
    v_mfma_f32_32x32x16_bf16 v[80:95], a[36:39], v[24:27], v[80:95]
    s_add_u32 s15, s15, 4194304
    s_add_u32 s34, s4, s15
    s_addc_u32 s35, s5, 0
    s_add_u32 s38, s34, 0x1000
    s_addc_u32 s39, s35, 0
    v_mfma_f32_32x32x16_bf16 v[96:111], a[164:167], v[24:27], v[96:111]
    ds_read_b128 v[24:27], v4 offset:0
    s_waitcnt lgkmcnt(6)
    v_mfma_f32_32x32x16_bf16 v[80:95], a[40:43], v[28:31], v[80:95]
    v_mfma_f32_32x32x16_bf16 v[96:111], a[168:171], v[28:31], v[96:111]
    ds_read_b128 v[28:31], v4 offset:1024
    s_waitcnt lgkmcnt(6)
    v_mfma_f32_32x32x16_bf16 v[80:95], a[44:47], v[32:35], v[80:95]
    v_mfma_f32_32x32x16_bf16 v[96:111], a[172:175], v[32:35], v[96:111]
    ds_read_b128 v[32:35], v4 offset:2048
    s_waitcnt lgkmcnt(6)
    v_mfma_f32_32x32x16_bf16 v[80:95], a[48:51], v[36:39], v[80:95]
    v_mfma_f32_32x32x16_bf16 v[96:111], a[176:179], v[36:39], v[96:111]
    ds_read_b128 v[36:39], v4 offset:3072
    s_mov_b32 m0, s29
    s_waitcnt lgkmcnt(6)
    v_mfma_f32_32x32x16_bf16 v[80:95], a[52:55], v[40:43], v[80:95]
    global_load_lds_dwordx4 v1, s[34:35] offset:0 sc1
    v_mfma_f32_32x32x16_bf16 v[96:111], a[180:183], v[40:43], v[96:111]
    ds_read_b128 v[40:43], v4 offset:4096
    s_waitcnt lgkmcnt(6)
    v_mfma_f32_32x32x16_bf16 v[80:95], a[56:59], v[44:47], v[80:95]
    global_load_lds_dwordx4 v1, s[34:35] offset:1024 sc1
    v_mfma_f32_32x32x16_bf16 v[96:111], a[184:187], v[44:47], v[96:111]
    ds_read_b128 v[44:47], v4 offset:5120
    s_waitcnt lgkmcnt(6)
    v_mfma_f32_32x32x16_bf16 v[80:95], a[60:63], v[20:23], v[80:95]
    global_load_lds_dwordx4 v1, s[34:35] offset:2048 sc1
    v_mfma_f32_32x32x16_bf16 v[96:111], a[188:191], v[20:23], v[96:111]
    ds_read_b128 v[20:23], v4 offset:6144
    s_waitcnt lgkmcnt(6)
    v_mfma_f32_32x32x16_bf16 v[80:95], a[64:67], v[24:27], v[80:95]
    global_load_lds_dwordx4 v1, s[34:35] offset:3072 sc1
    v_mfma_f32_32x32x16_bf16 v[96:111], a[192:195], v[24:27], v[96:111]
    ds_read_b128 v[24:27], v4 offset:7168
    s_add_u32 m0, s29, 4096
    s_waitcnt lgkmcnt(6)
    v_mfma_f32_32x32x16_bf16 v[80:95], a[68:71], v[28:31], v[80:95]
    global_load_lds_dwordx4 v1, s[38:39] offset:0 sc1
    v_mfma_f32_32x32x16_bf16 v[96:111], a[196:199], v[28:31], v[96:111]
    ds_read_b128 v[28:31], v5 offset:0
    s_waitcnt lgkmcnt(6)
    v_mfma_f32_32x32x16_bf16 v[80:95], a[72:75], v[32:35], v[80:95]
    global_load_lds_dwordx4 v1, s[38:39] offset:1024 sc1
    v_mfma_f32_32x32x16_bf16 v[96:111], a[200:203], v[32:35], v[96:111]
    ds_read_b128 v[32:35], v5 offset:1024
    s_waitcnt lgkmcnt(6)
    v_mfma_f32_32x32x16_bf16 v[80:95], a[76:79], v[36:39], v[80:95]
    global_load_lds_dwordx4 v1, s[38:39] offset:2048 sc1
    v_mfma_f32_32x32x16_bf16 v[96:111], a[204:207], v[36:39], v[96:111]
    ds_read_b128 v[36:39], v5 offset:2048
    s_waitcnt lgkmcnt(6)
    v_mfma_f32_32x32x16_bf16 v[80:95], a[80:83], v[40:43], v[80:95]
    global_load_lds_dwordx4 v1, s[38:39] offset:3072 sc1
    v_mfma_f32_32x32x16_bf16 v[96:111], a[208:211], v[40:43], v[96:111]
    ds_read_b128 v[40:43], v5 offset:3072
    s_waitcnt lgkmcnt(6)
    v_mfma_f32_32x32x16_bf16 v[80:95], a[84:87], v[44:47], v[80:95]
    v_mfma_f32_32x32x16_bf16 v[96:111], a[212:215], v[44:47], v[96:111]
    ds_read_b128 v[44:47], v5 offset:4096
    s_waitcnt lgkmcnt(6)
    v_mfma_f32_32x32x16_bf16 v[80:95], a[88:91], v[20:23], v[80:95]
    v_mfma_f32_32x32x16_bf16 v[96:111], a[216:219], v[20:23], v[96:111]
    ds_read_b128 v[20:23], v5 offset:5120
    s_waitcnt lgkmcnt(6)
    v_mfma_f32_32x32x16_bf16 v[80:95], a[92:95], v[24:27], v[80:95]
    v_mfma_f32_32x32x16_bf16 v[96:111], a[220:223], v[24:27], v[96:111]
    ds_read_b128 v[24:27], v5 offset:6144
    s_waitcnt lgkmcnt(6)
    v_mfma_f32_32x32x16_bf16 v[80:95], a[96:99], v[28:31], v[80:95]
    v_mfma_f32_32x32x16_bf16 v[96:111], a[224:227], v[28:31], v[96:111]
    ds_read_b128 v[28:31], v5 offset:7168
    s_waitcnt lgkmcnt(6)
    v_mfma_f32_32x32x16_bf16 v[80:95], a[100:103], v[32:35], v[80:95]
    s_waitcnt lgkmcnt(5)
    v_mfma_f32_32x32x16_bf16 v[80:95], a[104:107], v[36:39], v[80:95]
    s_waitcnt lgkmcnt(4)
    v_mfma_f32_32x32x16_bf16 v[80:95], a[108:111], v[40:43], v[80:95]
    v_xor_b32 v2, 0x8000, v2
    v_xor_b32 v3, 0x8000, v3
    v_xor_b32 v4, 0x8000, v4
    v_xor_b32 v5, 0x8000, v5
    s_waitcnt lgkmcnt(3)
    v_mfma_f32_32x32x16_bf16 v[80:95], a[112:115], v[44:47], v[80:95]
    s_waitcnt lgkmcnt(2)
    v_mfma_f32_32x32x16_bf16 v[80:95], a[116:119], v[20:23], v[80:95]
    s_waitcnt lgkmcnt(1)
    v_mfma_f32_32x32x16_bf16 v[80:95], a[120:123], v[24:27], v[80:95]
    s_waitcnt vmcnt(8)
    global_store_dword v8, v12, s[4:5] sc1
    s_waitcnt lgkmcnt(0)
    v_mfma_f32_32x32x16_bf16 v[80:95], a[124:127], v[28:31], v[80:95]
    v_mfma_f32_32x32x16_bf16 v[96:111], a[228:231], v[32:35], v[96:111]
    s_mov_b64 s[40:41], s[48:49]
    v_mov_b32 v8, s54
    v_mov_b32 v12, s55
    v_mfma_f32_32x32x16_bf16 v[96:111], a[232:235], v[36:39], v[96:111]
    v_cvt_pk_bf16_f32 v80, v80, v88
    v_cvt_pk_bf16_f32 v81, v81, v89
    v_cvt_pk_bf16_f32 v82, v82, v90
    v_cvt_pk_bf16_f32 v83, v83, v91
    v_mfma_f32_32x32x16_bf16 v[96:111], a[236:239], v[40:43], v[96:111]
    global_store_dwordx4 v6, v[80:83], s[44:45] offset:0 sc1
    v_cvt_pk_bf16_f32 v84, v84, v92
    v_cvt_pk_bf16_f32 v85, v85, v93
    v_cvt_pk_bf16_f32 v86, v86, v94
    v_cvt_pk_bf16_f32 v87, v87, v95
    v_mfma_f32_32x32x16_bf16 v[96:111], a[240:243], v[44:47], v[96:111]
    s_waitcnt vmcnt(2)
    ds_read_b128 v[48:51], v2 offset:0
    ds_read_b128 v[52:55], v2 offset:1024
    v_mfma_f32_32x32x16_bf16 v[96:111], a[244:247], v[20:23], v[96:111]
    ds_read_b128 v[56:59], v2 offset:2048
    ds_read_b128 v[60:63], v2 offset:3072
    v_mfma_f32_32x32x16_bf16 v[96:111], a[248:251], v[24:27], v[96:111]
    ds_read_b128 v[64:67], v2 offset:4096
    ds_read_b128 v[68:71], v2 offset:5120
    v_mfma_f32_32x32x16_bf16 v[96:111], a[252:255], v[28:31], v[96:111]
    ds_read_b128 v[72:75], v2 offset:6144
    ds_read_b128 v[76:79], v2 offset:7168
    global_store_dwordx4 v6, v[84:87], s[44:45] offset:1024 sc1
    s_cmp_ge_u32 s27, 64
    s_cbranch_scc0 QH_HV
    s_nop 6
    v_cvt_pk_bf16_f32 v96, v96, v104
    v_cvt_pk_bf16_f32 v97, v97, v105
    v_cvt_pk_bf16_f32 v98, v98, v106
    v_cvt_pk_bf16_f32 v99, v99, v107
    global_store_dwordx4 v6, v[96:99], s[46:47] offset:0 sc1
    v_cvt_pk_bf16_f32 v100, v100, v108
    v_cvt_pk_bf16_f32 v101, v101, v109
    v_cvt_pk_bf16_f32 v102, v102, v110
    v_cvt_pk_bf16_f32 v103, v103, v111
    global_store_dwordx4 v6, v[100:103], s[46:47] offset:1024 sc1
    s_waitcnt lgkmcnt(0)
QH_FV:
    s_waitcnt vmcnt(0)
    global_store_dword v8, v12, s[4:5] sc1
    s_cmp_lt_u32 s27, 64
    s_cbranch_scc1 QH_SPIN0
    s_barrier
    s_cmp_eq_u32 s62, 0
    s_cbranch_scc1 RED_RET
    s_add_u32 s63, s63, 1
    s_mov_b32 s11, s63
    s_and_b32 s14, s11, 3
    s_cbranch_scc1 QH_IN
    s_endpgm
ROLE_ATT:
ROLE_WO:
    s_load_dwordx2 s[20:21], s[0:1], 40
    s_sub_u32 s14, s10, 2
    s_lshl_b32 s14, s14, 1
    s_bfe_u32 s15, s11, 0x10003
    s_add_u32 s63, s14, s15
    s_lshl_b32 s62, s63, 2
    s_add_u32 s62, s62, s9
    s_and_b32 s29, s11, 1
    s_bfe_u32 s11, s11, 0x10001
    s_lshl_b32 s22, s9, 13
    v_lshrrev_b32 v6, 4, v0
    v_lshlrev_b32 v7, 2, v6
    v_and_b32 v32, 15, v0
    v_xor_b32 v32, v32, v7
    v_lshlrev_b32 v32, 4, v32
    v_mul_u32_u24 v6, 0, v6
    v_add_u32 v32, v32, v6
    v_lshrrev_b32 v6, 7, v32
    v_add_u32 v6, s9, v6
    v_and_b32 v6, 3, v6
    v_and_b32 v32, 127, v32
    v_lshl_add_u32 v32, v6, 17, v32
    v_lshrrev_b32 v6, 4, v0
    v_lshl_add_u32 v32, v6, 10, v32
    s_lshl_b32 s14, s63, 19
    s_lshl_b32 s15, s11, 9
    s_add_u32 s14, s14, s15
    s_lshl_b32 s15, s9, 7
    s_add_u32 s14, s14, s15
    v_add_u32 v32, s14, v32
    v_xor_b32 v33, 0x40000, v32
    v_bfe_u32 v7, v0, 2, 2
    v_mul_u32_u24 v36, 320, v7
    v_lshl_add_u32 v36, v6, 10, v36
    v_and_b32 v7, 3, v0
    v_lshl_add_u32 v36, v7, 4, v36
    v_add_u32 v36, s22, v36
    v_xor_b32 v37, 64, v36
    v_xor_b32 v38, 128, v36
    v_xor_b32 v39, 192, v36
    v_lshlrev_b32 v2, 4, v0
    s_add_u32 s14, s9, 0
    s_and_b32 s14, s14, 3
    s_lshl_b32 s14, s14, 12
    v_add_u32 v12, s14, v2
    s_add_u32 s14, s9, 1
    s_and_b32 s14, s14, 3
    s_lshl_b32 s14, s14, 12
    v_add_u32 v13, s14, v2
    s_add_u32 s14, s9, 2
    s_and_b32 s14, s14, 3
    s_lshl_b32 s14, s14, 12
    v_add_u32 v14, s14, v2
    s_add_u32 s14, s9, 3
    s_and_b32 s14, s14, 3
    s_lshl_b32 s14, s14, 12
    v_add_u32 v15, s14, v2
    v_lshrrev_b32 v6, 5, v0
    v_lshlrev_b32 v148, 10, v6
    v_bfe_u32 v6, v0, 2, 2
    v_lshl_add_u32 v148, v6, 7, v148
    v_bfe_u32 v6, v0, 4, 1
    v_lshl_add_u32 v148, v6, 6, v148
    v_and_b32 v6, 3, v0
    v_lshl_add_u32 v148, v6, 4, v148
    v_mov_b32 v152, -1
    v_mov_b32 v153, -1
    v_mov_b32 v154, -1
    v_mov_b32 v155, -1
    s_lshl_b32 s15, s13, 5
    s_add_u32 s15, s15, s62
    s_lshl_b32 s15, s15, 8
    s_add_u32 s15, s15, 360448
    s_lshr_b32 s16, s62, 1
    s_lshl_b32 s16, s16, 7
    s_add_u32 s16, s16, 376832
    v_and_b32 v4, 3, v0
    v_lshlrev_b32 v4, 2, v4
    v_add_u32 v11, s16, v4
    v_add_u32 v4, s15, v4
    v_mov_b32 v149, v4
    s_cmp_eq_u32 s13, 0
    s_cselect_b32 s60, 0xf0f0f0f0, 0
    s_mov_b32 s61, s60
    s_waitcnt lgkmcnt(0)
    s_mul_i32 s15, s13, 68157440
    s_mul_i32 s16, s62, 2129920
    s_add_u32 s15, s15, s16
    s_add_u32 s15, s15, 18874368
    s_add_u32 s24, s4, s15
    s_addc_u32 s25, s5, 0
    s_mul_i32 s14, s13, 1048576
    s_lshl_b32 s15, s63, 15
    s_add_u32 s14, s14, s15
    s_lshl_b32 s15, s11, 14
    s_add_u32 s14, s14, s15
    s_lshl_b32 s15, s9, 12
    s_add_u32 s14, s14, s15
    s_lshl_b32 s15, s29, 9
    s_add_u32 s14, s14, s15
    s_add_u32 s14, s14, 161480704
    s_add_u32 s56, s4, s14
    s_addc_u32 s57, s5, 0
    v_mov_b32 v6, 0
    global_load_dword v6, v6, s[4:5] sc1
    s_waitcnt vmcnt(0)
    v_readfirstlane_b32 s8, v6
    s_add_u32 s8, s8, 1
    s_getreg_b32 s19, hwreg(HW_REG_XCC_ID)
    s_and_b32 s19, s19, 15
    s_lshl_b32 s14, s10, 8
    s_lshr_b32 s15, s2, 3
    s_lshl_b32 s15, s15, 3
    s_add_u32 s14, s14, s15
    s_add_u32 s14, s14, 333824
    s_cmp_lg_u32 s9, 0
    s_cbranch_scc1 XP_167
    v_mov_b32 v18, s14
    v_mov_b32 v16, s8
    v_mov_b32 v17, s19
    global_store_dwordx2 v18, v[16:17], s[4:5] sc1
XP_167:
    s_lshl_b32 s14, 0, 10
    s_add_u32 s14, s14, 335872
    v_mov_b32 v7, s14
    s_mov_b32 s12, 0
POLL_168:
    global_load_dword v6, v7, s[4:5] offset:0 sc1
    s_add_u32 s12, s12, 1
    s_mov_b32 s17, 28
    s_cmp_gt_u32 s12, 20000
    s_cbranch_scc1 TIMEOUT
    s_waitcnt vmcnt(0)
    v_cmp_ne_u32 vcc, s8, v6
    s_cbranch_vccnz POLL_168
    s_cmp_eq_u32 s13, 0
    s_cbranch_scc1 LS_169_E
    v_lshlrev_b32 v7, 4, v0
    v_add_u32 v7, 327680, v7
    s_mov_b32 s12, 0
LS_169:
    global_load_dword v6, v7, s[4:5] sc1
    s_add_u32 s12, s12, 1
    s_mov_b32 s17, 21
    s_cmp_gt_u32 s12, 20000
    s_cbranch_scc1 TIMEOUT
    s_waitcnt vmcnt(0)
    v_cmp_ne_u32 vcc, s8, v6
    s_cbranch_vccnz LS_169
LS_169_E:
    s_add_u32 s30, s20, 0x0
    s_addc_u32 s31, s21, 0
    s_add_u32 m0, s22, 0
    s_nop 0
    global_load_lds_dwordx4 v32, s[30:31]
    s_add_u32 s30, s20, 0x1000
    s_addc_u32 s31, s21, 0
    s_add_u32 m0, s22, 1024
    s_nop 0
    global_load_lds_dwordx4 v32, s[30:31]
    s_add_u32 s30, s20, 0x2000
    s_addc_u32 s31, s21, 0
    s_add_u32 m0, s22, 2048
    s_nop 0
    global_load_lds_dwordx4 v32, s[30:31]
    s_add_u32 s30, s20, 0x3000
    s_addc_u32 s31, s21, 0
    s_add_u32 m0, s22, 3072
    s_nop 0
    global_load_lds_dwordx4 v32, s[30:31]
    s_add_u32 s30, s20, 0x4000
    s_addc_u32 s31, s21, 0
    s_add_u32 m0, s22, 4096
    s_nop 0
    global_load_lds_dwordx4 v32, s[30:31]
    s_add_u32 s30, s20, 0x5000
    s_addc_u32 s31, s21, 0
    s_add_u32 m0, s22, 5120
    s_nop 0
    global_load_lds_dwordx4 v32, s[30:31]
    s_add_u32 s30, s20, 0x6000
    s_addc_u32 s31, s21, 0
    s_add_u32 m0, s22, 6144
    s_nop 0
    global_load_lds_dwordx4 v32, s[30:31]
    s_add_u32 s30, s20, 0x7000
    s_addc_u32 s31, s21, 0
    s_add_u32 m0, s22, 7168
    s_nop 0
    global_load_lds_dwordx4 v32, s[30:31]
    s_add_u32 s30, s20, 0x8000
    s_addc_u32 s31, s21, 0
    s_add_u32 m0, s22, 32768
    s_nop 0
    global_load_lds_dwordx4 v32, s[30:31]
    s_add_u32 s30, s20, 0x9000
    s_addc_u32 s31, s21, 0
    s_add_u32 m0, s22, 33792
    s_nop 0
    global_load_lds_dwordx4 v32, s[30:31]
    s_add_u32 s30, s20, 0xa000
    s_addc_u32 s31, s21, 0
    s_add_u32 m0, s22, 34816
    s_nop 0
    global_load_lds_dwordx4 v32, s[30:31]
    s_add_u32 s30, s20, 0xb000
    s_addc_u32 s31, s21, 0
    s_add_u32 m0, s22, 35840
    s_nop 0
    global_load_lds_dwordx4 v32, s[30:31]
    s_add_u32 s30, s20, 0xc000
    s_addc_u32 s31, s21, 0
    s_add_u32 m0, s22, 36864
    s_nop 0
    global_load_lds_dwordx4 v32, s[30:31]
    s_add_u32 s30, s20, 0xd000
    s_addc_u32 s31, s21, 0
    s_add_u32 m0, s22, 37888
    s_nop 0
    global_load_lds_dwordx4 v32, s[30:31]
    s_add_u32 s30, s20, 0xe000
    s_addc_u32 s31, s21, 0
    s_add_u32 m0, s22, 38912
    s_nop 0
    global_load_lds_dwordx4 v32, s[30:31]
    s_add_u32 s30, s20, 0xf000
    s_addc_u32 s31, s21, 0
    s_add_u32 m0, s22, 39936
    s_nop 0
    global_load_lds_dwordx4 v32, s[30:31]
    s_add_u32 s30, s20, 0x10000
    s_addc_u32 s31, s21, 0
    s_add_u32 m0, s22, 65536
    s_nop 0
    global_load_lds_dwordx4 v32, s[30:31]
    s_add_u32 s30, s20, 0x11000
    s_addc_u32 s31, s21, 0
    s_add_u32 m0, s22, 66560
    s_nop 0
    global_load_lds_dwordx4 v32, s[30:31]
    s_add_u32 s30, s20, 0x12000
    s_addc_u32 s31, s21, 0
    s_add_u32 m0, s22, 67584
    s_nop 0
    global_load_lds_dwordx4 v32, s[30:31]
    s_add_u32 s30, s20, 0x13000
    s_addc_u32 s31, s21, 0
    s_add_u32 m0, s22, 68608
    s_nop 0
    global_load_lds_dwordx4 v32, s[30:31]
    s_add_u32 s30, s20, 0x14000
    s_addc_u32 s31, s21, 0
    s_add_u32 m0, s22, 69632
    s_nop 0
    global_load_lds_dwordx4 v32, s[30:31]
    s_add_u32 s30, s20, 0x15000
    s_addc_u32 s31, s21, 0
    s_add_u32 m0, s22, 70656
    s_nop 0
    global_load_lds_dwordx4 v32, s[30:31]
    s_add_u32 s30, s20, 0x16000
    s_addc_u32 s31, s21, 0
    s_add_u32 m0, s22, 71680
    s_nop 0
    global_load_lds_dwordx4 v32, s[30:31]
    s_add_u32 s30, s20, 0x17000
    s_addc_u32 s31, s21, 0
    s_add_u32 m0, s22, 72704
    s_nop 0
    global_load_lds_dwordx4 v32, s[30:31]
    s_add_u32 s30, s20, 0x18000
    s_addc_u32 s31, s21, 0
    s_add_u32 m0, s22, 98304
    s_nop 0
    global_load_lds_dwordx4 v32, s[30:31]
    s_add_u32 s30, s20, 0x19000
    s_addc_u32 s31, s21, 0
    s_add_u32 m0, s22, 99328
    s_nop 0
    global_load_lds_dwordx4 v32, s[30:31]
    s_add_u32 s30, s20, 0x1a000
    s_addc_u32 s31, s21, 0
    s_add_u32 m0, s22, 100352
    s_nop 0
    global_load_lds_dwordx4 v32, s[30:31]
    s_add_u32 s30, s20, 0x1b000
    s_addc_u32 s31, s21, 0
    s_add_u32 m0, s22, 101376
    s_nop 0
    global_load_lds_dwordx4 v32, s[30:31]
    s_add_u32 s30, s20, 0x1c000
    s_addc_u32 s31, s21, 0
    s_add_u32 m0, s22, 102400
    s_nop 0
    global_load_lds_dwordx4 v32, s[30:31]
    s_add_u32 s30, s20, 0x1d000
    s_addc_u32 s31, s21, 0
    s_add_u32 m0, s22, 103424
    s_nop 0
    global_load_lds_dwordx4 v32, s[30:31]
    s_add_u32 s30, s20, 0x1e000
    s_addc_u32 s31, s21, 0
    s_add_u32 m0, s22, 104448
    s_nop 0
    global_load_lds_dwordx4 v32, s[30:31]
    s_add_u32 s30, s20, 0x1f000
    s_addc_u32 s31, s21, 0
    s_add_u32 m0, s22, 105472
    s_nop 0
    global_load_lds_dwordx4 v32, s[30:31]
    s_add_u32 s30, s20, 0x0
    s_addc_u32 s31, s21, 0
    s_add_u32 m0, s22, 131072
    s_nop 0
    global_load_lds_dwordx4 v33, s[30:31]
    s_add_u32 s30, s20, 0x1000
    s_addc_u32 s31, s21, 0
    s_add_u32 m0, s22, 132096
    s_nop 0
    global_load_lds_dwordx4 v33, s[30:31]
    s_add_u32 s30, s20, 0x2000
    s_addc_u32 s31, s21, 0
    s_add_u32 m0, s22, 133120
    s_nop 0
    global_load_lds_dwordx4 v33, s[30:31]
    s_add_u32 s30, s20, 0x3000
    s_addc_u32 s31, s21, 0
    s_add_u32 m0, s22, 134144
    s_nop 0
    global_load_lds_dwordx4 v33, s[30:31]
    s_add_u32 s30, s20, 0x4000
    s_addc_u32 s31, s21, 0
    s_add_u32 m0, s22, 135168
    s_nop 0
    global_load_lds_dwordx4 v33, s[30:31]
    s_add_u32 s30, s20, 0x5000
    s_addc_u32 s31, s21, 0
    s_add_u32 m0, s22, 136192
    s_nop 0
    global_load_lds_dwordx4 v33, s[30:31]
    s_add_u32 s30, s20, 0x6000
    s_addc_u32 s31, s21, 0
    s_add_u32 m0, s22, 137216
    s_nop 0
    global_load_lds_dwordx4 v33, s[30:31]
    s_add_u32 s30, s20, 0x7000
    s_addc_u32 s31, s21, 0
    s_add_u32 m0, s22, 138240
    s_nop 0
    global_load_lds_dwordx4 v33, s[30:31]
    s_waitcnt vmcnt(32)
    v_add_u32 v40, 0, v36
    ds_read_b64_tr_b16 a[0:1], v40 offset:0
    ds_read_b64_tr_b16 a[2:3], v40 offset:4096
    ds_read_b64_tr_b16 a[16:17], v40 offset:8
    ds_read_b64_tr_b16 a[18:19], v40 offset:4104
    v_add_u32 v41, 0, v37
    ds_read_b64_tr_b16 a[32:33], v41 offset:0
    ds_read_b64_tr_b16 a[34:35], v41 offset:4096
    ds_read_b64_tr_b16 a[48:49], v41 offset:8
    ds_read_b64_tr_b16 a[50:51], v41 offset:4104
    v_add_u32 v42, 0, v38
    ds_read_b64_tr_b16 a[64:65], v42 offset:0
    ds_read_b64_tr_b16 a[66:67], v42 offset:4096
    ds_read_b64_tr_b16 a[80:81], v42 offset:8
    ds_read_b64_tr_b16 a[82:83], v42 offset:4104
    v_add_u32 v43, 0, v39
    ds_read_b64_tr_b16 a[96:97], v43 offset:0
    ds_read_b64_tr_b16 a[98:99], v43 offset:4096
    ds_read_b64_tr_b16 a[112:113], v43 offset:8
    ds_read_b64_tr_b16 a[114:115], v43 offset:4104
    s_waitcnt lgkmcnt(0)
    s_add_u32 s30, s20, 0x8000
    s_addc_u32 s31, s21, 0
    s_add_u32 m0, s22, 0
    s_nop 0
    global_load_lds_dwordx4 v33, s[30:31]
    s_add_u32 s30, s20, 0x9000
    s_addc_u32 s31, s21, 0
    s_add_u32 m0, s22, 1024
    s_nop 0
    global_load_lds_dwordx4 v33, s[30:31]
    s_add_u32 s30, s20, 0xa000
    s_addc_u32 s31, s21, 0
    s_add_u32 m0, s22, 2048
    s_nop 0
    global_load_lds_dwordx4 v33, s[30:31]
    s_add_u32 s30, s20, 0xb000
    s_addc_u32 s31, s21, 0
    s_add_u32 m0, s22, 3072
    s_nop 0
    global_load_lds_dwordx4 v33, s[30:31]
    s_add_u32 s30, s20, 0xc000
    s_addc_u32 s31, s21, 0
    s_add_u32 m0, s22, 4096
    s_nop 0
    global_load_lds_dwordx4 v33, s[30:31]
    s_add_u32 s30, s20, 0xd000
    s_addc_u32 s31, s21, 0
    s_add_u32 m0, s22, 5120
    s_nop 0
    global_load_lds_dwordx4 v33, s[30:31]
    s_add_u32 s30, s20, 0xe000
    s_addc_u32 s31, s21, 0
    s_add_u32 m0, s22, 6144
    s_nop 0
    global_load_lds_dwordx4 v33, s[30:31]
    s_add_u32 s30, s20, 0xf000
    s_addc_u32 s31, s21, 0
    s_add_u32 m0, s22, 7168
    s_nop 0
    global_load_lds_dwordx4 v33, s[30:31]
    s_waitcnt vmcnt(32)
    v_add_u32 v40, 32768, v36
    ds_read_b64_tr_b16 a[4:5], v40 offset:0
    ds_read_b64_tr_b16 a[6:7], v40 offset:4096
    ds_read_b64_tr_b16 a[20:21], v40 offset:8
    ds_read_b64_tr_b16 a[22:23], v40 offset:4104
    v_add_u32 v41, 32768, v37
    ds_read_b64_tr_b16 a[36:37], v41 offset:0
    ds_read_b64_tr_b16 a[38:39], v41 offset:4096
    ds_read_b64_tr_b16 a[52:53], v41 offset:8
    ds_read_b64_tr_b16 a[54:55], v41 offset:4104
    v_add_u32 v42, 32768, v38
    ds_read_b64_tr_b16 a[68:69], v42 offset:0
    ds_read_b64_tr_b16 a[70:71], v42 offset:4096
    ds_read_b64_tr_b16 a[84:85], v42 offset:8
    ds_read_b64_tr_b16 a[86:87], v42 offset:4104
    v_add_u32 v43, 32768, v39
    ds_read_b64_tr_b16 a[100:101], v43 offset:0
    ds_read_b64_tr_b16 a[102:103], v43 offset:4096
    ds_read_b64_tr_b16 a[116:117], v43 offset:8
    ds_read_b64_tr_b16 a[118:119], v43 offset:4104
    s_waitcnt lgkmcnt(0)
    s_add_u32 s30, s20, 0x10000
    s_addc_u32 s31, s21, 0
    s_add_u32 m0, s22, 32768
    s_nop 0
    global_load_lds_dwordx4 v33, s[30:31]
    s_add_u32 s30, s20, 0x11000
    s_addc_u32 s31, s21, 0
    s_add_u32 m0, s22, 33792
    s_nop 0
    global_load_lds_dwordx4 v33, s[30:31]
    s_add_u32 s30, s20, 0x12000
    s_addc_u32 s31, s21, 0
    s_add_u32 m0, s22, 34816
    s_nop 0
    global_load_lds_dwordx4 v33, s[30:31]
    s_add_u32 s30, s20, 0x13000
    s_addc_u32 s31, s21, 0
    s_add_u32 m0, s22, 35840
    s_nop 0
    global_load_lds_dwordx4 v33, s[30:31]
    s_add_u32 s30, s20, 0x14000
    s_addc_u32 s31, s21, 0
    s_add_u32 m0, s22, 36864
    s_nop 0
    global_load_lds_dwordx4 v33, s[30:31]
    s_add_u32 s30, s20, 0x15000
    s_addc_u32 s31, s21, 0
    s_add_u32 m0, s22, 37888
    s_nop 0
    global_load_lds_dwordx4 v33, s[30:31]
    s_add_u32 s30, s20, 0x16000
    s_addc_u32 s31, s21, 0
    s_add_u32 m0, s22, 38912
    s_nop 0
    global_load_lds_dwordx4 v33, s[30:31]
    s_add_u32 s30, s20, 0x17000
    s_addc_u32 s31, s21, 0
    s_add_u32 m0, s22, 39936
    s_nop 0
    global_load_lds_dwordx4 v33, s[30:31]
    s_waitcnt vmcnt(32)
    v_add_u32 v40, 65536, v36
    ds_read_b64_tr_b16 a[8:9], v40 offset:0
    ds_read_b64_tr_b16 a[10:11], v40 offset:4096
    ds_read_b64_tr_b16 a[24:25], v40 offset:8
    ds_read_b64_tr_b16 a[26:27], v40 offset:4104
    v_add_u32 v41, 65536, v37
    ds_read_b64_tr_b16 a[40:41], v41 offset:0
    ds_read_b64_tr_b16 a[42:43], v41 offset:4096
    ds_read_b64_tr_b16 a[56:57], v41 offset:8
    ds_read_b64_tr_b16 a[58:59], v41 offset:4104
    v_add_u32 v42, 65536, v38
    ds_read_b64_tr_b16 a[72:73], v42 offset:0
    ds_read_b64_tr_b16 a[74:75], v42 offset:4096
    ds_read_b64_tr_b16 a[88:89], v42 offset:8
    ds_read_b64_tr_b16 a[90:91], v42 offset:4104
    v_add_u32 v43, 65536, v39
    ds_read_b64_tr_b16 a[104:105], v43 offset:0
    ds_read_b64_tr_b16 a[106:107], v43 offset:4096
    ds_read_b64_tr_b16 a[120:121], v43 offset:8
    ds_read_b64_tr_b16 a[122:123], v43 offset:4104
    s_waitcnt lgkmcnt(0)
    s_add_u32 s30, s20, 0x18000
    s_addc_u32 s31, s21, 0
    s_add_u32 m0, s22, 65536
    s_nop 0
    global_load_lds_dwordx4 v33, s[30:31]
    s_add_u32 s30, s20, 0x19000
    s_addc_u32 s31, s21, 0
    s_add_u32 m0, s22, 66560
    s_nop 0
    global_load_lds_dwordx4 v33, s[30:31]
    s_add_u32 s30, s20, 0x1a000
    s_addc_u32 s31, s21, 0
    s_add_u32 m0, s22, 67584
    s_nop 0
    global_load_lds_dwordx4 v33, s[30:31]
    s_add_u32 s30, s20, 0x1b000
    s_addc_u32 s31, s21, 0
    s_add_u32 m0, s22, 68608
    s_nop 0
    global_load_lds_dwordx4 v33, s[30:31]
    s_add_u32 s30, s20, 0x1c000
    s_addc_u32 s31, s21, 0
    s_add_u32 m0, s22, 69632
    s_nop 0
    global_load_lds_dwordx4 v33, s[30:31]
    s_add_u32 s30, s20, 0x1d000
    s_addc_u32 s31, s21, 0
    s_add_u32 m0, s22, 70656
    s_nop 0
    global_load_lds_dwordx4 v33, s[30:31]
    s_add_u32 s30, s20, 0x1e000
    s_addc_u32 s31, s21, 0
    s_add_u32 m0, s22, 71680
    s_nop 0
    global_load_lds_dwordx4 v33, s[30:31]
    s_add_u32 s30, s20, 0x1f000
    s_addc_u32 s31, s21, 0
    s_add_u32 m0, s22, 72704
    s_nop 0
    global_load_lds_dwordx4 v33, s[30:31]
    s_waitcnt vmcnt(32)
    v_add_u32 v40, 98304, v36
    ds_read_b64_tr_b16 a[12:13], v40 offset:0
    ds_read_b64_tr_b16 a[14:15], v40 offset:4096
    ds_read_b64_tr_b16 a[28:29], v40 offset:8
    ds_read_b64_tr_b16 a[30:31], v40 offset:4104
    v_add_u32 v41, 98304, v37
    ds_read_b64_tr_b16 a[44:45], v41 offset:0
    ds_read_b64_tr_b16 a[46:47], v41 offset:4096
    ds_read_b64_tr_b16 a[60:61], v41 offset:8
    ds_read_b64_tr_b16 a[62:63], v41 offset:4104
    v_add_u32 v42, 98304, v38
    ds_read_b64_tr_b16 a[76:77], v42 offset:0
    ds_read_b64_tr_b16 a[78:79], v42 offset:4096
    ds_read_b64_tr_b16 a[92:93], v42 offset:8
    ds_read_b64_tr_b16 a[94:95], v42 offset:4104
    v_add_u32 v43, 98304, v39
    ds_read_b64_tr_b16 a[108:109], v43 offset:0
    ds_read_b64_tr_b16 a[110:111], v43 offset:4096
    ds_read_b64_tr_b16 a[124:125], v43 offset:8
    ds_read_b64_tr_b16 a[126:127], v43 offset:4104
    s_waitcnt vmcnt(24)
    v_add_u32 v40, 131072, v36
    ds_read_b64_tr_b16 a[128:129], v40 offset:0
    ds_read_b64_tr_b16 a[130:131], v40 offset:4096
    ds_read_b64_tr_b16 a[144:145], v40 offset:8
    ds_read_b64_tr_b16 a[146:147], v40 offset:4104
    v_add_u32 v41, 131072, v37
    ds_read_b64_tr_b16 a[160:161], v41 offset:0
    ds_read_b64_tr_b16 a[162:163], v41 offset:4096
    ds_read_b64_tr_b16 a[176:177], v41 offset:8
    ds_read_b64_tr_b16 a[178:179], v41 offset:4104
    v_add_u32 v42, 131072, v38
    ds_read_b64_tr_b16 a[192:193], v42 offset:0
    ds_read_b64_tr_b16 a[194:195], v42 offset:4096
    ds_read_b64_tr_b16 a[208:209], v42 offset:8
    ds_read_b64_tr_b16 a[210:211], v42 offset:4104
    v_add_u32 v43, 131072, v39
    ds_read_b64_tr_b16 a[224:225], v43 offset:0
    ds_read_b64_tr_b16 a[226:227], v43 offset:4096
    ds_read_b64_tr_b16 a[240:241], v43 offset:8
    ds_read_b64_tr_b16 a[242:243], v43 offset:4104
    s_waitcnt vmcnt(16)
    v_add_u32 v40, 0, v36
    ds_read_b64_tr_b16 a[132:133], v40 offset:0
    ds_read_b64_tr_b16 a[134:135], v40 offset:4096
    ds_read_b64_tr_b16 a[148:149], v40 offset:8
    ds_read_b64_tr_b16 a[150:151], v40 offset:4104
    v_add_u32 v41, 0, v37
    ds_read_b64_tr_b16 a[164:165], v41 offset:0
    ds_read_b64_tr_b16 a[166:167], v41 offset:4096
    ds_read_b64_tr_b16 a[180:181], v41 offset:8
    ds_read_b64_tr_b16 a[182:183], v41 offset:4104
    v_add_u32 v42, 0, v38
    ds_read_b64_tr_b16 a[196:197], v42 offset:0
    ds_read_b64_tr_b16 a[198:199], v42 offset:4096
    ds_read_b64_tr_b16 a[212:213], v42 offset:8
    ds_read_b64_tr_b16 a[214:215], v42 offset:4104
    v_add_u32 v43, 0, v39
    ds_read_b64_tr_b16 a[228:229], v43 offset:0
    ds_read_b64_tr_b16 a[230:231], v43 offset:4096
    ds_read_b64_tr_b16 a[244:245], v43 offset:8
    ds_read_b64_tr_b16 a[246:247], v43 offset:4104
    s_waitcnt vmcnt(8)
    v_add_u32 v40, 32768, v36
    ds_read_b64_tr_b16 a[136:137], v40 offset:0
    ds_read_b64_tr_b16 a[138:139], v40 offset:4096
    ds_read_b64_tr_b16 a[152:153], v40 offset:8
    ds_read_b64_tr_b16 a[154:155], v40 offset:4104
    v_add_u32 v41, 32768, v37
    ds_read_b64_tr_b16 a[168:169], v41 offset:0
    ds_read_b64_tr_b16 a[170:171], v41 offset:4096
    ds_read_b64_tr_b16 a[184:185], v41 offset:8
    ds_read_b64_tr_b16 a[186:187], v41 offset:4104
    v_add_u32 v42, 32768, v38
    ds_read_b64_tr_b16 a[200:201], v42 offset:0
    ds_read_b64_tr_b16 a[202:203], v42 offset:4096
    ds_read_b64_tr_b16 a[216:217], v42 offset:8
    ds_read_b64_tr_b16 a[218:219], v42 offset:4104
    v_add_u32 v43, 32768, v39
    ds_read_b64_tr_b16 a[232:233], v43 offset:0
    ds_read_b64_tr_b16 a[234:235], v43 offset:4096
    ds_read_b64_tr_b16 a[248:249], v43 offset:8
    ds_read_b64_tr_b16 a[250:251], v43 offset:4104
    s_waitcnt vmcnt(0)
    v_add_u32 v40, 65536, v36
    ds_read_b64_tr_b16 a[140:141], v40 offset:0
    ds_read_b64_tr_b16 a[142:143], v40 offset:4096
    ds_read_b64_tr_b16 a[156:157], v40 offset:8
    ds_read_b64_tr_b16 a[158:159], v40 offset:4104
    v_add_u32 v41, 65536, v37
    ds_read_b64_tr_b16 a[172:173], v41 offset:0
    ds_read_b64_tr_b16 a[174:175], v41 offset:4096
    ds_read_b64_tr_b16 a[188:189], v41 offset:8
    ds_read_b64_tr_b16 a[190:191], v41 offset:4104
    v_add_u32 v42, 65536, v38
    ds_read_b64_tr_b16 a[204:205], v42 offset:0
    ds_read_b64_tr_b16 a[206:207], v42 offset:4096
    ds_read_b64_tr_b16 a[220:221], v42 offset:8
    ds_read_b64_tr_b16 a[222:223], v42 offset:4104
    v_add_u32 v43, 65536, v39
    ds_read_b64_tr_b16 a[236:237], v43 offset:0
    ds_read_b64_tr_b16 a[238:239], v43 offset:4096
    ds_read_b64_tr_b16 a[252:253], v43 offset:8
    ds_read_b64_tr_b16 a[254:255], v43 offset:4104
    s_waitcnt lgkmcnt(0)
    s_barrier
    s_add_u32 s38, s56, 0x0
    s_addc_u32 s39, s57, 0
    global_store_dwordx4 v148, v[152:155], s[38:39] offset:0 sc1
    global_store_dwordx4 v148, v[152:155], s[38:39] offset:2048 sc1
    s_add_u32 s38, s56, 0x40000
    s_addc_u32 s39, s57, 0
    global_store_dwordx4 v148, v[152:155], s[38:39] offset:0 sc1
    global_store_dwordx4 v148, v[152:155], s[38:39] offset:2048 sc1
    s_add_u32 s38, s56, 0x80000
    s_addc_u32 s39, s57, 0
    global_store_dwordx4 v148, v[152:155], s[38:39] offset:0 sc1
    global_store_dwordx4 v148, v[152:155], s[38:39] offset:2048 sc1
    s_add_u32 s38, s56, 0xc0000
    s_addc_u32 s39, s57, 0
    global_store_dwordx4 v148, v[152:155], s[38:39] offset:0 sc1
    global_store_dwordx4 v148, v[152:155], s[38:39] offset:2048 sc1
    s_lshl_b32 s14, s13, 10
    s_add_u32 s14, s14, 344064
    s_add_u32 s58, s4, s14
    s_addc_u32 s59, s5, 0
    v_and_b32 v3, 7, v0
    v_lshlrev_b32 v3, 7, v3
    v_lshrrev_b32 v6, 4, v0
    v_and_b32 v7, 15, v0
    v_lshlrev_b32 v8, 4, v7
    v_lshl_add_u32 v1, v6, 9, v8
    v_lshlrev_b32 v6, 2, v6
    v_sub_u32 v7, v7, v6
    s_lshl_b32 s14, s29, 4
    v_add_u32 v7, s14, v7
    v_cmp_le_i32 s[40:41], 0, v7
    v_cmp_le_i32 s[42:43], 1, v7
    v_cmp_le_i32 s[44:45], 2, v7
    v_cmp_le_i32 s[46:47], 3, v7
    v_cmp_le_i32 s[48:49], 16, v7
    v_cmp_le_i32 s[50:51], 17, v7
    v_cmp_le_i32 s[52:53], 18, v7
    v_cmp_le_i32 s[54:55], 19, v7
    v_mov_b32 v137, 0
    v_mov_b32 v138, 0
    s_lshl_b32 s29, s29, 8
    s_add_u32 s29, s29, 4096
    s_add_u32 s30, s24, s29
    s_addc_u32 s31, s25, 0
    s_add_u32 s32, s24, 0x3000
    s_addc_u32 s33, s25, 0
    s_add_u32 s34, s24, 0x5000
    s_addc_u32 s35, s25, 0
    s_add_u32 s36, s24, 0x6000
    s_addc_u32 s37, s25, 0
    s_waitcnt vmcnt(0)
    s_barrier
    s_getreg_b32 s19, hwreg(HW_REG_XCC_ID)
    s_and_b32 s19, s19, 15
    s_lshl_b32 s14, s10, 8
    s_lshr_b32 s15, s2, 3
    s_lshl_b32 s15, s15, 3
    s_add_u32 s14, s14, s15
    s_add_u32 s14, s14, 331776
    s_cmp_lg_u32 s9, 0
    s_cbranch_scc1 XP_170
    v_mov_b32 v18, s14
    v_mov_b32 v16, s8
    v_mov_b32 v17, s19
    global_store_dwordx2 v18, v[16:17], s[4:5] sc1
XP_170:
    v_and_b32 v17, 31, v0
    v_max_u32 v17, 14, v17
    v_and_or_b32 v17, v0, 32, v17
    v_lshlrev_b32 v17, 3, v17
    v_add_u32 v17, 333312, v17
    s_mov_b32 s12, 0
POLL_171:
    global_load_dword v16, v17, s[4:5] offset:0 sc1
    s_add_u32 s12, s12, 1
    s_mov_b32 s17, 24
    s_cmp_gt_u32 s12, 20000
    s_cbranch_scc1 TIMEOUT
    s_waitcnt vmcnt(0)
    v_cmp_ne_u32 vcc, s8, v16
    s_cbranch_vccnz POLL_171
    v_mov_b32 v9, 0x3e0293ee
    s_lshl_b32 s26, s8, 7
    s_add_u32 s26, s26, 1
    s_mov_b32 s23, 0
    s_add_u32 s21, s13, 59
    s_mov_b32 s62, 32768
    s_cmp_eq_u32 s13, 0
    s_cselect_b32 s20, 64, 59
    s_cselect_b32 s62, 67993600, s62
    s_cselect_b32 s63, 8320, 0
AW_NP:
    s_mov_b32 s12, 0
AP_172:
    global_load_dword v5, v149, s[4:5] sc1
    s_add_u32 s12, s12, 1
    s_mov_b32 s17, 13
    s_cmp_gt_u32 s12, 20000
    s_cbranch_scc1 TIMEOUT
    s_waitcnt vmcnt(0)
    v_subrev_u32 v5, s26, v5
    v_cmp_lt_u32 vcc, 63, v5
    s_cbranch_vccnz AP_172
    global_load_dwordx4 v[16:19], v1, s[30:31] offset:-4096 sc1
    global_load_dwordx4 v[20:23], v1, s[30:31] offset:-2048 sc1
    global_load_dwordx4 v[24:27], v1, s[30:31] offset:0 sc1
    global_load_dwordx4 v[28:31], v1, s[30:31] offset:2048 sc1
    global_load_dwordx4 v[32:35], v1, s[32:33] offset:-4096 sc1
    global_load_dwordx4 v[48:51], v1, s[32:33] offset:-3840 sc1
    global_load_dwordx4 v[36:39], v1, s[32:33] offset:-2048 sc1
    global_load_dwordx4 v[52:55], v1, s[32:33] offset:-1792 sc1
    global_load_dwordx4 v[40:43], v1, s[32:33] offset:0 sc1
    global_load_dwordx4 v[56:59], v1, s[32:33] offset:256 sc1
    global_load_dwordx4 v[44:47], v1, s[32:33] offset:2048 sc1
    global_load_dwordx4 v[60:63], v1, s[32:33] offset:2304 sc1
    global_load_dwordx4 v[64:67], v1, s[34:35] offset:-4096 sc1
    global_load_dwordx4 v[68:71], v1, s[34:35] offset:-3840 sc1
    global_load_dwordx4 v[72:75], v1, s[34:35] offset:-2048 sc1
    global_load_dwordx4 v[76:79], v1, s[34:35] offset:-1792 sc1
    global_load_dwordx4 v[80:83], v1, s[34:35] offset:0 sc1
    global_load_dwordx4 v[84:87], v1, s[34:35] offset:256 sc1
    global_load_dwordx4 v[88:91], v1, s[34:35] offset:2048 sc1
    global_load_dwordx4 v[92:95], v1, s[34:35] offset:2304 sc1
    global_load_dwordx4 v[96:99], v2, s[36:37] offset:0 sc1
    global_load_dwordx4 v[100:103], v2, s[36:37] offset:1024 sc1
    global_load_dwordx4 v[104:107], v2, s[36:37] offset:2048 sc1
    global_load_dwordx4 v[108:111], v2, s[36:37] offset:3072 sc1
    v_xor_b32 v4, 128, v4
    s_add_u32 s14, s23, 1
    s_cmp_ge_u32 s14, s20
    s_cselect_b32 s15, 64, 0
    s_add_u32 s26, s26, s15
    s_lshr_b32 s14, s14, 1
    s_bitcmp1_b32 0xfff80000, s14
    s_cselect_b64 vcc, s[60:61], 0
    v_cndmask_b32 v149, v4, v11, vcc
    s_add_u32 s26, s26, 1
    global_load_dword v10, v3, s[58:59] sc1
    global_load_dword v5, v149, s[4:5] sc1
    s_waitcnt vmcnt(0)
AW_LOOP:
    s_waitcnt vmcnt(20)
    s_waitcnt vmcnt(19)
    v_mfma_f32_16x16x32_bf16 v[120:123], v[32:35], v[16:19], 0
    s_add_u32 s24, s24, 0x8000
    s_addc_u32 s25, s25, 0
    v_mfma_f32_16x16x32_bf16 v[124:127], v[48:51], v[16:19], 0
    s_add_u32 s30, s24, s29
    s_addc_u32 s31, s25, 0
    s_add_u32 s32, s24, 0x3000
    s_addc_u32 s33, s25, 0
    s_add_u32 s34, s24, 0x5000
    s_addc_u32 s35, s25, 0
    s_waitcnt vmcnt(18)
    v_mfma_f32_16x16x32_bf16 v[120:123], v[36:39], v[20:23], v[120:123]
    s_bfe_u32 s27, s23, 0x10002
    s_and_b32 s14, s23, 3
    s_lshl_b32 s14, s14, 18
    s_add_u32 s38, s56, s14
    s_addc_u32 s39, s57, 0
    v_mfma_f32_16x16x32_bf16 v[124:127], v[52:55], v[20:23], v[124:127]
    s_lshl_b32 s28, s23, 3
    s_sub_u32 s28, s28, 24
    s_mov_b32 s12, 0
    s_waitcnt vmcnt(17)
    v_mfma_f32_16x16x32_bf16 v[120:123], v[40:43], v[24:27], v[120:123]
    v_mov_b32 v8, 0xf149f2ca
    s_waitcnt vmcnt(10)
    v_cmp_gt_i32 vcc, s28, v10
    v_mfma_f32_16x16x32_bf16 v[124:127], v[56:59], v[24:27], v[124:127]
    s_cbranch_vccnz AW_CS
AW_CR:
    v_mfma_f32_16x16x32_bf16 v[120:123], v[44:47], v[28:31], v[120:123]
    v_subrev_u32 v5, s26, v5
    v_cmp_lt_u32 vcc, 63, v5
    v_mfma_f32_16x16x32_bf16 v[124:127], v[60:63], v[28:31], v[124:127]
    s_cbranch_vccnz AW_N
    s_nop 2
    v_cndmask_b32 v120, v8, v120, s[40:41]
    v_cndmask_b32 v121, v8, v121, s[42:43]
    v_cndmask_b32 v122, v8, v122, s[44:45]
    global_load_dwordx4 v[32:35], v1, s[32:33] offset:-4096 sc1
    v_cndmask_b32 v123, v8, v123, s[46:47]
    v_cndmask_b32 v124, v8, v124, s[48:49]
    v_cndmask_b32 v125, v8, v125, s[50:51]
    v_cndmask_b32 v126, v8, v126, s[52:53]
    v_cndmask_b32 v127, v8, v127, s[54:55]
    v_max3_f32 v140, v120, v121, v122
    v_max3_f32 v140, v140, v123, v124
    global_load_dwordx4 v[48:51], v1, s[32:33] offset:-3840 sc1
    v_max3_f32 v140, v140, v125, v126
    v_max_f32 v146, v140, v127
    v_max_f32 v140, v140, v127
    s_nop 1
    v_permlane32_swap_b32 v140, v146
    v_max_f32 v140, v140, v146
    v_mov_b32 v146, v140
    s_nop 1
    v_permlane16_swap_b32 v140, v146
    global_load_dwordx4 v[36:39], v1, s[32:33] offset:-2048 sc1
    v_max_f32 v140, v140, v146
    v_mul_f32 v142, 0xbe0293ee, v140
    v_fma_f32 v120, v120, v9, v142
    v_fma_f32 v121, v121, v9, v142
    v_fma_f32 v122, v122, v9, v142
    v_fma_f32 v123, v123, v9, v142
    v_fma_f32 v124, v124, v9, v142
    global_load_dwordx4 v[52:55], v1, s[32:33] offset:-1792 sc1
    v_fma_f32 v125, v125, v9, v142
    v_fma_f32 v126, v126, v9, v142
    v_fma_f32 v127, v127, v9, v142
    v_exp_f32 v120, v120
    v_exp_f32 v121, v121
    v_exp_f32 v122, v122
    v_exp_f32 v123, v123
    global_load_dwordx4 v[40:43], v1, s[32:33] offset:0 sc1
    v_exp_f32 v124, v124
    v_exp_f32 v125, v125
    v_exp_f32 v126, v126
    v_exp_f32 v127, v127
    v_cvt_pk_bf16_f32 v132, v120, v121
    v_cvt_pk_bf16_f32 v133, v122, v123
    v_cvt_pk_bf16_f32 v134, v124, v125
    global_load_dwordx4 v[56:59], v1, s[32:33] offset:256 sc1
    v_cvt_pk_bf16_f32 v135, v126, v127
    s_nop 1
    v_mfma_f32_16x16x32_bf16 v[160:163], v[64:67], v[132:135], 0
    v_add_f32 v141, v120, v121
    v_add_f32 v141, v141, v122
    v_mfma_f32_16x16x32_bf16 v[164:167], v[68:71], v[132:135], 0
    v_add_f32 v141, v141, v123
    v_add_f32 v141, v141, v124
    global_load_dwordx4 v[44:47], v1, s[32:33] offset:2048 sc1
    v_mfma_f32_16x16x32_bf16 v[168:171], v[72:75], v[132:135], 0
    v_add_f32 v141, v141, v125
    v_add_f32 v141, v141, v126
    v_mfma_f32_16x16x32_bf16 v[172:175], v[76:79], v[132:135], 0
    v_add_f32 v146, v141, v127
    v_add_f32 v141, v141, v127
    s_waitcnt vmcnt(12)
    v_mfma_f32_16x16x32_bf16 v[176:179], v[80:83], v[132:135], 0
    global_load_dwordx4 v[60:63], v1, s[32:33] offset:2304 sc1
    v_permlane32_swap_b32 v141, v146
    v_add_f32 v141, v141, v146
    s_waitcnt vmcnt(12)
    v_mfma_f32_16x16x32_bf16 v[180:183], v[84:87], v[132:135], 0
    v_mov_b32 v146, v141
    s_nop 1
    v_permlane16_swap_b32 v141, v146
    s_waitcnt vmcnt(11)
    v_mfma_f32_16x16x32_bf16 v[184:187], v[88:91], v[132:135], 0
    v_add_f32 v141, v141, v146
    v_xor_b32 v4, 128, v4
    s_add_u32 s14, s23, 2
    s_cmp_ge_u32 s14, s20
    s_cselect_b32 s15, 64, 0
    s_add_u32 s26, s26, s15
    s_lshr_b32 s14, s14, 1
    s_bitcmp1_b32 0xfff80000, s14
    s_cselect_b64 vcc, s[60:61], 0
    s_waitcnt vmcnt(10)
    v_mfma_f32_16x16x32_bf16 v[188:191], v[92:95], v[132:135], 0
    v_cndmask_b32 v149, v4, v11, vcc
    s_add_u32 s26, s26, 1
AW_K0p:
    v_max3_u32 v6, v96, v100, v104
    v_max_u32 v6, v6, v108
    v_cmp_eq_u32 vcc, -1, v6
    v_mfma_f32_16x16x32_bf16 v[128:131], v[96:99], v[16:19], 0
    s_cbranch_vccnz AW_PKp
    s_mov_b32 vcc_lo, 0xcccccccc
    s_mov_b32 vcc_hi, 0xcccccccc
    v_mfma_f32_16x16x32_bf16 v[128:131], v[100:103], v[20:23], v[128:131]
    v_cndmask_b32_dpp v112, v98, v96, vcc quad_perm:[2,3,2,3] row_mask:0xf bank_mask:0xf
    v_mfma_f32_16x16x32_bf16 v[128:131], v[104:107], v[24:27], v[128:131]
    v_cndmask_b32_dpp v113, v99, v97, vcc quad_perm:[2,3,2,3] row_mask:0xf bank_mask:0xf
    v_mfma_f32_16x16x32_bf16 v[128:131], v[108:111], v[28:31], v[128:131]
    v_cndmask_b32_dpp v114, v102, v100, vcc quad_perm:[2,3,2,3] row_mask:0xf bank_mask:0xf
    v_cndmask_b32_dpp v115, v103, v101, vcc quad_perm:[2,3,2,3] row_mask:0xf bank_mask:0xf
    v_cndmask_b32_dpp v116, v106, v104, vcc quad_perm:[2,3,2,3] row_mask:0xf bank_mask:0xf
    v_cndmask_b32_dpp v117, v107, v105, vcc quad_perm:[2,3,2,3] row_mask:0xf bank_mask:0xf
    v_cndmask_b32_dpp v118, v110, v108, vcc quad_perm:[2,3,2,3] row_mask:0xf bank_mask:0xf
    v_cndmask_b32_dpp v119, v111, v109, vcc quad_perm:[2,3,2,3] row_mask:0xf bank_mask:0xf
AW_GOp:
    s_nop 1
    v_max3_f32 v142, v140, v128, v129
    v_max3_f32 v143, v140, v128, v129
    s_nop 1
    v_permlane32_swap_b32 v142, v143
    v_max_f32 v142, v142, v143
    v_mov_b32 v143, v142
    s_nop 1
    v_permlane16_swap_b32 v142, v143
    v_max_f32 v142, v142, v143
    v_mul_f32 v142, 0xbe0293ee, v142
    v_fma_f32 v128, v128, v9, v142
    v_fma_f32 v129, v129, v9, v142
    v_fma_f32 v144, v140, v9, v142
    v_exp_f32 v128, v128
    v_exp_f32 v129, v129
    v_exp_f32 v144, v144
    v_add_f32 v146, v128, v129
    v_add_f32 v147, v128, v129
    s_nop 1
    v_permlane32_swap_b32 v146, v147
    v_add_f32 v146, v146, v147
    v_mov_b32 v147, v146
    s_nop 1
    v_permlane16_swap_b32 v146, v147
    v_add_f32 v146, v146, v147
    v_fma_f32 v141, v141, v144, v146
    v_rcp_f32 v141, v141
    s_add_u32 s23, s23, 1
    s_add_u32 s36, s24, 0x6000
    s_addc_u32 s37, s25, 0
    v_mul_f32 v144, v144, v141
    v_mul_f32 v128, v128, v141
    v_mul_f32 v129, v129, v141
    v_pk_mul_f32 v[160:161], v[160:161], v[144:145] op_sel_hi:[1,0]
    v_pk_mul_f32 v[162:163], v[162:163], v[144:145] op_sel_hi:[1,0]
    v_cvt_pk_bf16_f32 v136, v128, v129
    v_cvt_pk_bf16_f32 v139, v128, v129
    v_pk_mul_f32 v[164:165], v[164:165], v[144:145] op_sel_hi:[1,0]
    v_mfma_f32_16x16x16_bf16 v[160:163], v[112:113], v[136:137], v[160:163]
    global_load_dwordx4 v[16:19], v1, s[30:31] offset:-4096 sc1
    v_pk_mul_f32 v[166:167], v[166:167], v[144:145] op_sel_hi:[1,0]
    v_pk_mul_f32 v[168:169], v[168:169], v[144:145] op_sel_hi:[1,0]
    v_pk_mul_f32 v[170:171], v[170:171], v[144:145] op_sel_hi:[1,0]
    v_mfma_f32_16x16x16_bf16 v[164:167], v[112:113], v[138:139], v[164:167]
    v_pk_mul_f32 v[172:173], v[172:173], v[144:145] op_sel_hi:[1,0]
    v_pk_mul_f32 v[174:175], v[174:175], v[144:145] op_sel_hi:[1,0]
    v_pk_mul_f32 v[176:177], v[176:177], v[144:145] op_sel_hi:[1,0]
    v_mfma_f32_16x16x16_bf16 v[168:171], v[114:115], v[136:137], v[168:171]
    v_pk_mul_f32 v[178:179], v[178:179], v[144:145] op_sel_hi:[1,0]
    v_pk_mul_f32 v[180:181], v[180:181], v[144:145] op_sel_hi:[1,0]
    v_pk_mul_f32 v[182:183], v[182:183], v[144:145] op_sel_hi:[1,0]
    v_mfma_f32_16x16x16_bf16 v[172:175], v[114:115], v[138:139], v[172:175]
    v_pk_mul_f32 v[184:185], v[184:185], v[144:145] op_sel_hi:[1,0]
    v_pk_mul_f32 v[186:187], v[186:187], v[144:145] op_sel_hi:[1,0]
    v_pk_mul_f32 v[188:189], v[188:189], v[144:145] op_sel_hi:[1,0]
    v_mfma_f32_16x16x16_bf16 v[176:179], v[116:117], v[136:137], v[176:179]
    global_load_dwordx4 v[20:23], v1, s[30:31] offset:-2048 sc1
    v_pk_mul_f32 v[190:191], v[190:191], v[144:145] op_sel_hi:[1,0]
    v_cvt_pk_bf16_f32 v160, v160, v161
    v_cvt_pk_bf16_f32 v161, v162, v163
    v_mfma_f32_16x16x16_bf16 v[180:183], v[116:117], v[138:139], v[180:183]
    v_cvt_pk_bf16_f32 v162, v164, v165
    v_cvt_pk_bf16_f32 v163, v166, v167
    ds_write_b128 v12, v[160:163] offset:0
    v_mfma_f32_16x16x16_bf16 v[184:187], v[118:119], v[136:137], v[184:187]
    v_cvt_pk_bf16_f32 v168, v168, v169
    v_cvt_pk_bf16_f32 v169, v170, v171
    v_cvt_pk_bf16_f32 v170, v172, v173
    v_mfma_f32_16x16x16_bf16 v[188:191], v[118:119], v[138:139], v[188:191]
    v_cvt_pk_bf16_f32 v171, v174, v175
    ds_write_b128 v12, v[168:171] offset:1024
    v_cvt_pk_bf16_f32 v176, v176, v177
    v_mfma_f32_16x16x32_bf16 v[192:195], a[0:3], v[160:163], 0
    global_load_dwordx4 v[24:27], v1, s[30:31] offset:0 sc1
    v_cvt_pk_bf16_f32 v177, v178, v179
    v_cvt_pk_bf16_f32 v178, v180, v181
    v_cvt_pk_bf16_f32 v179, v182, v183
    v_mfma_f32_16x16x32_bf16 v[196:199], a[16:19], v[160:163], 0
    ds_write_b128 v12, v[176:179] offset:2048
    v_cvt_pk_bf16_f32 v184, v184, v185
    v_cvt_pk_bf16_f32 v185, v186, v187
    v_mfma_f32_16x16x32_bf16 v[200:203], a[32:35], v[160:163], 0
    v_cvt_pk_bf16_f32 v186, v188, v189
    v_cvt_pk_bf16_f32 v187, v190, v191
    ds_write_b128 v12, v[184:187] offset:3072
    v_mfma_f32_16x16x32_bf16 v[204:207], a[48:51], v[160:163], 0
    v_mfma_f32_16x16x32_bf16 v[192:195], a[4:7], v[168:171], v[192:195]
    global_load_dwordx4 v[28:31], v1, s[30:31] offset:2048 sc1
    v_mfma_f32_16x16x32_bf16 v[196:199], a[20:23], v[168:171], v[196:199]
    s_waitcnt lgkmcnt(0)
    s_barrier
    ds_read_b128 v[208:211], v13 offset:0
    ds_read_b128 v[212:215], v13 offset:1024
    v_mfma_f32_16x16x32_bf16 v[200:203], a[36:39], v[168:171], v[200:203]
    ds_read_b128 v[216:219], v13 offset:2048
    ds_read_b128 v[220:223], v13 offset:3072
    v_mfma_f32_16x16x32_bf16 v[204:207], a[52:55], v[168:171], v[204:207]
    ds_read_b128 v[224:227], v14 offset:0
    v_mfma_f32_16x16x32_bf16 v[192:195], a[8:11], v[176:179], v[192:195]
    global_load_dwordx4 v[64:67], v1, s[34:35] offset:-4096 sc1
    v_xor_b32 v12, 0x4000, v12
    v_mfma_f32_16x16x32_bf16 v[196:199], a[24:27], v[176:179], v[196:199]
    ds_read_b128 v[228:231], v14 offset:1024
    v_mfma_f32_16x16x32_bf16 v[200:203], a[40:43], v[176:179], v[200:203]
    v_mfma_f32_16x16x32_bf16 v[204:207], a[56:59], v[176:179], v[204:207]
    ds_read_b128 v[232:235], v14 offset:2048
    v_mfma_f32_16x16x32_bf16 v[192:195], a[12:15], v[184:187], v[192:195]
    global_load_dwordx4 v[68:71], v1, s[34:35] offset:-3840 sc1
    v_mfma_f32_16x16x32_bf16 v[196:199], a[28:31], v[184:187], v[196:199]
    ds_read_b128 v[236:239], v14 offset:3072
    v_mfma_f32_16x16x32_bf16 v[200:203], a[44:47], v[184:187], v[200:203]
    v_mfma_f32_16x16x32_bf16 v[204:207], a[60:63], v[184:187], v[204:207]
    s_waitcnt lgkmcnt(7)
    v_mfma_f32_16x16x32_bf16 v[192:195], a[64:67], v[208:211], v[192:195]
    global_load_dwordx4 v[72:75], v1, s[34:35] offset:-2048 sc1
    v_mfma_f32_16x16x32_bf16 v[196:199], a[80:83], v[208:211], v[196:199]
    v_mfma_f32_16x16x32_bf16 v[200:203], a[96:99], v[208:211], v[200:203]
    v_mfma_f32_16x16x32_bf16 v[204:207], a[112:115], v[208:211], v[204:207]
    s_waitcnt lgkmcnt(6)
    v_mfma_f32_16x16x32_bf16 v[192:195], a[68:71], v[212:215], v[192:195]
    global_load_dwordx4 v[76:79], v1, s[34:35] offset:-1792 sc1
    v_mfma_f32_16x16x32_bf16 v[196:199], a[84:87], v[212:215], v[196:199]
    ds_read_b128 v[240:243], v15 offset:0
    v_mfma_f32_16x16x32_bf16 v[200:203], a[100:103], v[212:215], v[200:203]
    v_mfma_f32_16x16x32_bf16 v[204:207], a[116:119], v[212:215], v[204:207]
    ds_read_b128 v[244:247], v15 offset:1024
    s_waitcnt lgkmcnt(7)
    v_mfma_f32_16x16x32_bf16 v[192:195], a[72:75], v[216:219], v[192:195]
    global_load_dword v10, v3, s[58:59] sc1
    global_load_dword v5, v149, s[4:5] sc1
    v_mfma_f32_16x16x32_bf16 v[196:199], a[88:91], v[216:219], v[196:199]
    ds_read_b128 v[248:251], v15 offset:2048
    v_mfma_f32_16x16x32_bf16 v[200:203], a[104:107], v[216:219], v[200:203]
    v_mfma_f32_16x16x32_bf16 v[204:207], a[120:123], v[216:219], v[204:207]
    ds_read_b128 v[252:255], v15 offset:3072
    s_waitcnt lgkmcnt(8)
    v_mfma_f32_16x16x32_bf16 v[192:195], a[76:79], v[220:223], v[192:195]
    global_load_dwordx4 v[96:99], v2, s[36:37] offset:0 sc1
    v_xor_b32 v13, 0x4000, v13
    v_xor_b32 v14, 0x4000, v14
    v_xor_b32 v15, 0x4000, v15
    v_mfma_f32_16x16x32_bf16 v[196:199], a[92:95], v[220:223], v[196:199]
    v_mfma_f32_16x16x32_bf16 v[200:203], a[108:111], v[220:223], v[200:203]
    v_mfma_f32_16x16x32_bf16 v[204:207], a[124:127], v[220:223], v[204:207]
    s_waitcnt lgkmcnt(7)
    v_mfma_f32_16x16x32_bf16 v[192:195], a[128:131], v[224:227], v[192:195]
    global_load_dwordx4 v[100:103], v2, s[36:37] offset:1024 sc1
    v_mfma_f32_16x16x32_bf16 v[196:199], a[144:147], v[224:227], v[196:199]
    v_mfma_f32_16x16x32_bf16 v[200:203], a[160:163], v[224:227], v[200:203]
    v_mfma_f32_16x16x32_bf16 v[204:207], a[176:179], v[224:227], v[204:207]
    s_waitcnt lgkmcnt(6)
    v_mfma_f32_16x16x32_bf16 v[192:195], a[132:135], v[228:231], v[192:195]
    global_load_dwordx4 v[104:107], v2, s[36:37] offset:2048 sc1
    v_mfma_f32_16x16x32_bf16 v[196:199], a[148:151], v[228:231], v[196:199]
    v_mfma_f32_16x16x32_bf16 v[200:203], a[164:167], v[228:231], v[200:203]
    v_mfma_f32_16x16x32_bf16 v[204:207], a[180:183], v[228:231], v[204:207]
    s_waitcnt lgkmcnt(5)
    v_mfma_f32_16x16x32_bf16 v[192:195], a[136:139], v[232:235], v[192:195]
    global_load_dwordx4 v[108:111], v2, s[36:37] offset:3072 sc1
    v_mfma_f32_16x16x32_bf16 v[196:199], a[152:155], v[232:235], v[196:199]
    v_mfma_f32_16x16x32_bf16 v[200:203], a[168:171], v[232:235], v[200:203]
    v_mfma_f32_16x16x32_bf16 v[204:207], a[184:187], v[232:235], v[204:207]
    s_waitcnt lgkmcnt(4)
    v_mfma_f32_16x16x32_bf16 v[192:195], a[140:143], v[236:239], v[192:195]
    global_load_dwordx4 v[80:83], v1, s[34:35] offset:0 sc1
    v_mfma_f32_16x16x32_bf16 v[196:199], a[156:159], v[236:239], v[196:199]
    v_mfma_f32_16x16x32_bf16 v[200:203], a[172:175], v[236:239], v[200:203]
    v_mfma_f32_16x16x32_bf16 v[204:207], a[188:191], v[236:239], v[204:207]
    s_waitcnt lgkmcnt(3)
    v_mfma_f32_16x16x32_bf16 v[192:195], a[192:195], v[240:243], v[192:195]
    global_load_dwordx4 v[84:87], v1, s[34:35] offset:256 sc1
    v_mfma_f32_16x16x32_bf16 v[196:199], a[208:211], v[240:243], v[196:199]
    s_waitcnt lgkmcnt(2)
    v_mfma_f32_16x16x32_bf16 v[192:195], a[196:199], v[244:247], v[192:195]
    v_mfma_f32_16x16x32_bf16 v[196:199], a[212:215], v[244:247], v[196:199]
    s_waitcnt lgkmcnt(1)
    v_mfma_f32_16x16x32_bf16 v[192:195], a[200:203], v[248:251], v[192:195]
    global_load_dwordx4 v[88:91], v1, s[34:35] offset:2048 sc1
    v_mfma_f32_16x16x32_bf16 v[196:199], a[216:219], v[248:251], v[196:199]
    s_waitcnt lgkmcnt(0)
    v_mfma_f32_16x16x32_bf16 v[192:195], a[204:207], v[252:255], v[192:195]
    v_mfma_f32_16x16x32_bf16 v[196:199], a[220:223], v[252:255], v[196:199]
    v_mfma_f32_16x16x32_bf16 v[200:203], a[224:227], v[240:243], v[200:203]
    global_load_dwordx4 v[92:95], v1, s[34:35] offset:2304 sc1
    v_mfma_f32_16x16x32_bf16 v[204:207], a[240:243], v[240:243], v[204:207]
    v_cvt_pk_f16_f32 v152, v192, v193
    v_cvt_pk_f16_f32 v153, v194, v195
    v_mfma_f32_16x16x32_bf16 v[200:203], a[228:231], v[244:247], v[200:203]
    v_and_or_b32 v152, v152, -2, s27
    v_cvt_pk_f16_f32 v154, v196, v197
    v_mfma_f32_16x16x32_bf16 v[204:207], a[244:247], v[244:247], v[204:207]
    v_cvt_pk_f16_f32 v155, v198, v199
    global_store_dwordx4 v148, v[152:155], s[38:39] offset:0 sc1
    v_mfma_f32_16x16x32_bf16 v[200:203], a[232:235], v[248:251], v[200:203]
    v_mfma_f32_16x16x32_bf16 v[204:207], a[248:251], v[248:251], v[204:207]
    v_mfma_f32_16x16x32_bf16 v[200:203], a[236:239], v[252:255], v[200:203]
    v_mfma_f32_16x16x32_bf16 v[204:207], a[252:255], v[252:255], v[204:207]
    s_nop 3
    v_cvt_pk_f16_f32 v156, v200, v201
    v_cvt_pk_f16_f32 v157, v202, v203
    v_and_or_b32 v156, v156, -2, s27
    s_nop 0
    v_cvt_pk_f16_f32 v158, v204, v205
    v_cvt_pk_f16_f32 v159, v206, v207
    global_store_dwordx4 v148, v[156:159], s[38:39] offset:2048 sc1
    s_branch AW_LOOP
AW_N:
    s_nop 2
    v_cndmask_b32 v120, v8, v120, s[40:41]
    v_cndmask_b32 v121, v8, v121, s[42:43]
    v_cndmask_b32 v122, v8, v122, s[44:45]
    v_cndmask_b32 v123, v8, v123, s[46:47]
    v_cndmask_b32 v124, v8, v124, s[48:49]
    v_cndmask_b32 v125, v8, v125, s[50:51]
    v_cndmask_b32 v126, v8, v126, s[52:53]
    v_cndmask_b32 v127, v8, v127, s[54:55]
    v_max3_f32 v140, v120, v121, v122
    v_max3_f32 v140, v140, v123, v124
    v_max3_f32 v140, v140, v125, v126
    v_max_f32 v146, v140, v127
    v_max_f32 v140, v140, v127
    s_nop 1
    v_permlane32_swap_b32 v140, v146
    v_max_f32 v140, v140, v146
    v_mov_b32 v146, v140
    s_nop 1
    v_permlane16_swap_b32 v140, v146
    v_max_f32 v140, v140, v146
    v_mul_f32 v142, 0xbe0293ee, v140
    v_fma_f32 v120, v120, v9, v142
    v_fma_f32 v121, v121, v9, v142
    v_fma_f32 v122, v122, v9, v142
    v_fma_f32 v123, v123, v9, v142
    v_fma_f32 v124, v124, v9, v142
    v_fma_f32 v125, v125, v9, v142
    v_fma_f32 v126, v126, v9, v142
    v_fma_f32 v127, v127, v9, v142
    v_exp_f32 v120, v120
    v_exp_f32 v121, v121
    v_exp_f32 v122, v122
    v_exp_f32 v123, v123
    v_exp_f32 v124, v124
    v_exp_f32 v125, v125
    v_exp_f32 v126, v126
    v_exp_f32 v127, v127
    v_cvt_pk_bf16_f32 v132, v120, v121
    v_cvt_pk_bf16_f32 v133, v122, v123
    v_cvt_pk_bf16_f32 v134, v124, v125
    v_cvt_pk_bf16_f32 v135, v126, v127
    s_nop 1
    v_mfma_f32_16x16x32_bf16 v[160:163], v[64:67], v[132:135], 0
    v_add_f32 v141, v120, v121
    v_add_f32 v141, v141, v122
    v_mfma_f32_16x16x32_bf16 v[164:167], v[68:71], v[132:135], 0
    v_add_f32 v141, v141, v123
    v_add_f32 v141, v141, v124
    v_mfma_f32_16x16x32_bf16 v[168:171], v[72:75], v[132:135], 0
    v_add_f32 v141, v141, v125
    v_add_f32 v141, v141, v126
    v_mfma_f32_16x16x32_bf16 v[172:175], v[76:79], v[132:135], 0
    v_add_f32 v146, v141, v127
    v_add_f32 v141, v141, v127
    s_waitcnt vmcnt(5)
    v_mfma_f32_16x16x32_bf16 v[176:179], v[80:83], v[132:135], 0
    v_permlane32_swap_b32 v141, v146
    v_add_f32 v141, v141, v146
    s_waitcnt vmcnt(4)
    v_mfma_f32_16x16x32_bf16 v[180:183], v[84:87], v[132:135], 0
    v_mov_b32 v146, v141
    s_nop 1
    v_permlane16_swap_b32 v141, v146
    s_waitcnt vmcnt(3)
    v_mfma_f32_16x16x32_bf16 v[184:187], v[88:91], v[132:135], 0
    v_add_f32 v141, v141, v146
    s_waitcnt vmcnt(2)
    v_mfma_f32_16x16x32_bf16 v[188:191], v[92:95], v[132:135], 0
AW_K0n:
    v_max3_u32 v6, v96, v100, v104
    v_max_u32 v6, v6, v108
    v_cmp_eq_u32 vcc, -1, v6
    v_mfma_f32_16x16x32_bf16 v[128:131], v[96:99], v[16:19], 0
    s_cbranch_vccnz AW_PKn
    s_mov_b32 vcc_lo, 0xcccccccc
    s_mov_b32 vcc_hi, 0xcccccccc
    v_mfma_f32_16x16x32_bf16 v[128:131], v[100:103], v[20:23], v[128:131]
    v_cndmask_b32_dpp v112, v98, v96, vcc quad_perm:[2,3,2,3] row_mask:0xf bank_mask:0xf
    v_mfma_f32_16x16x32_bf16 v[128:131], v[104:107], v[24:27], v[128:131]
    v_cndmask_b32_dpp v113, v99, v97, vcc quad_perm:[2,3,2,3] row_mask:0xf bank_mask:0xf
    v_mfma_f32_16x16x32_bf16 v[128:131], v[108:111], v[28:31], v[128:131]
    v_cndmask_b32_dpp v114, v102, v100, vcc quad_perm:[2,3,2,3] row_mask:0xf bank_mask:0xf
    v_cndmask_b32_dpp v115, v103, v101, vcc quad_perm:[2,3,2,3] row_mask:0xf bank_mask:0xf
    v_cndmask_b32_dpp v116, v106, v104, vcc quad_perm:[2,3,2,3] row_mask:0xf bank_mask:0xf
    v_cndmask_b32_dpp v117, v107, v105, vcc quad_perm:[2,3,2,3] row_mask:0xf bank_mask:0xf
    v_cndmask_b32_dpp v118, v110, v108, vcc quad_perm:[2,3,2,3] row_mask:0xf bank_mask:0xf
    v_cndmask_b32_dpp v119, v111, v109, vcc quad_perm:[2,3,2,3] row_mask:0xf bank_mask:0xf
AW_GOn:
    s_nop 1
    v_max3_f32 v142, v140, v128, v129
    v_max3_f32 v143, v140, v128, v129
    s_nop 1
    v_permlane32_swap_b32 v142, v143
    v_max_f32 v142, v142, v143
    v_mov_b32 v143, v142
    s_nop 1
    v_permlane16_swap_b32 v142, v143
    v_max_f32 v142, v142, v143
    v_mul_f32 v142, 0xbe0293ee, v142
    v_fma_f32 v128, v128, v9, v142
    v_fma_f32 v129, v129, v9, v142
    v_fma_f32 v144, v140, v9, v142
    v_exp_f32 v128, v128
    v_exp_f32 v129, v129
    v_exp_f32 v144, v144
    v_add_f32 v146, v128, v129
    v_add_f32 v147, v128, v129
    s_nop 1
    v_permlane32_swap_b32 v146, v147
    v_add_f32 v146, v146, v147
    v_mov_b32 v147, v146
    s_nop 1
    v_permlane16_swap_b32 v146, v147
    v_add_f32 v146, v146, v147
    v_fma_f32 v141, v141, v144, v146
    v_rcp_f32 v141, v141
    s_add_u32 s23, s23, 1
    s_add_u32 s36, s24, 0x6000
    s_addc_u32 s37, s25, 0
    v_mul_f32 v144, v144, v141
    v_mul_f32 v128, v128, v141
    v_mul_f32 v129, v129, v141
    v_pk_mul_f32 v[160:161], v[160:161], v[144:145] op_sel_hi:[1,0]
    v_pk_mul_f32 v[162:163], v[162:163], v[144:145] op_sel_hi:[1,0]
    v_cvt_pk_bf16_f32 v136, v128, v129
    v_cvt_pk_bf16_f32 v139, v128, v129
    v_pk_mul_f32 v[164:165], v[164:165], v[144:145] op_sel_hi:[1,0]
    v_mfma_f32_16x16x16_bf16 v[160:163], v[112:113], v[136:137], v[160:163]
    v_pk_mul_f32 v[166:167], v[166:167], v[144:145] op_sel_hi:[1,0]
    v_pk_mul_f32 v[168:169], v[168:169], v[144:145] op_sel_hi:[1,0]
    v_pk_mul_f32 v[170:171], v[170:171], v[144:145] op_sel_hi:[1,0]
    v_mfma_f32_16x16x16_bf16 v[164:167], v[112:113], v[138:139], v[164:167]
    v_pk_mul_f32 v[172:173], v[172:173], v[144:145] op_sel_hi:[1,0]
    v_pk_mul_f32 v[174:175], v[174:175], v[144:145] op_sel_hi:[1,0]
    v_pk_mul_f32 v[176:177], v[176:177], v[144:145] op_sel_hi:[1,0]
    v_mfma_f32_16x16x16_bf16 v[168:171], v[114:115], v[136:137], v[168:171]
    v_pk_mul_f32 v[178:179], v[178:179], v[144:145] op_sel_hi:[1,0]
    v_pk_mul_f32 v[180:181], v[180:181], v[144:145] op_sel_hi:[1,0]
    v_pk_mul_f32 v[182:183], v[182:183], v[144:145] op_sel_hi:[1,0]
    v_mfma_f32_16x16x16_bf16 v[172:175], v[114:115], v[138:139], v[172:175]
    v_pk_mul_f32 v[184:185], v[184:185], v[144:145] op_sel_hi:[1,0]
    v_pk_mul_f32 v[186:187], v[186:187], v[144:145] op_sel_hi:[1,0]
    v_pk_mul_f32 v[188:189], v[188:189], v[144:145] op_sel_hi:[1,0]
    v_mfma_f32_16x16x16_bf16 v[176:179], v[116:117], v[136:137], v[176:179]
    v_pk_mul_f32 v[190:191], v[190:191], v[144:145] op_sel_hi:[1,0]
    v_cvt_pk_bf16_f32 v160, v160, v161
    v_cvt_pk_bf16_f32 v161, v162, v163
    v_mfma_f32_16x16x16_bf16 v[180:183], v[116:117], v[138:139], v[180:183]
    v_cvt_pk_bf16_f32 v162, v164, v165
    v_cvt_pk_bf16_f32 v163, v166, v167
    ds_write_b128 v12, v[160:163] offset:0
    v_mfma_f32_16x16x16_bf16 v[184:187], v[118:119], v[136:137], v[184:187]
    v_cvt_pk_bf16_f32 v168, v168, v169
    v_cvt_pk_bf16_f32 v169, v170, v171
    v_cvt_pk_bf16_f32 v170, v172, v173
    v_mfma_f32_16x16x16_bf16 v[188:191], v[118:119], v[138:139], v[188:191]
    v_cvt_pk_bf16_f32 v171, v174, v175
    ds_write_b128 v12, v[168:171] offset:1024
    v_cvt_pk_bf16_f32 v176, v176, v177
    v_mfma_f32_16x16x32_bf16 v[192:195], a[0:3], v[160:163], 0
    v_cvt_pk_bf16_f32 v177, v178, v179
    v_cvt_pk_bf16_f32 v178, v180, v181
    v_cvt_pk_bf16_f32 v179, v182, v183
    v_mfma_f32_16x16x32_bf16 v[196:199], a[16:19], v[160:163], 0
    ds_write_b128 v12, v[176:179] offset:2048
    v_cvt_pk_bf16_f32 v184, v184, v185
    v_cvt_pk_bf16_f32 v185, v186, v187
    v_mfma_f32_16x16x32_bf16 v[200:203], a[32:35], v[160:163], 0
    v_cvt_pk_bf16_f32 v186, v188, v189
    v_cvt_pk_bf16_f32 v187, v190, v191
    ds_write_b128 v12, v[184:187] offset:3072
    v_mfma_f32_16x16x32_bf16 v[204:207], a[48:51], v[160:163], 0
    v_mfma_f32_16x16x32_bf16 v[192:195], a[4:7], v[168:171], v[192:195]
    v_mfma_f32_16x16x32_bf16 v[196:199], a[20:23], v[168:171], v[196:199]
    s_waitcnt lgkmcnt(0)
    s_barrier
    ds_read_b128 v[208:211], v13 offset:0
    ds_read_b128 v[212:215], v13 offset:1024
    v_mfma_f32_16x16x32_bf16 v[200:203], a[36:39], v[168:171], v[200:203]
    ds_read_b128 v[216:219], v13 offset:2048
    ds_read_b128 v[220:223], v13 offset:3072
    v_mfma_f32_16x16x32_bf16 v[204:207], a[52:55], v[168:171], v[204:207]
    ds_read_b128 v[224:227], v14 offset:0
    v_mfma_f32_16x16x32_bf16 v[192:195], a[8:11], v[176:179], v[192:195]
    v_xor_b32 v12, 0x4000, v12
    v_mfma_f32_16x16x32_bf16 v[196:199], a[24:27], v[176:179], v[196:199]
    ds_read_b128 v[228:231], v14 offset:1024
    v_mfma_f32_16x16x32_bf16 v[200:203], a[40:43], v[176:179], v[200:203]
    v_mfma_f32_16x16x32_bf16 v[204:207], a[56:59], v[176:179], v[204:207]
    ds_read_b128 v[232:235], v14 offset:2048
    v_mfma_f32_16x16x32_bf16 v[192:195], a[12:15], v[184:187], v[192:195]
    v_mfma_f32_16x16x32_bf16 v[196:199], a[28:31], v[184:187], v[196:199]
    ds_read_b128 v[236:239], v14 offset:3072
    v_mfma_f32_16x16x32_bf16 v[200:203], a[44:47], v[184:187], v[200:203]
    v_mfma_f32_16x16x32_bf16 v[204:207], a[60:63], v[184:187], v[204:207]
    s_waitcnt lgkmcnt(7)
    v_mfma_f32_16x16x32_bf16 v[192:195], a[64:67], v[208:211], v[192:195]
    v_mfma_f32_16x16x32_bf16 v[196:199], a[80:83], v[208:211], v[196:199]
    v_mfma_f32_16x16x32_bf16 v[200:203], a[96:99], v[208:211], v[200:203]
    v_mfma_f32_16x16x32_bf16 v[204:207], a[112:115], v[208:211], v[204:207]
    s_waitcnt lgkmcnt(6)
    v_mfma_f32_16x16x32_bf16 v[192:195], a[68:71], v[212:215], v[192:195]
    v_mfma_f32_16x16x32_bf16 v[196:199], a[84:87], v[212:215], v[196:199]
    ds_read_b128 v[240:243], v15 offset:0
    v_mfma_f32_16x16x32_bf16 v[200:203], a[100:103], v[212:215], v[200:203]
    v_mfma_f32_16x16x32_bf16 v[204:207], a[116:119], v[212:215], v[204:207]
    ds_read_b128 v[244:247], v15 offset:1024
    s_waitcnt lgkmcnt(7)
    v_mfma_f32_16x16x32_bf16 v[192:195], a[72:75], v[216:219], v[192:195]
    v_mfma_f32_16x16x32_bf16 v[196:199], a[88:91], v[216:219], v[196:199]
    ds_read_b128 v[248:251], v15 offset:2048
    v_mfma_f32_16x16x32_bf16 v[200:203], a[104:107], v[216:219], v[200:203]
    v_mfma_f32_16x16x32_bf16 v[204:207], a[120:123], v[216:219], v[204:207]
    ds_read_b128 v[252:255], v15 offset:3072
    s_waitcnt lgkmcnt(8)
    v_mfma_f32_16x16x32_bf16 v[192:195], a[76:79], v[220:223], v[192:195]
    v_xor_b32 v13, 0x4000, v13
    v_xor_b32 v14, 0x4000, v14
    v_xor_b32 v15, 0x4000, v15
    v_mfma_f32_16x16x32_bf16 v[196:199], a[92:95], v[220:223], v[196:199]
    v_mfma_f32_16x16x32_bf16 v[200:203], a[108:111], v[220:223], v[200:203]
    v_mfma_f32_16x16x32_bf16 v[204:207], a[124:127], v[220:223], v[204:207]
    s_waitcnt lgkmcnt(7)
    v_mfma_f32_16x16x32_bf16 v[192:195], a[128:131], v[224:227], v[192:195]
    v_mfma_f32_16x16x32_bf16 v[196:199], a[144:147], v[224:227], v[196:199]
    v_mfma_f32_16x16x32_bf16 v[200:203], a[160:163], v[224:227], v[200:203]
    v_mfma_f32_16x16x32_bf16 v[204:207], a[176:179], v[224:227], v[204:207]
    s_waitcnt lgkmcnt(6)
    v_mfma_f32_16x16x32_bf16 v[192:195], a[132:135], v[228:231], v[192:195]
    v_mfma_f32_16x16x32_bf16 v[196:199], a[148:151], v[228:231], v[196:199]
    v_mfma_f32_16x16x32_bf16 v[200:203], a[164:167], v[228:231], v[200:203]
    v_mfma_f32_16x16x32_bf16 v[204:207], a[180:183], v[228:231], v[204:207]
    s_waitcnt lgkmcnt(5)
    v_mfma_f32_16x16x32_bf16 v[192:195], a[136:139], v[232:235], v[192:195]
    v_mfma_f32_16x16x32_bf16 v[196:199], a[152:155], v[232:235], v[196:199]
    v_mfma_f32_16x16x32_bf16 v[200:203], a[168:171], v[232:235], v[200:203]
    v_mfma_f32_16x16x32_bf16 v[204:207], a[184:187], v[232:235], v[204:207]
    s_waitcnt lgkmcnt(4)
    v_mfma_f32_16x16x32_bf16 v[192:195], a[140:143], v[236:239], v[192:195]
    v_mfma_f32_16x16x32_bf16 v[196:199], a[156:159], v[236:239], v[196:199]
    v_mfma_f32_16x16x32_bf16 v[200:203], a[172:175], v[236:239], v[200:203]
    v_mfma_f32_16x16x32_bf16 v[204:207], a[188:191], v[236:239], v[204:207]
    s_waitcnt lgkmcnt(3)
    v_mfma_f32_16x16x32_bf16 v[192:195], a[192:195], v[240:243], v[192:195]
    v_mfma_f32_16x16x32_bf16 v[196:199], a[208:211], v[240:243], v[196:199]
    s_waitcnt lgkmcnt(2)
    v_mfma_f32_16x16x32_bf16 v[192:195], a[196:199], v[244:247], v[192:195]
    v_mfma_f32_16x16x32_bf16 v[196:199], a[212:215], v[244:247], v[196:199]
    s_waitcnt lgkmcnt(1)
    v_mfma_f32_16x16x32_bf16 v[192:195], a[200:203], v[248:251], v[192:195]
    v_mfma_f32_16x16x32_bf16 v[196:199], a[216:219], v[248:251], v[196:199]
    s_waitcnt lgkmcnt(0)
    v_mfma_f32_16x16x32_bf16 v[192:195], a[204:207], v[252:255], v[192:195]
    v_mfma_f32_16x16x32_bf16 v[196:199], a[220:223], v[252:255], v[196:199]
    v_mfma_f32_16x16x32_bf16 v[200:203], a[224:227], v[240:243], v[200:203]
    v_mfma_f32_16x16x32_bf16 v[204:207], a[240:243], v[240:243], v[204:207]
    v_cvt_pk_f16_f32 v152, v192, v193
    v_cvt_pk_f16_f32 v153, v194, v195
    v_mfma_f32_16x16x32_bf16 v[200:203], a[228:231], v[244:247], v[200:203]
    v_and_or_b32 v152, v152, -2, s27
    v_cvt_pk_f16_f32 v154, v196, v197
    v_mfma_f32_16x16x32_bf16 v[204:207], a[244:247], v[244:247], v[204:207]
    v_cvt_pk_f16_f32 v155, v198, v199
    global_store_dwordx4 v148, v[152:155], s[38:39] offset:0 sc1
    v_mfma_f32_16x16x32_bf16 v[200:203], a[232:235], v[248:251], v[200:203]
    v_mfma_f32_16x16x32_bf16 v[204:207], a[248:251], v[248:251], v[204:207]
    v_mfma_f32_16x16x32_bf16 v[200:203], a[236:239], v[252:255], v[200:203]
    v_mfma_f32_16x16x32_bf16 v[204:207], a[252:255], v[252:255], v[204:207]
    s_nop 3
    v_cvt_pk_f16_f32 v156, v200, v201
    v_cvt_pk_f16_f32 v157, v202, v203
    v_and_or_b32 v156, v156, -2, s27
    s_nop 0
    v_cvt_pk_f16_f32 v158, v204, v205
    v_cvt_pk_f16_f32 v159, v206, v207
    global_store_dwordx4 v148, v[156:159], s[38:39] offset:2048 sc1
    s_cmp_lt_u32 s23, s20
    s_cbranch_scc1 AW_NP
    s_cmp_gt_u32 s21, 63
    s_cbranch_scc1 AW_E
    s_add_u32 s24, s24, s62
    s_addc_u32 s25, s25, 0
    s_add_u32 s30, s24, s29
    s_addc_u32 s31, s25, 0
    s_add_u32 s32, s24, 0x3000
    s_addc_u32 s33, s25, 0
    s_add_u32 s34, s24, 0x5000
    s_addc_u32 s35, s25, 0
    s_add_u32 s36, s24, 0x6000
    s_addc_u32 s37, s25, 0
    v_and_b32 v149, 0xffffff7f, v4
    v_add_u32 v149, s63, v149
    s_lshl_b32 s26, s8, 7
    s_add_u32 s26, s26, s21
    s_add_u32 s26, s26, 1
    s_mov_b32 s62, 32768
    s_add_u32 s21, s21, 2
    s_branch AW_NP
AW_E:
    s_endpgm
AW_PKp:
    global_load_dwordx4 v[96:99], v2, s[36:37] offset:0 sc1
    global_load_dwordx4 v[100:103], v2, s[36:37] offset:1024 sc1
    global_load_dwordx4 v[104:107], v2, s[36:37] offset:2048 sc1
    global_load_dwordx4 v[108:111], v2, s[36:37] offset:3072 sc1
    s_add_u32 s12, s12, 1
    s_mov_b32 s17, 14
    s_cmp_gt_u32 s12, 20000
    s_cbranch_scc1 TIMEOUT
    s_waitcnt vmcnt(0)
    s_branch AW_K0p
AW_PKn:
    global_load_dwordx4 v[96:99], v2, s[36:37] offset:0 sc1
    global_load_dwordx4 v[100:103], v2, s[36:37] offset:1024 sc1
    global_load_dwordx4 v[104:107], v2, s[36:37] offset:2048 sc1
    global_load_dwordx4 v[108:111], v2, s[36:37] offset:3072 sc1
    s_add_u32 s12, s12, 1
    s_mov_b32 s17, 14
    s_cmp_gt_u32 s12, 20000
    s_cbranch_scc1 TIMEOUT
    s_waitcnt vmcnt(0)
    s_branch AW_K0n
AW_CS:
    s_mov_b32 s12, 0
AW_CS_L:
    global_load_dword v10, v3, s[58:59] sc1
    s_add_u32 s12, s12, 1
    s_mov_b32 s17, 25
    s_cmp_gt_u32 s12, 20000
    s_cbranch_scc1 TIMEOUT
    s_waitcnt vmcnt(0)
    v_cmp_gt_i32 vcc, s28, v10
    s_cbranch_vccnz AW_CS_L
    s_branch AW_CR
TIMEOUT2:
    s_branch TIMEOUT
ROLE_CHAIN:
    s_load_dwordx4 s[20:23], s[0:1], 16
    s_load_dwordx4 s[24:27], s[0:1], 32
    s_load_dwordx2 s[56:57], s[0:1], 8
    s_mov_b32 s13, s10
    s_lshl_b32 s28, s9, 13
    s_lshl_b32 s31, s11, 2
    s_add_u32 s31, s31, s9
    v_lshrrev_b32 v110, 4, v0
    v_lshlrev_b32 v111, 2, v110
    v_and_b32 v100, 15, v0
    v_xor_b32 v100, v100, v111
    v_lshlrev_b32 v100, 4, v100
    v_mul_u32_u24 v110, 131072, v110
    v_add_u32 v100, v100, v110
    s_lshr_b32 s14, s9, 1
    s_lshl_b32 s14, s14, 19
    s_and_b32 s15, s9, 1
    s_lshl_b32 s15, s15, 16
    s_add_u32 s14, s14, s15
    s_lshl_b32 s15, s11, 8
    s_add_u32 s14, s14, s15
    v_add_u32 v100, s14, v100
    v_xor_b32 v101, 32, v100
    v_lshrrev_b32 v110, 4, v0
    v_lshlrev_b32 v111, 2, v110
    v_and_b32 v102, 15, v0
    v_xor_b32 v102, v102, v111
    v_lshlrev_b32 v102, 4, v102
    v_mul_u32_u24 v110, 1024, v110
    v_add_u32 v102, v102, v110
    s_lshl_b32 s14, s11, 17
    s_lshl_b32 s15, s9, 8
    s_add_u32 s14, s14, s15
    v_add_u32 v102, s14, v102
    v_xor_b32 v103, 32, v102
    v_bfe_u32 v110, v0, 2, 2
    v_mul_u32_u24 v111, 320, v110
    v_lshrrev_b32 v110, 4, v0
    v_lshl_add_u32 v111, v110, 11, v111
    v_and_b32 v110, 1, v110
    v_lshl_add_u32 v111, v110, 5, v111
    v_and_b32 v110, 3, v0
    v_lshl_add_u32 v111, v110, 3, v111
    s_lshl_b32 s14, s9, 6
    v_xor_b32 v104, s14, v111
    v_xor_b32 v107, 32, v104
    v_add_u32 v105, 65536, v104
    v_add_u32 v106, 131072, v104
    v_add_u32 v108, 65536, v107
    v_add_u32 v109, 131072, v107
    v_bfe_u32 v110, v0, 2, 1
    v_mul_u32_u24 v111, 320, v110
    v_lshrrev_b32 v110, 4, v0
    v_lshl_add_u32 v111, v110, 10, v111
    v_bfe_u32 v110, v0, 3, 1
    v_lshl_add_u32 v111, v110, 5, v111
    v_and_b32 v110, 3, v0
    v_lshl_add_u32 v111, v110, 3, v111
    v_add_u32 v111, s28, v111
    v_lshlrev_b32 v2, 4, v0
    v_add_u32 v114, s28, v2
    v_add_u32 v115, 0x10000, v114
    s_waitcnt lgkmcnt(0)
    v_mov_b32 v46, 0
    global_load_dword v46, v46, s[4:5] sc1
    s_lshl_b32 s14, s13, 20
    s_add_u32 s14, s14, 1048576
    s_add_u32 s32, s4, s14
    s_addc_u32 s33, s5, 0
    s_lshl_b32 s14, s13, 19
    s_add_u32 s14, s14, 3145728
    s_add_u32 s34, s4, s14
    s_addc_u32 s35, s5, 0
    s_lshl_b32 s14, s31, 11
    s_add_u32 s36, s34, s14
    s_addc_u32 s37, s35, 0
    s_mul_i32 s14, s13, 68157440
    s_mul_i32 s15, s11, 2129920
    s_add_u32 s14, s14, s15
    s_add_u32 s14, s14, 18874368
    s_add_u32 s38, s4, s14
    s_addc_u32 s39, s5, 0
    s_lshl_b32 s14, s13, 15
    s_lshl_b32 s15, s11, 4
    s_add_u32 s14, s14, s15
    s_lshl_b32 s15, s14, 1
    s_add_u32 s15, s15, 393216
    s_add_u32 s40, s4, s15
    s_addc_u32 s41, s5, 0
    s_lshl_b32 s14, s9, 11
    s_add_u32 s52, s32, s14
    s_addc_u32 s53, s33, 0
    s_add_u32 s50, s34, 0x8000
    s_addc_u32 s51, s35, 0
    s_mov_b64 s[42:43], s[52:53]
    s_mov_b32 s59, 0
    v_lshrrev_b32 v40, 4, v0
    v_and_b32 v41, 15, v0
    v_and_b32 v42, 3, v0
    v_lshlrev_b32 v42, 2, v42
    v_lshl_add_u32 v42, v40, 4, v42
    s_lshl_b32 s14, s31, 6
    v_add_u32 v9, s14, v42
    s_and_b32 s14, s31, 3
    s_lshl_b32 s14, s14, 11
    s_lshr_b32 s15, s31, 4
    s_lshl_b32 s15, s15, 7
    s_add_u32 s14, s14, s15
    s_bfe_u32 s15, s31, 0x20002
    s_lshl_b32 s15, s15, 3
    s_add_u32 s14, s14, s15
    v_lshrrev_b32 v43, 5, v0
    v_lshlrev_b32 v43, 10, v43
    v_bfe_u32 v44, v0, 4, 1
    v_lshl_add_u32 v43, v44, 6, v43
    v_and_b32 v44, 3, v0
    v_lshl_add_u32 v43, v44, 1, v43
    v_add_u32 v43, s14, v43
    global_load_ushort v44, v43, s[56:57]
    global_load_ushort v52, v43, s[56:57] offset:32
    v_mov_b32 v48, -1
    v_mov_b32 v49, -1
    v_mov_b32 v50, -1
    v_mov_b32 v51, -1
    global_store_dwordx4 v2, v[48:51], s[36:37] offset:0 sc1
    global_store_dwordx4 v2, v[48:51], s[36:37] offset:1024 sc1
    v_bfe_u32 v45, v0, 2, 2
    v_cmp_ne_u32 vcc, 0, v45
    s_nop 1
    v_cndmask_b32 v55, 0, v48, vcc
    v_lshl_add_u32 v53, v45, 13, v9
    v_and_b32 v45, 1, v45
    v_lshl_add_u32 v9, v45, 14, v9
    v_sub_u32 v10, 0, v45
    v_or_b32 v11, -2, v10
    s_cmp_eq_u32 s13, 0
    s_cbranch_scc1 CH_L0
    v_lshrrev_b32 v56, 4, v0
    v_lshlrev_b32 v56, 13, v56
    v_and_b32 v57, 1, v0
    v_lshl_add_u32 v56, v57, 7, v56
    s_lshl_b32 s14, s31, 15
    v_add_u32 v56, s14, v56
    v_bfe_u32 v57, v0, 1, 3
    v_lshl_add_u32 v57, v57, 10, v56
    s_lshr_b32 s14, s22, 8
    s_sub_u32 s15, 1, s14
    s_and_b32 s15, s15, 3
    s_lshl_b32 s15, s15, 8
    v_add_u32 v58, s15, v57
    global_load_dword v60, v58, s[22:23]
    s_sub_u32 s15, 31, s14
    s_and_b32 s15, s15, 31
    s_lshl_b32 s15, s15, 8
    v_add_u32 v59, s15, v56
    global_load_dword v64, v59, s[22:23]
    s_lshr_b32 s14, s24, 8
    s_sub_u32 s15, 1, s14
    s_and_b32 s15, s15, 3
    s_lshl_b32 s15, s15, 8
    v_add_u32 v58, s15, v57
    global_load_dword v61, v58, s[24:25]
    s_sub_u32 s15, 31, s14
    s_and_b32 s15, s15, 31
    s_lshl_b32 s15, s15, 8
    v_add_u32 v59, s15, v56
    global_load_dword v65, v59, s[24:25]
    s_lshr_b32 s14, s20, 8
    s_sub_u32 s15, 1, s14
    s_and_b32 s15, s15, 3
    s_lshl_b32 s15, s15, 8
    v_add_u32 v58, s15, v57
    global_load_dword v62, v58, s[20:21]
    s_sub_u32 s15, 31, s14
    s_and_b32 s15, s15, 31
    s_lshl_b32 s15, s15, 8
    v_add_u32 v59, s15, v56
    global_load_dword v66, v59, s[20:21]
    v_lshlrev_b32 v56, 7, v0
    s_lshl_b32 s14, s31, 13
    v_add_u32 v56, s14, v56
    s_waitcnt vmcnt(0)
    s_add_u32 s44, s26, 0x0
    s_addc_u32 s45, s27, 0
    global_load_dword v64, v56, s[44:45]
    s_add_u32 s44, s26, 0x100000
    s_addc_u32 s45, s27, 0
    global_load_dword v65, v56, s[44:45]
    s_add_u32 s44, s26, 0x200000
    s_addc_u32 s45, s27, 0
    global_load_dword v66, v56, s[44:45]
    s_add_u32 s44, s26, 0x300000
    s_addc_u32 s45, s27, 0
    global_load_dword v67, v56, s[44:45]
    s_waitcnt vmcnt(10)
    v_readfirstlane_b32 s8, v46
    s_add_u32 s8, s8, 1
    s_cmp_eq_u32 s13, 0
    s_cbranch_scc1 LS_173_E
    v_lshlrev_b32 v57, 4, v0
    v_add_u32 v57, 327680, v57
    s_mov_b32 s12, 0
LS_173:
    global_load_dword v56, v57, s[4:5] sc1
    s_add_u32 s12, s12, 1
    s_mov_b32 s17, 20
    s_cmp_gt_u32 s12, 20000
    s_cbranch_scc1 TIMEOUT2
    s_waitcnt vmcnt(0)
    v_cmp_ne_u32 vcc, s8, v56
    s_cbranch_vccnz LS_173
LS_173_E:
CH_L0:
    s_add_u32 s14, s9, 2
    s_and_b32 s14, s14, 3
    s_lshl_b32 s14, s14, 15
    s_add_u32 s62, s26, s14
    s_addc_u32 s63, s27, 0
    s_add_u32 s44, s62, 0x0
    s_addc_u32 s45, s63, 0
    s_add_u32 m0, s28, 65536
    s_nop 0
    global_load_lds_dwordx4 v102, s[44:45]
    s_add_u32 s44, s62, 0x4000
    s_addc_u32 s45, s63, 0
    s_add_u32 m0, s28, 66560
    s_nop 0
    global_load_lds_dwordx4 v102, s[44:45]
    s_add_u32 s44, s62, 0x1000
    s_addc_u32 s45, s63, 0
    s_add_u32 m0, s28, 67584
    s_nop 0
    global_load_lds_dwordx4 v102, s[44:45]
    s_add_u32 s44, s62, 0x5000
    s_addc_u32 s45, s63, 0
    s_add_u32 m0, s28, 68608
    s_nop 0
    global_load_lds_dwordx4 v102, s[44:45]
    s_add_u32 s44, s62, 0x2000
    s_addc_u32 s45, s63, 0
    s_add_u32 m0, s28, 69632
    s_nop 0
    global_load_lds_dwordx4 v102, s[44:45]
    s_add_u32 s44, s62, 0x6000
    s_addc_u32 s45, s63, 0
    s_add_u32 m0, s28, 70656
    s_nop 0
    global_load_lds_dwordx4 v102, s[44:45]
    s_add_u32 s44, s62, 0x3000
    s_addc_u32 s45, s63, 0
    s_add_u32 m0, s28, 71680
    s_nop 0
    global_load_lds_dwordx4 v102, s[44:45]
    s_add_u32 s44, s62, 0x7000
    s_addc_u32 s45, s63, 0
    s_add_u32 m0, s28, 72704
    s_nop 0
    global_load_lds_dwordx4 v102, s[44:45]
    s_add_u32 s14, s9, 3
    s_and_b32 s14, s14, 3
    s_lshl_b32 s14, s14, 15
    s_add_u32 s62, s26, s14
    s_addc_u32 s63, s27, 0
    s_add_u32 s44, s62, 0x0
    s_addc_u32 s45, s63, 0
    s_add_u32 m0, s28, 98304
    s_nop 0
    global_load_lds_dwordx4 v102, s[44:45]
    s_add_u32 s44, s62, 0x4000
    s_addc_u32 s45, s63, 0
    s_add_u32 m0, s28, 99328
    s_nop 0
    global_load_lds_dwordx4 v102, s[44:45]
    s_add_u32 s44, s62, 0x1000
    s_addc_u32 s45, s63, 0
    s_add_u32 m0, s28, 100352
    s_nop 0
    global_load_lds_dwordx4 v102, s[44:45]
    s_add_u32 s44, s62, 0x5000
    s_addc_u32 s45, s63, 0
    s_add_u32 m0, s28, 101376
    s_nop 0
    global_load_lds_dwordx4 v102, s[44:45]
    s_add_u32 s44, s62, 0x2000
    s_addc_u32 s45, s63, 0
    s_add_u32 m0, s28, 102400
    s_nop 0
    global_load_lds_dwordx4 v102, s[44:45]
    s_add_u32 s44, s62, 0x6000
    s_addc_u32 s45, s63, 0
    s_add_u32 m0, s28, 103424
    s_nop 0
    global_load_lds_dwordx4 v102, s[44:45]
    s_add_u32 s44, s62, 0x3000
    s_addc_u32 s45, s63, 0
    s_add_u32 m0, s28, 104448
    s_nop 0
    global_load_lds_dwordx4 v102, s[44:45]
    s_add_u32 s44, s62, 0x7000
    s_addc_u32 s45, s63, 0
    s_add_u32 m0, s28, 105472
    s_nop 0
    global_load_lds_dwordx4 v102, s[44:45]
    s_add_u32 s44, s22, 0x0
    s_addc_u32 s45, s23, 0
    s_add_u32 m0, s28, 0
    s_nop 0
    global_load_lds_dwordx4 v100, s[44:45]
    s_add_u32 s44, s22, 0x2000
    s_addc_u32 s45, s23, 0
    s_add_u32 m0, s28, 1024
    s_nop 0
    global_load_lds_dwordx4 v100, s[44:45]
    s_add_u32 s44, s22, 0x4000
    s_addc_u32 s45, s23, 0
    s_add_u32 m0, s28, 2048
    s_nop 0
    global_load_lds_dwordx4 v101, s[44:45]
    s_add_u32 s44, s22, 0x6000
    s_addc_u32 s45, s23, 0
    s_add_u32 m0, s28, 3072
    s_nop 0
    global_load_lds_dwordx4 v101, s[44:45]
    s_add_u32 s44, s22, 0x8000
    s_addc_u32 s45, s23, 0
    s_add_u32 m0, s28, 4096
    s_nop 0
    global_load_lds_dwordx4 v100, s[44:45]
    s_add_u32 s44, s22, 0xa000
    s_addc_u32 s45, s23, 0
    s_add_u32 m0, s28, 5120
    s_nop 0
    global_load_lds_dwordx4 v100, s[44:45]
    s_add_u32 s44, s22, 0xc000
    s_addc_u32 s45, s23, 0
    s_add_u32 m0, s28, 6144
    s_nop 0
    global_load_lds_dwordx4 v101, s[44:45]
    s_add_u32 s44, s22, 0xe000
    s_addc_u32 s45, s23, 0
    s_add_u32 m0, s28, 7168
    s_nop 0
    global_load_lds_dwordx4 v101, s[44:45]
    v_and_b32 v56, 1, v0
    v_mov_b32 v57, 0x4444
    v_mov_b32 v58, 0xeeee
    v_cmp_eq_u32 vcc, 0, v56
    s_nop 1
    v_cndmask_b32 v1, v58, v57, vcc
    v_and_b32 v56, 2, v0
    v_cmp_eq_u32 vcc, 0, v56
    s_nop 1
    v_cndmask_b32 v56, v58, v57, vcc
    v_lshl_or_b32 v1, v56, 16, v1
    v_add_u32 v3, 131072, v2
    v_add_u32 v4, 0x10000, v2
    v_lshl_add_u32 v25, v40, 4, v3
    v_or_b32 v56, 32, v3
    v_lshl_add_u32 v6, v40, 4, v56
    v_lshrrev_b32 v56, 2, v41
    v_mul_u32_u24 v56, 272, v56
    v_lshl_add_u32 v56, v40, 6, v56
    v_and_b32 v57, 3, v0
    v_lshl_add_u32 v56, v57, 2, v56
    s_mul_i32 s14, s9, 1088
    s_add_u32 s14, s14, 24576
    v_add_u32 v57, s14, v25
    s_add_u32 s14, s14, 131072
    v_add_u32 v5, s14, v56
    v_and_b32 v56, 2, v0
    v_mul_u32_u24 v56, 20, v56
    v_sub_u32 v56, 40, v56
    v_add_u32 v13, v56, v57
    s_lshl_b32 s14, s9, 10
    s_add_u32 s14, s14, 28672
    s_add_u32 s46, s38, s14
    s_addc_u32 s47, s39, 0
    v_lshlrev_b32 v56, 4, v41
    v_lshl_add_u32 v56, v40, 9, v56
    s_lshl_b32 s14, s9, 11
    v_add_u32 v7, s14, v56
    v_and_b32 v56, 12, v0
    v_add_u32 v56, v56, v40
    v_lshlrev_b32 v56, 11, v56
    v_and_b32 v57, 3, v0
    v_lshl_add_u32 v56, v57, 4, v56
    s_lshl_b32 s14, s9, 16
    s_lshl_b32 s15, s11, 6
    s_add_u32 s14, s14, s15
    v_add_u32 v8, s14, v56
    s_lshl_b32 s14, s9, 2
    v_mov_b32 v15, s14
    v_mov_b32 v24, 0
    v_mov_b32 v26, 0
    v_mov_b32 v27, 0
    v_and_b32 v56, 3, v0
    v_lshlrev_b32 v57, 4, v56
    v_mov_b32 v58, 0x3c00
    v_lshlrev_b32 v57, v57, v58
    v_cmp_gt_u32 vcc, 2, v56
    s_nop 1
    v_cndmask_b32 v16, 0, v57, vcc
    s_getreg_b32 s58, hwreg(HW_REG_XCC_ID)
    s_and_b32 s58, s58, 15
    v_mov_b32 v47, s58
    s_lshl_b32 s14, s13, 10
    s_add_u32 s14, s14, 327680
    s_add_u32 s48, s4, s14
    s_addc_u32 s49, s5, 0
    s_lshl_b32 s14, s31, 3
    v_mov_b32 v54, s14
    s_waitcnt vmcnt(26)
    v_lshl_or_b32 v44, v52, 16, v44
    v_min_u32 v44, -2, v44
    v_or_b32 v44, v44, v55
    global_store_dword v53, v44, s[32:33] sc1
    v_add_u32 v46, 1, v46
    s_nop 0
    v_readfirstlane_b32 s8, v46
    s_mov_b32 s56, 0x3e0293ee
    s_waitcnt vmcnt(17)
    v_xor_b32 v112, 0, v111
    v_add_u32 v112, 0x10000, v112
    ds_read_b64_tr_b16 v[64:65], v112 offset:0
    ds_read_b64_tr_b16 v[68:69], v112 offset:4096
    v_xor_b32 v112, 128, v111
    v_add_u32 v112, 0x10000, v112
    ds_read_b64_tr_b16 v[66:67], v112 offset:512
    ds_read_b64_tr_b16 v[70:71], v112 offset:4608
    v_xor_b32 v112, 64, v111
    v_add_u32 v112, 0x10000, v112
    ds_read_b64_tr_b16 v[72:73], v112 offset:0
    ds_read_b64_tr_b16 v[76:77], v112 offset:4096
    v_xor_b32 v112, 192, v111
    v_add_u32 v112, 0x10000, v112
    ds_read_b64_tr_b16 v[74:75], v112 offset:512
    ds_read_b64_tr_b16 v[78:79], v112 offset:4608
    v_xor_b32 v112, 128, v111
    v_add_u32 v112, 0x10000, v112
    ds_read_b64_tr_b16 v[80:81], v112 offset:0
    ds_read_b64_tr_b16 v[84:85], v112 offset:4096
    v_xor_b32 v112, 0, v111
    v_add_u32 v112, 0x10000, v112
    ds_read_b64_tr_b16 v[82:83], v112 offset:512
    ds_read_b64_tr_b16 v[86:87], v112 offset:4608
    v_xor_b32 v112, 192, v111
    v_add_u32 v112, 0x10000, v112
    ds_read_b64_tr_b16 v[88:89], v112 offset:0
    ds_read_b64_tr_b16 v[92:93], v112 offset:4096
    v_xor_b32 v112, 64, v111
    v_add_u32 v112, 0x10000, v112
    ds_read_b64_tr_b16 v[90:91], v112 offset:512
    ds_read_b64_tr_b16 v[94:95], v112 offset:4608
    s_waitcnt lgkmcnt(0)
    ds_write_b128 v115, v[64:67] offset:0
    ds_write_b128 v115, v[68:71] offset:1024
    ds_write_b128 v115, v[72:75] offset:2048
    ds_write_b128 v115, v[76:79] offset:3072
    ds_write_b128 v115, v[80:83] offset:4096
    ds_write_b128 v115, v[84:87] offset:5120
    ds_write_b128 v115, v[88:91] offset:6144
    ds_write_b128 v115, v[92:95] offset:7168
    s_waitcnt lgkmcnt(0)
    s_add_u32 s44, s24, 0x0
    s_addc_u32 s45, s25, 0
    s_add_u32 m0, s28, 32768
    s_nop 0
    global_load_lds_dwordx4 v100, s[44:45]
    s_add_u32 s44, s24, 0x2000
    s_addc_u32 s45, s25, 0
    s_add_u32 m0, s28, 33792
    s_nop 0
    global_load_lds_dwordx4 v100, s[44:45]
    s_add_u32 s44, s24, 0x4000
    s_addc_u32 s45, s25, 0
    s_add_u32 m0, s28, 34816
    s_nop 0
    global_load_lds_dwordx4 v101, s[44:45]
    s_add_u32 s44, s24, 0x6000
    s_addc_u32 s45, s25, 0
    s_add_u32 m0, s28, 35840
    s_nop 0
    global_load_lds_dwordx4 v101, s[44:45]
    s_add_u32 s44, s24, 0x8000
    s_addc_u32 s45, s25, 0
    s_add_u32 m0, s28, 36864
    s_nop 0
    global_load_lds_dwordx4 v100, s[44:45]
    s_add_u32 s44, s24, 0xa000
    s_addc_u32 s45, s25, 0
    s_add_u32 m0, s28, 37888
    s_nop 0
    global_load_lds_dwordx4 v100, s[44:45]
    s_add_u32 s44, s24, 0xc000
    s_addc_u32 s45, s25, 0
    s_add_u32 m0, s28, 38912
    s_nop 0
    global_load_lds_dwordx4 v101, s[44:45]
    s_add_u32 s44, s24, 0xe000
    s_addc_u32 s45, s25, 0
    s_add_u32 m0, s28, 39936
    s_nop 0
    global_load_lds_dwordx4 v101, s[44:45]
    s_waitcnt vmcnt(17)
    v_xor_b32 v112, 0, v111
    v_add_u32 v112, 0x10000, v112
    ds_read_b64_tr_b16 v[64:65], v112 offset:32768
    ds_read_b64_tr_b16 v[68:69], v112 offset:36864
    v_xor_b32 v112, 128, v111
    v_add_u32 v112, 0x10000, v112
    ds_read_b64_tr_b16 v[66:67], v112 offset:33280
    ds_read_b64_tr_b16 v[70:71], v112 offset:37376
    v_xor_b32 v112, 64, v111
    v_add_u32 v112, 0x10000, v112
    ds_read_b64_tr_b16 v[72:73], v112 offset:32768
    ds_read_b64_tr_b16 v[76:77], v112 offset:36864
    v_xor_b32 v112, 192, v111
    v_add_u32 v112, 0x10000, v112
    ds_read_b64_tr_b16 v[74:75], v112 offset:33280
    ds_read_b64_tr_b16 v[78:79], v112 offset:37376
    v_xor_b32 v112, 128, v111
    v_add_u32 v112, 0x10000, v112
    ds_read_b64_tr_b16 v[80:81], v112 offset:32768
    ds_read_b64_tr_b16 v[84:85], v112 offset:36864
    v_xor_b32 v112, 0, v111
    v_add_u32 v112, 0x10000, v112
    ds_read_b64_tr_b16 v[82:83], v112 offset:33280
    ds_read_b64_tr_b16 v[86:87], v112 offset:37376
    v_xor_b32 v112, 192, v111
    v_add_u32 v112, 0x10000, v112
    ds_read_b64_tr_b16 v[88:89], v112 offset:32768
    ds_read_b64_tr_b16 v[92:93], v112 offset:36864
    v_xor_b32 v112, 64, v111
    v_add_u32 v112, 0x10000, v112
    ds_read_b64_tr_b16 v[90:91], v112 offset:33280
    ds_read_b64_tr_b16 v[94:95], v112 offset:37376
    s_waitcnt lgkmcnt(0)
    ds_write_b128 v115, v[64:67] offset:32768
    ds_write_b128 v115, v[68:71] offset:33792
    ds_write_b128 v115, v[72:75] offset:34816
    ds_write_b128 v115, v[76:79] offset:35840
    ds_write_b128 v115, v[80:83] offset:36864
    ds_write_b128 v115, v[84:87] offset:37888
    ds_write_b128 v115, v[88:91] offset:38912
    ds_write_b128 v115, v[92:95] offset:39936
    s_waitcnt lgkmcnt(0)
    s_add_u32 s44, s22, 0x100000
    s_addc_u32 s45, s23, 0
    s_add_u32 m0, s28, 131072
    s_nop 0
    global_load_lds_dwordx4 v100, s[44:45]
    s_add_u32 s44, s22, 0x102000
    s_addc_u32 s45, s23, 0
    s_add_u32 m0, s28, 132096
    s_nop 0
    global_load_lds_dwordx4 v100, s[44:45]
    s_add_u32 s44, s22, 0x104000
    s_addc_u32 s45, s23, 0
    s_add_u32 m0, s28, 133120
    s_nop 0
    global_load_lds_dwordx4 v101, s[44:45]
    s_add_u32 s44, s22, 0x106000
    s_addc_u32 s45, s23, 0
    s_add_u32 m0, s28, 134144
    s_nop 0
    global_load_lds_dwordx4 v101, s[44:45]
    s_add_u32 s44, s22, 0x108000
    s_addc_u32 s45, s23, 0
    s_add_u32 m0, s28, 135168
    s_nop 0
    global_load_lds_dwordx4 v100, s[44:45]
    s_add_u32 s44, s22, 0x10a000
    s_addc_u32 s45, s23, 0
    s_add_u32 m0, s28, 136192
    s_nop 0
    global_load_lds_dwordx4 v100, s[44:45]
    s_add_u32 s44, s22, 0x10c000
    s_addc_u32 s45, s23, 0
    s_add_u32 m0, s28, 137216
    s_nop 0
    global_load_lds_dwordx4 v101, s[44:45]
    s_add_u32 s44, s22, 0x10e000
    s_addc_u32 s45, s23, 0
    s_add_u32 m0, s28, 138240
    s_nop 0
    global_load_lds_dwordx4 v101, s[44:45]
    s_waitcnt vmcnt(17)
    s_waitcnt lgkmcnt(0)
    s_barrier
    s_cmp_lg_u32 s9, 0
    s_cbranch_scc1 CHR_175
    ds_read_b64_tr_b16 a[128:129], v104 offset:0
    ds_read_b64_tr_b16 a[130:131], v104 offset:1024
    ds_read_b64_tr_b16 a[132:133], v104 offset:8192
    ds_read_b64_tr_b16 a[134:135], v104 offset:9216
    ds_read_b64_tr_b16 a[192:193], v107 offset:0
    ds_read_b64_tr_b16 a[194:195], v107 offset:1024
    ds_read_b64_tr_b16 a[196:197], v107 offset:8192
    ds_read_b64_tr_b16 a[198:199], v107 offset:9216
    ds_read_b64_tr_b16 a[136:137], v104 offset:16384
    ds_read_b64_tr_b16 a[138:139], v104 offset:17408
    ds_read_b64_tr_b16 a[140:141], v104 offset:24576
    ds_read_b64_tr_b16 a[142:143], v104 offset:25600
    ds_read_b64_tr_b16 a[200:201], v107 offset:16384
    ds_read_b64_tr_b16 a[202:203], v107 offset:17408
    ds_read_b64_tr_b16 a[204:205], v107 offset:24576
    ds_read_b64_tr_b16 a[206:207], v107 offset:25600
    s_branch CHR_174
CHR_175:
    s_cmp_lg_u32 s9, 1
    s_cbranch_scc1 CHR_176
    ds_read_b64_tr_b16 a[176:177], v104 offset:0
    ds_read_b64_tr_b16 a[178:179], v104 offset:1024
    ds_read_b64_tr_b16 a[180:181], v104 offset:8192
    ds_read_b64_tr_b16 a[182:183], v104 offset:9216
    ds_read_b64_tr_b16 a[240:241], v107 offset:0
    ds_read_b64_tr_b16 a[242:243], v107 offset:1024
    ds_read_b64_tr_b16 a[244:245], v107 offset:8192
    ds_read_b64_tr_b16 a[246:247], v107 offset:9216
    ds_read_b64_tr_b16 a[184:185], v104 offset:16384
    ds_read_b64_tr_b16 a[186:187], v104 offset:17408
    ds_read_b64_tr_b16 a[188:189], v104 offset:24576
    ds_read_b64_tr_b16 a[190:191], v104 offset:25600
    ds_read_b64_tr_b16 a[248:249], v107 offset:16384
    ds_read_b64_tr_b16 a[250:251], v107 offset:17408
    ds_read_b64_tr_b16 a[252:253], v107 offset:24576
    ds_read_b64_tr_b16 a[254:255], v107 offset:25600
    s_branch CHR_174
CHR_176:
    s_cmp_lg_u32 s9, 2
    s_cbranch_scc1 CHR_177
    ds_read_b64_tr_b16 a[160:161], v104 offset:0
    ds_read_b64_tr_b16 a[162:163], v104 offset:1024
    ds_read_b64_tr_b16 a[164:165], v104 offset:8192
    ds_read_b64_tr_b16 a[166:167], v104 offset:9216
    ds_read_b64_tr_b16 a[224:225], v107 offset:0
    ds_read_b64_tr_b16 a[226:227], v107 offset:1024
    ds_read_b64_tr_b16 a[228:229], v107 offset:8192
    ds_read_b64_tr_b16 a[230:231], v107 offset:9216
    ds_read_b64_tr_b16 a[168:169], v104 offset:16384
    ds_read_b64_tr_b16 a[170:171], v104 offset:17408
    ds_read_b64_tr_b16 a[172:173], v104 offset:24576
    ds_read_b64_tr_b16 a[174:175], v104 offset:25600
    ds_read_b64_tr_b16 a[232:233], v107 offset:16384
    ds_read_b64_tr_b16 a[234:235], v107 offset:17408
    ds_read_b64_tr_b16 a[236:237], v107 offset:24576
    ds_read_b64_tr_b16 a[238:239], v107 offset:25600
    s_branch CHR_174
CHR_177:
    ds_read_b64_tr_b16 a[144:145], v104 offset:0
    ds_read_b64_tr_b16 a[146:147], v104 offset:1024
    ds_read_b64_tr_b16 a[148:149], v104 offset:8192
    ds_read_b64_tr_b16 a[150:151], v104 offset:9216
    ds_read_b64_tr_b16 a[208:209], v107 offset:0
    ds_read_b64_tr_b16 a[210:211], v107 offset:1024
    ds_read_b64_tr_b16 a[212:213], v107 offset:8192
    ds_read_b64_tr_b16 a[214:215], v107 offset:9216
    ds_read_b64_tr_b16 a[152:153], v104 offset:16384
    ds_read_b64_tr_b16 a[154:155], v104 offset:17408
    ds_read_b64_tr_b16 a[156:157], v104 offset:24576
    ds_read_b64_tr_b16 a[158:159], v104 offset:25600
    ds_read_b64_tr_b16 a[216:217], v107 offset:16384
    ds_read_b64_tr_b16 a[218:219], v107 offset:17408
    ds_read_b64_tr_b16 a[220:221], v107 offset:24576
    ds_read_b64_tr_b16 a[222:223], v107 offset:25600
CHR_174:
    s_waitcnt lgkmcnt(0)
    s_barrier
    s_add_u32 s44, s24, 0x100000
    s_addc_u32 s45, s25, 0
    s_add_u32 m0, s28, 0
    s_nop 0
    global_load_lds_dwordx4 v100, s[44:45]
    s_add_u32 s44, s24, 0x102000
    s_addc_u32 s45, s25, 0
    s_add_u32 m0, s28, 1024
    s_nop 0
    global_load_lds_dwordx4 v100, s[44:45]
    s_add_u32 s44, s24, 0x104000
    s_addc_u32 s45, s25, 0
    s_add_u32 m0, s28, 2048
    s_nop 0
    global_load_lds_dwordx4 v101, s[44:45]
    s_add_u32 s44, s24, 0x106000
    s_addc_u32 s45, s25, 0
    s_add_u32 m0, s28, 3072
    s_nop 0
    global_load_lds_dwordx4 v101, s[44:45]
    s_add_u32 s44, s24, 0x108000
    s_addc_u32 s45, s25, 0
    s_add_u32 m0, s28, 4096
    s_nop 0
    global_load_lds_dwordx4 v100, s[44:45]
    s_add_u32 s44, s24, 0x10a000
    s_addc_u32 s45, s25, 0
    s_add_u32 m0, s28, 5120
    s_nop 0
    global_load_lds_dwordx4 v100, s[44:45]
    s_add_u32 s44, s24, 0x10c000
    s_addc_u32 s45, s25, 0
    s_add_u32 m0, s28, 6144
    s_nop 0
    global_load_lds_dwordx4 v101, s[44:45]
    s_add_u32 s44, s24, 0x10e000
    s_addc_u32 s45, s25, 0
    s_add_u32 m0, s28, 7168
    s_nop 0
    global_load_lds_dwordx4 v101, s[44:45]
    s_waitcnt vmcnt(16)
    s_waitcnt lgkmcnt(0)
    s_barrier
    s_cmp_lg_u32 s9, 0
    s_cbranch_scc1 CHR_180
    ds_read_b64_tr_b16 v[128:129], v104 offset:32768
    ds_read_b64_tr_b16 v[130:131], v104 offset:33792
    ds_read_b64_tr_b16 v[132:133], v104 offset:40960
    ds_read_b64_tr_b16 v[134:135], v104 offset:41984
    ds_read_b64_tr_b16 v[192:193], v107 offset:32768
    ds_read_b64_tr_b16 v[194:195], v107 offset:33792
    ds_read_b64_tr_b16 v[196:197], v107 offset:40960
    ds_read_b64_tr_b16 v[198:199], v107 offset:41984
    ds_read_b64_tr_b16 v[136:137], v104 offset:49152
    ds_read_b64_tr_b16 v[138:139], v104 offset:50176
    ds_read_b64_tr_b16 v[140:141], v104 offset:57344
    ds_read_b64_tr_b16 v[142:143], v104 offset:58368
    ds_read_b64_tr_b16 v[200:201], v107 offset:49152
    ds_read_b64_tr_b16 v[202:203], v107 offset:50176
    ds_read_b64_tr_b16 v[204:205], v107 offset:57344
    ds_read_b64_tr_b16 v[206:207], v107 offset:58368
    s_branch CHR_179
CHR_180:
    s_cmp_lg_u32 s9, 1
    s_cbranch_scc1 CHR_181
    ds_read_b64_tr_b16 v[176:177], v104 offset:32768
    ds_read_b64_tr_b16 v[178:179], v104 offset:33792
    ds_read_b64_tr_b16 v[180:181], v104 offset:40960
    ds_read_b64_tr_b16 v[182:183], v104 offset:41984
    ds_read_b64_tr_b16 v[240:241], v107 offset:32768
    ds_read_b64_tr_b16 v[242:243], v107 offset:33792
    ds_read_b64_tr_b16 v[244:245], v107 offset:40960
    ds_read_b64_tr_b16 v[246:247], v107 offset:41984
    ds_read_b64_tr_b16 v[184:185], v104 offset:49152
    ds_read_b64_tr_b16 v[186:187], v104 offset:50176
    ds_read_b64_tr_b16 v[188:189], v104 offset:57344
    ds_read_b64_tr_b16 v[190:191], v104 offset:58368
    ds_read_b64_tr_b16 v[248:249], v107 offset:49152
    ds_read_b64_tr_b16 v[250:251], v107 offset:50176
    ds_read_b64_tr_b16 v[252:253], v107 offset:57344
    ds_read_b64_tr_b16 v[254:255], v107 offset:58368
    s_branch CHR_179
CHR_181:
    s_cmp_lg_u32 s9, 2
    s_cbranch_scc1 CHR_182
    ds_read_b64_tr_b16 v[160:161], v104 offset:32768
    ds_read_b64_tr_b16 v[162:163], v104 offset:33792
    ds_read_b64_tr_b16 v[164:165], v104 offset:40960
    ds_read_b64_tr_b16 v[166:167], v104 offset:41984
    ds_read_b64_tr_b16 v[224:225], v107 offset:32768
    ds_read_b64_tr_b16 v[226:227], v107 offset:33792
    ds_read_b64_tr_b16 v[228:229], v107 offset:40960
    ds_read_b64_tr_b16 v[230:231], v107 offset:41984
    ds_read_b64_tr_b16 v[168:169], v104 offset:49152
    ds_read_b64_tr_b16 v[170:171], v104 offset:50176
    ds_read_b64_tr_b16 v[172:173], v104 offset:57344
    ds_read_b64_tr_b16 v[174:175], v104 offset:58368
    ds_read_b64_tr_b16 v[232:233], v107 offset:49152
    ds_read_b64_tr_b16 v[234:235], v107 offset:50176
    ds_read_b64_tr_b16 v[236:237], v107 offset:57344
    ds_read_b64_tr_b16 v[238:239], v107 offset:58368
    s_branch CHR_179
CHR_182:
    ds_read_b64_tr_b16 v[144:145], v104 offset:32768
    ds_read_b64_tr_b16 v[146:147], v104 offset:33792
    ds_read_b64_tr_b16 v[148:149], v104 offset:40960
    ds_read_b64_tr_b16 v[150:151], v104 offset:41984
    ds_read_b64_tr_b16 v[208:209], v107 offset:32768
    ds_read_b64_tr_b16 v[210:211], v107 offset:33792
    ds_read_b64_tr_b16 v[212:213], v107 offset:40960
    ds_read_b64_tr_b16 v[214:215], v107 offset:41984
    ds_read_b64_tr_b16 v[152:153], v104 offset:49152
    ds_read_b64_tr_b16 v[154:155], v104 offset:50176
    ds_read_b64_tr_b16 v[156:157], v104 offset:57344
    ds_read_b64_tr_b16 v[158:159], v104 offset:58368
    ds_read_b64_tr_b16 v[216:217], v107 offset:49152
    ds_read_b64_tr_b16 v[218:219], v107 offset:50176
    ds_read_b64_tr_b16 v[220:221], v107 offset:57344
    ds_read_b64_tr_b16 v[222:223], v107 offset:58368
CHR_179:
    s_waitcnt lgkmcnt(0)
    s_barrier
    s_add_u32 s44, s22, 0x200000
    s_addc_u32 s45, s23, 0
    s_add_u32 m0, s28, 32768
    s_nop 0
    global_load_lds_dwordx4 v100, s[44:45]
    s_add_u32 s44, s22, 0x202000
    s_addc_u32 s45, s23, 0
    s_add_u32 m0, s28, 33792
    s_nop 0
    global_load_lds_dwordx4 v100, s[44:45]
    s_add_u32 s44, s22, 0x204000
    s_addc_u32 s45, s23, 0
    s_add_u32 m0, s28, 34816
    s_nop 0
    global_load_lds_dwordx4 v101, s[44:45]
    s_add_u32 s44, s22, 0x206000
    s_addc_u32 s45, s23, 0
    s_add_u32 m0, s28, 35840
    s_nop 0
    global_load_lds_dwordx4 v101, s[44:45]
    s_add_u32 s44, s22, 0x208000
    s_addc_u32 s45, s23, 0
    s_add_u32 m0, s28, 36864
    s_nop 0
    global_load_lds_dwordx4 v100, s[44:45]
    s_add_u32 s44, s22, 0x20a000
    s_addc_u32 s45, s23, 0
    s_add_u32 m0, s28, 37888
    s_nop 0
    global_load_lds_dwordx4 v100, s[44:45]
    s_add_u32 s44, s22, 0x20c000
    s_addc_u32 s45, s23, 0
    s_add_u32 m0, s28, 38912
    s_nop 0
    global_load_lds_dwordx4 v101, s[44:45]
    s_add_u32 s44, s22, 0x20e000
    s_addc_u32 s45, s23, 0
    s_add_u32 m0, s28, 39936
    s_nop 0
    global_load_lds_dwordx4 v101, s[44:45]
    s_waitcnt vmcnt(16)
    s_waitcnt lgkmcnt(0)
    s_barrier
    s_cmp_lg_u32 s9, 0
    s_cbranch_scc1 CHR_185
    ds_read_b64_tr_b16 a[144:145], v106 offset:0
    ds_read_b64_tr_b16 a[146:147], v106 offset:1024
    ds_read_b64_tr_b16 a[148:149], v106 offset:8192
    ds_read_b64_tr_b16 a[150:151], v106 offset:9216
    ds_read_b64_tr_b16 a[208:209], v109 offset:0
    ds_read_b64_tr_b16 a[210:211], v109 offset:1024
    ds_read_b64_tr_b16 a[212:213], v109 offset:8192
    ds_read_b64_tr_b16 a[214:215], v109 offset:9216
    ds_read_b64_tr_b16 a[152:153], v106 offset:16384
    ds_read_b64_tr_b16 a[154:155], v106 offset:17408
    ds_read_b64_tr_b16 a[156:157], v106 offset:24576
    ds_read_b64_tr_b16 a[158:159], v106 offset:25600
    ds_read_b64_tr_b16 a[216:217], v109 offset:16384
    ds_read_b64_tr_b16 a[218:219], v109 offset:17408
    ds_read_b64_tr_b16 a[220:221], v109 offset:24576
    ds_read_b64_tr_b16 a[222:223], v109 offset:25600
    s_branch CHR_184
CHR_185:
    s_cmp_lg_u32 s9, 1
    s_cbranch_scc1 CHR_186
    ds_read_b64_tr_b16 a[128:129], v106 offset:0
    ds_read_b64_tr_b16 a[130:131], v106 offset:1024
    ds_read_b64_tr_b16 a[132:133], v106 offset:8192
    ds_read_b64_tr_b16 a[134:135], v106 offset:9216
    ds_read_b64_tr_b16 a[192:193], v109 offset:0
    ds_read_b64_tr_b16 a[194:195], v109 offset:1024
    ds_read_b64_tr_b16 a[196:197], v109 offset:8192
    ds_read_b64_tr_b16 a[198:199], v109 offset:9216
    ds_read_b64_tr_b16 a[136:137], v106 offset:16384
    ds_read_b64_tr_b16 a[138:139], v106 offset:17408
    ds_read_b64_tr_b16 a[140:141], v106 offset:24576
    ds_read_b64_tr_b16 a[142:143], v106 offset:25600
    ds_read_b64_tr_b16 a[200:201], v109 offset:16384
    ds_read_b64_tr_b16 a[202:203], v109 offset:17408
    ds_read_b64_tr_b16 a[204:205], v109 offset:24576
    ds_read_b64_tr_b16 a[206:207], v109 offset:25600
    s_branch CHR_184
CHR_186:
    s_cmp_lg_u32 s9, 2
    s_cbranch_scc1 CHR_187
    ds_read_b64_tr_b16 a[176:177], v106 offset:0
    ds_read_b64_tr_b16 a[178:179], v106 offset:1024
    ds_read_b64_tr_b16 a[180:181], v106 offset:8192
    ds_read_b64_tr_b16 a[182:183], v106 offset:9216
    ds_read_b64_tr_b16 a[240:241], v109 offset:0
    ds_read_b64_tr_b16 a[242:243], v109 offset:1024
    ds_read_b64_tr_b16 a[244:245], v109 offset:8192
    ds_read_b64_tr_b16 a[246:247], v109 offset:9216
    ds_read_b64_tr_b16 a[184:185], v106 offset:16384
    ds_read_b64_tr_b16 a[186:187], v106 offset:17408
    ds_read_b64_tr_b16 a[188:189], v106 offset:24576
    ds_read_b64_tr_b16 a[190:191], v106 offset:25600
    ds_read_b64_tr_b16 a[248:249], v109 offset:16384
    ds_read_b64_tr_b16 a[250:251], v109 offset:17408
    ds_read_b64_tr_b16 a[252:253], v109 offset:24576
    ds_read_b64_tr_b16 a[254:255], v109 offset:25600
    s_branch CHR_184
CHR_187:
    ds_read_b64_tr_b16 a[160:161], v106 offset:0
    ds_read_b64_tr_b16 a[162:163], v106 offset:1024
    ds_read_b64_tr_b16 a[164:165], v106 offset:8192
    ds_read_b64_tr_b16 a[166:167], v106 offset:9216
    ds_read_b64_tr_b16 a[224:225], v109 offset:0
    ds_read_b64_tr_b16 a[226:227], v109 offset:1024
    ds_read_b64_tr_b16 a[228:229], v109 offset:8192
    ds_read_b64_tr_b16 a[230:231], v109 offset:9216
    ds_read_b64_tr_b16 a[168:169], v106 offset:16384
    ds_read_b64_tr_b16 a[170:171], v106 offset:17408
    ds_read_b64_tr_b16 a[172:173], v106 offset:24576
    ds_read_b64_tr_b16 a[174:175], v106 offset:25600
    ds_read_b64_tr_b16 a[232:233], v109 offset:16384
    ds_read_b64_tr_b16 a[234:235], v109 offset:17408
    ds_read_b64_tr_b16 a[236:237], v109 offset:24576
    ds_read_b64_tr_b16 a[238:239], v109 offset:25600
CHR_184:
    s_waitcnt lgkmcnt(0)
    s_barrier
    s_add_u32 s44, s24, 0x200000
    s_addc_u32 s45, s25, 0
    s_add_u32 m0, s28, 131072
    s_nop 0
    global_load_lds_dwordx4 v100, s[44:45]
    s_add_u32 s44, s24, 0x202000
    s_addc_u32 s45, s25, 0
    s_add_u32 m0, s28, 132096
    s_nop 0
    global_load_lds_dwordx4 v100, s[44:45]
    s_add_u32 s44, s24, 0x204000
    s_addc_u32 s45, s25, 0
    s_add_u32 m0, s28, 133120
    s_nop 0
    global_load_lds_dwordx4 v101, s[44:45]
    s_add_u32 s44, s24, 0x206000
    s_addc_u32 s45, s25, 0
    s_add_u32 m0, s28, 134144
    s_nop 0
    global_load_lds_dwordx4 v101, s[44:45]
    s_add_u32 s44, s24, 0x208000
    s_addc_u32 s45, s25, 0
    s_add_u32 m0, s28, 135168
    s_nop 0
    global_load_lds_dwordx4 v100, s[44:45]
    s_add_u32 s44, s24, 0x20a000
    s_addc_u32 s45, s25, 0
    s_add_u32 m0, s28, 136192
    s_nop 0
    global_load_lds_dwordx4 v100, s[44:45]
    s_add_u32 s44, s24, 0x20c000
    s_addc_u32 s45, s25, 0
    s_add_u32 m0, s28, 137216
    s_nop 0
    global_load_lds_dwordx4 v101, s[44:45]
    s_add_u32 s44, s24, 0x20e000
    s_addc_u32 s45, s25, 0
    s_add_u32 m0, s28, 138240
    s_nop 0
    global_load_lds_dwordx4 v101, s[44:45]
    s_waitcnt vmcnt(16)
    s_waitcnt lgkmcnt(0)
    s_barrier
    s_cmp_lg_u32 s9, 0
    s_cbranch_scc1 CHR_190
    ds_read_b64_tr_b16 v[144:145], v104 offset:0
    ds_read_b64_tr_b16 v[146:147], v104 offset:1024
    ds_read_b64_tr_b16 v[148:149], v104 offset:8192
    ds_read_b64_tr_b16 v[150:151], v104 offset:9216
    ds_read_b64_tr_b16 v[208:209], v107 offset:0
    ds_read_b64_tr_b16 v[210:211], v107 offset:1024
    ds_read_b64_tr_b16 v[212:213], v107 offset:8192
    ds_read_b64_tr_b16 v[214:215], v107 offset:9216
    ds_read_b64_tr_b16 v[152:153], v104 offset:16384
    ds_read_b64_tr_b16 v[154:155], v104 offset:17408
    ds_read_b64_tr_b16 v[156:157], v104 offset:24576
    ds_read_b64_tr_b16 v[158:159], v104 offset:25600
    ds_read_b64_tr_b16 v[216:217], v107 offset:16384
    ds_read_b64_tr_b16 v[218:219], v107 offset:17408
    ds_read_b64_tr_b16 v[220:221], v107 offset:24576
    ds_read_b64_tr_b16 v[222:223], v107 offset:25600
    s_branch CHR_189
CHR_190:
    s_cmp_lg_u32 s9, 1
    s_cbranch_scc1 CHR_191
    ds_read_b64_tr_b16 v[128:129], v104 offset:0
    ds_read_b64_tr_b16 v[130:131], v104 offset:1024
    ds_read_b64_tr_b16 v[132:133], v104 offset:8192
    ds_read_b64_tr_b16 v[134:135], v104 offset:9216
    ds_read_b64_tr_b16 v[192:193], v107 offset:0
    ds_read_b64_tr_b16 v[194:195], v107 offset:1024
    ds_read_b64_tr_b16 v[196:197], v107 offset:8192
    ds_read_b64_tr_b16 v[198:199], v107 offset:9216
    ds_read_b64_tr_b16 v[136:137], v104 offset:16384
    ds_read_b64_tr_b16 v[138:139], v104 offset:17408
    ds_read_b64_tr_b16 v[140:141], v104 offset:24576
    ds_read_b64_tr_b16 v[142:143], v104 offset:25600
    ds_read_b64_tr_b16 v[200:201], v107 offset:16384
    ds_read_b64_tr_b16 v[202:203], v107 offset:17408
    ds_read_b64_tr_b16 v[204:205], v107 offset:24576
    ds_read_b64_tr_b16 v[206:207], v107 offset:25600
    s_branch CHR_189
CHR_191:
    s_cmp_lg_u32 s9, 2
    s_cbranch_scc1 CHR_192
    ds_read_b64_tr_b16 v[176:177], v104 offset:0
    ds_read_b64_tr_b16 v[178:179], v104 offset:1024
    ds_read_b64_tr_b16 v[180:181], v104 offset:8192
    ds_read_b64_tr_b16 v[182:183], v104 offset:9216
    ds_read_b64_tr_b16 v[240:241], v107 offset:0
    ds_read_b64_tr_b16 v[242:243], v107 offset:1024
    ds_read_b64_tr_b16 v[244:245], v107 offset:8192
    ds_read_b64_tr_b16 v[246:247], v107 offset:9216
    ds_read_b64_tr_b16 v[184:185], v104 offset:16384
    ds_read_b64_tr_b16 v[186:187], v104 offset:17408
    ds_read_b64_tr_b16 v[188:189], v104 offset:24576
    ds_read_b64_tr_b16 v[190:191], v104 offset:25600
    ds_read_b64_tr_b16 v[248:249], v107 offset:16384
    ds_read_b64_tr_b16 v[250:251], v107 offset:17408
    ds_read_b64_tr_b16 v[252:253], v107 offset:24576
    ds_read_b64_tr_b16 v[254:255], v107 offset:25600
    s_branch CHR_189
CHR_192:
    ds_read_b64_tr_b16 v[160:161], v104 offset:0
    ds_read_b64_tr_b16 v[162:163], v104 offset:1024
    ds_read_b64_tr_b16 v[164:165], v104 offset:8192
    ds_read_b64_tr_b16 v[166:167], v104 offset:9216
    ds_read_b64_tr_b16 v[224:225], v107 offset:0
    ds_read_b64_tr_b16 v[226:227], v107 offset:1024
    ds_read_b64_tr_b16 v[228:229], v107 offset:8192
    ds_read_b64_tr_b16 v[230:231], v107 offset:9216
    ds_read_b64_tr_b16 v[168:169], v104 offset:16384
    ds_read_b64_tr_b16 v[170:171], v104 offset:17408
    ds_read_b64_tr_b16 v[172:173], v104 offset:24576
    ds_read_b64_tr_b16 v[174:175], v104 offset:25600
    ds_read_b64_tr_b16 v[232:233], v107 offset:16384
    ds_read_b64_tr_b16 v[234:235], v107 offset:17408
    ds_read_b64_tr_b16 v[236:237], v107 offset:24576
    ds_read_b64_tr_b16 v[238:239], v107 offset:25600
CHR_189:
    s_waitcnt lgkmcnt(0)
    s_barrier
    s_add_u32 s44, s22, 0x300000
    s_addc_u32 s45, s23, 0
    s_add_u32 m0, s28, 0
    s_nop 0
    global_load_lds_dwordx4 v100, s[44:45]
    s_add_u32 s44, s22, 0x302000
    s_addc_u32 s45, s23, 0
    s_add_u32 m0, s28, 1024
    s_nop 0
    global_load_lds_dwordx4 v100, s[44:45]
    s_add_u32 s44, s22, 0x304000
    s_addc_u32 s45, s23, 0
    s_add_u32 m0, s28, 2048
    s_nop 0
    global_load_lds_dwordx4 v101, s[44:45]
    s_add_u32 s44, s22, 0x306000
    s_addc_u32 s45, s23, 0
    s_add_u32 m0, s28, 3072
    s_nop 0
    global_load_lds_dwordx4 v101, s[44:45]
    s_add_u32 s44, s22, 0x308000
    s_addc_u32 s45, s23, 0
    s_add_u32 m0, s28, 4096
    s_nop 0
    global_load_lds_dwordx4 v100, s[44:45]
    s_add_u32 s44, s22, 0x30a000
    s_addc_u32 s45, s23, 0
    s_add_u32 m0, s28, 5120
    s_nop 0
    global_load_lds_dwordx4 v100, s[44:45]
    s_add_u32 s44, s22, 0x30c000
    s_addc_u32 s45, s23, 0
    s_add_u32 m0, s28, 6144
    s_nop 0
    global_load_lds_dwordx4 v101, s[44:45]
    s_add_u32 s44, s22, 0x30e000
    s_addc_u32 s45, s23, 0
    s_add_u32 m0, s28, 7168
    s_nop 0
    global_load_lds_dwordx4 v101, s[44:45]
    global_store_dwordx2 v54, v[46:47], s[48:49] sc1
    s_waitcnt vmcnt(17)
    s_waitcnt lgkmcnt(0)
    s_barrier
    s_cmp_lg_u32 s9, 0
    s_cbranch_scc1 CHR_195
    ds_read_b64_tr_b16 a[160:161], v104 offset:32768
    ds_read_b64_tr_b16 a[162:163], v104 offset:33792
    ds_read_b64_tr_b16 a[164:165], v104 offset:40960
    ds_read_b64_tr_b16 a[166:167], v104 offset:41984
    ds_read_b64_tr_b16 a[224:225], v107 offset:32768
    ds_read_b64_tr_b16 a[226:227], v107 offset:33792
    ds_read_b64_tr_b16 a[228:229], v107 offset:40960
    ds_read_b64_tr_b16 a[230:231], v107 offset:41984
    ds_read_b64_tr_b16 a[168:169], v104 offset:49152
    ds_read_b64_tr_b16 a[170:171], v104 offset:50176
    ds_read_b64_tr_b16 a[172:173], v104 offset:57344
    ds_read_b64_tr_b16 a[174:175], v104 offset:58368
    ds_read_b64_tr_b16 a[232:233], v107 offset:49152
    ds_read_b64_tr_b16 a[234:235], v107 offset:50176
    ds_read_b64_tr_b16 a[236:237], v107 offset:57344
    ds_read_b64_tr_b16 a[238:239], v107 offset:58368
    s_branch CHR_194
CHR_195:
    s_cmp_lg_u32 s9, 1
    s_cbranch_scc1 CHR_196
    ds_read_b64_tr_b16 a[144:145], v104 offset:32768
    ds_read_b64_tr_b16 a[146:147], v104 offset:33792
    ds_read_b64_tr_b16 a[148:149], v104 offset:40960
    ds_read_b64_tr_b16 a[150:151], v104 offset:41984
    ds_read_b64_tr_b16 a[208:209], v107 offset:32768
    ds_read_b64_tr_b16 a[210:211], v107 offset:33792
    ds_read_b64_tr_b16 a[212:213], v107 offset:40960
    ds_read_b64_tr_b16 a[214:215], v107 offset:41984
    ds_read_b64_tr_b16 a[152:153], v104 offset:49152
    ds_read_b64_tr_b16 a[154:155], v104 offset:50176
    ds_read_b64_tr_b16 a[156:157], v104 offset:57344
    ds_read_b64_tr_b16 a[158:159], v104 offset:58368
    ds_read_b64_tr_b16 a[216:217], v107 offset:49152
    ds_read_b64_tr_b16 a[218:219], v107 offset:50176
    ds_read_b64_tr_b16 a[220:221], v107 offset:57344
    ds_read_b64_tr_b16 a[222:223], v107 offset:58368
    s_branch CHR_194
CHR_196:
    s_cmp_lg_u32 s9, 2
    s_cbranch_scc1 CHR_197
    ds_read_b64_tr_b16 a[128:129], v104 offset:32768
    ds_read_b64_tr_b16 a[130:131], v104 offset:33792
    ds_read_b64_tr_b16 a[132:133], v104 offset:40960
    ds_read_b64_tr_b16 a[134:135], v104 offset:41984
    ds_read_b64_tr_b16 a[192:193], v107 offset:32768
    ds_read_b64_tr_b16 a[194:195], v107 offset:33792
    ds_read_b64_tr_b16 a[196:197], v107 offset:40960
    ds_read_b64_tr_b16 a[198:199], v107 offset:41984
    ds_read_b64_tr_b16 a[136:137], v104 offset:49152
    ds_read_b64_tr_b16 a[138:139], v104 offset:50176
    ds_read_b64_tr_b16 a[140:141], v104 offset:57344
    ds_read_b64_tr_b16 a[142:143], v104 offset:58368
    ds_read_b64_tr_b16 a[200:201], v107 offset:49152
    ds_read_b64_tr_b16 a[202:203], v107 offset:50176
    ds_read_b64_tr_b16 a[204:205], v107 offset:57344
    ds_read_b64_tr_b16 a[206:207], v107 offset:58368
    s_branch CHR_194
CHR_197:
    ds_read_b64_tr_b16 a[176:177], v104 offset:32768
    ds_read_b64_tr_b16 a[178:179], v104 offset:33792
    ds_read_b64_tr_b16 a[180:181], v104 offset:40960
    ds_read_b64_tr_b16 a[182:183], v104 offset:41984
    ds_read_b64_tr_b16 a[240:241], v107 offset:32768
    ds_read_b64_tr_b16 a[242:243], v107 offset:33792
    ds_read_b64_tr_b16 a[244:245], v107 offset:40960
    ds_read_b64_tr_b16 a[246:247], v107 offset:41984
    ds_read_b64_tr_b16 a[184:185], v104 offset:49152
    ds_read_b64_tr_b16 a[186:187], v104 offset:50176
    ds_read_b64_tr_b16 a[188:189], v104 offset:57344
    ds_read_b64_tr_b16 a[190:191], v104 offset:58368
    ds_read_b64_tr_b16 a[248:249], v107 offset:49152
    ds_read_b64_tr_b16 a[250:251], v107 offset:50176
    ds_read_b64_tr_b16 a[252:253], v107 offset:57344
    ds_read_b64_tr_b16 a[254:255], v107 offset:58368
CHR_194:
    s_waitcnt lgkmcnt(0)
    s_barrier
    s_add_u32 s44, s24, 0x300000
    s_addc_u32 s45, s25, 0
    s_add_u32 m0, s28, 32768
    s_nop 0
    global_load_lds_dwordx4 v100, s[44:45]
    s_add_u32 s44, s24, 0x302000
    s_addc_u32 s45, s25, 0
    s_add_u32 m0, s28, 33792
    s_nop 0
    global_load_lds_dwordx4 v100, s[44:45]
    s_add_u32 s44, s24, 0x304000
    s_addc_u32 s45, s25, 0
    s_add_u32 m0, s28, 34816
    s_nop 0
    global_load_lds_dwordx4 v101, s[44:45]
    s_add_u32 s44, s24, 0x306000
    s_addc_u32 s45, s25, 0
    s_add_u32 m0, s28, 35840
    s_nop 0
    global_load_lds_dwordx4 v101, s[44:45]
    s_add_u32 s44, s24, 0x308000
    s_addc_u32 s45, s25, 0
    s_add_u32 m0, s28, 36864
    s_nop 0
    global_load_lds_dwordx4 v100, s[44:45]
    s_add_u32 s44, s24, 0x30a000
    s_addc_u32 s45, s25, 0
    s_add_u32 m0, s28, 37888
    s_nop 0
    global_load_lds_dwordx4 v100, s[44:45]
    s_add_u32 s44, s24, 0x30c000
    s_addc_u32 s45, s25, 0
    s_add_u32 m0, s28, 38912
    s_nop 0
    global_load_lds_dwordx4 v101, s[44:45]
    s_add_u32 s44, s24, 0x30e000
    s_addc_u32 s45, s25, 0
    s_add_u32 m0, s28, 39936
    s_nop 0
    global_load_lds_dwordx4 v101, s[44:45]
    s_waitcnt vmcnt(17)
    s_waitcnt lgkmcnt(0)
    s_barrier
    s_cmp_lg_u32 s9, 0
    s_cbranch_scc1 CHR_200
    ds_read_b64_tr_b16 v[160:161], v106 offset:0
    ds_read_b64_tr_b16 v[162:163], v106 offset:1024
    ds_read_b64_tr_b16 v[164:165], v106 offset:8192
    ds_read_b64_tr_b16 v[166:167], v106 offset:9216
    ds_read_b64_tr_b16 v[224:225], v109 offset:0
    ds_read_b64_tr_b16 v[226:227], v109 offset:1024
    ds_read_b64_tr_b16 v[228:229], v109 offset:8192
    ds_read_b64_tr_b16 v[230:231], v109 offset:9216
    ds_read_b64_tr_b16 v[168:169], v106 offset:16384
    ds_read_b64_tr_b16 v[170:171], v106 offset:17408
    ds_read_b64_tr_b16 v[172:173], v106 offset:24576
    ds_read_b64_tr_b16 v[174:175], v106 offset:25600
    ds_read_b64_tr_b16 v[232:233], v109 offset:16384
    ds_read_b64_tr_b16 v[234:235], v109 offset:17408
    ds_read_b64_tr_b16 v[236:237], v109 offset:24576
    ds_read_b64_tr_b16 v[238:239], v109 offset:25600
    s_branch CHR_199
CHR_200:
    s_cmp_lg_u32 s9, 1
    s_cbranch_scc1 CHR_201
    ds_read_b64_tr_b16 v[144:145], v106 offset:0
    ds_read_b64_tr_b16 v[146:147], v106 offset:1024
    ds_read_b64_tr_b16 v[148:149], v106 offset:8192
    ds_read_b64_tr_b16 v[150:151], v106 offset:9216
    ds_read_b64_tr_b16 v[208:209], v109 offset:0
    ds_read_b64_tr_b16 v[210:211], v109 offset:1024
    ds_read_b64_tr_b16 v[212:213], v109 offset:8192
    ds_read_b64_tr_b16 v[214:215], v109 offset:9216
    ds_read_b64_tr_b16 v[152:153], v106 offset:16384
    ds_read_b64_tr_b16 v[154:155], v106 offset:17408
    ds_read_b64_tr_b16 v[156:157], v106 offset:24576
    ds_read_b64_tr_b16 v[158:159], v106 offset:25600
    ds_read_b64_tr_b16 v[216:217], v109 offset:16384
    ds_read_b64_tr_b16 v[218:219], v109 offset:17408
    ds_read_b64_tr_b16 v[220:221], v109 offset:24576
    ds_read_b64_tr_b16 v[222:223], v109 offset:25600
    s_branch CHR_199
CHR_201:
    s_cmp_lg_u32 s9, 2
    s_cbranch_scc1 CHR_202
    ds_read_b64_tr_b16 v[128:129], v106 offset:0
    ds_read_b64_tr_b16 v[130:131], v106 offset:1024
    ds_read_b64_tr_b16 v[132:133], v106 offset:8192
    ds_read_b64_tr_b16 v[134:135], v106 offset:9216
    ds_read_b64_tr_b16 v[192:193], v109 offset:0
    ds_read_b64_tr_b16 v[194:195], v109 offset:1024
    ds_read_b64_tr_b16 v[196:197], v109 offset:8192
    ds_read_b64_tr_b16 v[198:199], v109 offset:9216
    ds_read_b64_tr_b16 v[136:137], v106 offset:16384
    ds_read_b64_tr_b16 v[138:139], v106 offset:17408
    ds_read_b64_tr_b16 v[140:141], v106 offset:24576
    ds_read_b64_tr_b16 v[142:143], v106 offset:25600
    ds_read_b64_tr_b16 v[200:201], v109 offset:16384
    ds_read_b64_tr_b16 v[202:203], v109 offset:17408
    ds_read_b64_tr_b16 v[204:205], v109 offset:24576
    ds_read_b64_tr_b16 v[206:207], v109 offset:25600
    s_branch CHR_199
CHR_202:
    ds_read_b64_tr_b16 v[176:177], v106 offset:0
    ds_read_b64_tr_b16 v[178:179], v106 offset:1024
    ds_read_b64_tr_b16 v[180:181], v106 offset:8192
    ds_read_b64_tr_b16 v[182:183], v106 offset:9216
    ds_read_b64_tr_b16 v[240:241], v109 offset:0
    ds_read_b64_tr_b16 v[242:243], v109 offset:1024
    ds_read_b64_tr_b16 v[244:245], v109 offset:8192
    ds_read_b64_tr_b16 v[246:247], v109 offset:9216
    ds_read_b64_tr_b16 v[184:185], v106 offset:16384
    ds_read_b64_tr_b16 v[186:187], v106 offset:17408
    ds_read_b64_tr_b16 v[188:189], v106 offset:24576
    ds_read_b64_tr_b16 v[190:191], v106 offset:25600
    ds_read_b64_tr_b16 v[248:249], v109 offset:16384
    ds_read_b64_tr_b16 v[250:251], v109 offset:17408
    ds_read_b64_tr_b16 v[252:253], v109 offset:24576
    ds_read_b64_tr_b16 v[254:255], v109 offset:25600
CHR_199:
    s_waitcnt lgkmcnt(0)
    s_barrier
    s_add_u32 s44, s20, 0x0
    s_addc_u32 s45, s21, 0
    s_add_u32 m0, s28, 131072
    s_nop 0
    global_load_lds_dwordx4 v100, s[44:45]
    s_add_u32 s44, s20, 0x2000
    s_addc_u32 s45, s21, 0
    s_add_u32 m0, s28, 132096
    s_nop 0
    global_load_lds_dwordx4 v100, s[44:45]
    s_add_u32 s44, s20, 0x4000
    s_addc_u32 s45, s21, 0
    s_add_u32 m0, s28, 133120
    s_nop 0
    global_load_lds_dwordx4 v101, s[44:45]
    s_add_u32 s44, s20, 0x6000
    s_addc_u32 s45, s21, 0
    s_add_u32 m0, s28, 134144
    s_nop 0
    global_load_lds_dwordx4 v101, s[44:45]
    s_add_u32 s44, s20, 0x8000
    s_addc_u32 s45, s21, 0
    s_add_u32 m0, s28, 135168
    s_nop 0
    global_load_lds_dwordx4 v100, s[44:45]
    s_add_u32 s44, s20, 0xa000
    s_addc_u32 s45, s21, 0
    s_add_u32 m0, s28, 136192
    s_nop 0
    global_load_lds_dwordx4 v100, s[44:45]
    s_add_u32 s44, s20, 0xc000
    s_addc_u32 s45, s21, 0
    s_add_u32 m0, s28, 137216
    s_nop 0
    global_load_lds_dwordx4 v101, s[44:45]
    s_add_u32 s44, s20, 0xe000
    s_addc_u32 s45, s21, 0
    s_add_u32 m0, s28, 138240
    s_nop 0
    global_load_lds_dwordx4 v101, s[44:45]
    s_waitcnt vmcnt(17)
    s_waitcnt lgkmcnt(0)
    s_barrier
    s_cmp_lg_u32 s9, 0
    s_cbranch_scc1 CHR_205
    ds_read_b64_tr_b16 a[176:177], v104 offset:0
    ds_read_b64_tr_b16 a[178:179], v104 offset:1024
    ds_read_b64_tr_b16 a[180:181], v104 offset:8192
    ds_read_b64_tr_b16 a[182:183], v104 offset:9216
    ds_read_b64_tr_b16 a[240:241], v107 offset:0
    ds_read_b64_tr_b16 a[242:243], v107 offset:1024
    ds_read_b64_tr_b16 a[244:245], v107 offset:8192
    ds_read_b64_tr_b16 a[246:247], v107 offset:9216
    ds_read_b64_tr_b16 a[184:185], v104 offset:16384
    ds_read_b64_tr_b16 a[186:187], v104 offset:17408
    ds_read_b64_tr_b16 a[188:189], v104 offset:24576
    ds_read_b64_tr_b16 a[190:191], v104 offset:25600
    ds_read_b64_tr_b16 a[248:249], v107 offset:16384
    ds_read_b64_tr_b16 a[250:251], v107 offset:17408
    ds_read_b64_tr_b16 a[252:253], v107 offset:24576
    ds_read_b64_tr_b16 a[254:255], v107 offset:25600
    s_branch CHR_204
CHR_205:
    s_cmp_lg_u32 s9, 1
    s_cbranch_scc1 CHR_206
    ds_read_b64_tr_b16 a[160:161], v104 offset:0
    ds_read_b64_tr_b16 a[162:163], v104 offset:1024
    ds_read_b64_tr_b16 a[164:165], v104 offset:8192
    ds_read_b64_tr_b16 a[166:167], v104 offset:9216
    ds_read_b64_tr_b16 a[224:225], v107 offset:0
    ds_read_b64_tr_b16 a[226:227], v107 offset:1024
    ds_read_b64_tr_b16 a[228:229], v107 offset:8192
    ds_read_b64_tr_b16 a[230:231], v107 offset:9216
    ds_read_b64_tr_b16 a[168:169], v104 offset:16384
    ds_read_b64_tr_b16 a[170:171], v104 offset:17408
    ds_read_b64_tr_b16 a[172:173], v104 offset:24576
    ds_read_b64_tr_b16 a[174:175], v104 offset:25600
    ds_read_b64_tr_b16 a[232:233], v107 offset:16384
    ds_read_b64_tr_b16 a[234:235], v107 offset:17408
    ds_read_b64_tr_b16 a[236:237], v107 offset:24576
    ds_read_b64_tr_b16 a[238:239], v107 offset:25600
    s_branch CHR_204
CHR_206:
    s_cmp_lg_u32 s9, 2
    s_cbranch_scc1 CHR_207
    ds_read_b64_tr_b16 a[144:145], v104 offset:0
    ds_read_b64_tr_b16 a[146:147], v104 offset:1024
    ds_read_b64_tr_b16 a[148:149], v104 offset:8192
    ds_read_b64_tr_b16 a[150:151], v104 offset:9216
    ds_read_b64_tr_b16 a[208:209], v107 offset:0
    ds_read_b64_tr_b16 a[210:211], v107 offset:1024
    ds_read_b64_tr_b16 a[212:213], v107 offset:8192
    ds_read_b64_tr_b16 a[214:215], v107 offset:9216
    ds_read_b64_tr_b16 a[152:153], v104 offset:16384
    ds_read_b64_tr_b16 a[154:155], v104 offset:17408
    ds_read_b64_tr_b16 a[156:157], v104 offset:24576
    ds_read_b64_tr_b16 a[158:159], v104 offset:25600
    ds_read_b64_tr_b16 a[216:217], v107 offset:16384
    ds_read_b64_tr_b16 a[218:219], v107 offset:17408
    ds_read_b64_tr_b16 a[220:221], v107 offset:24576
    ds_read_b64_tr_b16 a[222:223], v107 offset:25600
    s_branch CHR_204
CHR_207:
    ds_read_b64_tr_b16 a[128:129], v104 offset:0
    ds_read_b64_tr_b16 a[130:131], v104 offset:1024
    ds_read_b64_tr_b16 a[132:133], v104 offset:8192
    ds_read_b64_tr_b16 a[134:135], v104 offset:9216
    ds_read_b64_tr_b16 a[192:193], v107 offset:0
    ds_read_b64_tr_b16 a[194:195], v107 offset:1024
    ds_read_b64_tr_b16 a[196:197], v107 offset:8192
    ds_read_b64_tr_b16 a[198:199], v107 offset:9216
    ds_read_b64_tr_b16 a[136:137], v104 offset:16384
    ds_read_b64_tr_b16 a[138:139], v104 offset:17408
    ds_read_b64_tr_b16 a[140:141], v104 offset:24576
    ds_read_b64_tr_b16 a[142:143], v104 offset:25600
    ds_read_b64_tr_b16 a[200:201], v107 offset:16384
    ds_read_b64_tr_b16 a[202:203], v107 offset:17408
    ds_read_b64_tr_b16 a[204:205], v107 offset:24576
    ds_read_b64_tr_b16 a[206:207], v107 offset:25600
CHR_204:
    s_waitcnt lgkmcnt(0)
    s_barrier
    s_add_u32 s44, s20, 0x100000
    s_addc_u32 s45, s21, 0
    s_add_u32 m0, s28, 0
    s_nop 0
    global_load_lds_dwordx4 v100, s[44:45]
    s_add_u32 s44, s20, 0x102000
    s_addc_u32 s45, s21, 0
    s_add_u32 m0, s28, 1024
    s_nop 0
    global_load_lds_dwordx4 v100, s[44:45]
    s_add_u32 s44, s20, 0x104000
    s_addc_u32 s45, s21, 0
    s_add_u32 m0, s28, 2048
    s_nop 0
    global_load_lds_dwordx4 v101, s[44:45]
    s_add_u32 s44, s20, 0x106000
    s_addc_u32 s45, s21, 0
    s_add_u32 m0, s28, 3072
    s_nop 0
    global_load_lds_dwordx4 v101, s[44:45]
    s_add_u32 s44, s20, 0x108000
    s_addc_u32 s45, s21, 0
    s_add_u32 m0, s28, 4096
    s_nop 0
    global_load_lds_dwordx4 v100, s[44:45]
    s_add_u32 s44, s20, 0x10a000
    s_addc_u32 s45, s21, 0
    s_add_u32 m0, s28, 5120
    s_nop 0
    global_load_lds_dwordx4 v100, s[44:45]
    s_add_u32 s44, s20, 0x10c000
    s_addc_u32 s45, s21, 0
    s_add_u32 m0, s28, 6144
    s_nop 0
    global_load_lds_dwordx4 v101, s[44:45]
    s_add_u32 s44, s20, 0x10e000
    s_addc_u32 s45, s21, 0
    s_add_u32 m0, s28, 7168
    s_nop 0
    global_load_lds_dwordx4 v101, s[44:45]
    s_waitcnt vmcnt(16)
    s_waitcnt lgkmcnt(0)
    s_barrier
    s_cmp_lg_u32 s9, 0
    s_cbranch_scc1 CHR_210
    ds_read_b64_tr_b16 v[176:177], v104 offset:32768
    ds_read_b64_tr_b16 v[178:179], v104 offset:33792
    ds_read_b64_tr_b16 v[180:181], v104 offset:40960
    ds_read_b64_tr_b16 v[182:183], v104 offset:41984
    ds_read_b64_tr_b16 v[240:241], v107 offset:32768
    ds_read_b64_tr_b16 v[242:243], v107 offset:33792
    ds_read_b64_tr_b16 v[244:245], v107 offset:40960
    ds_read_b64_tr_b16 v[246:247], v107 offset:41984
    ds_read_b64_tr_b16 v[184:185], v104 offset:49152
    ds_read_b64_tr_b16 v[186:187], v104 offset:50176
    ds_read_b64_tr_b16 v[188:189], v104 offset:57344
    ds_read_b64_tr_b16 v[190:191], v104 offset:58368
    ds_read_b64_tr_b16 v[248:249], v107 offset:49152
    ds_read_b64_tr_b16 v[250:251], v107 offset:50176
    ds_read_b64_tr_b16 v[252:253], v107 offset:57344
    ds_read_b64_tr_b16 v[254:255], v107 offset:58368
    s_branch CHR_209
CHR_210:
    s_cmp_lg_u32 s9, 1
    s_cbranch_scc1 CHR_211
    ds_read_b64_tr_b16 v[160:161], v104 offset:32768
    ds_read_b64_tr_b16 v[162:163], v104 offset:33792
    ds_read_b64_tr_b16 v[164:165], v104 offset:40960
    ds_read_b64_tr_b16 v[166:167], v104 offset:41984
    ds_read_b64_tr_b16 v[224:225], v107 offset:32768
    ds_read_b64_tr_b16 v[226:227], v107 offset:33792
    ds_read_b64_tr_b16 v[228:229], v107 offset:40960
    ds_read_b64_tr_b16 v[230:231], v107 offset:41984
    ds_read_b64_tr_b16 v[168:169], v104 offset:49152
    ds_read_b64_tr_b16 v[170:171], v104 offset:50176
    ds_read_b64_tr_b16 v[172:173], v104 offset:57344
    ds_read_b64_tr_b16 v[174:175], v104 offset:58368
    ds_read_b64_tr_b16 v[232:233], v107 offset:49152
    ds_read_b64_tr_b16 v[234:235], v107 offset:50176
    ds_read_b64_tr_b16 v[236:237], v107 offset:57344
    ds_read_b64_tr_b16 v[238:239], v107 offset:58368
    s_branch CHR_209
CHR_211:
    s_cmp_lg_u32 s9, 2
    s_cbranch_scc1 CHR_212
    ds_read_b64_tr_b16 v[144:145], v104 offset:32768
    ds_read_b64_tr_b16 v[146:147], v104 offset:33792
    ds_read_b64_tr_b16 v[148:149], v104 offset:40960
    ds_read_b64_tr_b16 v[150:151], v104 offset:41984
    ds_read_b64_tr_b16 v[208:209], v107 offset:32768
    ds_read_b64_tr_b16 v[210:211], v107 offset:33792
    ds_read_b64_tr_b16 v[212:213], v107 offset:40960
    ds_read_b64_tr_b16 v[214:215], v107 offset:41984
    ds_read_b64_tr_b16 v[152:153], v104 offset:49152
    ds_read_b64_tr_b16 v[154:155], v104 offset:50176
    ds_read_b64_tr_b16 v[156:157], v104 offset:57344
    ds_read_b64_tr_b16 v[158:159], v104 offset:58368
    ds_read_b64_tr_b16 v[216:217], v107 offset:49152
    ds_read_b64_tr_b16 v[218:219], v107 offset:50176
    ds_read_b64_tr_b16 v[220:221], v107 offset:57344
    ds_read_b64_tr_b16 v[222:223], v107 offset:58368
    s_branch CHR_209
CHR_212:
    ds_read_b64_tr_b16 v[128:129], v104 offset:32768
    ds_read_b64_tr_b16 v[130:131], v104 offset:33792
    ds_read_b64_tr_b16 v[132:133], v104 offset:40960
    ds_read_b64_tr_b16 v[134:135], v104 offset:41984
    ds_read_b64_tr_b16 v[192:193], v107 offset:32768
    ds_read_b64_tr_b16 v[194:195], v107 offset:33792
    ds_read_b64_tr_b16 v[196:197], v107 offset:40960
    ds_read_b64_tr_b16 v[198:199], v107 offset:41984
    ds_read_b64_tr_b16 v[136:137], v104 offset:49152
    ds_read_b64_tr_b16 v[138:139], v104 offset:50176
    ds_read_b64_tr_b16 v[140:141], v104 offset:57344
    ds_read_b64_tr_b16 v[142:143], v104 offset:58368
    ds_read_b64_tr_b16 v[200:201], v107 offset:49152
    ds_read_b64_tr_b16 v[202:203], v107 offset:50176
    ds_read_b64_tr_b16 v[204:205], v107 offset:57344
    ds_read_b64_tr_b16 v[206:207], v107 offset:58368
CHR_209:
    s_waitcnt lgkmcnt(0)
    s_barrier
    s_add_u32 s44, s20, 0x200000
    s_addc_u32 s45, s21, 0
    s_add_u32 m0, s28, 32768
    s_nop 0
    global_load_lds_dwordx4 v100, s[44:45]
    s_add_u32 s44, s20, 0x202000
    s_addc_u32 s45, s21, 0
    s_add_u32 m0, s28, 33792
    s_nop 0
    global_load_lds_dwordx4 v100, s[44:45]
    s_add_u32 s44, s20, 0x204000
    s_addc_u32 s45, s21, 0
    s_add_u32 m0, s28, 34816
    s_nop 0
    global_load_lds_dwordx4 v101, s[44:45]
    s_add_u32 s44, s20, 0x206000
    s_addc_u32 s45, s21, 0
    s_add_u32 m0, s28, 35840
    s_nop 0
    global_load_lds_dwordx4 v101, s[44:45]
    s_add_u32 s44, s20, 0x208000
    s_addc_u32 s45, s21, 0
    s_add_u32 m0, s28, 36864
    s_nop 0
    global_load_lds_dwordx4 v100, s[44:45]
    s_add_u32 s44, s20, 0x20a000
    s_addc_u32 s45, s21, 0
    s_add_u32 m0, s28, 37888
    s_nop 0
    global_load_lds_dwordx4 v100, s[44:45]
    s_add_u32 s44, s20, 0x20c000
    s_addc_u32 s45, s21, 0
    s_add_u32 m0, s28, 38912
    s_nop 0
    global_load_lds_dwordx4 v101, s[44:45]
    s_add_u32 s44, s20, 0x20e000
    s_addc_u32 s45, s21, 0
    s_add_u32 m0, s28, 39936
    s_nop 0
    global_load_lds_dwordx4 v101, s[44:45]
    s_waitcnt vmcnt(16)
    s_waitcnt lgkmcnt(0)
    s_barrier
    s_cmp_lg_u32 s9, 0
    s_cbranch_scc1 CHR_215
    ds_read_b64_tr_b16 a[0:1], v106 offset:0
    ds_read_b64_tr_b16 a[2:3], v106 offset:1024
    ds_read_b64_tr_b16 a[4:5], v106 offset:8192
    ds_read_b64_tr_b16 a[6:7], v106 offset:9216
    ds_read_b64_tr_b16 a[64:65], v109 offset:0
    ds_read_b64_tr_b16 a[66:67], v109 offset:1024
    ds_read_b64_tr_b16 a[68:69], v109 offset:8192
    ds_read_b64_tr_b16 a[70:71], v109 offset:9216
    ds_read_b64_tr_b16 a[8:9], v106 offset:16384
    ds_read_b64_tr_b16 a[10:11], v106 offset:17408
    ds_read_b64_tr_b16 a[12:13], v106 offset:24576
    ds_read_b64_tr_b16 a[14:15], v106 offset:25600
    ds_read_b64_tr_b16 a[72:73], v109 offset:16384
    ds_read_b64_tr_b16 a[74:75], v109 offset:17408
    ds_read_b64_tr_b16 a[76:77], v109 offset:24576
    ds_read_b64_tr_b16 a[78:79], v109 offset:25600
    s_branch CHR_214
CHR_215:
    s_cmp_lg_u32 s9, 1
    s_cbranch_scc1 CHR_216
    ds_read_b64_tr_b16 a[48:49], v106 offset:0
    ds_read_b64_tr_b16 a[50:51], v106 offset:1024
    ds_read_b64_tr_b16 a[52:53], v106 offset:8192
    ds_read_b64_tr_b16 a[54:55], v106 offset:9216
    ds_read_b64_tr_b16 a[112:113], v109 offset:0
    ds_read_b64_tr_b16 a[114:115], v109 offset:1024
    ds_read_b64_tr_b16 a[116:117], v109 offset:8192
    ds_read_b64_tr_b16 a[118:119], v109 offset:9216
    ds_read_b64_tr_b16 a[56:57], v106 offset:16384
    ds_read_b64_tr_b16 a[58:59], v106 offset:17408
    ds_read_b64_tr_b16 a[60:61], v106 offset:24576
    ds_read_b64_tr_b16 a[62:63], v106 offset:25600
    ds_read_b64_tr_b16 a[120:121], v109 offset:16384
    ds_read_b64_tr_b16 a[122:123], v109 offset:17408
    ds_read_b64_tr_b16 a[124:125], v109 offset:24576
    ds_read_b64_tr_b16 a[126:127], v109 offset:25600
    s_branch CHR_214
CHR_216:
    s_cmp_lg_u32 s9, 2
    s_cbranch_scc1 CHR_217
    ds_read_b64_tr_b16 a[32:33], v106 offset:0
    ds_read_b64_tr_b16 a[34:35], v106 offset:1024
    ds_read_b64_tr_b16 a[36:37], v106 offset:8192
    ds_read_b64_tr_b16 a[38:39], v106 offset:9216
    ds_read_b64_tr_b16 a[96:97], v109 offset:0
    ds_read_b64_tr_b16 a[98:99], v109 offset:1024
    ds_read_b64_tr_b16 a[100:101], v109 offset:8192
    ds_read_b64_tr_b16 a[102:103], v109 offset:9216
    ds_read_b64_tr_b16 a[40:41], v106 offset:16384
    ds_read_b64_tr_b16 a[42:43], v106 offset:17408
    ds_read_b64_tr_b16 a[44:45], v106 offset:24576
    ds_read_b64_tr_b16 a[46:47], v106 offset:25600
    ds_read_b64_tr_b16 a[104:105], v109 offset:16384
    ds_read_b64_tr_b16 a[106:107], v109 offset:17408
    ds_read_b64_tr_b16 a[108:109], v109 offset:24576
    ds_read_b64_tr_b16 a[110:111], v109 offset:25600
    s_branch CHR_214
CHR_217:
    ds_read_b64_tr_b16 a[16:17], v106 offset:0
    ds_read_b64_tr_b16 a[18:19], v106 offset:1024
    ds_read_b64_tr_b16 a[20:21], v106 offset:8192
    ds_read_b64_tr_b16 a[22:23], v106 offset:9216
    ds_read_b64_tr_b16 a[80:81], v109 offset:0
    ds_read_b64_tr_b16 a[82:83], v109 offset:1024
    ds_read_b64_tr_b16 a[84:85], v109 offset:8192
    ds_read_b64_tr_b16 a[86:87], v109 offset:9216
    ds_read_b64_tr_b16 a[24:25], v106 offset:16384
    ds_read_b64_tr_b16 a[26:27], v106 offset:17408
    ds_read_b64_tr_b16 a[28:29], v106 offset:24576
    ds_read_b64_tr_b16 a[30:31], v106 offset:25600
    ds_read_b64_tr_b16 a[88:89], v109 offset:16384
    ds_read_b64_tr_b16 a[90:91], v109 offset:17408
    ds_read_b64_tr_b16 a[92:93], v109 offset:24576
    ds_read_b64_tr_b16 a[94:95], v109 offset:25600
CHR_214:
    s_waitcnt lgkmcnt(0)
    s_barrier
    s_add_u32 s44, s20, 0x300000
    s_addc_u32 s45, s21, 0
    s_add_u32 m0, s28, 131072
    s_nop 0
    global_load_lds_dwordx4 v100, s[44:45]
    s_add_u32 s44, s20, 0x302000
    s_addc_u32 s45, s21, 0
    s_add_u32 m0, s28, 132096
    s_nop 0
    global_load_lds_dwordx4 v100, s[44:45]
    s_add_u32 s44, s20, 0x304000
    s_addc_u32 s45, s21, 0
    s_add_u32 m0, s28, 133120
    s_nop 0
    global_load_lds_dwordx4 v101, s[44:45]
    s_add_u32 s44, s20, 0x306000
    s_addc_u32 s45, s21, 0
    s_add_u32 m0, s28, 134144
    s_nop 0
    global_load_lds_dwordx4 v101, s[44:45]
    s_add_u32 s44, s20, 0x308000
    s_addc_u32 s45, s21, 0
    s_add_u32 m0, s28, 135168
    s_nop 0
    global_load_lds_dwordx4 v100, s[44:45]
    s_add_u32 s44, s20, 0x30a000
    s_addc_u32 s45, s21, 0
    s_add_u32 m0, s28, 136192
    s_nop 0
    global_load_lds_dwordx4 v100, s[44:45]
    s_add_u32 s44, s20, 0x30c000
    s_addc_u32 s45, s21, 0
    s_add_u32 m0, s28, 137216
    s_nop 0
    global_load_lds_dwordx4 v101, s[44:45]
    s_add_u32 s44, s20, 0x30e000
    s_addc_u32 s45, s21, 0
    s_add_u32 m0, s28, 138240
    s_nop 0
    global_load_lds_dwordx4 v101, s[44:45]
    global_load_dwordx4 v[96:99], v2, s[48:49] sc1
    global_load_dword v14, v15, s[40:41] sc1
    s_waitcnt vmcnt(18)
    s_waitcnt lgkmcnt(0)
    s_barrier
    s_cmp_lg_u32 s9, 0
    s_cbranch_scc1 CHR_220
    ds_read_b64_tr_b16 a[16:17], v104 offset:0
    ds_read_b64_tr_b16 a[18:19], v104 offset:1024
    ds_read_b64_tr_b16 a[20:21], v104 offset:8192
    ds_read_b64_tr_b16 a[22:23], v104 offset:9216
    ds_read_b64_tr_b16 a[80:81], v107 offset:0
    ds_read_b64_tr_b16 a[82:83], v107 offset:1024
    ds_read_b64_tr_b16 a[84:85], v107 offset:8192
    ds_read_b64_tr_b16 a[86:87], v107 offset:9216
    ds_read_b64_tr_b16 a[24:25], v104 offset:16384
    ds_read_b64_tr_b16 a[26:27], v104 offset:17408
    ds_read_b64_tr_b16 a[28:29], v104 offset:24576
    ds_read_b64_tr_b16 a[30:31], v104 offset:25600
    ds_read_b64_tr_b16 a[88:89], v107 offset:16384
    ds_read_b64_tr_b16 a[90:91], v107 offset:17408
    ds_read_b64_tr_b16 a[92:93], v107 offset:24576
    ds_read_b64_tr_b16 a[94:95], v107 offset:25600
    s_branch CHR_219
CHR_220:
    s_cmp_lg_u32 s9, 1
    s_cbranch_scc1 CHR_221
    ds_read_b64_tr_b16 a[0:1], v104 offset:0
    ds_read_b64_tr_b16 a[2:3], v104 offset:1024
    ds_read_b64_tr_b16 a[4:5], v104 offset:8192
    ds_read_b64_tr_b16 a[6:7], v104 offset:9216
    ds_read_b64_tr_b16 a[64:65], v107 offset:0
    ds_read_b64_tr_b16 a[66:67], v107 offset:1024
    ds_read_b64_tr_b16 a[68:69], v107 offset:8192
    ds_read_b64_tr_b16 a[70:71], v107 offset:9216
    ds_read_b64_tr_b16 a[8:9], v104 offset:16384
    ds_read_b64_tr_b16 a[10:11], v104 offset:17408
    ds_read_b64_tr_b16 a[12:13], v104 offset:24576
    ds_read_b64_tr_b16 a[14:15], v104 offset:25600
    ds_read_b64_tr_b16 a[72:73], v107 offset:16384
    ds_read_b64_tr_b16 a[74:75], v107 offset:17408
    ds_read_b64_tr_b16 a[76:77], v107 offset:24576
    ds_read_b64_tr_b16 a[78:79], v107 offset:25600
    s_branch CHR_219
CHR_221:
    s_cmp_lg_u32 s9, 2
    s_cbranch_scc1 CHR_222
    ds_read_b64_tr_b16 a[48:49], v104 offset:0
    ds_read_b64_tr_b16 a[50:51], v104 offset:1024
    ds_read_b64_tr_b16 a[52:53], v104 offset:8192
    ds_read_b64_tr_b16 a[54:55], v104 offset:9216
    ds_read_b64_tr_b16 a[112:113], v107 offset:0
    ds_read_b64_tr_b16 a[114:115], v107 offset:1024
    ds_read_b64_tr_b16 a[116:117], v107 offset:8192
    ds_read_b64_tr_b16 a[118:119], v107 offset:9216
    ds_read_b64_tr_b16 a[56:57], v104 offset:16384
    ds_read_b64_tr_b16 a[58:59], v104 offset:17408
    ds_read_b64_tr_b16 a[60:61], v104 offset:24576
    ds_read_b64_tr_b16 a[62:63], v104 offset:25600
    ds_read_b64_tr_b16 a[120:121], v107 offset:16384
    ds_read_b64_tr_b16 a[122:123], v107 offset:17408
    ds_read_b64_tr_b16 a[124:125], v107 offset:24576
    ds_read_b64_tr_b16 a[126:127], v107 offset:25600
    s_branch CHR_219
CHR_222:
    ds_read_b64_tr_b16 a[32:33], v104 offset:0
    ds_read_b64_tr_b16 a[34:35], v104 offset:1024
    ds_read_b64_tr_b16 a[36:37], v104 offset:8192
    ds_read_b64_tr_b16 a[38:39], v104 offset:9216
    ds_read_b64_tr_b16 a[96:97], v107 offset:0
    ds_read_b64_tr_b16 a[98:99], v107 offset:1024
    ds_read_b64_tr_b16 a[100:101], v107 offset:8192
    ds_read_b64_tr_b16 a[102:103], v107 offset:9216
    ds_read_b64_tr_b16 a[40:41], v104 offset:16384
    ds_read_b64_tr_b16 a[42:43], v104 offset:17408
    ds_read_b64_tr_b16 a[44:45], v104 offset:24576
    ds_read_b64_tr_b16 a[46:47], v104 offset:25600
    ds_read_b64_tr_b16 a[104:105], v107 offset:16384
    ds_read_b64_tr_b16 a[106:107], v107 offset:17408
    ds_read_b64_tr_b16 a[108:109], v107 offset:24576
    ds_read_b64_tr_b16 a[110:111], v107 offset:25600
CHR_219:
    s_waitcnt lgkmcnt(0)
    s_barrier
    s_add_u32 s14, s9, 0
    s_and_b32 s14, s14, 3
    s_lshl_b32 s14, s14, 15
    s_add_u32 s62, s26, s14
    s_addc_u32 s63, s27, 0
    s_add_u32 s44, s62, 0x0
    s_addc_u32 s45, s63, 0
    s_add_u32 m0, s28, 0
    s_nop 0
    global_load_lds_dwordx4 v102, s[44:45]
    s_add_u32 s44, s62, 0x4000
    s_addc_u32 s45, s63, 0
    s_add_u32 m0, s28, 1024
    s_nop 0
    global_load_lds_dwordx4 v102, s[44:45]
    s_add_u32 s44, s62, 0x1000
    s_addc_u32 s45, s63, 0
    s_add_u32 m0, s28, 2048
    s_nop 0
    global_load_lds_dwordx4 v102, s[44:45]
    s_add_u32 s44, s62, 0x5000
    s_addc_u32 s45, s63, 0
    s_add_u32 m0, s28, 3072
    s_nop 0
    global_load_lds_dwordx4 v102, s[44:45]
    s_add_u32 s44, s62, 0x2000
    s_addc_u32 s45, s63, 0
    s_add_u32 m0, s28, 4096
    s_nop 0
    global_load_lds_dwordx4 v102, s[44:45]
    s_add_u32 s44, s62, 0x6000
    s_addc_u32 s45, s63, 0
    s_add_u32 m0, s28, 5120
    s_nop 0
    global_load_lds_dwordx4 v102, s[44:45]
    s_add_u32 s44, s62, 0x3000
    s_addc_u32 s45, s63, 0
    s_add_u32 m0, s28, 6144
    s_nop 0
    global_load_lds_dwordx4 v102, s[44:45]
    s_add_u32 s44, s62, 0x7000
    s_addc_u32 s45, s63, 0
    s_add_u32 m0, s28, 7168
    s_nop 0
    global_load_lds_dwordx4 v102, s[44:45]
    s_waitcnt vmcnt(18)
    s_waitcnt lgkmcnt(0)
    s_barrier
    s_cmp_lg_u32 s9, 0
    s_cbranch_scc1 CHR_225
    ds_read_b64_tr_b16 a[32:33], v104 offset:32768
    ds_read_b64_tr_b16 a[34:35], v104 offset:33792
    ds_read_b64_tr_b16 a[36:37], v104 offset:40960
    ds_read_b64_tr_b16 a[38:39], v104 offset:41984
    ds_read_b64_tr_b16 a[96:97], v107 offset:32768
    ds_read_b64_tr_b16 a[98:99], v107 offset:33792
    ds_read_b64_tr_b16 a[100:101], v107 offset:40960
    ds_read_b64_tr_b16 a[102:103], v107 offset:41984
    ds_read_b64_tr_b16 a[40:41], v104 offset:49152
    ds_read_b64_tr_b16 a[42:43], v104 offset:50176
    ds_read_b64_tr_b16 a[44:45], v104 offset:57344
    ds_read_b64_tr_b16 a[46:47], v104 offset:58368
    ds_read_b64_tr_b16 a[104:105], v107 offset:49152
    ds_read_b64_tr_b16 a[106:107], v107 offset:50176
    ds_read_b64_tr_b16 a[108:109], v107 offset:57344
    ds_read_b64_tr_b16 a[110:111], v107 offset:58368
    s_branch CHR_224
CHR_225:
    s_cmp_lg_u32 s9, 1
    s_cbranch_scc1 CHR_226
    ds_read_b64_tr_b16 a[16:17], v104 offset:32768
    ds_read_b64_tr_b16 a[18:19], v104 offset:33792
    ds_read_b64_tr_b16 a[20:21], v104 offset:40960
    ds_read_b64_tr_b16 a[22:23], v104 offset:41984
    ds_read_b64_tr_b16 a[80:81], v107 offset:32768
    ds_read_b64_tr_b16 a[82:83], v107 offset:33792
    ds_read_b64_tr_b16 a[84:85], v107 offset:40960
    ds_read_b64_tr_b16 a[86:87], v107 offset:41984
    ds_read_b64_tr_b16 a[24:25], v104 offset:49152
    ds_read_b64_tr_b16 a[26:27], v104 offset:50176
    ds_read_b64_tr_b16 a[28:29], v104 offset:57344
    ds_read_b64_tr_b16 a[30:31], v104 offset:58368
    ds_read_b64_tr_b16 a[88:89], v107 offset:49152
    ds_read_b64_tr_b16 a[90:91], v107 offset:50176
    ds_read_b64_tr_b16 a[92:93], v107 offset:57344
    ds_read_b64_tr_b16 a[94:95], v107 offset:58368
    s_branch CHR_224
CHR_226:
    s_cmp_lg_u32 s9, 2
    s_cbranch_scc1 CHR_227
    ds_read_b64_tr_b16 a[0:1], v104 offset:32768
    ds_read_b64_tr_b16 a[2:3], v104 offset:33792
    ds_read_b64_tr_b16 a[4:5], v104 offset:40960
    ds_read_b64_tr_b16 a[6:7], v104 offset:41984
    ds_read_b64_tr_b16 a[64:65], v107 offset:32768
    ds_read_b64_tr_b16 a[66:67], v107 offset:33792
    ds_read_b64_tr_b16 a[68:69], v107 offset:40960
    ds_read_b64_tr_b16 a[70:71], v107 offset:41984
    ds_read_b64_tr_b16 a[8:9], v104 offset:49152
    ds_read_b64_tr_b16 a[10:11], v104 offset:50176
    ds_read_b64_tr_b16 a[12:13], v104 offset:57344
    ds_read_b64_tr_b16 a[14:15], v104 offset:58368
    ds_read_b64_tr_b16 a[72:73], v107 offset:49152
    ds_read_b64_tr_b16 a[74:75], v107 offset:50176
    ds_read_b64_tr_b16 a[76:77], v107 offset:57344
    ds_read_b64_tr_b16 a[78:79], v107 offset:58368
    s_branch CHR_224
CHR_227:
    ds_read_b64_tr_b16 a[48:49], v104 offset:32768
    ds_read_b64_tr_b16 a[50:51], v104 offset:33792
    ds_read_b64_tr_b16 a[52:53], v104 offset:40960
    ds_read_b64_tr_b16 a[54:55], v104 offset:41984
    ds_read_b64_tr_b16 a[112:113], v107 offset:32768
    ds_read_b64_tr_b16 a[114:115], v107 offset:33792
    ds_read_b64_tr_b16 a[116:117], v107 offset:40960
    ds_read_b64_tr_b16 a[118:119], v107 offset:41984
    ds_read_b64_tr_b16 a[56:57], v104 offset:49152
    ds_read_b64_tr_b16 a[58:59], v104 offset:50176
    ds_read_b64_tr_b16 a[60:61], v104 offset:57344
    ds_read_b64_tr_b16 a[62:63], v104 offset:58368
    ds_read_b64_tr_b16 a[120:121], v107 offset:49152
    ds_read_b64_tr_b16 a[122:123], v107 offset:50176
    ds_read_b64_tr_b16 a[124:125], v107 offset:57344
    ds_read_b64_tr_b16 a[126:127], v107 offset:58368
CHR_224:
    s_waitcnt lgkmcnt(0)
    s_barrier
    s_add_u32 s14, s9, 1
    s_and_b32 s14, s14, 3
    s_lshl_b32 s14, s14, 15
    s_add_u32 s62, s26, s14
    s_addc_u32 s63, s27, 0
    s_add_u32 s44, s62, 0x0
    s_addc_u32 s45, s63, 0
    s_add_u32 m0, s28, 32768
    s_nop 0
    global_load_lds_dwordx4 v102, s[44:45]
    s_add_u32 s44, s62, 0x4000
    s_addc_u32 s45, s63, 0
    s_add_u32 m0, s28, 33792
    s_nop 0
    global_load_lds_dwordx4 v102, s[44:45]
    s_add_u32 s44, s62, 0x1000
    s_addc_u32 s45, s63, 0
    s_add_u32 m0, s28, 34816
    s_nop 0
    global_load_lds_dwordx4 v102, s[44:45]
    s_add_u32 s44, s62, 0x5000
    s_addc_u32 s45, s63, 0
    s_add_u32 m0, s28, 35840
    s_nop 0
    global_load_lds_dwordx4 v102, s[44:45]
    s_add_u32 s44, s62, 0x2000
    s_addc_u32 s45, s63, 0
    s_add_u32 m0, s28, 36864
    s_nop 0
    global_load_lds_dwordx4 v102, s[44:45]
    s_add_u32 s44, s62, 0x6000
    s_addc_u32 s45, s63, 0
    s_add_u32 m0, s28, 37888
    s_nop 0
    global_load_lds_dwordx4 v102, s[44:45]
    s_add_u32 s44, s62, 0x3000
    s_addc_u32 s45, s63, 0
    s_add_u32 m0, s28, 38912
    s_nop 0
    global_load_lds_dwordx4 v102, s[44:45]
    s_add_u32 s44, s62, 0x7000
    s_addc_u32 s45, s63, 0
    s_add_u32 m0, s28, 39936
    s_nop 0
    global_load_lds_dwordx4 v102, s[44:45]
    s_waitcnt vmcnt(18)
    s_waitcnt lgkmcnt(0)
    s_barrier
    s_cmp_lg_u32 s9, 0
    s_cbranch_scc1 CHR_230
    ds_read_b64_tr_b16 a[48:49], v106 offset:0
    ds_read_b64_tr_b16 a[50:51], v106 offset:1024
    ds_read_b64_tr_b16 a[52:53], v106 offset:8192
    ds_read_b64_tr_b16 a[54:55], v106 offset:9216
    ds_read_b64_tr_b16 a[112:113], v109 offset:0
    ds_read_b64_tr_b16 a[114:115], v109 offset:1024
    ds_read_b64_tr_b16 a[116:117], v109 offset:8192
    ds_read_b64_tr_b16 a[118:119], v109 offset:9216
    ds_read_b64_tr_b16 a[56:57], v106 offset:16384
    ds_read_b64_tr_b16 a[58:59], v106 offset:17408
    ds_read_b64_tr_b16 a[60:61], v106 offset:24576
    ds_read_b64_tr_b16 a[62:63], v106 offset:25600
    ds_read_b64_tr_b16 a[120:121], v109 offset:16384
    ds_read_b64_tr_b16 a[122:123], v109 offset:17408
    ds_read_b64_tr_b16 a[124:125], v109 offset:24576
    ds_read_b64_tr_b16 a[126:127], v109 offset:25600
    s_branch CHR_229
CHR_230:
    s_cmp_lg_u32 s9, 1
    s_cbranch_scc1 CHR_231
    ds_read_b64_tr_b16 a[32:33], v106 offset:0
    ds_read_b64_tr_b16 a[34:35], v106 offset:1024
    ds_read_b64_tr_b16 a[36:37], v106 offset:8192
    ds_read_b64_tr_b16 a[38:39], v106 offset:9216
    ds_read_b64_tr_b16 a[96:97], v109 offset:0
    ds_read_b64_tr_b16 a[98:99], v109 offset:1024
    ds_read_b64_tr_b16 a[100:101], v109 offset:8192
    ds_read_b64_tr_b16 a[102:103], v109 offset:9216
    ds_read_b64_tr_b16 a[40:41], v106 offset:16384
    ds_read_b64_tr_b16 a[42:43], v106 offset:17408
    ds_read_b64_tr_b16 a[44:45], v106 offset:24576
    ds_read_b64_tr_b16 a[46:47], v106 offset:25600
    ds_read_b64_tr_b16 a[104:105], v109 offset:16384
    ds_read_b64_tr_b16 a[106:107], v109 offset:17408
    ds_read_b64_tr_b16 a[108:109], v109 offset:24576
    ds_read_b64_tr_b16 a[110:111], v109 offset:25600
    s_branch CHR_229
CHR_231:
    s_cmp_lg_u32 s9, 2
    s_cbranch_scc1 CHR_232
    ds_read_b64_tr_b16 a[16:17], v106 offset:0
    ds_read_b64_tr_b16 a[18:19], v106 offset:1024
    ds_read_b64_tr_b16 a[20:21], v106 offset:8192
    ds_read_b64_tr_b16 a[22:23], v106 offset:9216
    ds_read_b64_tr_b16 a[80:81], v109 offset:0
    ds_read_b64_tr_b16 a[82:83], v109 offset:1024
    ds_read_b64_tr_b16 a[84:85], v109 offset:8192
    ds_read_b64_tr_b16 a[86:87], v109 offset:9216
    ds_read_b64_tr_b16 a[24:25], v106 offset:16384
    ds_read_b64_tr_b16 a[26:27], v106 offset:17408
    ds_read_b64_tr_b16 a[28:29], v106 offset:24576
    ds_read_b64_tr_b16 a[30:31], v106 offset:25600
    ds_read_b64_tr_b16 a[88:89], v109 offset:16384
    ds_read_b64_tr_b16 a[90:91], v109 offset:17408
    ds_read_b64_tr_b16 a[92:93], v109 offset:24576
    ds_read_b64_tr_b16 a[94:95], v109 offset:25600
    s_branch CHR_229
CHR_232:
    ds_read_b64_tr_b16 a[0:1], v106 offset:0
    ds_read_b64_tr_b16 a[2:3], v106 offset:1024
    ds_read_b64_tr_b16 a[4:5], v106 offset:8192
    ds_read_b64_tr_b16 a[6:7], v106 offset:9216
    ds_read_b64_tr_b16 a[64:65], v109 offset:0
    ds_read_b64_tr_b16 a[66:67], v109 offset:1024
    ds_read_b64_tr_b16 a[68:69], v109 offset:8192
    ds_read_b64_tr_b16 a[70:71], v109 offset:9216
    ds_read_b64_tr_b16 a[8:9], v106 offset:16384
    ds_read_b64_tr_b16 a[10:11], v106 offset:17408
    ds_read_b64_tr_b16 a[12:13], v106 offset:24576
    ds_read_b64_tr_b16 a[14:15], v106 offset:25600
    ds_read_b64_tr_b16 a[72:73], v109 offset:16384
    ds_read_b64_tr_b16 a[74:75], v109 offset:17408
    ds_read_b64_tr_b16 a[76:77], v109 offset:24576
    ds_read_b64_tr_b16 a[78:79], v109 offset:25600
CHR_229:
    s_waitcnt vmcnt(8)
    s_waitcnt lgkmcnt(0)
    s_barrier
    v_cmp_ne_u32 s[54:55], s8, v14
    s_add_u32 s44, s38, 0x2000
    s_addc_u32 s45, s39, 0
    s_add_u32 s62, s38, 0x4000
    s_addc_u32 s63, s39, 0
    s_lshl_b32 s14, s9, 11
    s_add_u32 m0, s14, 139264
    s_nop 0
    global_load_lds_dwordx4 v7, s[44:45] offset:0 sc1
    s_add_u32 m0, s14, 140032
    s_nop 0
    global_load_lds_dwordx4 v7, s[44:45] offset:256 sc1
    s_add_u32 m0, s14, 147456
    s_nop 0
    global_load_lds_dwordx4 v7, s[62:63] offset:0 sc1
    s_add_u32 m0, s14, 148224
    s_nop 0
    global_load_lds_dwordx4 v7, s[62:63] offset:256 sc1
    global_load_dword v14, v15, s[40:41] offset:1024 sc1
    v_xor_b32 v112, 0, v111
    ds_read_b64_tr_b16 v[64:65], v112 offset:0
    ds_read_b64_tr_b16 v[68:69], v112 offset:4096
    v_xor_b32 v112, 128, v111
    ds_read_b64_tr_b16 v[66:67], v112 offset:512
    ds_read_b64_tr_b16 v[70:71], v112 offset:4608
    v_xor_b32 v112, 64, v111
    ds_read_b64_tr_b16 v[72:73], v112 offset:0
    ds_read_b64_tr_b16 v[76:77], v112 offset:4096
    v_xor_b32 v112, 192, v111
    ds_read_b64_tr_b16 v[74:75], v112 offset:512
    ds_read_b64_tr_b16 v[78:79], v112 offset:4608
    v_xor_b32 v112, 128, v111
    ds_read_b64_tr_b16 v[80:81], v112 offset:0
    ds_read_b64_tr_b16 v[84:85], v112 offset:4096
    v_xor_b32 v112, 0, v111
    ds_read_b64_tr_b16 v[82:83], v112 offset:512
    ds_read_b64_tr_b16 v[86:87], v112 offset:4608
    v_xor_b32 v112, 192, v111
    ds_read_b64_tr_b16 v[88:89], v112 offset:0
    ds_read_b64_tr_b16 v[92:93], v112 offset:4096
    v_xor_b32 v112, 64, v111
    ds_read_b64_tr_b16 v[90:91], v112 offset:512
    ds_read_b64_tr_b16 v[94:95], v112 offset:4608
    s_waitcnt lgkmcnt(0)
    ds_write_b128 v114, a[0:3] offset:0
    ds_write_b128 v114, a[4:7] offset:1024
    ds_write_b128 v114, a[64:67] offset:2048
    ds_write_b128 v114, a[68:71] offset:3072
    ds_write_b128 v114, a[8:11] offset:4096
    ds_write_b128 v114, a[12:15] offset:5120
    ds_write_b128 v114, a[72:75] offset:6144
    ds_write_b128 v114, a[76:79] offset:7168
    s_waitcnt lgkmcnt(0)
    v_accvgpr_write_b32 a0, v64
    v_accvgpr_write_b32 a1, v65
    v_accvgpr_write_b32 a2, v66
    v_accvgpr_write_b32 a3, v67
    v_accvgpr_write_b32 a4, v68
    v_accvgpr_write_b32 a5, v69
    v_accvgpr_write_b32 a6, v70
    v_accvgpr_write_b32 a7, v71
    v_accvgpr_write_b32 a64, v72
    v_accvgpr_write_b32 a65, v73
    v_accvgpr_write_b32 a66, v74
    v_accvgpr_write_b32 a67, v75
    v_accvgpr_write_b32 a68, v76
    v_accvgpr_write_b32 a69, v77
    v_accvgpr_write_b32 a70, v78
    v_accvgpr_write_b32 a71, v79
    v_accvgpr_write_b32 a8, v80
    v_accvgpr_write_b32 a9, v81
    v_accvgpr_write_b32 a10, v82
    v_accvgpr_write_b32 a11, v83
    v_accvgpr_write_b32 a12, v84
    v_accvgpr_write_b32 a13, v85
    v_accvgpr_write_b32 a14, v86
    v_accvgpr_write_b32 a15, v87
    v_accvgpr_write_b32 a72, v88
    v_accvgpr_write_b32 a73, v89
    v_accvgpr_write_b32 a74, v90
    v_accvgpr_write_b32 a75, v91
    v_accvgpr_write_b32 a76, v92
    v_accvgpr_write_b32 a77, v93
    v_accvgpr_write_b32 a78, v94
    v_accvgpr_write_b32 a79, v95
    s_waitcnt vmcnt(5)
    v_xor_b32 v112, 0, v111
    ds_read_b64_tr_b16 v[64:65], v112 offset:32768
    ds_read_b64_tr_b16 v[68:69], v112 offset:36864
    v_xor_b32 v112, 128, v111
    ds_read_b64_tr_b16 v[66:67], v112 offset:33280
    ds_read_b64_tr_b16 v[70:71], v112 offset:37376
    v_xor_b32 v112, 64, v111
    ds_read_b64_tr_b16 v[72:73], v112 offset:32768
    ds_read_b64_tr_b16 v[76:77], v112 offset:36864
    v_xor_b32 v112, 192, v111
    ds_read_b64_tr_b16 v[74:75], v112 offset:33280
    ds_read_b64_tr_b16 v[78:79], v112 offset:37376
    v_xor_b32 v112, 128, v111
    ds_read_b64_tr_b16 v[80:81], v112 offset:32768
    ds_read_b64_tr_b16 v[84:85], v112 offset:36864
    v_xor_b32 v112, 0, v111
    ds_read_b64_tr_b16 v[82:83], v112 offset:33280
    ds_read_b64_tr_b16 v[86:87], v112 offset:37376
    v_xor_b32 v112, 192, v111
    ds_read_b64_tr_b16 v[88:89], v112 offset:32768
    ds_read_b64_tr_b16 v[92:93], v112 offset:36864
    v_xor_b32 v112, 64, v111
    ds_read_b64_tr_b16 v[90:91], v112 offset:33280
    ds_read_b64_tr_b16 v[94:95], v112 offset:37376
    s_waitcnt lgkmcnt(0)
    ds_write_b128 v114, v[128:131] offset:32768
    ds_write_b128 v114, v[132:135] offset:33792
    ds_write_b128 v114, v[192:195] offset:34816
    ds_write_b128 v114, v[196:199] offset:35840
    ds_write_b128 v114, v[136:139] offset:36864
    ds_write_b128 v114, v[140:143] offset:37888
    ds_write_b128 v114, v[200:203] offset:38912
    ds_write_b128 v114, v[204:207] offset:39936
    s_waitcnt lgkmcnt(0)
    v_mov_b32 v128, v64
    v_mov_b32 v129, v65
    v_mov_b32 v130, v66
    v_mov_b32 v131, v67
    v_mov_b32 v132, v68
    v_mov_b32 v133, v69
    v_mov_b32 v134, v70
    v_mov_b32 v135, v71
    v_mov_b32 v192, v72
    v_mov_b32 v193, v73
    v_mov_b32 v194, v74
    v_mov_b32 v195, v75
    v_mov_b32 v196, v76
    v_mov_b32 v197, v77
    v_mov_b32 v198, v78
    v_mov_b32 v199, v79
    v_mov_b32 v136, v80
    v_mov_b32 v137, v81
    v_mov_b32 v138, v82
    v_mov_b32 v139, v83
    v_mov_b32 v140, v84
    v_mov_b32 v141, v85
    v_mov_b32 v142, v86
    v_mov_b32 v143, v87
    v_mov_b32 v200, v88
    v_mov_b32 v201, v89
    v_mov_b32 v202, v90
    v_mov_b32 v203, v91
    v_mov_b32 v204, v92
    v_mov_b32 v205, v93
    v_mov_b32 v206, v94
    v_mov_b32 v207, v95
    s_mov_b32 s20, 0xf000f
    s_mov_b32 s21, 0xf000f
    s_mov_b32 s22, 0xf000f0
    s_mov_b32 s23, 0xf000f0
    s_mov_b32 s24, 0xf000f00
    s_mov_b32 s25, 0xf000f00
    s_mov_b32 s26, 0xf000f000
    s_mov_b32 s27, 0xf000f000
    s_mov_b32 s12, 0
    s_branch CH_HS1
CH_HS:
    global_load_dwordx4 v[96:99], v2, s[48:49] sc1
    s_add_u32 s12, s12, 1
    s_mov_b32 s17, 8
    s_cmp_gt_u32 s12, 20000
    s_cbranch_scc1 TIMEOUT2
CH_HS1:
    s_waitcnt vmcnt(0)
    v_xor_b32 v96, s8, v96
    v_xor_b32 v98, s8, v98
    v_or_b32 v96, v96, v98
    v_cmp_ne_u32 vcc, 0, v96
    s_cbranch_vccnz CH_HS
    v_xor_b32 v97, s58, v97
    v_xor_b32 v99, s58, v99
    v_or_b32 v97, v97, v99
    v_cmp_ne_u32 s[60:61], 0, v97
    s_cmp_eq_u64 s[54:55], 0
    s_cbranch_scc1 CH_KV0
    s_mov_b32 s12, 0
POLL_234:
    global_load_dword v14, v15, s[40:41] offset:0 sc1
    s_add_u32 s12, s12, 1
    s_mov_b32 s17, 9
    s_cmp_gt_u32 s12, 20000
    s_cbranch_scc1 TIMEOUT2
    s_waitcnt vmcnt(0)
    v_cmp_ne_u32 vcc, s8, v14
    s_cbranch_vccnz POLL_234
    s_add_u32 s44, s38, 0x2000
    s_addc_u32 s45, s39, 0
    s_add_u32 s62, s38, 0x4000
    s_addc_u32 s63, s39, 0
    s_lshl_b32 s14, s9, 11
    s_add_u32 m0, s14, 139264
    s_nop 0
    global_load_lds_dwordx4 v7, s[44:45] offset:0 sc1
    s_add_u32 m0, s14, 140032
    s_nop 0
    global_load_lds_dwordx4 v7, s[44:45] offset:256 sc1
    s_add_u32 m0, s14, 147456
    s_nop 0
    global_load_lds_dwordx4 v7, s[62:63] offset:0 sc1
    s_add_u32 m0, s14, 148224
    s_nop 0
    global_load_lds_dwordx4 v7, s[62:63] offset:256 sc1
    global_load_dword v14, v15, s[40:41] offset:1024 sc1
CH_KV0:
    s_mov_b32 s29, 0
    s_mov_b32 s30, 0
    s_waitcnt vmcnt(0) lgkmcnt(0)
    v_mov_b32 v15, v16
    s_barrier
    s_cmp_lg_u64 s[60:61], 0
    s_mov_b32 s60, 0xcccccccc
    s_mov_b32 s61, 0xcccccccc
    s_cbranch_scc1 CH_SL
    s_cmp_eq_u32 s9, 1
    s_cbranch_scc1 CH_INf1
    s_cmp_eq_u32 s9, 2
    s_cbranch_scc1 CH_INf2
    s_cmp_eq_u32 s9, 3
    s_cbranch_scc1 CH_INf3
CH_INf0:
    ds_read_b128 v[104:107], v2 offset:32768
    ds_read_b128 v[108:111], v2 offset:33792
    ds_read_b128 v[112:115], v2 offset:34816
    ds_read_b128 v[116:119], v2 offset:35840
    ds_read_b128 v[120:123], v2 offset:36864
    ds_read_b128 v[124:127], v2 offset:37888
    ds_read_b128 v[64:67], v2 offset:38912
    ds_read_b128 v[68:71], v2 offset:39936
    v_mov_b64 v[72:73], 0
    v_mov_b64 v[74:75], 0
    v_mov_b64 v[76:77], 0
    v_mov_b64 v[78:79], 0
    v_mov_b64 v[80:81], 0
    v_mov_b64 v[82:83], 0
    v_mov_b64 v[84:85], 0
    v_mov_b64 v[86:87], 0
    v_mov_b64 v[88:89], 0
    v_mov_b64 v[90:91], 0
    v_mov_b64 v[92:93], 0
    v_mov_b64 v[94:95], 0
CH_LOOPf0:
    ds_read_b128 v[28:31], v25 offset:24576
    ds_read_b128 v[32:35], v2 offset:0
    ds_read_b128 v[36:39], v2 offset:1024
    ds_read_b128 v[40:43], v2 offset:2048
    ds_read_b128 v[44:47], v2 offset:3072
    ds_read_b128 v[48:51], v2 offset:4096
    ds_read_b128 v[52:55], v2 offset:5120
    ds_read_b128 v[56:59], v2 offset:6144
    ds_read_b128 v[60:63], v2 offset:7168
    ds_read_b128 v[16:19], v3 offset:16384
    ds_read_b128 v[20:23], v3 offset:17408
    s_add_u32 s44, s38, 0xa000
    s_addc_u32 s45, s39, 0
    s_add_u32 s62, s38, 0xc000
    s_addc_u32 s63, s39, 0
    s_waitcnt lgkmcnt(0)
    global_load_dwordx4 v[96:99], v2, s[42:43] sc1
    global_load_dwordx4 v[100:103], v2, s[42:43] offset:1024 sc1
    s_mov_b32 s12, 0
    s_waitcnt lgkmcnt(0)
    v_min_u32 v28, -2, v28
CH_PMf0:
    s_waitcnt vmcnt(0)
    ds_write_b128 v3, v[96:99] offset:0
    ds_write_b128 v3, v[100:103] offset:1024
    v_max3_u32 v0, v96, v97, v98
    v_max3_u32 v0, v0, v99, v100
    v_max3_u32 v0, v0, v101, v102
    v_max_u32 v0, v0, v103
    v_cmp_eq_u32 vcc, -1, v0
    v_smfmac_f32_16x16x64_bf16 v[88:91], v[96:99], v[104:111], v1
    v_smfmac_f32_16x16x64_bf16 v[92:95], v[96:99], v[112:119], v1
    s_cbranch_vccnz CH_RMf0
    v_smfmac_f32_16x16x64_bf16 v[88:91], v[100:103], v[120:127], v1
    v_smfmac_f32_16x16x64_bf16 v[92:95], v[100:103], v[64:71], v1
    v_smfmac_f32_16x16x64_bf16 v[72:75], v[96:99], v[32:39], v1
    s_cmp_eq_u32 s29, 63
    s_waitcnt lgkmcnt(0)
    s_barrier
    s_cbranch_scc1 CH_FINf0
    ds_read_b128 v[104:107], v3 offset:2048
    ds_read_b128 v[108:111], v3 offset:3072
    v_smfmac_f32_16x16x64_bf16 v[76:79], v[96:99], v[40:47], v1
    ds_read_b128 v[112:115], v3 offset:4096
    ds_read_b128 v[116:119], v3 offset:5120
    v_smfmac_f32_16x16x64_bf16 v[72:75], v[100:103], v[48:55], v1
    ds_read_b128 v[120:123], v3 offset:6144
    ds_read_b128 v[124:127], v3 offset:7168
    v_smfmac_f32_16x16x64_bf16 v[76:79], v[100:103], v[56:63], v1
    global_load_dword v14, v24, s[40:41] offset:1024 sc1
    v_smfmac_f32_16x16x64_bf16 v[80:83], v[96:99], a[128:135], v1
    v_smfmac_f32_16x16x64_bf16 v[84:87], v[96:99], a[192:199], v1
    global_store_dwordx4 v2, v[28:31], s[46:47] sc1
    v_smfmac_f32_16x16x64_bf16 v[80:83], v[100:103], a[136:143], v1
    s_add_u32 s46, s38, 0x6000
    s_addc_u32 s47, s39, 0
    v_smfmac_f32_16x16x64_bf16 v[84:87], v[100:103], a[200:207], v1
    s_waitcnt lgkmcnt(5)
    v_mov_b32 v28, 0x3f803f80
    v_smfmac_f32_16x16x64_bf16 v[72:75], v[104:107], a[16:23], v1
    ds_read_b128 v[32:35], v3 offset:8192
    v_mov_b32 v29, 0x3f803f80
    v_smfmac_f32_16x16x64_bf16 v[76:79], v[104:107], a[80:87], v1
    s_waitcnt lgkmcnt(5)
    ds_read_b128 v[36:39], v3 offset:10240
    v_mov_b32 v30, 0x3f803f80
    v_smfmac_f32_16x16x64_bf16 v[72:75], v[108:111], a[24:31], v1
    ds_read_b128 v[40:43], v3 offset:12288
    v_mov_b32 v31, 0x3f803f80
    v_smfmac_f32_16x16x64_bf16 v[76:79], v[108:111], a[88:95], v1
    s_waitcnt lgkmcnt(6)
    ds_read_b128 v[44:47], v3 offset:14336
    v_smfmac_f32_16x16x64_bf16 v[72:75], v[112:115], a[32:39], v1
    ds_read_b128 v[48:51], v3 offset:9216
    v_smfmac_f32_16x16x64_bf16 v[76:79], v[112:115], a[96:103], v1
    s_waitcnt lgkmcnt(7)
    ds_read_b128 v[52:55], v3 offset:11264
    v_smfmac_f32_16x16x64_bf16 v[72:75], v[116:119], a[40:47], v1
    ds_read_b128 v[56:59], v3 offset:13312
    v_smfmac_f32_16x16x64_bf16 v[76:79], v[116:119], a[104:111], v1
    s_waitcnt lgkmcnt(8)
    ds_read_b128 v[60:63], v3 offset:15360
    v_smfmac_f32_16x16x64_bf16 v[72:75], v[120:123], a[48:55], v1
    v_smfmac_f32_16x16x64_bf16 v[76:79], v[120:123], a[112:119], v1
    s_waitcnt lgkmcnt(8)
    v_smfmac_f32_16x16x64_bf16 v[72:75], v[124:127], a[56:63], v1
    v_smfmac_f32_16x16x64_bf16 v[76:79], v[124:127], a[120:127], v1
    v_smfmac_f32_16x16x64_bf16 v[80:83], v[104:107], a[144:151], v1
    v_add_f32 v72, v72, v73
    v_smfmac_f32_16x16x64_bf16 v[84:87], v[104:107], a[208:215], v1
    v_add_f32 v74, v74, v75
    v_smfmac_f32_16x16x64_bf16 v[80:83], v[108:111], a[152:159], v1
    v_add_f32 v76, v76, v77
    v_smfmac_f32_16x16x64_bf16 v[84:87], v[108:111], a[216:223], v1
    v_add_f32 v78, v78, v79
    v_smfmac_f32_16x16x64_bf16 v[80:83], v[112:115], a[160:167], v1
    v_cvt_pk_bf16_f32 v73, v72, v76
    v_smfmac_f32_16x16x64_bf16 v[84:87], v[112:115], a[224:231], v1
    v_cvt_pk_bf16_f32 v75, v74, v78
    v_smfmac_f32_16x16x64_bf16 v[80:83], v[116:119], a[168:175], v1
    ds_write2_b32 v5, v73, v75 offset0:8 offset1:12
    v_smfmac_f32_16x16x64_bf16 v[84:87], v[116:119], a[232:239], v1
    v_smfmac_f32_16x16x64_bf16 v[80:83], v[120:123], a[176:183], v1
    v_smfmac_f32_16x16x64_bf16 v[84:87], v[120:123], a[240:247], v1
    v_smfmac_f32_16x16x64_bf16 v[80:83], v[124:127], a[184:191], v1
    v_smfmac_f32_16x16x64_bf16 v[84:87], v[124:127], a[248:255], v1
    s_waitcnt vmcnt(2)
    s_waitcnt lgkmcnt(0)
    s_barrier
    ds_read_b128 v[72:75], v6 offset:24576
    v_smfmac_f32_16x16x64_bf16 v[88:91], v[104:107], v[144:151], v1
    s_mov_b32 m0, 139264
    ds_read_b128 v[76:79], v6 offset:25664
    v_add_f32 v80, v80, v81
    v_smfmac_f32_16x16x64_bf16 v[92:95], v[104:107], v[208:215], v1
    s_waitcnt vmcnt(1)
    v_cmp_ne_u32 s[54:55], s8, v14
    global_load_lds_dwordx4 v7, s[44:45] offset:0 sc1
    ds_read_b128 v[96:99], v6 offset:26752
    v_add_f32 v82, v82, v83
    v_smfmac_f32_16x16x64_bf16 v[88:91], v[108:111], v[152:159], v1
    s_mov_b32 m0, 140032
    ds_read_b128 v[100:103], v6 offset:27840
    v_add_f32 v84, v84, v85
    v_smfmac_f32_16x16x64_bf16 v[92:95], v[108:111], v[216:223], v1
    s_waitcnt lgkmcnt(3)
    global_load_lds_dwordx4 v7, s[44:45] offset:256 sc1
    v_add_f32 v86, v86, v87
    v_mfma_f32_16x16x32_bf16 v[64:67], v[32:35], v[72:75], 0
    s_mov_b32 m0, 147456
    s_waitcnt lgkmcnt(2)
    v_cvt_pk_bf16_f32 v81, v80, v84
    v_cvt_pk_bf16_f32 v83, v82, v86
    v_mfma_f32_16x16x32_bf16 v[64:67], v[36:39], v[76:79], v[64:67]
    s_waitcnt lgkmcnt(1)
    global_load_lds_dwordx4 v7, s[62:63] offset:0 sc1
    ds_write2_b32 v5, v81, v83 offset0:0 offset1:4
    v_mfma_f32_16x16x32_bf16 v[64:67], v[40:43], v[96:99], v[64:67]
    s_mov_b32 m0, 148224
    s_waitcnt lgkmcnt(1)
    v_mfma_f32_16x16x32_bf16 v[64:67], v[44:47], v[100:103], v[64:67]
    global_load_lds_dwordx4 v7, s[62:63] offset:256 sc1
    v_mfma_f32_16x16x32_bf16 v[68:71], v[48:51], v[72:75], 0
    v_mfma_f32_16x16x32_bf16 v[68:71], v[52:55], v[76:79], v[68:71]
    v_mfma_f32_16x16x32_bf16 v[68:71], v[56:59], v[96:99], v[68:71]
    s_waitcnt lgkmcnt(0)
    s_barrier
    ds_read_b128 v[32:35], v6 offset:24544
    v_mfma_f32_16x16x32_bf16 v[68:71], v[60:63], v[100:103], v[68:71]
    ds_read_b128 v[36:39], v6 offset:25632
    ds_read_b128 v[40:43], v6 offset:26720
    v_smfmac_f32_16x16x64_bf16 v[88:91], v[112:115], v[160:167], v1
    ds_read_b128 v[44:47], v6 offset:27808
    v_smfmac_f32_16x16x64_bf16 v[92:95], v[112:115], v[224:231], v1
    ds_read_b128 v[48:51], v4 offset:0
    v_max3_f32 v84, v64, v65, v66
    v_smfmac_f32_16x16x64_bf16 v[88:91], v[116:119], v[168:175], v1
    ds_read_b128 v[52:55], v4 offset:1024
    v_max3_f32 v84, v84, v67, v68
    v_smfmac_f32_16x16x64_bf16 v[92:95], v[116:119], v[232:239], v1
    s_waitcnt lgkmcnt(5)
    ds_read_b128 v[56:59], v4 offset:32768
    v_max3_f32 v84, v84, v69, v70
    v_mfma_f32_16x16x32_bf16 v[80:83], v[32:35], v[72:75], 0
    s_waitcnt lgkmcnt(5)
    ds_read_b128 v[60:63], v4 offset:33792
    v_max_f32 v84, v84, v71
    v_mfma_f32_16x16x32_bf16 v[80:83], v[36:39], v[76:79], v[80:83]
    s_waitcnt lgkmcnt(5)
    ds_read_b128 v[32:35], v4 offset:2048
    v_mfma_f32_16x16x32_bf16 v[80:83], v[40:43], v[96:99], v[80:83]
    s_waitcnt lgkmcnt(5)
    ds_read_b128 v[36:39], v4 offset:3072
    v_mfma_f32_16x16x32_bf16 v[80:83], v[44:47], v[100:103], v[80:83]
    ds_read_b128 v[72:75], v4 offset:34816
    v_smfmac_f32_16x16x64_bf16 v[88:91], v[120:123], v[176:183], v1
    ds_read_b128 v[76:79], v4 offset:35840
    v_smfmac_f32_16x16x64_bf16 v[92:95], v[120:123], v[240:247], v1
    ds_read_b128 v[40:43], v4 offset:4096
    v_max3_f32 v85, v84, v80, v81
    v_max3_f32 v84, v84, v80, v81
    v_smfmac_f32_16x16x64_bf16 v[88:91], v[124:127], v[184:191], v1
    ds_read_b128 v[44:47], v4 offset:5120
    v_permlane32_swap_b32 v84, v85
    v_max_f32 v84, v84, v85
    v_mov_b32 v85, v84
    v_smfmac_f32_16x16x64_bf16 v[92:95], v[124:127], v[248:255], v1
    ds_read_b128 v[96:99], v4 offset:36864
    v_permlane16_swap_b32 v84, v85
    v_max_f32 v84, v84, v85
    v_mul_f32 v86, 0xbe0293ee, v84
    v_pk_fma_f32 v[64:65], v[64:65], s[56:57], v[86:87] op_sel_hi:[1,0,0]
    v_pk_fma_f32 v[66:67], v[66:67], s[56:57], v[86:87] op_sel_hi:[1,0,0]
    v_pk_fma_f32 v[68:69], v[68:69], s[56:57], v[86:87] op_sel_hi:[1,0,0]
    v_pk_fma_f32 v[70:71], v[70:71], s[56:57], v[86:87] op_sel_hi:[1,0,0]
    v_pk_fma_f32 v[80:81], v[80:81], s[56:57], v[86:87] op_sel_hi:[1,0,0]
    v_mfma_f32_32x32x8_bf16 v[104:119], v[24:25], v[26:27], 0
    ds_read_b128 v[100:103], v4 offset:37888
    v_exp_f32 v64, v64
    v_exp_f32 v65, v65
    v_exp_f32 v66, v66
    v_exp_f32 v67, v67
    v_exp_f32 v68, v68
    v_exp_f32 v69, v69
    v_exp_f32 v70, v70
    v_exp_f32 v71, v71
    v_exp_f32 v80, v80
    v_exp_f32 v81, v81
    v_cvt_pk_bf16_f32 v84, v64, v65
    v_cvt_pk_bf16_f32 v85, v66, v67
    v_cvt_pk_bf16_f32 v86, v68, v69
    v_cvt_pk_bf16_f32 v87, v70, v71
    v_add_f32 v88, v88, v89
    v_add_f32 v90, v90, v91
    v_mfma_f32_16x16x32_bf16 v[120:123], v[16:19], v[84:87], 0
    v_cvt_pk_bf16_f32 v26, v80, v81
    v_cvt_pk_bf16_f32 v0, v88, v90
    v_mfma_f32_16x16x32_bf16 v[124:127], v[20:23], v[84:87], 0
    v_add_f32 v92, v92, v93
    v_add_f32 v94, v94, v95
    v_mfma_f32_16x16x16_bf16 v[120:123], v[0:1], v[26:27], v[120:123]
    v_cvt_pk_bf16_f32 v12, v92, v94
    s_add_u32 s38, s38, 0x8000
    s_addc_u32 s39, s39, 0
    v_mfma_f32_16x16x16_bf16 v[124:127], v[12:13], v[26:27], v[124:127]
    ds_read_b128 v[64:67], v4 offset:6144
    v_mfma_f32_16x16x32_bf16 v[80:83], v[84:87], v[28:31], 0
    v_cvt_pk_bf16_f32 v92, v120, v121
    v_cvt_pk_bf16_f32 v93, v122, v123
    v_mfma_f32_16x16x16_bf16 v[80:83], v[26:27], v[28:29], v[80:83]
    v_cvt_pk_bf16_f32 v94, v124, v125
    v_cvt_pk_bf16_f32 v95, v126, v127
    v_cndmask_b32 v88, v94, v92, s[60:61]
    v_cndmask_b32 v89, v95, v93, s[60:61]
    v_smfmac_f32_16x16x64_bf16 v[104:107], v[92:95], a[0:7], v1 abid:1
    ds_write_b64 v13, v[88:89] offset:4352
    v_smfmac_f32_16x16x64_bf16 v[108:111], v[92:95], a[64:71], v1 abid:1
    v_smfmac_f32_16x16x64_bf16 v[112:115], v[92:95], a[8:15], v1 abid:1
    v_smfmac_f32_16x16x64_bf16 v[116:119], v[92:95], a[72:79], v1 abid:1
    v_add_u32 v9, 0x2000, v9
    v_and_b32 v9, 0x7fff, v9
    s_waitcnt lgkmcnt(0)
    s_barrier
    ds_read_b128 v[16:19], v6 offset:28896
    ds_read_b128 v[20:23], v6 offset:30016
    ds_read_b128 v[88:91], v6 offset:29984
    ds_write2_b32 v13, v0, v12 offset0:0 offset1:1
    v_rcp_f32 v0, v82
    v_rcp_f32 v12, v83
    s_waitcnt lgkmcnt(3)
    v_smfmac_f32_16x16x64_bf16 v[104:107], v[16:19], v[128:135], v1 abid:1
    s_waitcnt lgkmcnt(2)
    ds_read_b128 v[68:71], v4 offset:7168
    v_smfmac_f32_16x16x64_bf16 v[104:107], v[20:23], v[48:55], v1 abid:1
    s_waitcnt lgkmcnt(2)
    ds_read_b128 v[120:123], v4 offset:38912
    v_smfmac_f32_16x16x64_bf16 v[104:107], v[88:91], v[56:63], v1 abid:1
    ds_read_b128 v[124:127], v4 offset:39936
    v_smfmac_f32_16x16x64_bf16 v[108:111], v[16:19], v[192:199], v1 abid:1
    v_smfmac_f32_16x16x64_bf16 v[108:111], v[20:23], v[32:39], v1 abid:1
    v_fma_mixlo_f16 v28, v104, v0, 0
    v_fma_mixlo_f16 v30, v105, v12, 0
    v_smfmac_f32_16x16x64_bf16 v[108:111], v[88:91], v[72:79], v1 abid:1
    v_and_or_b32 v28, v28, -2, s30
    v_fma_mixhi_f16 v28, v106, v0, 0
    v_smfmac_f32_16x16x64_bf16 v[112:115], v[16:19], v[136:143], v1 abid:1
    v_fma_mixhi_f16 v30, v107, v12, 0
    v_smfmac_f32_16x16x64_bf16 v[112:115], v[20:23], v[40:47], v1 abid:1
    v_fma_mixlo_f16 v29, v108, v0, 0
    v_fma_mixlo_f16 v31, v109, v12, 0
    v_smfmac_f32_16x16x64_bf16 v[112:115], v[88:91], v[96:103], v1 abid:1
    v_fma_mixhi_f16 v29, v110, v0, 0
    v_fma_mixhi_f16 v31, v111, v12, 0
    v_smfmac_f32_16x16x64_bf16 v[116:119], v[16:19], v[200:207], v1 abid:1
    s_waitcnt lgkmcnt(2)
    global_store_dwordx4 v8, v[28:31], s[34:35]
    v_smfmac_f32_16x16x64_bf16 v[116:119], v[20:23], v[64:71], v1 abid:1
    s_waitcnt lgkmcnt(0)
    v_fma_mixlo_f16 v84, v112, v0, 0
    v_fma_mixlo_f16 v86, v113, v12, 0
    v_smfmac_f32_16x16x64_bf16 v[116:119], v[88:91], v[120:127], v1 abid:1
    v_and_or_b32 v84, v84, -2, s30
    v_fma_mixhi_f16 v84, v114, v0, 0
    v_fma_mixhi_f16 v86, v115, v12, 0
    s_nop 4
    v_fma_mixlo_f16 v85, v116, v0, 0
    v_fma_mixlo_f16 v87, v117, v12, 0
    v_fma_mixhi_f16 v85, v118, v0, 0
    v_fma_mixhi_f16 v87, v119, v12, 0
    global_store_dwordx4 v8, v[84:87], s[50:51]
    s_cmp_lg_u64 s[54:55], 0
    s_cbranch_scc1 CH_KVf0
CH_KVRf0:
    ds_read_b128 v[104:107], v2 offset:32768
    ds_read_b128 v[108:111], v2 offset:33792
    ds_read_b128 v[112:115], v2 offset:34816
    ds_read_b128 v[116:119], v2 offset:35840
    ds_read_b128 v[120:123], v2 offset:36864
    ds_read_b128 v[124:127], v2 offset:37888
    ds_read_b128 v[64:67], v2 offset:38912
    ds_read_b128 v[68:71], v2 offset:39936
    s_add_u32 s40, s40, 0x400
    s_addc_u32 s41, s41, 0
    s_add_u32 s59, s59, 0x2000
    s_and_b32 s59, s59, 0x7fff
    s_add_u32 s42, s52, s59
    s_addc_u32 s43, s53, 0
    s_mov_b32 s12, 0
    s_add_u32 s29, s29, 1
    v_mov_b64 v[72:73], 0
    v_mov_b64 v[74:75], 0
    v_mov_b64 v[76:77], 0
    v_mov_b64 v[78:79], 0
    v_mov_b64 v[80:81], 0
    v_mov_b64 v[82:83], 0
    v_mov_b64 v[84:85], 0
    v_mov_b64 v[86:87], 0
    v_mov_b64 v[88:89], 0
    v_mov_b64 v[90:91], 0
    v_mov_b64 v[92:93], 0
    v_mov_b64 v[94:95], 0
    s_waitcnt lgkmcnt(0)
    global_load_dwordx4 v[32:35], v2, s[36:37] sc1
    global_load_dwordx4 v[36:39], v2, s[36:37] offset:1024 sc1
    v_cndmask_b32 v56, 0, v15, s[20:21]
    v_cndmask_b32 v57, 0, v15, s[22:23]
    v_cndmask_b32 v58, 0, v15, s[24:25]
    v_cndmask_b32 v59, 0, v15, s[26:27]
CH_PAf0:
    s_waitcnt vmcnt(0)
    s_nop 0
    v_mfma_f32_16x16x32_f16 v[60:63], v[56:59], v[32:35], 0
    v_xor_b32 v0, s30, v32
    v_bitop3_b32 v0, v0, v36, s30 bitop3:0xf6
    v_mfma_f32_16x16x32_f16 v[60:63], v[56:59], v[36:39], v[60:63]
    v_and_b32 v0, 1, v0
    v_cmp_ne_u32 vcc, 0, v0
    s_cbranch_vccnz CH_PAf0_R
CH_PJf0:
    s_nop 4
    v_add_f32_dpp v60, v60, v60 row_ror:8 row_mask:0xf bank_mask:0xf
    v_add_f32_dpp v61, v61, v61 row_ror:8 row_mask:0xf bank_mask:0xf
    s_xor_b32 s30, s30, 1
    v_add_f32_dpp v60, v60, v60 row_ror:4 row_mask:0xf bank_mask:0xf
    v_add_f32_dpp v61, v61, v61 row_ror:4 row_mask:0xf bank_mask:0xf
    v_cvt_pk_bf16_f32 v12, v60, v61
    v_med3_u32 v12, v12, v10, v11
    global_store_dword v9, v12, s[32:33]
    s_branch CH_LOOPf0
CH_PAf0_R:
    global_load_dwordx4 v[32:35], v2, s[36:37] sc1
    global_load_dwordx4 v[36:39], v2, s[36:37] offset:1024 sc1
    s_add_u32 s12, s12, 1
    s_mov_b32 s17, 7
    s_cmp_gt_u32 s12, 20000
    s_cbranch_scc1 TIMEOUT2
    s_branch CH_PAf0
CH_RMf0:
    global_load_dwordx4 v[96:99], v2, s[42:43] sc1
    global_load_dwordx4 v[100:103], v2, s[42:43] offset:1024 sc1
    s_add_u32 s12, s12, 1
    s_mov_b32 s17, 5
    s_cmp_gt_u32 s12, 20000
    s_cbranch_scc1 TIMEOUT2
    v_mov_b64 v[88:89], 0
    v_mov_b64 v[90:91], 0
    v_mov_b64 v[92:93], 0
    v_mov_b64 v[94:95], 0
    s_branch CH_PMf0
CH_KVf0:
    s_mov_b32 s12, 0
POLL_235:
    global_load_dword v0, v24, s[40:41] offset:1024 sc1
    s_add_u32 s12, s12, 1
    s_mov_b32 s17, 6
    s_cmp_gt_u32 s12, 20000
    s_cbranch_scc1 TIMEOUT2
    s_waitcnt vmcnt(0)
    v_cmp_ne_u32 vcc, s8, v0
    s_cbranch_vccnz POLL_235
    s_mov_b32 m0, 139264
    s_nop 0
    global_load_lds_dwordx4 v7, s[44:45] offset:0 sc1
    s_mov_b32 m0, 140032
    s_nop 0
    global_load_lds_dwordx4 v7, s[44:45] offset:256 sc1
    s_mov_b32 m0, 147456
    s_nop 0
    global_load_lds_dwordx4 v7, s[62:63] offset:0 sc1
    s_mov_b32 m0, 148224
    s_nop 0
    global_load_lds_dwordx4 v7, s[62:63] offset:256 sc1
    s_branch CH_KVRf0
CH_FINf0:
    ds_read_b128 v[104:107], v3 offset:2048
    ds_read_b128 v[108:111], v3 offset:3072
    ds_read_b128 v[112:115], v3 offset:4096
    ds_read_b128 v[116:119], v3 offset:5120
    ds_read_b128 v[120:123], v3 offset:6144
    ds_read_b128 v[124:127], v3 offset:7168
    global_store_dwordx4 v2, v[28:31], s[46:47] sc1
    v_smfmac_f32_16x16x64_bf16 v[80:83], v[96:99], a[128:135], v1
    v_smfmac_f32_16x16x64_bf16 v[84:87], v[96:99], a[192:199], v1
    v_smfmac_f32_16x16x64_bf16 v[80:83], v[100:103], a[136:143], v1
    v_smfmac_f32_16x16x64_bf16 v[84:87], v[100:103], a[200:207], v1
    s_add_u32 s46, s38, 0x6000
    s_addc_u32 s47, s39, 0
    s_waitcnt lgkmcnt(5)
    v_smfmac_f32_16x16x64_bf16 v[80:83], v[104:107], a[144:151], v1
    v_smfmac_f32_16x16x64_bf16 v[84:87], v[104:107], a[208:215], v1
    v_smfmac_f32_16x16x64_bf16 v[88:91], v[104:107], v[144:151], v1
    v_smfmac_f32_16x16x64_bf16 v[92:95], v[104:107], v[208:215], v1
    s_waitcnt lgkmcnt(4)
    v_smfmac_f32_16x16x64_bf16 v[80:83], v[108:111], a[152:159], v1
    v_smfmac_f32_16x16x64_bf16 v[84:87], v[108:111], a[216:223], v1
    v_smfmac_f32_16x16x64_bf16 v[88:91], v[108:111], v[152:159], v1
    v_smfmac_f32_16x16x64_bf16 v[92:95], v[108:111], v[216:223], v1
    s_waitcnt lgkmcnt(3)
    v_smfmac_f32_16x16x64_bf16 v[80:83], v[112:115], a[160:167], v1
    v_smfmac_f32_16x16x64_bf16 v[84:87], v[112:115], a[224:231], v1
    v_smfmac_f32_16x16x64_bf16 v[88:91], v[112:115], v[160:167], v1
    v_smfmac_f32_16x16x64_bf16 v[92:95], v[112:115], v[224:231], v1
    s_waitcnt lgkmcnt(2)
    v_smfmac_f32_16x16x64_bf16 v[80:83], v[116:119], a[168:175], v1
    v_smfmac_f32_16x16x64_bf16 v[84:87], v[116:119], a[232:239], v1
    v_smfmac_f32_16x16x64_bf16 v[88:91], v[116:119], v[168:175], v1
    v_smfmac_f32_16x16x64_bf16 v[92:95], v[116:119], v[232:239], v1
    s_waitcnt lgkmcnt(1)
    v_smfmac_f32_16x16x64_bf16 v[80:83], v[120:123], a[176:183], v1
    v_smfmac_f32_16x16x64_bf16 v[84:87], v[120:123], a[240:247], v1
    s_waitcnt lgkmcnt(0)
    v_smfmac_f32_16x16x64_bf16 v[80:83], v[124:127], a[184:191], v1
    v_smfmac_f32_16x16x64_bf16 v[84:87], v[124:127], a[248:255], v1
    v_smfmac_f32_16x16x64_bf16 v[88:91], v[120:123], v[176:183], v1
    v_smfmac_f32_16x16x64_bf16 v[92:95], v[120:123], v[240:247], v1
    v_smfmac_f32_16x16x64_bf16 v[88:91], v[124:127], v[184:191], v1
    v_add_f32 v80, v80, v81
    v_add_f32 v82, v82, v83
    v_smfmac_f32_16x16x64_bf16 v[92:95], v[124:127], v[248:255], v1
    v_add_f32 v84, v84, v85
    v_add_f32 v86, v86, v87
    v_cvt_pk_bf16_f32 v81, v80, v84
    v_cvt_pk_bf16_f32 v83, v82, v86
    ds_write2_b32 v5, v81, v83 offset0:0 offset1:4
    v_add_f32 v88, v88, v89
    v_add_f32 v90, v90, v91
    s_nop 0
    v_add_f32 v92, v92, v93
    v_add_f32 v94, v94, v95
    v_cvt_pk_bf16_f32 v0, v88, v90
    v_cvt_pk_bf16_f32 v12, v92, v94
    ds_write2_b32 v13, v0, v12 offset0:0 offset1:1
    s_waitcnt lgkmcnt(0)
    ds_read_b128 v[28:31], v25 offset:24576
    s_waitcnt lgkmcnt(0)
    v_min_u32 v28, -2, v28
    global_store_dwordx4 v2, v[28:31], s[46:47] sc1
    s_endpgm
CH_INf1:
    ds_read_b128 v[104:107], v2 offset:40960
    ds_read_b128 v[108:111], v2 offset:41984
    ds_read_b128 v[112:115], v2 offset:43008
    ds_read_b128 v[116:119], v2 offset:44032
    ds_read_b128 v[120:123], v2 offset:45056
    ds_read_b128 v[124:127], v2 offset:46080
    ds_read_b128 v[64:67], v2 offset:47104
    ds_read_b128 v[68:71], v2 offset:48128
    v_mov_b64 v[72:73], 0
    v_mov_b64 v[74:75], 0
    v_mov_b64 v[76:77], 0
    v_mov_b64 v[78:79], 0
    v_mov_b64 v[80:81], 0
    v_mov_b64 v[82:83], 0
    v_mov_b64 v[84:85], 0
    v_mov_b64 v[86:87], 0
    v_mov_b64 v[88:89], 0
    v_mov_b64 v[90:91], 0
    v_mov_b64 v[92:93], 0
    v_mov_b64 v[94:95], 0
CH_LOOPf1:
    ds_read_b128 v[28:31], v25 offset:25664
    ds_read_b128 v[32:35], v2 offset:8192
    ds_read_b128 v[36:39], v2 offset:9216
    ds_read_b128 v[40:43], v2 offset:10240
    ds_read_b128 v[44:47], v2 offset:11264
    ds_read_b128 v[48:51], v2 offset:12288
    ds_read_b128 v[52:55], v2 offset:13312
    ds_read_b128 v[56:59], v2 offset:14336
    ds_read_b128 v[60:63], v2 offset:15360
    ds_read_b128 v[16:19], v3 offset:18432
    ds_read_b128 v[20:23], v3 offset:19456
    s_add_u32 s44, s38, 0xa000
    s_addc_u32 s45, s39, 0
    s_add_u32 s62, s38, 0xc000
    s_addc_u32 s63, s39, 0
    s_waitcnt lgkmcnt(0)
    global_load_dwordx4 v[96:99], v2, s[42:43] sc1
    global_load_dwordx4 v[100:103], v2, s[42:43] offset:1024 sc1
    s_mov_b32 s12, 0
    s_waitcnt lgkmcnt(0)
    v_min_u32 v28, -2, v28
CH_PMf1:
    s_waitcnt vmcnt(0)
    ds_write_b128 v3, v[96:99] offset:2048
    ds_write_b128 v3, v[100:103] offset:3072
    v_max3_u32 v0, v96, v97, v98
    v_max3_u32 v0, v0, v99, v100
    v_max3_u32 v0, v0, v101, v102
    v_max_u32 v0, v0, v103
    v_cmp_eq_u32 vcc, -1, v0
    v_smfmac_f32_16x16x64_bf16 v[88:91], v[96:99], v[104:111], v1
    v_smfmac_f32_16x16x64_bf16 v[92:95], v[96:99], v[112:119], v1
    s_cbranch_vccnz CH_RMf1
    v_smfmac_f32_16x16x64_bf16 v[88:91], v[100:103], v[120:127], v1
    v_smfmac_f32_16x16x64_bf16 v[92:95], v[100:103], v[64:71], v1
    v_smfmac_f32_16x16x64_bf16 v[72:75], v[96:99], v[32:39], v1
    s_cmp_eq_u32 s29, 63
    s_waitcnt lgkmcnt(0)
    s_barrier
    s_cbranch_scc1 CH_FINf1
    ds_read_b128 v[104:107], v3 offset:4096
    ds_read_b128 v[108:111], v3 offset:5120
    v_smfmac_f32_16x16x64_bf16 v[76:79], v[96:99], v[40:47], v1
    ds_read_b128 v[112:115], v3 offset:6144
    ds_read_b128 v[116:119], v3 offset:7168
    v_smfmac_f32_16x16x64_bf16 v[72:75], v[100:103], v[48:55], v1
    ds_read_b128 v[120:123], v3 offset:0
    ds_read_b128 v[124:127], v3 offset:1024
    v_smfmac_f32_16x16x64_bf16 v[76:79], v[100:103], v[56:63], v1
    global_load_dword v14, v24, s[40:41] offset:1028 sc1
    v_smfmac_f32_16x16x64_bf16 v[80:83], v[96:99], a[128:135], v1
    v_smfmac_f32_16x16x64_bf16 v[84:87], v[96:99], a[192:199], v1
    global_store_dwordx4 v2, v[28:31], s[46:47] sc1
    v_smfmac_f32_16x16x64_bf16 v[80:83], v[100:103], a[136:143], v1
    s_add_u32 s46, s38, 0x6400
    s_addc_u32 s47, s39, 0
    v_smfmac_f32_16x16x64_bf16 v[84:87], v[100:103], a[200:207], v1
    s_waitcnt lgkmcnt(5)
    v_mov_b32 v28, 0x3f803f80
    v_smfmac_f32_16x16x64_bf16 v[72:75], v[104:107], a[16:23], v1
    ds_read_b128 v[32:35], v3 offset:8192
    v_mov_b32 v29, 0x3f803f80
    v_smfmac_f32_16x16x64_bf16 v[76:79], v[104:107], a[80:87], v1
    s_waitcnt lgkmcnt(5)
    ds_read_b128 v[36:39], v3 offset:10240
    v_mov_b32 v30, 0x3f803f80
    v_smfmac_f32_16x16x64_bf16 v[72:75], v[108:111], a[24:31], v1
    ds_read_b128 v[40:43], v3 offset:12288
    v_mov_b32 v31, 0x3f803f80
    v_smfmac_f32_16x16x64_bf16 v[76:79], v[108:111], a[88:95], v1
    s_waitcnt lgkmcnt(6)
    ds_read_b128 v[44:47], v3 offset:14336
    v_smfmac_f32_16x16x64_bf16 v[72:75], v[112:115], a[32:39], v1
    ds_read_b128 v[48:51], v3 offset:9216
    v_smfmac_f32_16x16x64_bf16 v[76:79], v[112:115], a[96:103], v1
    s_waitcnt lgkmcnt(7)
    ds_read_b128 v[52:55], v3 offset:11264
    v_smfmac_f32_16x16x64_bf16 v[72:75], v[116:119], a[40:47], v1
    ds_read_b128 v[56:59], v3 offset:13312
    v_smfmac_f32_16x16x64_bf16 v[76:79], v[116:119], a[104:111], v1
    s_waitcnt lgkmcnt(8)
    ds_read_b128 v[60:63], v3 offset:15360
    v_smfmac_f32_16x16x64_bf16 v[72:75], v[120:123], a[48:55], v1
    v_smfmac_f32_16x16x64_bf16 v[76:79], v[120:123], a[112:119], v1
    s_waitcnt lgkmcnt(8)
    v_smfmac_f32_16x16x64_bf16 v[72:75], v[124:127], a[56:63], v1
    v_smfmac_f32_16x16x64_bf16 v[76:79], v[124:127], a[120:127], v1
    v_smfmac_f32_16x16x64_bf16 v[80:83], v[104:107], a[144:151], v1
    v_add_f32 v72, v72, v73
    v_smfmac_f32_16x16x64_bf16 v[84:87], v[104:107], a[208:215], v1
    v_add_f32 v74, v74, v75
    v_smfmac_f32_16x16x64_bf16 v[80:83], v[108:111], a[152:159], v1
    v_add_f32 v76, v76, v77
    v_smfmac_f32_16x16x64_bf16 v[84:87], v[108:111], a[216:223], v1
    v_add_f32 v78, v78, v79
    v_smfmac_f32_16x16x64_bf16 v[80:83], v[112:115], a[160:167], v1
    v_cvt_pk_bf16_f32 v73, v72, v76
    v_smfmac_f32_16x16x64_bf16 v[84:87], v[112:115], a[224:231], v1
    v_cvt_pk_bf16_f32 v75, v74, v78
    v_smfmac_f32_16x16x64_bf16 v[80:83], v[116:119], a[168:175], v1
    ds_write2_b32 v5, v73, v75 offset0:8 offset1:12
    v_smfmac_f32_16x16x64_bf16 v[84:87], v[116:119], a[232:239], v1
    v_smfmac_f32_16x16x64_bf16 v[80:83], v[120:123], a[176:183], v1
    v_smfmac_f32_16x16x64_bf16 v[84:87], v[120:123], a[240:247], v1
    v_smfmac_f32_16x16x64_bf16 v[80:83], v[124:127], a[184:191], v1
    v_smfmac_f32_16x16x64_bf16 v[84:87], v[124:127], a[248:255], v1
    s_waitcnt vmcnt(2)
    s_waitcnt lgkmcnt(0)
    s_barrier
    ds_read_b128 v[72:75], v6 offset:24576
    v_smfmac_f32_16x16x64_bf16 v[88:91], v[104:107], v[144:151], v1
    s_mov_b32 m0, 141312
    ds_read_b128 v[76:79], v6 offset:25664
    v_add_f32 v80, v80, v81
    v_smfmac_f32_16x16x64_bf16 v[92:95], v[104:107], v[208:215], v1
    s_waitcnt vmcnt(1)
    v_cmp_ne_u32 s[54:55], s8, v14
    global_load_lds_dwordx4 v7, s[44:45] offset:0 sc1
    ds_read_b128 v[96:99], v6 offset:26752
    v_add_f32 v82, v82, v83
    v_smfmac_f32_16x16x64_bf16 v[88:91], v[108:111], v[152:159], v1
    s_mov_b32 m0, 142080
    ds_read_b128 v[100:103], v6 offset:27840
    v_add_f32 v84, v84, v85
    v_smfmac_f32_16x16x64_bf16 v[92:95], v[108:111], v[216:223], v1
    s_waitcnt lgkmcnt(3)
    global_load_lds_dwordx4 v7, s[44:45] offset:256 sc1
    v_add_f32 v86, v86, v87
    v_mfma_f32_16x16x32_bf16 v[64:67], v[32:35], v[72:75], 0
    s_mov_b32 m0, 149504
    s_waitcnt lgkmcnt(2)
    v_cvt_pk_bf16_f32 v81, v80, v84
    v_cvt_pk_bf16_f32 v83, v82, v86
    v_mfma_f32_16x16x32_bf16 v[64:67], v[36:39], v[76:79], v[64:67]
    s_waitcnt lgkmcnt(1)
    global_load_lds_dwordx4 v7, s[62:63] offset:0 sc1
    ds_write2_b32 v5, v81, v83 offset0:0 offset1:4
    v_mfma_f32_16x16x32_bf16 v[64:67], v[40:43], v[96:99], v[64:67]
    s_mov_b32 m0, 150272
    s_waitcnt lgkmcnt(1)
    v_mfma_f32_16x16x32_bf16 v[64:67], v[44:47], v[100:103], v[64:67]
    global_load_lds_dwordx4 v7, s[62:63] offset:256 sc1
    v_mfma_f32_16x16x32_bf16 v[68:71], v[48:51], v[72:75], 0
    v_mfma_f32_16x16x32_bf16 v[68:71], v[52:55], v[76:79], v[68:71]
    v_mfma_f32_16x16x32_bf16 v[68:71], v[56:59], v[96:99], v[68:71]
    s_waitcnt lgkmcnt(0)
    s_barrier
    ds_read_b128 v[32:35], v6 offset:24544
    v_mfma_f32_16x16x32_bf16 v[68:71], v[60:63], v[100:103], v[68:71]
    ds_read_b128 v[36:39], v6 offset:25632
    ds_read_b128 v[40:43], v6 offset:26720
    v_smfmac_f32_16x16x64_bf16 v[88:91], v[112:115], v[160:167], v1
    ds_read_b128 v[44:47], v6 offset:27808
    v_smfmac_f32_16x16x64_bf16 v[92:95], v[112:115], v[224:231], v1
    ds_read_b128 v[48:51], v4 offset:8192
    v_max3_f32 v84, v64, v65, v66
    v_smfmac_f32_16x16x64_bf16 v[88:91], v[116:119], v[168:175], v1
    ds_read_b128 v[52:55], v4 offset:9216
    v_max3_f32 v84, v84, v67, v68
    v_smfmac_f32_16x16x64_bf16 v[92:95], v[116:119], v[232:239], v1
    s_waitcnt lgkmcnt(5)
    ds_read_b128 v[56:59], v4 offset:40960
    v_max3_f32 v84, v84, v69, v70
    v_mfma_f32_16x16x32_bf16 v[80:83], v[32:35], v[72:75], 0
    s_waitcnt lgkmcnt(5)
    ds_read_b128 v[60:63], v4 offset:41984
    v_max_f32 v84, v84, v71
    v_mfma_f32_16x16x32_bf16 v[80:83], v[36:39], v[76:79], v[80:83]
    s_waitcnt lgkmcnt(5)
    ds_read_b128 v[32:35], v4 offset:10240
    v_mfma_f32_16x16x32_bf16 v[80:83], v[40:43], v[96:99], v[80:83]
    s_waitcnt lgkmcnt(5)
    ds_read_b128 v[36:39], v4 offset:11264
    v_mfma_f32_16x16x32_bf16 v[80:83], v[44:47], v[100:103], v[80:83]
    ds_read_b128 v[72:75], v4 offset:43008
    v_smfmac_f32_16x16x64_bf16 v[88:91], v[120:123], v[176:183], v1
    ds_read_b128 v[76:79], v4 offset:44032
    v_smfmac_f32_16x16x64_bf16 v[92:95], v[120:123], v[240:247], v1
    ds_read_b128 v[40:43], v4 offset:12288
    v_max3_f32 v85, v84, v80, v81
    v_max3_f32 v84, v84, v80, v81
    v_smfmac_f32_16x16x64_bf16 v[88:91], v[124:127], v[184:191], v1
    ds_read_b128 v[44:47], v4 offset:13312
    v_permlane32_swap_b32 v84, v85
    v_max_f32 v84, v84, v85
    v_mov_b32 v85, v84
    v_smfmac_f32_16x16x64_bf16 v[92:95], v[124:127], v[248:255], v1
    ds_read_b128 v[96:99], v4 offset:45056
    v_permlane16_swap_b32 v84, v85
    v_max_f32 v84, v84, v85
    v_mul_f32 v86, 0xbe0293ee, v84
    v_pk_fma_f32 v[64:65], v[64:65], s[56:57], v[86:87] op_sel_hi:[1,0,0]
    v_pk_fma_f32 v[66:67], v[66:67], s[56:57], v[86:87] op_sel_hi:[1,0,0]
    v_pk_fma_f32 v[68:69], v[68:69], s[56:57], v[86:87] op_sel_hi:[1,0,0]
    v_pk_fma_f32 v[70:71], v[70:71], s[56:57], v[86:87] op_sel_hi:[1,0,0]
    v_pk_fma_f32 v[80:81], v[80:81], s[56:57], v[86:87] op_sel_hi:[1,0,0]
    v_mfma_f32_32x32x8_bf16 v[104:119], v[24:25], v[26:27], 0
    ds_read_b128 v[100:103], v4 offset:46080
    v_exp_f32 v64, v64
    v_exp_f32 v65, v65
    v_exp_f32 v66, v66
    v_exp_f32 v67, v67
    v_exp_f32 v68, v68
    v_exp_f32 v69, v69
    v_exp_f32 v70, v70
    v_exp_f32 v71, v71
    v_exp_f32 v80, v80
    v_exp_f32 v81, v81
    v_cvt_pk_bf16_f32 v84, v64, v65
    v_cvt_pk_bf16_f32 v85, v66, v67
    v_cvt_pk_bf16_f32 v86, v68, v69
    v_cvt_pk_bf16_f32 v87, v70, v71
    v_add_f32 v88, v88, v89
    v_add_f32 v90, v90, v91
    v_mfma_f32_16x16x32_bf16 v[120:123], v[16:19], v[84:87], 0
    v_cvt_pk_bf16_f32 v26, v80, v81
    v_cvt_pk_bf16_f32 v0, v88, v90
    v_mfma_f32_16x16x32_bf16 v[124:127], v[20:23], v[84:87], 0
    v_add_f32 v92, v92, v93
    v_add_f32 v94, v94, v95
    v_mfma_f32_16x16x16_bf16 v[120:123], v[0:1], v[26:27], v[120:123]
    v_cvt_pk_bf16_f32 v12, v92, v94
    s_add_u32 s38, s38, 0x8000
    s_addc_u32 s39, s39, 0
    v_mfma_f32_16x16x16_bf16 v[124:127], v[12:13], v[26:27], v[124:127]
    ds_read_b128 v[64:67], v4 offset:14336
    v_mfma_f32_16x16x32_bf16 v[80:83], v[84:87], v[28:31], 0
    v_cvt_pk_bf16_f32 v92, v120, v121
    v_cvt_pk_bf16_f32 v93, v122, v123
    v_mfma_f32_16x16x16_bf16 v[80:83], v[26:27], v[28:29], v[80:83]
    v_cvt_pk_bf16_f32 v94, v124, v125
    v_cvt_pk_bf16_f32 v95, v126, v127
    v_cndmask_b32 v88, v94, v92, s[60:61]
    v_cndmask_b32 v89, v95, v93, s[60:61]
    v_smfmac_f32_16x16x64_bf16 v[104:107], v[92:95], a[0:7], v1 abid:1
    ds_write_b64 v13, v[88:89] offset:3232
    v_smfmac_f32_16x16x64_bf16 v[108:111], v[92:95], a[64:71], v1 abid:1
    v_smfmac_f32_16x16x64_bf16 v[112:115], v[92:95], a[8:15], v1 abid:1
    v_smfmac_f32_16x16x64_bf16 v[116:119], v[92:95], a[72:79], v1 abid:1
    v_add_u32 v9, 0x2000, v9
    v_and_b32 v9, 0x7fff, v9
    s_waitcnt lgkmcnt(0)
    s_barrier
    ds_read_b128 v[16:19], v6 offset:30016
    ds_read_b128 v[20:23], v6 offset:29984
    ds_read_b128 v[88:91], v6 offset:28928
    ds_write2_b32 v13, v0, v12 offset0:0 offset1:1
    v_rcp_f32 v0, v82
    v_rcp_f32 v12, v83
    s_waitcnt lgkmcnt(3)
    v_smfmac_f32_16x16x64_bf16 v[104:107], v[16:19], v[128:135], v1 abid:1
    s_waitcnt lgkmcnt(2)
    ds_read_b128 v[68:71], v4 offset:15360
    v_smfmac_f32_16x16x64_bf16 v[104:107], v[20:23], v[48:55], v1 abid:1
    s_waitcnt lgkmcnt(2)
    ds_read_b128 v[120:123], v4 offset:47104
    v_smfmac_f32_16x16x64_bf16 v[104:107], v[88:91], v[56:63], v1 abid:1
    ds_read_b128 v[124:127], v4 offset:48128
    v_smfmac_f32_16x16x64_bf16 v[108:111], v[16:19], v[192:199], v1 abid:1
    v_smfmac_f32_16x16x64_bf16 v[108:111], v[20:23], v[32:39], v1 abid:1
    v_fma_mixlo_f16 v28, v104, v0, 0
    v_fma_mixlo_f16 v30, v105, v12, 0
    v_smfmac_f32_16x16x64_bf16 v[108:111], v[88:91], v[72:79], v1 abid:1
    v_and_or_b32 v28, v28, -2, s30
    v_fma_mixhi_f16 v28, v106, v0, 0
    v_smfmac_f32_16x16x64_bf16 v[112:115], v[16:19], v[136:143], v1 abid:1
    v_fma_mixhi_f16 v30, v107, v12, 0
    v_smfmac_f32_16x16x64_bf16 v[112:115], v[20:23], v[40:47], v1 abid:1
    v_fma_mixlo_f16 v29, v108, v0, 0
    v_fma_mixlo_f16 v31, v109, v12, 0
    v_smfmac_f32_16x16x64_bf16 v[112:115], v[88:91], v[96:103], v1 abid:1
    v_fma_mixhi_f16 v29, v110, v0, 0
    v_fma_mixhi_f16 v31, v111, v12, 0
    v_smfmac_f32_16x16x64_bf16 v[116:119], v[16:19], v[200:207], v1 abid:1
    s_waitcnt lgkmcnt(2)
    global_store_dwordx4 v8, v[28:31], s[34:35]
    v_smfmac_f32_16x16x64_bf16 v[116:119], v[20:23], v[64:71], v1 abid:1
    s_waitcnt lgkmcnt(0)
    v_fma_mixlo_f16 v84, v112, v0, 0
    v_fma_mixlo_f16 v86, v113, v12, 0
    v_smfmac_f32_16x16x64_bf16 v[116:119], v[88:91], v[120:127], v1 abid:1
    v_and_or_b32 v84, v84, -2, s30
    v_fma_mixhi_f16 v84, v114, v0, 0
    v_fma_mixhi_f16 v86, v115, v12, 0
    s_nop 4
    v_fma_mixlo_f16 v85, v116, v0, 0
    v_fma_mixlo_f16 v87, v117, v12, 0
    v_fma_mixhi_f16 v85, v118, v0, 0
    v_fma_mixhi_f16 v87, v119, v12, 0
    global_store_dwordx4 v8, v[84:87], s[50:51]
    s_cmp_lg_u64 s[54:55], 0
    s_cbranch_scc1 CH_KVf1
CH_KVRf1:
    ds_read_b128 v[104:107], v2 offset:40960
    ds_read_b128 v[108:111], v2 offset:41984
    ds_read_b128 v[112:115], v2 offset:43008
    ds_read_b128 v[116:119], v2 offset:44032
    ds_read_b128 v[120:123], v2 offset:45056
    ds_read_b128 v[124:127], v2 offset:46080
    ds_read_b128 v[64:67], v2 offset:47104
    ds_read_b128 v[68:71], v2 offset:48128
    s_add_u32 s40, s40, 0x400
    s_addc_u32 s41, s41, 0
    s_add_u32 s59, s59, 0x2000
    s_and_b32 s59, s59, 0x7fff
    s_add_u32 s42, s52, s59
    s_addc_u32 s43, s53, 0
    s_mov_b32 s12, 0
    s_add_u32 s29, s29, 1
    v_mov_b64 v[72:73], 0
    v_mov_b64 v[74:75], 0
    v_mov_b64 v[76:77], 0
    v_mov_b64 v[78:79], 0
    v_mov_b64 v[80:81], 0
    v_mov_b64 v[82:83], 0
    v_mov_b64 v[84:85], 0
    v_mov_b64 v[86:87], 0
    v_mov_b64 v[88:89], 0
    v_mov_b64 v[90:91], 0
    v_mov_b64 v[92:93], 0
    v_mov_b64 v[94:95], 0
    s_waitcnt lgkmcnt(0)
    global_load_dwordx4 v[32:35], v2, s[36:37] sc1
    global_load_dwordx4 v[36:39], v2, s[36:37] offset:1024 sc1
    v_cndmask_b32 v56, 0, v15, s[20:21]
    v_cndmask_b32 v57, 0, v15, s[22:23]
    v_cndmask_b32 v58, 0, v15, s[24:25]
    v_cndmask_b32 v59, 0, v15, s[26:27]
CH_PAf1:
    s_waitcnt vmcnt(0)
    s_nop 0
    v_mfma_f32_16x16x32_f16 v[60:63], v[56:59], v[32:35], 0
    v_xor_b32 v0, s30, v32
    v_bitop3_b32 v0, v0, v36, s30 bitop3:0xf6
    v_mfma_f32_16x16x32_f16 v[60:63], v[56:59], v[36:39], v[60:63]
    v_and_b32 v0, 1, v0
    v_cmp_ne_u32 vcc, 0, v0
    s_cbranch_vccnz CH_PAf1_R
CH_PJf1:
    s_nop 4
    v_add_f32_dpp v60, v60, v60 row_ror:8 row_mask:0xf bank_mask:0xf
    v_add_f32_dpp v61, v61, v61 row_ror:8 row_mask:0xf bank_mask:0xf
    s_xor_b32 s30, s30, 1
    v_add_f32_dpp v60, v60, v60 row_ror:4 row_mask:0xf bank_mask:0xf
    v_add_f32_dpp v61, v61, v61 row_ror:4 row_mask:0xf bank_mask:0xf
    v_cvt_pk_bf16_f32 v12, v60, v61
    v_med3_u32 v12, v12, v10, v11
    global_store_dword v9, v12, s[32:33]
    s_branch CH_LOOPf1
CH_PAf1_R:
    global_load_dwordx4 v[32:35], v2, s[36:37] sc1
    global_load_dwordx4 v[36:39], v2, s[36:37] offset:1024 sc1
    s_add_u32 s12, s12, 1
    s_mov_b32 s17, 7
    s_cmp_gt_u32 s12, 20000
    s_cbranch_scc1 TIMEOUT2
    s_branch CH_PAf1
CH_RMf1:
    global_load_dwordx4 v[96:99], v2, s[42:43] sc1
    global_load_dwordx4 v[100:103], v2, s[42:43] offset:1024 sc1
    s_add_u32 s12, s12, 1
    s_mov_b32 s17, 5
    s_cmp_gt_u32 s12, 20000
    s_cbranch_scc1 TIMEOUT2
    v_mov_b64 v[88:89], 0
    v_mov_b64 v[90:91], 0
    v_mov_b64 v[92:93], 0
    v_mov_b64 v[94:95], 0
    s_branch CH_PMf1
CH_KVf1:
    s_mov_b32 s12, 0
POLL_236:
    global_load_dword v0, v24, s[40:41] offset:1028 sc1
    s_add_u32 s12, s12, 1
    s_mov_b32 s17, 6
    s_cmp_gt_u32 s12, 20000
    s_cbranch_scc1 TIMEOUT2
    s_waitcnt vmcnt(0)
    v_cmp_ne_u32 vcc, s8, v0
    s_cbranch_vccnz POLL_236
    s_mov_b32 m0, 141312
    s_nop 0
    global_load_lds_dwordx4 v7, s[44:45] offset:0 sc1
    s_mov_b32 m0, 142080
    s_nop 0
    global_load_lds_dwordx4 v7, s[44:45] offset:256 sc1
    s_mov_b32 m0, 149504
    s_nop 0
    global_load_lds_dwordx4 v7, s[62:63] offset:0 sc1
    s_mov_b32 m0, 150272
    s_nop 0
    global_load_lds_dwordx4 v7, s[62:63] offset:256 sc1
    s_branch CH_KVRf1
CH_FINf1:
    ds_read_b128 v[104:107], v3 offset:4096
    ds_read_b128 v[108:111], v3 offset:5120
    ds_read_b128 v[112:115], v3 offset:6144
    ds_read_b128 v[116:119], v3 offset:7168
    ds_read_b128 v[120:123], v3 offset:0
    ds_read_b128 v[124:127], v3 offset:1024
    global_store_dwordx4 v2, v[28:31], s[46:47] sc1
    v_smfmac_f32_16x16x64_bf16 v[80:83], v[96:99], a[128:135], v1
    v_smfmac_f32_16x16x64_bf16 v[84:87], v[96:99], a[192:199], v1
    v_smfmac_f32_16x16x64_bf16 v[80:83], v[100:103], a[136:143], v1
    v_smfmac_f32_16x16x64_bf16 v[84:87], v[100:103], a[200:207], v1
    s_add_u32 s46, s38, 0x6400
    s_addc_u32 s47, s39, 0
    s_waitcnt lgkmcnt(5)
    v_smfmac_f32_16x16x64_bf16 v[80:83], v[104:107], a[144:151], v1
    v_smfmac_f32_16x16x64_bf16 v[84:87], v[104:107], a[208:215], v1
    v_smfmac_f32_16x16x64_bf16 v[88:91], v[104:107], v[144:151], v1
    v_smfmac_f32_16x16x64_bf16 v[92:95], v[104:107], v[208:215], v1
    s_waitcnt lgkmcnt(4)
    v_smfmac_f32_16x16x64_bf16 v[80:83], v[108:111], a[152:159], v1
    v_smfmac_f32_16x16x64_bf16 v[84:87], v[108:111], a[216:223], v1
    v_smfmac_f32_16x16x64_bf16 v[88:91], v[108:111], v[152:159], v1
    v_smfmac_f32_16x16x64_bf16 v[92:95], v[108:111], v[216:223], v1
    s_waitcnt lgkmcnt(3)
    v_smfmac_f32_16x16x64_bf16 v[80:83], v[112:115], a[160:167], v1
    v_smfmac_f32_16x16x64_bf16 v[84:87], v[112:115], a[224:231], v1
    v_smfmac_f32_16x16x64_bf16 v[88:91], v[112:115], v[160:167], v1
    v_smfmac_f32_16x16x64_bf16 v[92:95], v[112:115], v[224:231], v1
    s_waitcnt lgkmcnt(2)
    v_smfmac_f32_16x16x64_bf16 v[80:83], v[116:119], a[168:175], v1
    v_smfmac_f32_16x16x64_bf16 v[84:87], v[116:119], a[232:239], v1
    v_smfmac_f32_16x16x64_bf16 v[88:91], v[116:119], v[168:175], v1
    v_smfmac_f32_16x16x64_bf16 v[92:95], v[116:119], v[232:239], v1
    s_waitcnt lgkmcnt(1)
    v_smfmac_f32_16x16x64_bf16 v[80:83], v[120:123], a[176:183], v1
    v_smfmac_f32_16x16x64_bf16 v[84:87], v[120:123], a[240:247], v1
    s_waitcnt lgkmcnt(0)
    v_smfmac_f32_16x16x64_bf16 v[80:83], v[124:127], a[184:191], v1
    v_smfmac_f32_16x16x64_bf16 v[84:87], v[124:127], a[248:255], v1
    v_smfmac_f32_16x16x64_bf16 v[88:91], v[120:123], v[176:183], v1
    v_smfmac_f32_16x16x64_bf16 v[92:95], v[120:123], v[240:247], v1
    v_smfmac_f32_16x16x64_bf16 v[88:91], v[124:127], v[184:191], v1
    v_add_f32 v80, v80, v81
    v_add_f32 v82, v82, v83
    v_smfmac_f32_16x16x64_bf16 v[92:95], v[124:127], v[248:255], v1
    v_add_f32 v84, v84, v85
    v_add_f32 v86, v86, v87
    v_cvt_pk_bf16_f32 v81, v80, v84
    v_cvt_pk_bf16_f32 v83, v82, v86
    ds_write2_b32 v5, v81, v83 offset0:0 offset1:4
    v_add_f32 v88, v88, v89
    v_add_f32 v90, v90, v91
    s_nop 0
    v_add_f32 v92, v92, v93
    v_add_f32 v94, v94, v95
    v_cvt_pk_bf16_f32 v0, v88, v90
    v_cvt_pk_bf16_f32 v12, v92, v94
    ds_write2_b32 v13, v0, v12 offset0:0 offset1:1
    s_waitcnt lgkmcnt(0)
    ds_read_b128 v[28:31], v25 offset:25664
    s_waitcnt lgkmcnt(0)
    v_min_u32 v28, -2, v28
    global_store_dwordx4 v2, v[28:31], s[46:47] sc1
    s_endpgm
CH_INf2:
    ds_read_b128 v[104:107], v2 offset:49152
    ds_read_b128 v[108:111], v2 offset:50176
    ds_read_b128 v[112:115], v2 offset:51200
    ds_read_b128 v[116:119], v2 offset:52224
    ds_read_b128 v[120:123], v2 offset:53248
    ds_read_b128 v[124:127], v2 offset:54272
    ds_read_b128 v[64:67], v2 offset:55296
    ds_read_b128 v[68:71], v2 offset:56320
    v_mov_b64 v[72:73], 0
    v_mov_b64 v[74:75], 0
    v_mov_b64 v[76:77], 0
    v_mov_b64 v[78:79], 0
    v_mov_b64 v[80:81], 0
    v_mov_b64 v[82:83], 0
    v_mov_b64 v[84:85], 0
    v_mov_b64 v[86:87], 0
    v_mov_b64 v[88:89], 0
    v_mov_b64 v[90:91], 0
    v_mov_b64 v[92:93], 0
    v_mov_b64 v[94:95], 0
CH_LOOPf2:
    ds_read_b128 v[28:31], v25 offset:26752
    ds_read_b128 v[32:35], v2 offset:16384
    ds_read_b128 v[36:39], v2 offset:17408
    ds_read_b128 v[40:43], v2 offset:18432
    ds_read_b128 v[44:47], v2 offset:19456
    ds_read_b128 v[48:51], v2 offset:20480
    ds_read_b128 v[52:55], v2 offset:21504
    ds_read_b128 v[56:59], v2 offset:22528
    ds_read_b128 v[60:63], v2 offset:23552
    ds_read_b128 v[16:19], v3 offset:20480
    ds_read_b128 v[20:23], v3 offset:21504
    s_add_u32 s44, s38, 0xa000
    s_addc_u32 s45, s39, 0
    s_add_u32 s62, s38, 0xc000
    s_addc_u32 s63, s39, 0
    s_waitcnt lgkmcnt(0)
    global_load_dwordx4 v[96:99], v2, s[42:43] sc1
    global_load_dwordx4 v[100:103], v2, s[42:43] offset:1024 sc1
    s_mov_b32 s12, 0
    s_waitcnt lgkmcnt(0)
    v_min_u32 v28, -2, v28
CH_PMf2:
    s_waitcnt vmcnt(0)
    ds_write_b128 v3, v[96:99] offset:4096
    ds_write_b128 v3, v[100:103] offset:5120
    v_max3_u32 v0, v96, v97, v98
    v_max3_u32 v0, v0, v99, v100
    v_max3_u32 v0, v0, v101, v102
    v_max_u32 v0, v0, v103
    v_cmp_eq_u32 vcc, -1, v0
    v_smfmac_f32_16x16x64_bf16 v[88:91], v[96:99], v[104:111], v1
    v_smfmac_f32_16x16x64_bf16 v[92:95], v[96:99], v[112:119], v1
    s_cbranch_vccnz CH_RMf2
    v_smfmac_f32_16x16x64_bf16 v[88:91], v[100:103], v[120:127], v1
    v_smfmac_f32_16x16x64_bf16 v[92:95], v[100:103], v[64:71], v1
    v_smfmac_f32_16x16x64_bf16 v[72:75], v[96:99], v[32:39], v1
    s_cmp_eq_u32 s29, 63
    s_waitcnt lgkmcnt(0)
    s_barrier
    s_cbranch_scc1 CH_FINf2
    ds_read_b128 v[104:107], v3 offset:6144
    ds_read_b128 v[108:111], v3 offset:7168
    v_smfmac_f32_16x16x64_bf16 v[76:79], v[96:99], v[40:47], v1
    ds_read_b128 v[112:115], v3 offset:0
    ds_read_b128 v[116:119], v3 offset:1024
    v_smfmac_f32_16x16x64_bf16 v[72:75], v[100:103], v[48:55], v1
    ds_read_b128 v[120:123], v3 offset:2048
    ds_read_b128 v[124:127], v3 offset:3072
    v_smfmac_f32_16x16x64_bf16 v[76:79], v[100:103], v[56:63], v1
    global_load_dword v14, v24, s[40:41] offset:1032 sc1
    v_smfmac_f32_16x16x64_bf16 v[80:83], v[96:99], a[128:135], v1
    v_smfmac_f32_16x16x64_bf16 v[84:87], v[96:99], a[192:199], v1
    global_store_dwordx4 v2, v[28:31], s[46:47] sc1
    v_smfmac_f32_16x16x64_bf16 v[80:83], v[100:103], a[136:143], v1
    s_add_u32 s46, s38, 0x6800
    s_addc_u32 s47, s39, 0
    v_smfmac_f32_16x16x64_bf16 v[84:87], v[100:103], a[200:207], v1
    s_waitcnt lgkmcnt(5)
    v_mov_b32 v28, 0x3f803f80
    v_smfmac_f32_16x16x64_bf16 v[72:75], v[104:107], a[16:23], v1
    ds_read_b128 v[32:35], v3 offset:8192
    v_mov_b32 v29, 0x3f803f80
    v_smfmac_f32_16x16x64_bf16 v[76:79], v[104:107], a[80:87], v1
    s_waitcnt lgkmcnt(5)
    ds_read_b128 v[36:39], v3 offset:10240
    v_mov_b32 v30, 0x3f803f80
    v_smfmac_f32_16x16x64_bf16 v[72:75], v[108:111], a[24:31], v1
    ds_read_b128 v[40:43], v3 offset:12288
    v_mov_b32 v31, 0x3f803f80
    v_smfmac_f32_16x16x64_bf16 v[76:79], v[108:111], a[88:95], v1
    s_waitcnt lgkmcnt(6)
    ds_read_b128 v[44:47], v3 offset:14336
    v_smfmac_f32_16x16x64_bf16 v[72:75], v[112:115], a[32:39], v1
    ds_read_b128 v[48:51], v3 offset:9216
    v_smfmac_f32_16x16x64_bf16 v[76:79], v[112:115], a[96:103], v1
    s_waitcnt lgkmcnt(7)
    ds_read_b128 v[52:55], v3 offset:11264
    v_smfmac_f32_16x16x64_bf16 v[72:75], v[116:119], a[40:47], v1
    ds_read_b128 v[56:59], v3 offset:13312
    v_smfmac_f32_16x16x64_bf16 v[76:79], v[116:119], a[104:111], v1
    s_waitcnt lgkmcnt(8)
    ds_read_b128 v[60:63], v3 offset:15360
    v_smfmac_f32_16x16x64_bf16 v[72:75], v[120:123], a[48:55], v1
    v_smfmac_f32_16x16x64_bf16 v[76:79], v[120:123], a[112:119], v1
    s_waitcnt lgkmcnt(8)
    v_smfmac_f32_16x16x64_bf16 v[72:75], v[124:127], a[56:63], v1
    v_smfmac_f32_16x16x64_bf16 v[76:79], v[124:127], a[120:127], v1
    v_smfmac_f32_16x16x64_bf16 v[80:83], v[104:107], a[144:151], v1
    v_add_f32 v72, v72, v73
    v_smfmac_f32_16x16x64_bf16 v[84:87], v[104:107], a[208:215], v1
    v_add_f32 v74, v74, v75
    v_smfmac_f32_16x16x64_bf16 v[80:83], v[108:111], a[152:159], v1
    v_add_f32 v76, v76, v77
    v_smfmac_f32_16x16x64_bf16 v[84:87], v[108:111], a[216:223], v1
    v_add_f32 v78, v78, v79
    v_smfmac_f32_16x16x64_bf16 v[80:83], v[112:115], a[160:167], v1
    v_cvt_pk_bf16_f32 v73, v72, v76
    v_smfmac_f32_16x16x64_bf16 v[84:87], v[112:115], a[224:231], v1
    v_cvt_pk_bf16_f32 v75, v74, v78
    v_smfmac_f32_16x16x64_bf16 v[80:83], v[116:119], a[168:175], v1
    ds_write2_b32 v5, v73, v75 offset0:8 offset1:12
    v_smfmac_f32_16x16x64_bf16 v[84:87], v[116:119], a[232:239], v1
    v_smfmac_f32_16x16x64_bf16 v[80:83], v[120:123], a[176:183], v1
    v_smfmac_f32_16x16x64_bf16 v[84:87], v[120:123], a[240:247], v1
    v_smfmac_f32_16x16x64_bf16 v[80:83], v[124:127], a[184:191], v1
    v_smfmac_f32_16x16x64_bf16 v[84:87], v[124:127], a[248:255], v1
    s_waitcnt vmcnt(2)
    s_waitcnt lgkmcnt(0)
    s_barrier
    ds_read_b128 v[72:75], v6 offset:24576
    v_smfmac_f32_16x16x64_bf16 v[88:91], v[104:107], v[144:151], v1
    s_mov_b32 m0, 143360
    ds_read_b128 v[76:79], v6 offset:25664
    v_add_f32 v80, v80, v81
    v_smfmac_f32_16x16x64_bf16 v[92:95], v[104:107], v[208:215], v1
    s_waitcnt vmcnt(1)
    v_cmp_ne_u32 s[54:55], s8, v14
    global_load_lds_dwordx4 v7, s[44:45] offset:0 sc1
    ds_read_b128 v[96:99], v6 offset:26752
    v_add_f32 v82, v82, v83
    v_smfmac_f32_16x16x64_bf16 v[88:91], v[108:111], v[152:159], v1
    s_mov_b32 m0, 144128
    ds_read_b128 v[100:103], v6 offset:27840
    v_add_f32 v84, v84, v85
    v_smfmac_f32_16x16x64_bf16 v[92:95], v[108:111], v[216:223], v1
    s_waitcnt lgkmcnt(3)
    global_load_lds_dwordx4 v7, s[44:45] offset:256 sc1
    v_add_f32 v86, v86, v87
    v_mfma_f32_16x16x32_bf16 v[64:67], v[32:35], v[72:75], 0
    s_mov_b32 m0, 151552
    s_waitcnt lgkmcnt(2)
    v_cvt_pk_bf16_f32 v81, v80, v84
    v_cvt_pk_bf16_f32 v83, v82, v86
    v_mfma_f32_16x16x32_bf16 v[64:67], v[36:39], v[76:79], v[64:67]
    s_waitcnt lgkmcnt(1)
    global_load_lds_dwordx4 v7, s[62:63] offset:0 sc1
    ds_write2_b32 v5, v81, v83 offset0:0 offset1:4
    v_mfma_f32_16x16x32_bf16 v[64:67], v[40:43], v[96:99], v[64:67]
    s_mov_b32 m0, 152320
    s_waitcnt lgkmcnt(1)
    v_mfma_f32_16x16x32_bf16 v[64:67], v[44:47], v[100:103], v[64:67]
    global_load_lds_dwordx4 v7, s[62:63] offset:256 sc1
    v_mfma_f32_16x16x32_bf16 v[68:71], v[48:51], v[72:75], 0
    v_mfma_f32_16x16x32_bf16 v[68:71], v[52:55], v[76:79], v[68:71]
    v_mfma_f32_16x16x32_bf16 v[68:71], v[56:59], v[96:99], v[68:71]
    s_waitcnt lgkmcnt(0)
    s_barrier
    ds_read_b128 v[32:35], v6 offset:24544
    v_mfma_f32_16x16x32_bf16 v[68:71], v[60:63], v[100:103], v[68:71]
    ds_read_b128 v[36:39], v6 offset:25632
    ds_read_b128 v[40:43], v6 offset:26720
    v_smfmac_f32_16x16x64_bf16 v[88:91], v[112:115], v[160:167], v1
    ds_read_b128 v[44:47], v6 offset:27808
    v_smfmac_f32_16x16x64_bf16 v[92:95], v[112:115], v[224:231], v1
    ds_read_b128 v[48:51], v4 offset:16384
    v_max3_f32 v84, v64, v65, v66
    v_smfmac_f32_16x16x64_bf16 v[88:91], v[116:119], v[168:175], v1
    ds_read_b128 v[52:55], v4 offset:17408
    v_max3_f32 v84, v84, v67, v68
    v_smfmac_f32_16x16x64_bf16 v[92:95], v[116:119], v[232:239], v1
    s_waitcnt lgkmcnt(5)
    ds_read_b128 v[56:59], v4 offset:49152
    v_max3_f32 v84, v84, v69, v70
    v_mfma_f32_16x16x32_bf16 v[80:83], v[32:35], v[72:75], 0
    s_waitcnt lgkmcnt(5)
    ds_read_b128 v[60:63], v4 offset:50176
    v_max_f32 v84, v84, v71
    v_mfma_f32_16x16x32_bf16 v[80:83], v[36:39], v[76:79], v[80:83]
    s_waitcnt lgkmcnt(5)
    ds_read_b128 v[32:35], v4 offset:18432
    v_mfma_f32_16x16x32_bf16 v[80:83], v[40:43], v[96:99], v[80:83]
    s_waitcnt lgkmcnt(5)
    ds_read_b128 v[36:39], v4 offset:19456
    v_mfma_f32_16x16x32_bf16 v[80:83], v[44:47], v[100:103], v[80:83]
    ds_read_b128 v[72:75], v4 offset:51200
    v_smfmac_f32_16x16x64_bf16 v[88:91], v[120:123], v[176:183], v1
    ds_read_b128 v[76:79], v4 offset:52224
    v_smfmac_f32_16x16x64_bf16 v[92:95], v[120:123], v[240:247], v1
    ds_read_b128 v[40:43], v4 offset:20480
    v_max3_f32 v85, v84, v80, v81
    v_max3_f32 v84, v84, v80, v81
    v_smfmac_f32_16x16x64_bf16 v[88:91], v[124:127], v[184:191], v1
    ds_read_b128 v[44:47], v4 offset:21504
    v_permlane32_swap_b32 v84, v85
    v_max_f32 v84, v84, v85
    v_mov_b32 v85, v84
    v_smfmac_f32_16x16x64_bf16 v[92:95], v[124:127], v[248:255], v1
    ds_read_b128 v[96:99], v4 offset:53248
    v_permlane16_swap_b32 v84, v85
    v_max_f32 v84, v84, v85
    v_mul_f32 v86, 0xbe0293ee, v84
    v_pk_fma_f32 v[64:65], v[64:65], s[56:57], v[86:87] op_sel_hi:[1,0,0]
    v_pk_fma_f32 v[66:67], v[66:67], s[56:57], v[86:87] op_sel_hi:[1,0,0]
    v_pk_fma_f32 v[68:69], v[68:69], s[56:57], v[86:87] op_sel_hi:[1,0,0]
    v_pk_fma_f32 v[70:71], v[70:71], s[56:57], v[86:87] op_sel_hi:[1,0,0]
    v_pk_fma_f32 v[80:81], v[80:81], s[56:57], v[86:87] op_sel_hi:[1,0,0]
    v_mfma_f32_32x32x8_bf16 v[104:119], v[24:25], v[26:27], 0
    ds_read_b128 v[100:103], v4 offset:54272
    v_exp_f32 v64, v64
    v_exp_f32 v65, v65
    v_exp_f32 v66, v66
    v_exp_f32 v67, v67
    v_exp_f32 v68, v68
    v_exp_f32 v69, v69
    v_exp_f32 v70, v70
    v_exp_f32 v71, v71
    v_exp_f32 v80, v80
    v_exp_f32 v81, v81
    v_cvt_pk_bf16_f32 v84, v64, v65
    v_cvt_pk_bf16_f32 v85, v66, v67
    v_cvt_pk_bf16_f32 v86, v68, v69
    v_cvt_pk_bf16_f32 v87, v70, v71
    v_add_f32 v88, v88, v89
    v_add_f32 v90, v90, v91
    v_mfma_f32_16x16x32_bf16 v[120:123], v[16:19], v[84:87], 0
    v_cvt_pk_bf16_f32 v26, v80, v81
    v_cvt_pk_bf16_f32 v0, v88, v90
    v_mfma_f32_16x16x32_bf16 v[124:127], v[20:23], v[84:87], 0
    v_add_f32 v92, v92, v93
    v_add_f32 v94, v94, v95
    v_mfma_f32_16x16x16_bf16 v[120:123], v[0:1], v[26:27], v[120:123]
    v_cvt_pk_bf16_f32 v12, v92, v94
    s_add_u32 s38, s38, 0x8000
    s_addc_u32 s39, s39, 0
    v_mfma_f32_16x16x16_bf16 v[124:127], v[12:13], v[26:27], v[124:127]
    ds_read_b128 v[64:67], v4 offset:22528
    v_mfma_f32_16x16x32_bf16 v[80:83], v[84:87], v[28:31], 0
    v_cvt_pk_bf16_f32 v92, v120, v121
    v_cvt_pk_bf16_f32 v93, v122, v123
    v_mfma_f32_16x16x16_bf16 v[80:83], v[26:27], v[28:29], v[80:83]
    v_cvt_pk_bf16_f32 v94, v124, v125
    v_cvt_pk_bf16_f32 v95, v126, v127
    v_cndmask_b32 v88, v94, v92, s[60:61]
    v_cndmask_b32 v89, v95, v93, s[60:61]
    v_smfmac_f32_16x16x64_bf16 v[104:107], v[92:95], a[0:7], v1 abid:1
    ds_write_b64 v13, v[88:89] offset:3264
    v_smfmac_f32_16x16x64_bf16 v[108:111], v[92:95], a[64:71], v1 abid:1
    v_smfmac_f32_16x16x64_bf16 v[112:115], v[92:95], a[8:15], v1 abid:1
    v_smfmac_f32_16x16x64_bf16 v[116:119], v[92:95], a[72:79], v1 abid:1
    v_add_u32 v9, 0x2000, v9
    v_and_b32 v9, 0x7fff, v9
    s_waitcnt lgkmcnt(0)
    s_barrier
    ds_read_b128 v[16:19], v6 offset:29984
    ds_read_b128 v[20:23], v6 offset:28928
    ds_read_b128 v[88:91], v6 offset:28896
    ds_write2_b32 v13, v0, v12 offset0:0 offset1:1
    v_rcp_f32 v0, v82
    v_rcp_f32 v12, v83
    s_waitcnt lgkmcnt(3)
    v_smfmac_f32_16x16x64_bf16 v[104:107], v[16:19], v[128:135], v1 abid:1
    s_waitcnt lgkmcnt(2)
    ds_read_b128 v[68:71], v4 offset:23552
    v_smfmac_f32_16x16x64_bf16 v[104:107], v[20:23], v[48:55], v1 abid:1
    s_waitcnt lgkmcnt(2)
    ds_read_b128 v[120:123], v4 offset:55296
    v_smfmac_f32_16x16x64_bf16 v[104:107], v[88:91], v[56:63], v1 abid:1
    ds_read_b128 v[124:127], v4 offset:56320
    v_smfmac_f32_16x16x64_bf16 v[108:111], v[16:19], v[192:199], v1 abid:1
    v_smfmac_f32_16x16x64_bf16 v[108:111], v[20:23], v[32:39], v1 abid:1
    v_fma_mixlo_f16 v28, v104, v0, 0
    v_fma_mixlo_f16 v30, v105, v12, 0
    v_smfmac_f32_16x16x64_bf16 v[108:111], v[88:91], v[72:79], v1 abid:1
    v_and_or_b32 v28, v28, -2, s30
    v_fma_mixhi_f16 v28, v106, v0, 0
    v_smfmac_f32_16x16x64_bf16 v[112:115], v[16:19], v[136:143], v1 abid:1
    v_fma_mixhi_f16 v30, v107, v12, 0
    v_smfmac_f32_16x16x64_bf16 v[112:115], v[20:23], v[40:47], v1 abid:1
    v_fma_mixlo_f16 v29, v108, v0, 0
    v_fma_mixlo_f16 v31, v109, v12, 0
    v_smfmac_f32_16x16x64_bf16 v[112:115], v[88:91], v[96:103], v1 abid:1
    v_fma_mixhi_f16 v29, v110, v0, 0
    v_fma_mixhi_f16 v31, v111, v12, 0
    v_smfmac_f32_16x16x64_bf16 v[116:119], v[16:19], v[200:207], v1 abid:1
    s_waitcnt lgkmcnt(2)
    global_store_dwordx4 v8, v[28:31], s[34:35]
    v_smfmac_f32_16x16x64_bf16 v[116:119], v[20:23], v[64:71], v1 abid:1
    s_waitcnt lgkmcnt(0)
    v_fma_mixlo_f16 v84, v112, v0, 0
    v_fma_mixlo_f16 v86, v113, v12, 0
    v_smfmac_f32_16x16x64_bf16 v[116:119], v[88:91], v[120:127], v1 abid:1
    v_and_or_b32 v84, v84, -2, s30
    v_fma_mixhi_f16 v84, v114, v0, 0
    v_fma_mixhi_f16 v86, v115, v12, 0
    s_nop 4
    v_fma_mixlo_f16 v85, v116, v0, 0
    v_fma_mixlo_f16 v87, v117, v12, 0
    v_fma_mixhi_f16 v85, v118, v0, 0
    v_fma_mixhi_f16 v87, v119, v12, 0
    global_store_dwordx4 v8, v[84:87], s[50:51]
    s_cmp_lg_u64 s[54:55], 0
    s_cbranch_scc1 CH_KVf2
CH_KVRf2:
    ds_read_b128 v[104:107], v2 offset:49152
    ds_read_b128 v[108:111], v2 offset:50176
    ds_read_b128 v[112:115], v2 offset:51200
    ds_read_b128 v[116:119], v2 offset:52224
    ds_read_b128 v[120:123], v2 offset:53248
    ds_read_b128 v[124:127], v2 offset:54272
    ds_read_b128 v[64:67], v2 offset:55296
    ds_read_b128 v[68:71], v2 offset:56320
    s_add_u32 s40, s40, 0x400
    s_addc_u32 s41, s41, 0
    s_add_u32 s59, s59, 0x2000
    s_and_b32 s59, s59, 0x7fff
    s_add_u32 s42, s52, s59
    s_addc_u32 s43, s53, 0
    s_mov_b32 s12, 0
    s_add_u32 s29, s29, 1
    v_mov_b64 v[72:73], 0
    v_mov_b64 v[74:75], 0
    v_mov_b64 v[76:77], 0
    v_mov_b64 v[78:79], 0
    v_mov_b64 v[80:81], 0
    v_mov_b64 v[82:83], 0
    v_mov_b64 v[84:85], 0
    v_mov_b64 v[86:87], 0
    v_mov_b64 v[88:89], 0
    v_mov_b64 v[90:91], 0
    v_mov_b64 v[92:93], 0
    v_mov_b64 v[94:95], 0
    s_waitcnt lgkmcnt(0)
    global_load_dwordx4 v[32:35], v2, s[36:37] sc1
    global_load_dwordx4 v[36:39], v2, s[36:37] offset:1024 sc1
    v_cndmask_b32 v56, 0, v15, s[20:21]
    v_cndmask_b32 v57, 0, v15, s[22:23]
    v_cndmask_b32 v58, 0, v15, s[24:25]
    v_cndmask_b32 v59, 0, v15, s[26:27]
CH_PAf2:
    s_waitcnt vmcnt(0)
    s_nop 0
    v_mfma_f32_16x16x32_f16 v[60:63], v[56:59], v[32:35], 0
    v_xor_b32 v0, s30, v32
    v_bitop3_b32 v0, v0, v36, s30 bitop3:0xf6
    v_mfma_f32_16x16x32_f16 v[60:63], v[56:59], v[36:39], v[60:63]
    v_and_b32 v0, 1, v0
    v_cmp_ne_u32 vcc, 0, v0
    s_cbranch_vccnz CH_PAf2_R
CH_PJf2:
    s_nop 4
    v_add_f32_dpp v60, v60, v60 row_ror:8 row_mask:0xf bank_mask:0xf
    v_add_f32_dpp v61, v61, v61 row_ror:8 row_mask:0xf bank_mask:0xf
    s_xor_b32 s30, s30, 1
    v_add_f32_dpp v60, v60, v60 row_ror:4 row_mask:0xf bank_mask:0xf
    v_add_f32_dpp v61, v61, v61 row_ror:4 row_mask:0xf bank_mask:0xf
    v_cvt_pk_bf16_f32 v12, v60, v61
    v_med3_u32 v12, v12, v10, v11
    global_store_dword v9, v12, s[32:33]
    s_branch CH_LOOPf2
CH_PAf2_R:
    global_load_dwordx4 v[32:35], v2, s[36:37] sc1
    global_load_dwordx4 v[36:39], v2, s[36:37] offset:1024 sc1
    s_add_u32 s12, s12, 1
    s_mov_b32 s17, 7
    s_cmp_gt_u32 s12, 20000
    s_cbranch_scc1 TIMEOUT2
    s_branch CH_PAf2
CH_RMf2:
    global_load_dwordx4 v[96:99], v2, s[42:43] sc1
    global_load_dwordx4 v[100:103], v2, s[42:43] offset:1024 sc1
    s_add_u32 s12, s12, 1
    s_mov_b32 s17, 5
    s_cmp_gt_u32 s12, 20000
    s_cbranch_scc1 TIMEOUT2
    v_mov_b64 v[88:89], 0
    v_mov_b64 v[90:91], 0
    v_mov_b64 v[92:93], 0
    v_mov_b64 v[94:95], 0
    s_branch CH_PMf2
CH_KVf2:
    s_mov_b32 s12, 0
POLL_237:
    global_load_dword v0, v24, s[40:41] offset:1032 sc1
    s_add_u32 s12, s12, 1
    s_mov_b32 s17, 6
    s_cmp_gt_u32 s12, 20000
    s_cbranch_scc1 TIMEOUT2
    s_waitcnt vmcnt(0)
    v_cmp_ne_u32 vcc, s8, v0
    s_cbranch_vccnz POLL_237
    s_mov_b32 m0, 143360
    s_nop 0
    global_load_lds_dwordx4 v7, s[44:45] offset:0 sc1
    s_mov_b32 m0, 144128
    s_nop 0
    global_load_lds_dwordx4 v7, s[44:45] offset:256 sc1
    s_mov_b32 m0, 151552
    s_nop 0
    global_load_lds_dwordx4 v7, s[62:63] offset:0 sc1
    s_mov_b32 m0, 152320
    s_nop 0
    global_load_lds_dwordx4 v7, s[62:63] offset:256 sc1
    s_branch CH_KVRf2
CH_FINf2:
    ds_read_b128 v[104:107], v3 offset:6144
    ds_read_b128 v[108:111], v3 offset:7168
    ds_read_b128 v[112:115], v3 offset:0
    ds_read_b128 v[116:119], v3 offset:1024
    ds_read_b128 v[120:123], v3 offset:2048
    ds_read_b128 v[124:127], v3 offset:3072
    global_store_dwordx4 v2, v[28:31], s[46:47] sc1
    v_smfmac_f32_16x16x64_bf16 v[80:83], v[96:99], a[128:135], v1
    v_smfmac_f32_16x16x64_bf16 v[84:87], v[96:99], a[192:199], v1
    v_smfmac_f32_16x16x64_bf16 v[80:83], v[100:103], a[136:143], v1
    v_smfmac_f32_16x16x64_bf16 v[84:87], v[100:103], a[200:207], v1
    s_add_u32 s46, s38, 0x6800
    s_addc_u32 s47, s39, 0
    s_waitcnt lgkmcnt(5)
    v_smfmac_f32_16x16x64_bf16 v[80:83], v[104:107], a[144:151], v1
    v_smfmac_f32_16x16x64_bf16 v[84:87], v[104:107], a[208:215], v1
    v_smfmac_f32_16x16x64_bf16 v[88:91], v[104:107], v[144:151], v1
    v_smfmac_f32_16x16x64_bf16 v[92:95], v[104:107], v[208:215], v1
    s_waitcnt lgkmcnt(4)
    v_smfmac_f32_16x16x64_bf16 v[80:83], v[108:111], a[152:159], v1
    v_smfmac_f32_16x16x64_bf16 v[84:87], v[108:111], a[216:223], v1
    v_smfmac_f32_16x16x64_bf16 v[88:91], v[108:111], v[152:159], v1
    v_smfmac_f32_16x16x64_bf16 v[92:95], v[108:111], v[216:223], v1
    s_waitcnt lgkmcnt(3)
    v_smfmac_f32_16x16x64_bf16 v[80:83], v[112:115], a[160:167], v1
    v_smfmac_f32_16x16x64_bf16 v[84:87], v[112:115], a[224:231], v1
    v_smfmac_f32_16x16x64_bf16 v[88:91], v[112:115], v[160:167], v1
    v_smfmac_f32_16x16x64_bf16 v[92:95], v[112:115], v[224:231], v1
    s_waitcnt lgkmcnt(2)
    v_smfmac_f32_16x16x64_bf16 v[80:83], v[116:119], a[168:175], v1
    v_smfmac_f32_16x16x64_bf16 v[84:87], v[116:119], a[232:239], v1
    v_smfmac_f32_16x16x64_bf16 v[88:91], v[116:119], v[168:175], v1
    v_smfmac_f32_16x16x64_bf16 v[92:95], v[116:119], v[232:239], v1
    s_waitcnt lgkmcnt(1)
    v_smfmac_f32_16x16x64_bf16 v[80:83], v[120:123], a[176:183], v1
    v_smfmac_f32_16x16x64_bf16 v[84:87], v[120:123], a[240:247], v1
    s_waitcnt lgkmcnt(0)
    v_smfmac_f32_16x16x64_bf16 v[80:83], v[124:127], a[184:191], v1
    v_smfmac_f32_16x16x64_bf16 v[84:87], v[124:127], a[248:255], v1
    v_smfmac_f32_16x16x64_bf16 v[88:91], v[120:123], v[176:183], v1
    v_smfmac_f32_16x16x64_bf16 v[92:95], v[120:123], v[240:247], v1
    v_smfmac_f32_16x16x64_bf16 v[88:91], v[124:127], v[184:191], v1
    v_add_f32 v80, v80, v81
    v_add_f32 v82, v82, v83
    v_smfmac_f32_16x16x64_bf16 v[92:95], v[124:127], v[248:255], v1
    v_add_f32 v84, v84, v85
    v_add_f32 v86, v86, v87
    v_cvt_pk_bf16_f32 v81, v80, v84
    v_cvt_pk_bf16_f32 v83, v82, v86
    ds_write2_b32 v5, v81, v83 offset0:0 offset1:4
    v_add_f32 v88, v88, v89
    v_add_f32 v90, v90, v91
    s_nop 0
    v_add_f32 v92, v92, v93
    v_add_f32 v94, v94, v95
    v_cvt_pk_bf16_f32 v0, v88, v90
    v_cvt_pk_bf16_f32 v12, v92, v94
    ds_write2_b32 v13, v0, v12 offset0:0 offset1:1
    s_waitcnt lgkmcnt(0)
    ds_read_b128 v[28:31], v25 offset:26752
    s_waitcnt lgkmcnt(0)
    v_min_u32 v28, -2, v28
    global_store_dwordx4 v2, v[28:31], s[46:47] sc1
    s_endpgm
CH_INf3:
    ds_read_b128 v[104:107], v2 offset:57344
    ds_read_b128 v[108:111], v2 offset:58368
    ds_read_b128 v[112:115], v2 offset:59392
    ds_read_b128 v[116:119], v2 offset:60416
    ds_read_b128 v[120:123], v2 offset:61440
    ds_read_b128 v[124:127], v2 offset:62464
    ds_read_b128 v[64:67], v2 offset:63488
    ds_read_b128 v[68:71], v2 offset:64512
    v_mov_b64 v[72:73], 0
    v_mov_b64 v[74:75], 0
    v_mov_b64 v[76:77], 0
    v_mov_b64 v[78:79], 0
    v_mov_b64 v[80:81], 0
    v_mov_b64 v[82:83], 0
    v_mov_b64 v[84:85], 0
    v_mov_b64 v[86:87], 0
    v_mov_b64 v[88:89], 0
    v_mov_b64 v[90:91], 0
    v_mov_b64 v[92:93], 0
    v_mov_b64 v[94:95], 0
CH_LOOPf3:
    ds_read_b128 v[28:31], v25 offset:27840
    ds_read_b128 v[32:35], v2 offset:24576
    ds_read_b128 v[36:39], v2 offset:25600
    ds_read_b128 v[40:43], v2 offset:26624
    ds_read_b128 v[44:47], v2 offset:27648
    ds_read_b128 v[48:51], v2 offset:28672
    ds_read_b128 v[52:55], v2 offset:29696
    ds_read_b128 v[56:59], v2 offset:30720
    ds_read_b128 v[60:63], v2 offset:31744
    ds_read_b128 v[16:19], v3 offset:22528
    ds_read_b128 v[20:23], v3 offset:23552
    s_add_u32 s44, s38, 0xa000
    s_addc_u32 s45, s39, 0
    s_add_u32 s62, s38, 0xc000
    s_addc_u32 s63, s39, 0
    s_waitcnt lgkmcnt(0)
    global_load_dwordx4 v[96:99], v2, s[42:43] sc1
    global_load_dwordx4 v[100:103], v2, s[42:43] offset:1024 sc1
    s_mov_b32 s12, 0
    s_waitcnt lgkmcnt(0)
    v_min_u32 v28, -2, v28
CH_PMf3:
    s_waitcnt vmcnt(0)
    ds_write_b128 v3, v[96:99] offset:6144
    ds_write_b128 v3, v[100:103] offset:7168
    v_max3_u32 v0, v96, v97, v98
    v_max3_u32 v0, v0, v99, v100
    v_max3_u32 v0, v0, v101, v102
    v_max_u32 v0, v0, v103
    v_cmp_eq_u32 vcc, -1, v0
    v_smfmac_f32_16x16x64_bf16 v[88:91], v[96:99], v[104:111], v1
    v_smfmac_f32_16x16x64_bf16 v[92:95], v[96:99], v[112:119], v1
    s_cbranch_vccnz CH_RMf3
    v_smfmac_f32_16x16x64_bf16 v[88:91], v[100:103], v[120:127], v1
    v_smfmac_f32_16x16x64_bf16 v[92:95], v[100:103], v[64:71], v1
    v_smfmac_f32_16x16x64_bf16 v[72:75], v[96:99], v[32:39], v1
    s_cmp_eq_u32 s29, 63
    s_waitcnt lgkmcnt(0)
    s_barrier
    s_cbranch_scc1 CH_FINf3
    ds_read_b128 v[104:107], v3 offset:0
    ds_read_b128 v[108:111], v3 offset:1024
    v_smfmac_f32_16x16x64_bf16 v[76:79], v[96:99], v[40:47], v1
    ds_read_b128 v[112:115], v3 offset:2048
    ds_read_b128 v[116:119], v3 offset:3072
    v_smfmac_f32_16x16x64_bf16 v[72:75], v[100:103], v[48:55], v1
    ds_read_b128 v[120:123], v3 offset:4096
    ds_read_b128 v[124:127], v3 offset:5120
    v_smfmac_f32_16x16x64_bf16 v[76:79], v[100:103], v[56:63], v1
    global_load_dword v14, v24, s[40:41] offset:1036 sc1
    v_smfmac_f32_16x16x64_bf16 v[80:83], v[96:99], a[128:135], v1
    v_smfmac_f32_16x16x64_bf16 v[84:87], v[96:99], a[192:199], v1
    global_store_dwordx4 v2, v[28:31], s[46:47] sc1
    v_smfmac_f32_16x16x64_bf16 v[80:83], v[100:103], a[136:143], v1
    s_add_u32 s46, s38, 0x6c00
    s_addc_u32 s47, s39, 0
    v_smfmac_f32_16x16x64_bf16 v[84:87], v[100:103], a[200:207], v1
    s_waitcnt lgkmcnt(5)
    v_mov_b32 v28, 0x3f803f80
    v_smfmac_f32_16x16x64_bf16 v[72:75], v[104:107], a[16:23], v1
    ds_read_b128 v[32:35], v3 offset:8192
    v_mov_b32 v29, 0x3f803f80
    v_smfmac_f32_16x16x64_bf16 v[76:79], v[104:107], a[80:87], v1
    s_waitcnt lgkmcnt(5)
    ds_read_b128 v[36:39], v3 offset:10240
    v_mov_b32 v30, 0x3f803f80
    v_smfmac_f32_16x16x64_bf16 v[72:75], v[108:111], a[24:31], v1
    ds_read_b128 v[40:43], v3 offset:12288
    v_mov_b32 v31, 0x3f803f80
    v_smfmac_f32_16x16x64_bf16 v[76:79], v[108:111], a[88:95], v1
    s_waitcnt lgkmcnt(6)
    ds_read_b128 v[44:47], v3 offset:14336
    v_smfmac_f32_16x16x64_bf16 v[72:75], v[112:115], a[32:39], v1
    ds_read_b128 v[48:51], v3 offset:9216
    v_smfmac_f32_16x16x64_bf16 v[76:79], v[112:115], a[96:103], v1
    s_waitcnt lgkmcnt(7)
    ds_read_b128 v[52:55], v3 offset:11264
    v_smfmac_f32_16x16x64_bf16 v[72:75], v[116:119], a[40:47], v1
    ds_read_b128 v[56:59], v3 offset:13312
    v_smfmac_f32_16x16x64_bf16 v[76:79], v[116:119], a[104:111], v1
    s_waitcnt lgkmcnt(8)
    ds_read_b128 v[60:63], v3 offset:15360
    v_smfmac_f32_16x16x64_bf16 v[72:75], v[120:123], a[48:55], v1
    v_smfmac_f32_16x16x64_bf16 v[76:79], v[120:123], a[112:119], v1
    s_waitcnt lgkmcnt(8)
    v_smfmac_f32_16x16x64_bf16 v[72:75], v[124:127], a[56:63], v1
    v_smfmac_f32_16x16x64_bf16 v[76:79], v[124:127], a[120:127], v1
    v_smfmac_f32_16x16x64_bf16 v[80:83], v[104:107], a[144:151], v1
    v_add_f32 v72, v72, v73
    v_smfmac_f32_16x16x64_bf16 v[84:87], v[104:107], a[208:215], v1
    v_add_f32 v74, v74, v75
    v_smfmac_f32_16x16x64_bf16 v[80:83], v[108:111], a[152:159], v1
    v_add_f32 v76, v76, v77
    v_smfmac_f32_16x16x64_bf16 v[84:87], v[108:111], a[216:223], v1
    v_add_f32 v78, v78, v79
    v_smfmac_f32_16x16x64_bf16 v[80:83], v[112:115], a[160:167], v1
    v_cvt_pk_bf16_f32 v73, v72, v76
    v_smfmac_f32_16x16x64_bf16 v[84:87], v[112:115], a[224:231], v1
    v_cvt_pk_bf16_f32 v75, v74, v78
    v_smfmac_f32_16x16x64_bf16 v[80:83], v[116:119], a[168:175], v1
    ds_write2_b32 v5, v73, v75 offset0:8 offset1:12
    v_smfmac_f32_16x16x64_bf16 v[84:87], v[116:119], a[232:239], v1
    v_smfmac_f32_16x16x64_bf16 v[80:83], v[120:123], a[176:183], v1
    v_smfmac_f32_16x16x64_bf16 v[84:87], v[120:123], a[240:247], v1
    v_smfmac_f32_16x16x64_bf16 v[80:83], v[124:127], a[184:191], v1
    v_smfmac_f32_16x16x64_bf16 v[84:87], v[124:127], a[248:255], v1
    s_waitcnt vmcnt(2)
    s_waitcnt lgkmcnt(0)
    s_barrier
    ds_read_b128 v[72:75], v6 offset:24576
    v_smfmac_f32_16x16x64_bf16 v[88:91], v[104:107], v[144:151], v1
    s_mov_b32 m0, 145408
    ds_read_b128 v[76:79], v6 offset:25664
    v_add_f32 v80, v80, v81
    v_smfmac_f32_16x16x64_bf16 v[92:95], v[104:107], v[208:215], v1
    s_waitcnt vmcnt(1)
    v_cmp_ne_u32 s[54:55], s8, v14
    global_load_lds_dwordx4 v7, s[44:45] offset:0 sc1
    ds_read_b128 v[96:99], v6 offset:26752
    v_add_f32 v82, v82, v83
    v_smfmac_f32_16x16x64_bf16 v[88:91], v[108:111], v[152:159], v1
    s_mov_b32 m0, 146176
    ds_read_b128 v[100:103], v6 offset:27840
    v_add_f32 v84, v84, v85
    v_smfmac_f32_16x16x64_bf16 v[92:95], v[108:111], v[216:223], v1
    s_waitcnt lgkmcnt(3)
    global_load_lds_dwordx4 v7, s[44:45] offset:256 sc1
    v_add_f32 v86, v86, v87
    v_mfma_f32_16x16x32_bf16 v[64:67], v[32:35], v[72:75], 0
    s_mov_b32 m0, 153600
    s_waitcnt lgkmcnt(2)
    v_cvt_pk_bf16_f32 v81, v80, v84
    v_cvt_pk_bf16_f32 v83, v82, v86
    v_mfma_f32_16x16x32_bf16 v[64:67], v[36:39], v[76:79], v[64:67]
    s_waitcnt lgkmcnt(1)
    global_load_lds_dwordx4 v7, s[62:63] offset:0 sc1
    ds_write2_b32 v5, v81, v83 offset0:0 offset1:4
    v_mfma_f32_16x16x32_bf16 v[64:67], v[40:43], v[96:99], v[64:67]
    s_mov_b32 m0, 154368
    s_waitcnt lgkmcnt(1)
    v_mfma_f32_16x16x32_bf16 v[64:67], v[44:47], v[100:103], v[64:67]
    global_load_lds_dwordx4 v7, s[62:63] offset:256 sc1
    v_mfma_f32_16x16x32_bf16 v[68:71], v[48:51], v[72:75], 0
    v_mfma_f32_16x16x32_bf16 v[68:71], v[52:55], v[76:79], v[68:71]
    v_mfma_f32_16x16x32_bf16 v[68:71], v[56:59], v[96:99], v[68:71]
    s_waitcnt lgkmcnt(0)
    s_barrier
    ds_read_b128 v[32:35], v6 offset:24544
    v_mfma_f32_16x16x32_bf16 v[68:71], v[60:63], v[100:103], v[68:71]
    ds_read_b128 v[36:39], v6 offset:25632
    ds_read_b128 v[40:43], v6 offset:26720
    v_smfmac_f32_16x16x64_bf16 v[88:91], v[112:115], v[160:167], v1
    ds_read_b128 v[44:47], v6 offset:27808
    v_smfmac_f32_16x16x64_bf16 v[92:95], v[112:115], v[224:231], v1
    ds_read_b128 v[48:51], v4 offset:24576
    v_max3_f32 v84, v64, v65, v66
    v_smfmac_f32_16x16x64_bf16 v[88:91], v[116:119], v[168:175], v1
    ds_read_b128 v[52:55], v4 offset:25600
    v_max3_f32 v84, v84, v67, v68
    v_smfmac_f32_16x16x64_bf16 v[92:95], v[116:119], v[232:239], v1
    s_waitcnt lgkmcnt(5)
    ds_read_b128 v[56:59], v4 offset:57344
    v_max3_f32 v84, v84, v69, v70
    v_mfma_f32_16x16x32_bf16 v[80:83], v[32:35], v[72:75], 0
    s_waitcnt lgkmcnt(5)
    ds_read_b128 v[60:63], v4 offset:58368
    v_max_f32 v84, v84, v71
    v_mfma_f32_16x16x32_bf16 v[80:83], v[36:39], v[76:79], v[80:83]
    s_waitcnt lgkmcnt(5)
    ds_read_b128 v[32:35], v4 offset:26624
    v_mfma_f32_16x16x32_bf16 v[80:83], v[40:43], v[96:99], v[80:83]
    s_waitcnt lgkmcnt(5)
    ds_read_b128 v[36:39], v4 offset:27648
    v_mfma_f32_16x16x32_bf16 v[80:83], v[44:47], v[100:103], v[80:83]
    ds_read_b128 v[72:75], v4 offset:59392
    v_smfmac_f32_16x16x64_bf16 v[88:91], v[120:123], v[176:183], v1
    ds_read_b128 v[76:79], v4 offset:60416
    v_smfmac_f32_16x16x64_bf16 v[92:95], v[120:123], v[240:247], v1
    ds_read_b128 v[40:43], v4 offset:28672
    v_max3_f32 v85, v84, v80, v81
    v_max3_f32 v84, v84, v80, v81
    v_smfmac_f32_16x16x64_bf16 v[88:91], v[124:127], v[184:191], v1
    ds_read_b128 v[44:47], v4 offset:29696
    v_permlane32_swap_b32 v84, v85
    v_max_f32 v84, v84, v85
    v_mov_b32 v85, v84
    v_smfmac_f32_16x16x64_bf16 v[92:95], v[124:127], v[248:255], v1
    ds_read_b128 v[96:99], v4 offset:61440
    v_permlane16_swap_b32 v84, v85
    v_max_f32 v84, v84, v85
    v_mul_f32 v86, 0xbe0293ee, v84
    v_pk_fma_f32 v[64:65], v[64:65], s[56:57], v[86:87] op_sel_hi:[1,0,0]
    v_pk_fma_f32 v[66:67], v[66:67], s[56:57], v[86:87] op_sel_hi:[1,0,0]
    v_pk_fma_f32 v[68:69], v[68:69], s[56:57], v[86:87] op_sel_hi:[1,0,0]
    v_pk_fma_f32 v[70:71], v[70:71], s[56:57], v[86:87] op_sel_hi:[1,0,0]
    v_pk_fma_f32 v[80:81], v[80:81], s[56:57], v[86:87] op_sel_hi:[1,0,0]
    v_mfma_f32_32x32x8_bf16 v[104:119], v[24:25], v[26:27], 0
    ds_read_b128 v[100:103], v4 offset:62464
    v_exp_f32 v64, v64
    v_exp_f32 v65, v65
    v_exp_f32 v66, v66
    v_exp_f32 v67, v67
    v_exp_f32 v68, v68
    v_exp_f32 v69, v69
    v_exp_f32 v70, v70
    v_exp_f32 v71, v71
    v_exp_f32 v80, v80
    v_exp_f32 v81, v81
    v_cvt_pk_bf16_f32 v84, v64, v65
    v_cvt_pk_bf16_f32 v85, v66, v67
    v_cvt_pk_bf16_f32 v86, v68, v69
    v_cvt_pk_bf16_f32 v87, v70, v71
    v_add_f32 v88, v88, v89
    v_add_f32 v90, v90, v91
    v_mfma_f32_16x16x32_bf16 v[120:123], v[16:19], v[84:87], 0
    v_cvt_pk_bf16_f32 v26, v80, v81
    v_cvt_pk_bf16_f32 v0, v88, v90
    v_mfma_f32_16x16x32_bf16 v[124:127], v[20:23], v[84:87], 0
    v_add_f32 v92, v92, v93
    v_add_f32 v94, v94, v95
    v_mfma_f32_16x16x16_bf16 v[120:123], v[0:1], v[26:27], v[120:123]
    v_cvt_pk_bf16_f32 v12, v92, v94
    s_add_u32 s38, s38, 0x8000
    s_addc_u32 s39, s39, 0
    v_mfma_f32_16x16x16_bf16 v[124:127], v[12:13], v[26:27], v[124:127]
    ds_read_b128 v[64:67], v4 offset:30720
    v_mfma_f32_16x16x32_bf16 v[80:83], v[84:87], v[28:31], 0
    v_cvt_pk_bf16_f32 v92, v120, v121
    v_cvt_pk_bf16_f32 v93, v122, v123
    v_mfma_f32_16x16x16_bf16 v[80:83], v[26:27], v[28:29], v[80:83]
    v_cvt_pk_bf16_f32 v94, v124, v125
    v_cvt_pk_bf16_f32 v95, v126, v127
    v_cndmask_b32 v88, v94, v92, s[60:61]
    v_cndmask_b32 v89, v95, v93, s[60:61]
    v_smfmac_f32_16x16x64_bf16 v[104:107], v[92:95], a[0:7], v1 abid:1
    ds_write_b64 v13, v[88:89] offset:2144
    v_smfmac_f32_16x16x64_bf16 v[108:111], v[92:95], a[64:71], v1 abid:1
    v_smfmac_f32_16x16x64_bf16 v[112:115], v[92:95], a[8:15], v1 abid:1
    v_smfmac_f32_16x16x64_bf16 v[116:119], v[92:95], a[72:79], v1 abid:1
    v_add_u32 v9, 0x2000, v9
    v_and_b32 v9, 0x7fff, v9
    s_waitcnt lgkmcnt(0)
    s_barrier
    ds_read_b128 v[16:19], v6 offset:28928
    ds_read_b128 v[20:23], v6 offset:28896
    ds_read_b128 v[88:91], v6 offset:30016
    ds_write2_b32 v13, v0, v12 offset0:0 offset1:1
    v_rcp_f32 v0, v82
    v_rcp_f32 v12, v83
    s_waitcnt lgkmcnt(3)
    v_smfmac_f32_16x16x64_bf16 v[104:107], v[16:19], v[128:135], v1 abid:1
    s_waitcnt lgkmcnt(2)
    ds_read_b128 v[68:71], v4 offset:31744
    v_smfmac_f32_16x16x64_bf16 v[104:107], v[20:23], v[48:55], v1 abid:1
    s_waitcnt lgkmcnt(2)
    ds_read_b128 v[120:123], v4 offset:63488
    v_smfmac_f32_16x16x64_bf16 v[104:107], v[88:91], v[56:63], v1 abid:1
    ds_read_b128 v[124:127], v4 offset:64512
    v_smfmac_f32_16x16x64_bf16 v[108:111], v[16:19], v[192:199], v1 abid:1
    v_smfmac_f32_16x16x64_bf16 v[108:111], v[20:23], v[32:39], v1 abid:1
    v_fma_mixlo_f16 v28, v104, v0, 0
    v_fma_mixlo_f16 v30, v105, v12, 0
    v_smfmac_f32_16x16x64_bf16 v[108:111], v[88:91], v[72:79], v1 abid:1
    v_and_or_b32 v28, v28, -2, s30
    v_fma_mixhi_f16 v28, v106, v0, 0
    v_smfmac_f32_16x16x64_bf16 v[112:115], v[16:19], v[136:143], v1 abid:1
    v_fma_mixhi_f16 v30, v107, v12, 0
    v_smfmac_f32_16x16x64_bf16 v[112:115], v[20:23], v[40:47], v1 abid:1
    v_fma_mixlo_f16 v29, v108, v0, 0
    v_fma_mixlo_f16 v31, v109, v12, 0
    v_smfmac_f32_16x16x64_bf16 v[112:115], v[88:91], v[96:103], v1 abid:1
    v_fma_mixhi_f16 v29, v110, v0, 0
    v_fma_mixhi_f16 v31, v111, v12, 0
    v_smfmac_f32_16x16x64_bf16 v[116:119], v[16:19], v[200:207], v1 abid:1
    s_waitcnt lgkmcnt(2)
    global_store_dwordx4 v8, v[28:31], s[34:35]
    v_smfmac_f32_16x16x64_bf16 v[116:119], v[20:23], v[64:71], v1 abid:1
    s_waitcnt lgkmcnt(0)
    v_fma_mixlo_f16 v84, v112, v0, 0
    v_fma_mixlo_f16 v86, v113, v12, 0
    v_smfmac_f32_16x16x64_bf16 v[116:119], v[88:91], v[120:127], v1 abid:1
    v_and_or_b32 v84, v84, -2, s30
    v_fma_mixhi_f16 v84, v114, v0, 0
    v_fma_mixhi_f16 v86, v115, v12, 0
    s_nop 4
    v_fma_mixlo_f16 v85, v116, v0, 0
    v_fma_mixlo_f16 v87, v117, v12, 0
    v_fma_mixhi_f16 v85, v118, v0, 0
    v_fma_mixhi_f16 v87, v119, v12, 0
    global_store_dwordx4 v8, v[84:87], s[50:51]
    s_cmp_lg_u64 s[54:55], 0
    s_cbranch_scc1 CH_KVf3
CH_KVRf3:
    ds_read_b128 v[104:107], v2 offset:57344
    ds_read_b128 v[108:111], v2 offset:58368
    ds_read_b128 v[112:115], v2 offset:59392
    ds_read_b128 v[116:119], v2 offset:60416
    ds_read_b128 v[120:123], v2 offset:61440
    ds_read_b128 v[124:127], v2 offset:62464
    ds_read_b128 v[64:67], v2 offset:63488
    ds_read_b128 v[68:71], v2 offset:64512
    s_add_u32 s40, s40, 0x400
    s_addc_u32 s41, s41, 0
    s_add_u32 s59, s59, 0x2000
    s_and_b32 s59, s59, 0x7fff
    s_add_u32 s42, s52, s59
    s_addc_u32 s43, s53, 0
    s_mov_b32 s12, 0
    s_add_u32 s29, s29, 1
    v_mov_b64 v[72:73], 0
    v_mov_b64 v[74:75], 0
    v_mov_b64 v[76:77], 0
    v_mov_b64 v[78:79], 0
    v_mov_b64 v[80:81], 0
    v_mov_b64 v[82:83], 0
    v_mov_b64 v[84:85], 0
    v_mov_b64 v[86:87], 0
    v_mov_b64 v[88:89], 0
    v_mov_b64 v[90:91], 0
    v_mov_b64 v[92:93], 0
    v_mov_b64 v[94:95], 0
    s_waitcnt lgkmcnt(0)
    global_load_dwordx4 v[32:35], v2, s[36:37] sc1
    global_load_dwordx4 v[36:39], v2, s[36:37] offset:1024 sc1
    v_cndmask_b32 v56, 0, v15, s[20:21]
    v_cndmask_b32 v57, 0, v15, s[22:23]
    v_cndmask_b32 v58, 0, v15, s[24:25]
    v_cndmask_b32 v59, 0, v15, s[26:27]
CH_PAf3:
    s_waitcnt vmcnt(0)
    s_nop 0
    v_mfma_f32_16x16x32_f16 v[60:63], v[56:59], v[32:35], 0
    v_xor_b32 v0, s30, v32
    v_bitop3_b32 v0, v0, v36, s30 bitop3:0xf6
    v_mfma_f32_16x16x32_f16 v[60:63], v[56:59], v[36:39], v[60:63]
    v_and_b32 v0, 1, v0
    v_cmp_ne_u32 vcc, 0, v0
    s_cbranch_vccnz CH_PAf3_R
CH_PJf3:
    s_nop 4
    v_add_f32_dpp v60, v60, v60 row_ror:8 row_mask:0xf bank_mask:0xf
    v_add_f32_dpp v61, v61, v61 row_ror:8 row_mask:0xf bank_mask:0xf
    s_xor_b32 s30, s30, 1
    v_add_f32_dpp v60, v60, v60 row_ror:4 row_mask:0xf bank_mask:0xf
    v_add_f32_dpp v61, v61, v61 row_ror:4 row_mask:0xf bank_mask:0xf
    v_cvt_pk_bf16_f32 v12, v60, v61
    v_med3_u32 v12, v12, v10, v11
    global_store_dword v9, v12, s[32:33]
    s_branch CH_LOOPf3
CH_PAf3_R:
    global_load_dwordx4 v[32:35], v2, s[36:37] sc1
    global_load_dwordx4 v[36:39], v2, s[36:37] offset:1024 sc1
    s_add_u32 s12, s12, 1
    s_mov_b32 s17, 7
    s_cmp_gt_u32 s12, 20000
    s_cbranch_scc1 TIMEOUT2
    s_branch CH_PAf3
CH_RMf3:
    global_load_dwordx4 v[96:99], v2, s[42:43] sc1
    global_load_dwordx4 v[100:103], v2, s[42:43] offset:1024 sc1
    s_add_u32 s12, s12, 1
    s_mov_b32 s17, 5
    s_cmp_gt_u32 s12, 20000
    s_cbranch_scc1 TIMEOUT2
    v_mov_b64 v[88:89], 0
    v_mov_b64 v[90:91], 0
    v_mov_b64 v[92:93], 0
    v_mov_b64 v[94:95], 0
    s_branch CH_PMf3
CH_KVf3:
    s_mov_b32 s12, 0
POLL_238:
    global_load_dword v0, v24, s[40:41] offset:1036 sc1
    s_add_u32 s12, s12, 1
    s_mov_b32 s17, 6
    s_cmp_gt_u32 s12, 20000
    s_cbranch_scc1 TIMEOUT2
    s_waitcnt vmcnt(0)
    v_cmp_ne_u32 vcc, s8, v0
    s_cbranch_vccnz POLL_238
    s_mov_b32 m0, 145408
    s_nop 0
    global_load_lds_dwordx4 v7, s[44:45] offset:0 sc1
    s_mov_b32 m0, 146176
    s_nop 0
    global_load_lds_dwordx4 v7, s[44:45] offset:256 sc1
    s_mov_b32 m0, 153600
    s_nop 0
    global_load_lds_dwordx4 v7, s[62:63] offset:0 sc1
    s_mov_b32 m0, 154368
    s_nop 0
    global_load_lds_dwordx4 v7, s[62:63] offset:256 sc1
    s_branch CH_KVRf3
CH_FINf3:
    ds_read_b128 v[104:107], v3 offset:0
    ds_read_b128 v[108:111], v3 offset:1024
    ds_read_b128 v[112:115], v3 offset:2048
    ds_read_b128 v[116:119], v3 offset:3072
    ds_read_b128 v[120:123], v3 offset:4096
    ds_read_b128 v[124:127], v3 offset:5120
    global_store_dwordx4 v2, v[28:31], s[46:47] sc1
    v_smfmac_f32_16x16x64_bf16 v[80:83], v[96:99], a[128:135], v1
    v_smfmac_f32_16x16x64_bf16 v[84:87], v[96:99], a[192:199], v1
    v_smfmac_f32_16x16x64_bf16 v[80:83], v[100:103], a[136:143], v1
    v_smfmac_f32_16x16x64_bf16 v[84:87], v[100:103], a[200:207], v1
    s_add_u32 s46, s38, 0x6c00
    s_addc_u32 s47, s39, 0
    s_waitcnt lgkmcnt(5)
    v_smfmac_f32_16x16x64_bf16 v[80:83], v[104:107], a[144:151], v1
    v_smfmac_f32_16x16x64_bf16 v[84:87], v[104:107], a[208:215], v1
    v_smfmac_f32_16x16x64_bf16 v[88:91], v[104:107], v[144:151], v1
    v_smfmac_f32_16x16x64_bf16 v[92:95], v[104:107], v[208:215], v1
    s_waitcnt lgkmcnt(4)
    v_smfmac_f32_16x16x64_bf16 v[80:83], v[108:111], a[152:159], v1
    v_smfmac_f32_16x16x64_bf16 v[84:87], v[108:111], a[216:223], v1
    v_smfmac_f32_16x16x64_bf16 v[88:91], v[108:111], v[152:159], v1
    v_smfmac_f32_16x16x64_bf16 v[92:95], v[108:111], v[216:223], v1
    s_waitcnt lgkmcnt(3)
    v_smfmac_f32_16x16x64_bf16 v[80:83], v[112:115], a[160:167], v1
    v_smfmac_f32_16x16x64_bf16 v[84:87], v[112:115], a[224:231], v1
    v_smfmac_f32_16x16x64_bf16 v[88:91], v[112:115], v[160:167], v1
    v_smfmac_f32_16x16x64_bf16 v[92:95], v[112:115], v[224:231], v1
    s_waitcnt lgkmcnt(2)
    v_smfmac_f32_16x16x64_bf16 v[80:83], v[116:119], a[168:175], v1
    v_smfmac_f32_16x16x64_bf16 v[84:87], v[116:119], a[232:239], v1
    v_smfmac_f32_16x16x64_bf16 v[88:91], v[116:119], v[168:175], v1
    v_smfmac_f32_16x16x64_bf16 v[92:95], v[116:119], v[232:239], v1
    s_waitcnt lgkmcnt(1)
    v_smfmac_f32_16x16x64_bf16 v[80:83], v[120:123], a[176:183], v1
    v_smfmac_f32_16x16x64_bf16 v[84:87], v[120:123], a[240:247], v1
    s_waitcnt lgkmcnt(0)
    v_smfmac_f32_16x16x64_bf16 v[80:83], v[124:127], a[184:191], v1
    v_smfmac_f32_16x16x64_bf16 v[84:87], v[124:127], a[248:255], v1
    v_smfmac_f32_16x16x64_bf16 v[88:91], v[120:123], v[176:183], v1
    v_smfmac_f32_16x16x64_bf16 v[92:95], v[120:123], v[240:247], v1
    v_smfmac_f32_16x16x64_bf16 v[88:91], v[124:127], v[184:191], v1
    v_add_f32 v80, v80, v81
    v_add_f32 v82, v82, v83
    v_smfmac_f32_16x16x64_bf16 v[92:95], v[124:127], v[248:255], v1
    v_add_f32 v84, v84, v85
    v_add_f32 v86, v86, v87
    v_cvt_pk_bf16_f32 v81, v80, v84
    v_cvt_pk_bf16_f32 v83, v82, v86
    ds_write2_b32 v5, v81, v83 offset0:0 offset1:4
    v_add_f32 v88, v88, v89
    v_add_f32 v90, v90, v91
    s_nop 0
    v_add_f32 v92, v92, v93
    v_add_f32 v94, v94, v95
    v_cvt_pk_bf16_f32 v0, v88, v90
    v_cvt_pk_bf16_f32 v12, v92, v94
    ds_write2_b32 v13, v0, v12 offset0:0 offset1:1
    s_waitcnt lgkmcnt(0)
    ds_read_b128 v[28:31], v25 offset:27840
    s_waitcnt lgkmcnt(0)
    v_min_u32 v28, -2, v28
    global_store_dwordx4 v2, v[28:31], s[46:47] sc1
    s_endpgm
CH_SL:
    s_cmp_eq_u32 s9, 1
    s_cbranch_scc1 CH_INs1
    s_cmp_eq_u32 s9, 2
    s_cbranch_scc1 CH_INs2
    s_cmp_eq_u32 s9, 3
    s_cbranch_scc1 CH_INs3
CH_INs0:
    ds_read_b128 v[104:107], v2 offset:32768
    ds_read_b128 v[108:111], v2 offset:33792
    ds_read_b128 v[112:115], v2 offset:34816
    ds_read_b128 v[116:119], v2 offset:35840
    ds_read_b128 v[120:123], v2 offset:36864
    ds_read_b128 v[124:127], v2 offset:37888
    ds_read_b128 v[64:67], v2 offset:38912
    ds_read_b128 v[68:71], v2 offset:39936
    v_mov_b64 v[72:73], 0
    v_mov_b64 v[74:75], 0
    v_mov_b64 v[76:77], 0
    v_mov_b64 v[78:79], 0
    v_mov_b64 v[80:81], 0
    v_mov_b64 v[82:83], 0
    v_mov_b64 v[84:85], 0
    v_mov_b64 v[86:87], 0
    v_mov_b64 v[88:89], 0
    v_mov_b64 v[90:91], 0
    v_mov_b64 v[92:93], 0
    v_mov_b64 v[94:95], 0
CH_LOOPs0:
    ds_read_b128 v[28:31], v25 offset:24576
    ds_read_b128 v[32:35], v2 offset:0
    ds_read_b128 v[36:39], v2 offset:1024
    ds_read_b128 v[40:43], v2 offset:2048
    ds_read_b128 v[44:47], v2 offset:3072
    ds_read_b128 v[48:51], v2 offset:4096
    ds_read_b128 v[52:55], v2 offset:5120
    ds_read_b128 v[56:59], v2 offset:6144
    ds_read_b128 v[60:63], v2 offset:7168
    ds_read_b128 v[16:19], v3 offset:16384
    ds_read_b128 v[20:23], v3 offset:17408
    s_add_u32 s44, s38, 0xa000
    s_addc_u32 s45, s39, 0
    s_add_u32 s62, s38, 0xc000
    s_addc_u32 s63, s39, 0
    s_waitcnt lgkmcnt(0)
    global_load_dwordx4 v[96:99], v2, s[42:43] sc1
    global_load_dwordx4 v[100:103], v2, s[42:43] offset:1024 sc1
    s_mov_b32 s12, 0
    s_waitcnt lgkmcnt(0)
    v_min_u32 v28, -2, v28
CH_PMs0:
    s_waitcnt vmcnt(0)
    ds_write_b128 v3, v[96:99] offset:0
    ds_write_b128 v3, v[100:103] offset:1024
    v_max3_u32 v0, v96, v97, v98
    v_max3_u32 v0, v0, v99, v100
    v_max3_u32 v0, v0, v101, v102
    v_max_u32 v0, v0, v103
    v_cmp_eq_u32 vcc, -1, v0
    v_smfmac_f32_16x16x64_bf16 v[88:91], v[96:99], v[104:111], v1
    v_smfmac_f32_16x16x64_bf16 v[92:95], v[96:99], v[112:119], v1
    s_cbranch_vccnz CH_RMs0
    v_smfmac_f32_16x16x64_bf16 v[88:91], v[100:103], v[120:127], v1
    v_smfmac_f32_16x16x64_bf16 v[92:95], v[100:103], v[64:71], v1
    v_smfmac_f32_16x16x64_bf16 v[72:75], v[96:99], v[32:39], v1
    s_cmp_eq_u32 s29, 63
    s_waitcnt lgkmcnt(0)
    s_barrier
    s_cbranch_scc1 CH_FINs0
    ds_read_b128 v[104:107], v3 offset:2048
    ds_read_b128 v[108:111], v3 offset:3072
    v_smfmac_f32_16x16x64_bf16 v[76:79], v[96:99], v[40:47], v1
    ds_read_b128 v[112:115], v3 offset:4096
    ds_read_b128 v[116:119], v3 offset:5120
    v_smfmac_f32_16x16x64_bf16 v[72:75], v[100:103], v[48:55], v1
    ds_read_b128 v[120:123], v3 offset:6144
    ds_read_b128 v[124:127], v3 offset:7168
    v_smfmac_f32_16x16x64_bf16 v[76:79], v[100:103], v[56:63], v1
    global_load_dword v14, v24, s[40:41] offset:1024 sc1
    v_smfmac_f32_16x16x64_bf16 v[80:83], v[96:99], a[128:135], v1
    v_smfmac_f32_16x16x64_bf16 v[84:87], v[96:99], a[192:199], v1
    global_store_dwordx4 v2, v[28:31], s[46:47] sc1
    v_smfmac_f32_16x16x64_bf16 v[80:83], v[100:103], a[136:143], v1
    s_add_u32 s46, s38, 0x6000
    s_addc_u32 s47, s39, 0
    v_smfmac_f32_16x16x64_bf16 v[84:87], v[100:103], a[200:207], v1
    s_waitcnt lgkmcnt(5)
    v_mov_b32 v28, 0x3f803f80
    v_smfmac_f32_16x16x64_bf16 v[72:75], v[104:107], a[16:23], v1
    ds_read_b128 v[32:35], v3 offset:8192
    v_mov_b32 v29, 0x3f803f80
    v_smfmac_f32_16x16x64_bf16 v[76:79], v[104:107], a[80:87], v1
    s_waitcnt lgkmcnt(5)
    ds_read_b128 v[36:39], v3 offset:10240
    v_mov_b32 v30, 0x3f803f80
    v_smfmac_f32_16x16x64_bf16 v[72:75], v[108:111], a[24:31], v1
    ds_read_b128 v[40:43], v3 offset:12288
    v_mov_b32 v31, 0x3f803f80
    v_smfmac_f32_16x16x64_bf16 v[76:79], v[108:111], a[88:95], v1
    s_waitcnt lgkmcnt(6)
    ds_read_b128 v[44:47], v3 offset:14336
    v_smfmac_f32_16x16x64_bf16 v[72:75], v[112:115], a[32:39], v1
    ds_read_b128 v[48:51], v3 offset:9216
    v_smfmac_f32_16x16x64_bf16 v[76:79], v[112:115], a[96:103], v1
    s_waitcnt lgkmcnt(7)
    ds_read_b128 v[52:55], v3 offset:11264
    v_smfmac_f32_16x16x64_bf16 v[72:75], v[116:119], a[40:47], v1
    ds_read_b128 v[56:59], v3 offset:13312
    v_smfmac_f32_16x16x64_bf16 v[76:79], v[116:119], a[104:111], v1
    s_waitcnt lgkmcnt(8)
    ds_read_b128 v[60:63], v3 offset:15360
    v_smfmac_f32_16x16x64_bf16 v[72:75], v[120:123], a[48:55], v1
    v_smfmac_f32_16x16x64_bf16 v[76:79], v[120:123], a[112:119], v1
    s_waitcnt lgkmcnt(8)
    v_smfmac_f32_16x16x64_bf16 v[72:75], v[124:127], a[56:63], v1
    v_smfmac_f32_16x16x64_bf16 v[76:79], v[124:127], a[120:127], v1
    v_smfmac_f32_16x16x64_bf16 v[80:83], v[104:107], a[144:151], v1
    v_add_f32 v72, v72, v73
    v_smfmac_f32_16x16x64_bf16 v[84:87], v[104:107], a[208:215], v1
    v_add_f32 v74, v74, v75
    v_smfmac_f32_16x16x64_bf16 v[80:83], v[108:111], a[152:159], v1
    v_add_f32 v76, v76, v77
    v_smfmac_f32_16x16x64_bf16 v[84:87], v[108:111], a[216:223], v1
    v_add_f32 v78, v78, v79
    v_smfmac_f32_16x16x64_bf16 v[80:83], v[112:115], a[160:167], v1
    v_cvt_pk_bf16_f32 v73, v72, v76
    v_smfmac_f32_16x16x64_bf16 v[84:87], v[112:115], a[224:231], v1
    v_cvt_pk_bf16_f32 v75, v74, v78
    v_smfmac_f32_16x16x64_bf16 v[80:83], v[116:119], a[168:175], v1
    ds_write2_b32 v5, v73, v75 offset0:8 offset1:12
    v_smfmac_f32_16x16x64_bf16 v[84:87], v[116:119], a[232:239], v1
    v_smfmac_f32_16x16x64_bf16 v[80:83], v[120:123], a[176:183], v1
    v_smfmac_f32_16x16x64_bf16 v[84:87], v[120:123], a[240:247], v1
    v_smfmac_f32_16x16x64_bf16 v[80:83], v[124:127], a[184:191], v1
    v_smfmac_f32_16x16x64_bf16 v[84:87], v[124:127], a[248:255], v1
    s_waitcnt vmcnt(2)
    s_waitcnt lgkmcnt(0)
    s_barrier
    ds_read_b128 v[72:75], v6 offset:24576
    v_smfmac_f32_16x16x64_bf16 v[88:91], v[104:107], v[144:151], v1
    s_mov_b32 m0, 139264
    ds_read_b128 v[76:79], v6 offset:25664
    v_add_f32 v80, v80, v81
    v_smfmac_f32_16x16x64_bf16 v[92:95], v[104:107], v[208:215], v1
    s_waitcnt vmcnt(1)
    v_cmp_ne_u32 s[54:55], s8, v14
    global_load_lds_dwordx4 v7, s[44:45] offset:0 sc1
    ds_read_b128 v[96:99], v6 offset:26752
    v_add_f32 v82, v82, v83
    v_smfmac_f32_16x16x64_bf16 v[88:91], v[108:111], v[152:159], v1
    s_mov_b32 m0, 140032
    ds_read_b128 v[100:103], v6 offset:27840
    v_add_f32 v84, v84, v85
    v_smfmac_f32_16x16x64_bf16 v[92:95], v[108:111], v[216:223], v1
    s_waitcnt lgkmcnt(3)
    global_load_lds_dwordx4 v7, s[44:45] offset:256 sc1
    v_add_f32 v86, v86, v87
    v_mfma_f32_16x16x32_bf16 v[64:67], v[32:35], v[72:75], 0
    s_mov_b32 m0, 147456
    s_waitcnt lgkmcnt(2)
    v_cvt_pk_bf16_f32 v81, v80, v84
    v_cvt_pk_bf16_f32 v83, v82, v86
    v_mfma_f32_16x16x32_bf16 v[64:67], v[36:39], v[76:79], v[64:67]
    s_waitcnt lgkmcnt(1)
    global_load_lds_dwordx4 v7, s[62:63] offset:0 sc1
    ds_write2_b32 v5, v81, v83 offset0:0 offset1:4
    v_mfma_f32_16x16x32_bf16 v[64:67], v[40:43], v[96:99], v[64:67]
    s_mov_b32 m0, 148224
    s_waitcnt lgkmcnt(1)
    v_mfma_f32_16x16x32_bf16 v[64:67], v[44:47], v[100:103], v[64:67]
    global_load_lds_dwordx4 v7, s[62:63] offset:256 sc1
    v_mfma_f32_16x16x32_bf16 v[68:71], v[48:51], v[72:75], 0
    v_mfma_f32_16x16x32_bf16 v[68:71], v[52:55], v[76:79], v[68:71]
    v_mfma_f32_16x16x32_bf16 v[68:71], v[56:59], v[96:99], v[68:71]
    s_waitcnt lgkmcnt(0)
    s_barrier
    ds_read_b128 v[32:35], v6 offset:24544
    v_mfma_f32_16x16x32_bf16 v[68:71], v[60:63], v[100:103], v[68:71]
    ds_read_b128 v[36:39], v6 offset:25632
    ds_read_b128 v[40:43], v6 offset:26720
    v_smfmac_f32_16x16x64_bf16 v[88:91], v[112:115], v[160:167], v1
    ds_read_b128 v[44:47], v6 offset:27808
    v_smfmac_f32_16x16x64_bf16 v[92:95], v[112:115], v[224:231], v1
    ds_read_b128 v[48:51], v4 offset:0
    v_max3_f32 v84, v64, v65, v66
    v_smfmac_f32_16x16x64_bf16 v[88:91], v[116:119], v[168:175], v1
    ds_read_b128 v[52:55], v4 offset:1024
    v_max3_f32 v84, v84, v67, v68
    v_smfmac_f32_16x16x64_bf16 v[92:95], v[116:119], v[232:239], v1
    s_waitcnt lgkmcnt(5)
    ds_read_b128 v[56:59], v4 offset:32768
    v_max3_f32 v84, v84, v69, v70
    v_mfma_f32_16x16x32_bf16 v[80:83], v[32:35], v[72:75], 0
    s_waitcnt lgkmcnt(5)
    ds_read_b128 v[60:63], v4 offset:33792
    v_max_f32 v84, v84, v71
    v_mfma_f32_16x16x32_bf16 v[80:83], v[36:39], v[76:79], v[80:83]
    s_waitcnt lgkmcnt(5)
    ds_read_b128 v[32:35], v4 offset:2048
    v_mfma_f32_16x16x32_bf16 v[80:83], v[40:43], v[96:99], v[80:83]
    s_waitcnt lgkmcnt(5)
    ds_read_b128 v[36:39], v4 offset:3072
    v_mfma_f32_16x16x32_bf16 v[80:83], v[44:47], v[100:103], v[80:83]
    ds_read_b128 v[72:75], v4 offset:34816
    v_smfmac_f32_16x16x64_bf16 v[88:91], v[120:123], v[176:183], v1
    ds_read_b128 v[76:79], v4 offset:35840
    v_smfmac_f32_16x16x64_bf16 v[92:95], v[120:123], v[240:247], v1
    ds_read_b128 v[40:43], v4 offset:4096
    v_max3_f32 v85, v84, v80, v81
    v_max3_f32 v84, v84, v80, v81
    v_smfmac_f32_16x16x64_bf16 v[88:91], v[124:127], v[184:191], v1
    ds_read_b128 v[44:47], v4 offset:5120
    v_permlane32_swap_b32 v84, v85
    v_max_f32 v84, v84, v85
    v_mov_b32 v85, v84
    v_smfmac_f32_16x16x64_bf16 v[92:95], v[124:127], v[248:255], v1
    ds_read_b128 v[96:99], v4 offset:36864
    v_permlane16_swap_b32 v84, v85
    v_max_f32 v84, v84, v85
    v_mul_f32 v86, 0xbe0293ee, v84
    v_pk_fma_f32 v[64:65], v[64:65], s[56:57], v[86:87] op_sel_hi:[1,0,0]
    v_pk_fma_f32 v[66:67], v[66:67], s[56:57], v[86:87] op_sel_hi:[1,0,0]
    v_pk_fma_f32 v[68:69], v[68:69], s[56:57], v[86:87] op_sel_hi:[1,0,0]
    v_pk_fma_f32 v[70:71], v[70:71], s[56:57], v[86:87] op_sel_hi:[1,0,0]
    v_pk_fma_f32 v[80:81], v[80:81], s[56:57], v[86:87] op_sel_hi:[1,0,0]
    v_mfma_f32_32x32x8_bf16 v[104:119], v[24:25], v[26:27], 0
    ds_read_b128 v[100:103], v4 offset:37888
    v_exp_f32 v64, v64
    v_exp_f32 v65, v65
    v_exp_f32 v66, v66
    v_exp_f32 v67, v67
    v_exp_f32 v68, v68
    v_exp_f32 v69, v69
    v_exp_f32 v70, v70
    v_exp_f32 v71, v71
    v_exp_f32 v80, v80
    v_exp_f32 v81, v81
    v_cvt_pk_bf16_f32 v84, v64, v65
    v_cvt_pk_bf16_f32 v85, v66, v67
    v_cvt_pk_bf16_f32 v86, v68, v69
    v_cvt_pk_bf16_f32 v87, v70, v71
    v_add_f32 v88, v88, v89
    v_add_f32 v90, v90, v91
    v_mfma_f32_16x16x32_bf16 v[120:123], v[16:19], v[84:87], 0
    v_cvt_pk_bf16_f32 v26, v80, v81
    v_cvt_pk_bf16_f32 v0, v88, v90
    v_mfma_f32_16x16x32_bf16 v[124:127], v[20:23], v[84:87], 0
    v_add_f32 v92, v92, v93
    v_add_f32 v94, v94, v95
    v_mfma_f32_16x16x16_bf16 v[120:123], v[0:1], v[26:27], v[120:123]
    v_cvt_pk_bf16_f32 v12, v92, v94
    s_add_u32 s38, s38, 0x8000
    s_addc_u32 s39, s39, 0
    v_mfma_f32_16x16x16_bf16 v[124:127], v[12:13], v[26:27], v[124:127]
    ds_read_b128 v[64:67], v4 offset:6144
    v_mfma_f32_16x16x32_bf16 v[80:83], v[84:87], v[28:31], 0
    v_cvt_pk_bf16_f32 v92, v120, v121
    v_cvt_pk_bf16_f32 v93, v122, v123
    v_mfma_f32_16x16x16_bf16 v[80:83], v[26:27], v[28:29], v[80:83]
    v_cvt_pk_bf16_f32 v94, v124, v125
    v_cvt_pk_bf16_f32 v95, v126, v127
    v_cndmask_b32 v88, v94, v92, s[60:61]
    v_cndmask_b32 v89, v95, v93, s[60:61]
    v_smfmac_f32_16x16x64_bf16 v[104:107], v[92:95], a[0:7], v1 abid:1
    ds_write_b64 v13, v[88:89] offset:4352
    v_smfmac_f32_16x16x64_bf16 v[108:111], v[92:95], a[64:71], v1 abid:1
    v_smfmac_f32_16x16x64_bf16 v[112:115], v[92:95], a[8:15], v1 abid:1
    v_smfmac_f32_16x16x64_bf16 v[116:119], v[92:95], a[72:79], v1 abid:1
    v_add_u32 v9, 0x2000, v9
    v_and_b32 v9, 0x7fff, v9
    s_waitcnt lgkmcnt(0)
    s_barrier
    ds_read_b128 v[16:19], v6 offset:28896
    ds_read_b128 v[20:23], v6 offset:30016
    ds_read_b128 v[88:91], v6 offset:29984
    ds_write2_b32 v13, v0, v12 offset0:0 offset1:1
    v_rcp_f32 v0, v82
    v_rcp_f32 v12, v83
    s_waitcnt lgkmcnt(3)
    v_smfmac_f32_16x16x64_bf16 v[104:107], v[16:19], v[128:135], v1 abid:1
    s_waitcnt lgkmcnt(2)
    ds_read_b128 v[68:71], v4 offset:7168
    v_smfmac_f32_16x16x64_bf16 v[104:107], v[20:23], v[48:55], v1 abid:1
    s_waitcnt lgkmcnt(2)
    ds_read_b128 v[120:123], v4 offset:38912
    v_smfmac_f32_16x16x64_bf16 v[104:107], v[88:91], v[56:63], v1 abid:1
    ds_read_b128 v[124:127], v4 offset:39936
    v_smfmac_f32_16x16x64_bf16 v[108:111], v[16:19], v[192:199], v1 abid:1
    v_smfmac_f32_16x16x64_bf16 v[108:111], v[20:23], v[32:39], v1 abid:1
    v_fma_mixlo_f16 v28, v104, v0, 0
    v_fma_mixlo_f16 v30, v105, v12, 0
    v_smfmac_f32_16x16x64_bf16 v[108:111], v[88:91], v[72:79], v1 abid:1
    v_and_or_b32 v28, v28, -2, s30
    v_fma_mixhi_f16 v28, v106, v0, 0
    v_smfmac_f32_16x16x64_bf16 v[112:115], v[16:19], v[136:143], v1 abid:1
    v_fma_mixhi_f16 v30, v107, v12, 0
    v_smfmac_f32_16x16x64_bf16 v[112:115], v[20:23], v[40:47], v1 abid:1
    v_fma_mixlo_f16 v29, v108, v0, 0
    v_fma_mixlo_f16 v31, v109, v12, 0
    v_smfmac_f32_16x16x64_bf16 v[112:115], v[88:91], v[96:103], v1 abid:1
    v_fma_mixhi_f16 v29, v110, v0, 0
    v_fma_mixhi_f16 v31, v111, v12, 0
    v_smfmac_f32_16x16x64_bf16 v[116:119], v[16:19], v[200:207], v1 abid:1
    s_waitcnt lgkmcnt(2)
    global_store_dwordx4 v8, v[28:31], s[34:35] sc1
    v_smfmac_f32_16x16x64_bf16 v[116:119], v[20:23], v[64:71], v1 abid:1
    s_waitcnt lgkmcnt(0)
    v_fma_mixlo_f16 v84, v112, v0, 0
    v_fma_mixlo_f16 v86, v113, v12, 0
    v_smfmac_f32_16x16x64_bf16 v[116:119], v[88:91], v[120:127], v1 abid:1
    v_and_or_b32 v84, v84, -2, s30
    v_fma_mixhi_f16 v84, v114, v0, 0
    v_fma_mixhi_f16 v86, v115, v12, 0
    s_nop 4
    v_fma_mixlo_f16 v85, v116, v0, 0
    v_fma_mixlo_f16 v87, v117, v12, 0
    v_fma_mixhi_f16 v85, v118, v0, 0
    v_fma_mixhi_f16 v87, v119, v12, 0
    global_store_dwordx4 v8, v[84:87], s[50:51] sc1
    s_cmp_lg_u64 s[54:55], 0
    s_cbranch_scc1 CH_KVs0
CH_KVRs0:
    ds_read_b128 v[104:107], v2 offset:32768
    ds_read_b128 v[108:111], v2 offset:33792
    ds_read_b128 v[112:115], v2 offset:34816
    ds_read_b128 v[116:119], v2 offset:35840
    ds_read_b128 v[120:123], v2 offset:36864
    ds_read_b128 v[124:127], v2 offset:37888
    ds_read_b128 v[64:67], v2 offset:38912
    ds_read_b128 v[68:71], v2 offset:39936
    s_add_u32 s40, s40, 0x400
    s_addc_u32 s41, s41, 0
    s_add_u32 s59, s59, 0x2000
    s_and_b32 s59, s59, 0x7fff
    s_add_u32 s42, s52, s59
    s_addc_u32 s43, s53, 0
    s_mov_b32 s12, 0
    s_add_u32 s29, s29, 1
    v_mov_b64 v[72:73], 0
    v_mov_b64 v[74:75], 0
    v_mov_b64 v[76:77], 0
    v_mov_b64 v[78:79], 0
    v_mov_b64 v[80:81], 0
    v_mov_b64 v[82:83], 0
    v_mov_b64 v[84:85], 0
    v_mov_b64 v[86:87], 0
    v_mov_b64 v[88:89], 0
    v_mov_b64 v[90:91], 0
    v_mov_b64 v[92:93], 0
    v_mov_b64 v[94:95], 0
    s_waitcnt lgkmcnt(0)
    global_load_dwordx4 v[32:35], v2, s[36:37] sc1
    global_load_dwordx4 v[36:39], v2, s[36:37] offset:1024 sc1
    v_cndmask_b32 v56, 0, v15, s[20:21]
    v_cndmask_b32 v57, 0, v15, s[22:23]
    v_cndmask_b32 v58, 0, v15, s[24:25]
    v_cndmask_b32 v59, 0, v15, s[26:27]
CH_PAs0:
    s_waitcnt vmcnt(0)
    s_nop 0
    v_mfma_f32_16x16x32_f16 v[60:63], v[56:59], v[32:35], 0
    v_xor_b32 v0, s30, v32
    v_bitop3_b32 v0, v0, v36, s30 bitop3:0xf6
    v_mfma_f32_16x16x32_f16 v[60:63], v[56:59], v[36:39], v[60:63]
    v_and_b32 v0, 1, v0
    v_cmp_ne_u32 vcc, 0, v0
    s_cbranch_vccnz CH_PAs0_R
CH_PJs0:
    s_nop 4
    v_add_f32_dpp v60, v60, v60 row_ror:8 row_mask:0xf bank_mask:0xf
    v_add_f32_dpp v61, v61, v61 row_ror:8 row_mask:0xf bank_mask:0xf
    s_xor_b32 s30, s30, 1
    v_add_f32_dpp v60, v60, v60 row_ror:4 row_mask:0xf bank_mask:0xf
    v_add_f32_dpp v61, v61, v61 row_ror:4 row_mask:0xf bank_mask:0xf
    v_cvt_pk_bf16_f32 v12, v60, v61
    v_med3_u32 v12, v12, v10, v11
    global_store_dword v9, v12, s[32:33] sc1
    s_branch CH_LOOPs0
CH_PAs0_R:
    global_load_dwordx4 v[32:35], v2, s[36:37] sc1
    global_load_dwordx4 v[36:39], v2, s[36:37] offset:1024 sc1
    s_add_u32 s12, s12, 1
    s_mov_b32 s17, 7
    s_cmp_gt_u32 s12, 20000
    s_cbranch_scc1 TIMEOUT2
    s_branch CH_PAs0
CH_RMs0:
    global_load_dwordx4 v[96:99], v2, s[42:43] sc1
    global_load_dwordx4 v[100:103], v2, s[42:43] offset:1024 sc1
    s_add_u32 s12, s12, 1
    s_mov_b32 s17, 5
    s_cmp_gt_u32 s12, 20000
    s_cbranch_scc1 TIMEOUT2
    v_mov_b64 v[88:89], 0
    v_mov_b64 v[90:91], 0
    v_mov_b64 v[92:93], 0
    v_mov_b64 v[94:95], 0
    s_branch CH_PMs0
CH_KVs0:
    s_mov_b32 s12, 0
POLL_239:
    global_load_dword v0, v24, s[40:41] offset:1024 sc1
    s_add_u32 s12, s12, 1
    s_mov_b32 s17, 6
    s_cmp_gt_u32 s12, 20000
    s_cbranch_scc1 TIMEOUT2
    s_waitcnt vmcnt(0)
    v_cmp_ne_u32 vcc, s8, v0
    s_cbranch_vccnz POLL_239
    s_mov_b32 m0, 139264
    s_nop 0
    global_load_lds_dwordx4 v7, s[44:45] offset:0 sc1
    s_mov_b32 m0, 140032
    s_nop 0
    global_load_lds_dwordx4 v7, s[44:45] offset:256 sc1
    s_mov_b32 m0, 147456
    s_nop 0
    global_load_lds_dwordx4 v7, s[62:63] offset:0 sc1
    s_mov_b32 m0, 148224
    s_nop 0
    global_load_lds_dwordx4 v7, s[62:63] offset:256 sc1
    s_branch CH_KVRs0
CH_FINs0:
    ds_read_b128 v[104:107], v3 offset:2048
    ds_read_b128 v[108:111], v3 offset:3072
    ds_read_b128 v[112:115], v3 offset:4096
    ds_read_b128 v[116:119], v3 offset:5120
    ds_read_b128 v[120:123], v3 offset:6144
    ds_read_b128 v[124:127], v3 offset:7168
    global_store_dwordx4 v2, v[28:31], s[46:47] sc1
    v_smfmac_f32_16x16x64_bf16 v[80:83], v[96:99], a[128:135], v1
    v_smfmac_f32_16x16x64_bf16 v[84:87], v[96:99], a[192:199], v1
    v_smfmac_f32_16x16x64_bf16 v[80:83], v[100:103], a[136:143], v1
    v_smfmac_f32_16x16x64_bf16 v[84:87], v[100:103], a[200:207], v1
    s_add_u32 s46, s38, 0x6000
    s_addc_u32 s47, s39, 0
    s_waitcnt lgkmcnt(5)
    v_smfmac_f32_16x16x64_bf16 v[80:83], v[104:107], a[144:151], v1
    v_smfmac_f32_16x16x64_bf16 v[84:87], v[104:107], a[208:215], v1
    v_smfmac_f32_16x16x64_bf16 v[88:91], v[104:107], v[144:151], v1
    v_smfmac_f32_16x16x64_bf16 v[92:95], v[104:107], v[208:215], v1
    s_waitcnt lgkmcnt(4)
    v_smfmac_f32_16x16x64_bf16 v[80:83], v[108:111], a[152:159], v1
    v_smfmac_f32_16x16x64_bf16 v[84:87], v[108:111], a[216:223], v1
    v_smfmac_f32_16x16x64_bf16 v[88:91], v[108:111], v[152:159], v1
    v_smfmac_f32_16x16x64_bf16 v[92:95], v[108:111], v[216:223], v1
    s_waitcnt lgkmcnt(3)
    v_smfmac_f32_16x16x64_bf16 v[80:83], v[112:115], a[160:167], v1
    v_smfmac_f32_16x16x64_bf16 v[84:87], v[112:115], a[224:231], v1
    v_smfmac_f32_16x16x64_bf16 v[88:91], v[112:115], v[160:167], v1
    v_smfmac_f32_16x16x64_bf16 v[92:95], v[112:115], v[224:231], v1
    s_waitcnt lgkmcnt(2)
    v_smfmac_f32_16x16x64_bf16 v[80:83], v[116:119], a[168:175], v1
    v_smfmac_f32_16x16x64_bf16 v[84:87], v[116:119], a[232:239], v1
    v_smfmac_f32_16x16x64_bf16 v[88:91], v[116:119], v[168:175], v1
    v_smfmac_f32_16x16x64_bf16 v[92:95], v[116:119], v[232:239], v1
    s_waitcnt lgkmcnt(1)
    v_smfmac_f32_16x16x64_bf16 v[80:83], v[120:123], a[176:183], v1
    v_smfmac_f32_16x16x64_bf16 v[84:87], v[120:123], a[240:247], v1
    s_waitcnt lgkmcnt(0)
    v_smfmac_f32_16x16x64_bf16 v[80:83], v[124:127], a[184:191], v1
    v_smfmac_f32_16x16x64_bf16 v[84:87], v[124:127], a[248:255], v1
    v_smfmac_f32_16x16x64_bf16 v[88:91], v[120:123], v[176:183], v1
    v_smfmac_f32_16x16x64_bf16 v[92:95], v[120:123], v[240:247], v1
    v_smfmac_f32_16x16x64_bf16 v[88:91], v[124:127], v[184:191], v1
    v_add_f32 v80, v80, v81
    v_add_f32 v82, v82, v83
    v_smfmac_f32_16x16x64_bf16 v[92:95], v[124:127], v[248:255], v1
    v_add_f32 v84, v84, v85
    v_add_f32 v86, v86, v87
    v_cvt_pk_bf16_f32 v81, v80, v84
    v_cvt_pk_bf16_f32 v83, v82, v86
    ds_write2_b32 v5, v81, v83 offset0:0 offset1:4
    v_add_f32 v88, v88, v89
    v_add_f32 v90, v90, v91
    s_nop 0
    v_add_f32 v92, v92, v93
    v_add_f32 v94, v94, v95
    v_cvt_pk_bf16_f32 v0, v88, v90
    v_cvt_pk_bf16_f32 v12, v92, v94
    ds_write2_b32 v13, v0, v12 offset0:0 offset1:1
    s_waitcnt lgkmcnt(0)
    ds_read_b128 v[28:31], v25 offset:24576
    s_waitcnt lgkmcnt(0)
    v_min_u32 v28, -2, v28
    global_store_dwordx4 v2, v[28:31], s[46:47] sc1
    s_endpgm
CH_INs1:
    ds_read_b128 v[104:107], v2 offset:40960
    ds_read_b128 v[108:111], v2 offset:41984
    ds_read_b128 v[112:115], v2 offset:43008
    ds_read_b128 v[116:119], v2 offset:44032
    ds_read_b128 v[120:123], v2 offset:45056
    ds_read_b128 v[124:127], v2 offset:46080
    ds_read_b128 v[64:67], v2 offset:47104
    ds_read_b128 v[68:71], v2 offset:48128
    v_mov_b64 v[72:73], 0
    v_mov_b64 v[74:75], 0
    v_mov_b64 v[76:77], 0
    v_mov_b64 v[78:79], 0
    v_mov_b64 v[80:81], 0
    v_mov_b64 v[82:83], 0
    v_mov_b64 v[84:85], 0
    v_mov_b64 v[86:87], 0
    v_mov_b64 v[88:89], 0
    v_mov_b64 v[90:91], 0
    v_mov_b64 v[92:93], 0
    v_mov_b64 v[94:95], 0
CH_LOOPs1:
    ds_read_b128 v[28:31], v25 offset:25664
    ds_read_b128 v[32:35], v2 offset:8192
    ds_read_b128 v[36:39], v2 offset:9216
    ds_read_b128 v[40:43], v2 offset:10240
    ds_read_b128 v[44:47], v2 offset:11264
    ds_read_b128 v[48:51], v2 offset:12288
    ds_read_b128 v[52:55], v2 offset:13312
    ds_read_b128 v[56:59], v2 offset:14336
    ds_read_b128 v[60:63], v2 offset:15360
    ds_read_b128 v[16:19], v3 offset:18432
    ds_read_b128 v[20:23], v3 offset:19456
    s_add_u32 s44, s38, 0xa000
    s_addc_u32 s45, s39, 0
    s_add_u32 s62, s38, 0xc000
    s_addc_u32 s63, s39, 0
    s_waitcnt lgkmcnt(0)
    global_load_dwordx4 v[96:99], v2, s[42:43] sc1
    global_load_dwordx4 v[100:103], v2, s[42:43] offset:1024 sc1
    s_mov_b32 s12, 0
    s_waitcnt lgkmcnt(0)
    v_min_u32 v28, -2, v28
CH_PMs1:
    s_waitcnt vmcnt(0)
    ds_write_b128 v3, v[96:99] offset:2048
    ds_write_b128 v3, v[100:103] offset:3072
    v_max3_u32 v0, v96, v97, v98
    v_max3_u32 v0, v0, v99, v100
    v_max3_u32 v0, v0, v101, v102
    v_max_u32 v0, v0, v103
    v_cmp_eq_u32 vcc, -1, v0
    v_smfmac_f32_16x16x64_bf16 v[88:91], v[96:99], v[104:111], v1
    v_smfmac_f32_16x16x64_bf16 v[92:95], v[96:99], v[112:119], v1
    s_cbranch_vccnz CH_RMs1
    v_smfmac_f32_16x16x64_bf16 v[88:91], v[100:103], v[120:127], v1
    v_smfmac_f32_16x16x64_bf16 v[92:95], v[100:103], v[64:71], v1
    v_smfmac_f32_16x16x64_bf16 v[72:75], v[96:99], v[32:39], v1
    s_cmp_eq_u32 s29, 63
    s_waitcnt lgkmcnt(0)
    s_barrier
    s_cbranch_scc1 CH_FINs1
    ds_read_b128 v[104:107], v3 offset:4096
    ds_read_b128 v[108:111], v3 offset:5120
    v_smfmac_f32_16x16x64_bf16 v[76:79], v[96:99], v[40:47], v1
    ds_read_b128 v[112:115], v3 offset:6144
    ds_read_b128 v[116:119], v3 offset:7168
    v_smfmac_f32_16x16x64_bf16 v[72:75], v[100:103], v[48:55], v1
    ds_read_b128 v[120:123], v3 offset:0
    ds_read_b128 v[124:127], v3 offset:1024
    v_smfmac_f32_16x16x64_bf16 v[76:79], v[100:103], v[56:63], v1
    global_load_dword v14, v24, s[40:41] offset:1028 sc1
    v_smfmac_f32_16x16x64_bf16 v[80:83], v[96:99], a[128:135], v1
    v_smfmac_f32_16x16x64_bf16 v[84:87], v[96:99], a[192:199], v1
    global_store_dwordx4 v2, v[28:31], s[46:47] sc1
    v_smfmac_f32_16x16x64_bf16 v[80:83], v[100:103], a[136:143], v1
    s_add_u32 s46, s38, 0x6400
    s_addc_u32 s47, s39, 0
    v_smfmac_f32_16x16x64_bf16 v[84:87], v[100:103], a[200:207], v1
    s_waitcnt lgkmcnt(5)
    v_mov_b32 v28, 0x3f803f80
    v_smfmac_f32_16x16x64_bf16 v[72:75], v[104:107], a[16:23], v1
    ds_read_b128 v[32:35], v3 offset:8192
    v_mov_b32 v29, 0x3f803f80
    v_smfmac_f32_16x16x64_bf16 v[76:79], v[104:107], a[80:87], v1
    s_waitcnt lgkmcnt(5)
    ds_read_b128 v[36:39], v3 offset:10240
    v_mov_b32 v30, 0x3f803f80
    v_smfmac_f32_16x16x64_bf16 v[72:75], v[108:111], a[24:31], v1
    ds_read_b128 v[40:43], v3 offset:12288
    v_mov_b32 v31, 0x3f803f80
    v_smfmac_f32_16x16x64_bf16 v[76:79], v[108:111], a[88:95], v1
    s_waitcnt lgkmcnt(6)
    ds_read_b128 v[44:47], v3 offset:14336
    v_smfmac_f32_16x16x64_bf16 v[72:75], v[112:115], a[32:39], v1
    ds_read_b128 v[48:51], v3 offset:9216
    v_smfmac_f32_16x16x64_bf16 v[76:79], v[112:115], a[96:103], v1
    s_waitcnt lgkmcnt(7)
    ds_read_b128 v[52:55], v3 offset:11264
    v_smfmac_f32_16x16x64_bf16 v[72:75], v[116:119], a[40:47], v1
    ds_read_b128 v[56:59], v3 offset:13312
    v_smfmac_f32_16x16x64_bf16 v[76:79], v[116:119], a[104:111], v1
    s_waitcnt lgkmcnt(8)
    ds_read_b128 v[60:63], v3 offset:15360
    v_smfmac_f32_16x16x64_bf16 v[72:75], v[120:123], a[48:55], v1
    v_smfmac_f32_16x16x64_bf16 v[76:79], v[120:123], a[112:119], v1
    s_waitcnt lgkmcnt(8)
    v_smfmac_f32_16x16x64_bf16 v[72:75], v[124:127], a[56:63], v1
    v_smfmac_f32_16x16x64_bf16 v[76:79], v[124:127], a[120:127], v1
    v_smfmac_f32_16x16x64_bf16 v[80:83], v[104:107], a[144:151], v1
    v_add_f32 v72, v72, v73
    v_smfmac_f32_16x16x64_bf16 v[84:87], v[104:107], a[208:215], v1
    v_add_f32 v74, v74, v75
    v_smfmac_f32_16x16x64_bf16 v[80:83], v[108:111], a[152:159], v1
    v_add_f32 v76, v76, v77
    v_smfmac_f32_16x16x64_bf16 v[84:87], v[108:111], a[216:223], v1
    v_add_f32 v78, v78, v79
    v_smfmac_f32_16x16x64_bf16 v[80:83], v[112:115], a[160:167], v1
    v_cvt_pk_bf16_f32 v73, v72, v76
    v_smfmac_f32_16x16x64_bf16 v[84:87], v[112:115], a[224:231], v1
    v_cvt_pk_bf16_f32 v75, v74, v78
    v_smfmac_f32_16x16x64_bf16 v[80:83], v[116:119], a[168:175], v1
    ds_write2_b32 v5, v73, v75 offset0:8 offset1:12
    v_smfmac_f32_16x16x64_bf16 v[84:87], v[116:119], a[232:239], v1
    v_smfmac_f32_16x16x64_bf16 v[80:83], v[120:123], a[176:183], v1
    v_smfmac_f32_16x16x64_bf16 v[84:87], v[120:123], a[240:247], v1
    v_smfmac_f32_16x16x64_bf16 v[80:83], v[124:127], a[184:191], v1
    v_smfmac_f32_16x16x64_bf16 v[84:87], v[124:127], a[248:255], v1
    s_waitcnt vmcnt(2)
    s_waitcnt lgkmcnt(0)
    s_barrier
    ds_read_b128 v[72:75], v6 offset:24576
    v_smfmac_f32_16x16x64_bf16 v[88:91], v[104:107], v[144:151], v1
    s_mov_b32 m0, 141312
    ds_read_b128 v[76:79], v6 offset:25664
    v_add_f32 v80, v80, v81
    v_smfmac_f32_16x16x64_bf16 v[92:95], v[104:107], v[208:215], v1
    s_waitcnt vmcnt(1)
    v_cmp_ne_u32 s[54:55], s8, v14
    global_load_lds_dwordx4 v7, s[44:45] offset:0 sc1
    ds_read_b128 v[96:99], v6 offset:26752
    v_add_f32 v82, v82, v83
    v_smfmac_f32_16x16x64_bf16 v[88:91], v[108:111], v[152:159], v1
    s_mov_b32 m0, 142080
    ds_read_b128 v[100:103], v6 offset:27840
    v_add_f32 v84, v84, v85
    v_smfmac_f32_16x16x64_bf16 v[92:95], v[108:111], v[216:223], v1
    s_waitcnt lgkmcnt(3)
    global_load_lds_dwordx4 v7, s[44:45] offset:256 sc1
    v_add_f32 v86, v86, v87
    v_mfma_f32_16x16x32_bf16 v[64:67], v[32:35], v[72:75], 0
    s_mov_b32 m0, 149504
    s_waitcnt lgkmcnt(2)
    v_cvt_pk_bf16_f32 v81, v80, v84
    v_cvt_pk_bf16_f32 v83, v82, v86
    v_mfma_f32_16x16x32_bf16 v[64:67], v[36:39], v[76:79], v[64:67]
    s_waitcnt lgkmcnt(1)
    global_load_lds_dwordx4 v7, s[62:63] offset:0 sc1
    ds_write2_b32 v5, v81, v83 offset0:0 offset1:4
    v_mfma_f32_16x16x32_bf16 v[64:67], v[40:43], v[96:99], v[64:67]
    s_mov_b32 m0, 150272
    s_waitcnt lgkmcnt(1)
    v_mfma_f32_16x16x32_bf16 v[64:67], v[44:47], v[100:103], v[64:67]
    global_load_lds_dwordx4 v7, s[62:63] offset:256 sc1
    v_mfma_f32_16x16x32_bf16 v[68:71], v[48:51], v[72:75], 0
    v_mfma_f32_16x16x32_bf16 v[68:71], v[52:55], v[76:79], v[68:71]
    v_mfma_f32_16x16x32_bf16 v[68:71], v[56:59], v[96:99], v[68:71]
    s_waitcnt lgkmcnt(0)
    s_barrier
    ds_read_b128 v[32:35], v6 offset:24544
    v_mfma_f32_16x16x32_bf16 v[68:71], v[60:63], v[100:103], v[68:71]
    ds_read_b128 v[36:39], v6 offset:25632
    ds_read_b128 v[40:43], v6 offset:26720
    v_smfmac_f32_16x16x64_bf16 v[88:91], v[112:115], v[160:167], v1
    ds_read_b128 v[44:47], v6 offset:27808
    v_smfmac_f32_16x16x64_bf16 v[92:95], v[112:115], v[224:231], v1
    ds_read_b128 v[48:51], v4 offset:8192
    v_max3_f32 v84, v64, v65, v66
    v_smfmac_f32_16x16x64_bf16 v[88:91], v[116:119], v[168:175], v1
    ds_read_b128 v[52:55], v4 offset:9216
    v_max3_f32 v84, v84, v67, v68
    v_smfmac_f32_16x16x64_bf16 v[92:95], v[116:119], v[232:239], v1
    s_waitcnt lgkmcnt(5)
    ds_read_b128 v[56:59], v4 offset:40960
    v_max3_f32 v84, v84, v69, v70
    v_mfma_f32_16x16x32_bf16 v[80:83], v[32:35], v[72:75], 0
    s_waitcnt lgkmcnt(5)
    ds_read_b128 v[60:63], v4 offset:41984
    v_max_f32 v84, v84, v71
    v_mfma_f32_16x16x32_bf16 v[80:83], v[36:39], v[76:79], v[80:83]
    s_waitcnt lgkmcnt(5)
    ds_read_b128 v[32:35], v4 offset:10240
    v_mfma_f32_16x16x32_bf16 v[80:83], v[40:43], v[96:99], v[80:83]
    s_waitcnt lgkmcnt(5)
    ds_read_b128 v[36:39], v4 offset:11264
    v_mfma_f32_16x16x32_bf16 v[80:83], v[44:47], v[100:103], v[80:83]
    ds_read_b128 v[72:75], v4 offset:43008
    v_smfmac_f32_16x16x64_bf16 v[88:91], v[120:123], v[176:183], v1
    ds_read_b128 v[76:79], v4 offset:44032
    v_smfmac_f32_16x16x64_bf16 v[92:95], v[120:123], v[240:247], v1
    ds_read_b128 v[40:43], v4 offset:12288
    v_max3_f32 v85, v84, v80, v81
    v_max3_f32 v84, v84, v80, v81
    v_smfmac_f32_16x16x64_bf16 v[88:91], v[124:127], v[184:191], v1
    ds_read_b128 v[44:47], v4 offset:13312
    v_permlane32_swap_b32 v84, v85
    v_max_f32 v84, v84, v85
    v_mov_b32 v85, v84
    v_smfmac_f32_16x16x64_bf16 v[92:95], v[124:127], v[248:255], v1
    ds_read_b128 v[96:99], v4 offset:45056
    v_permlane16_swap_b32 v84, v85
    v_max_f32 v84, v84, v85
    v_mul_f32 v86, 0xbe0293ee, v84
    v_pk_fma_f32 v[64:65], v[64:65], s[56:57], v[86:87] op_sel_hi:[1,0,0]
    v_pk_fma_f32 v[66:67], v[66:67], s[56:57], v[86:87] op_sel_hi:[1,0,0]
    v_pk_fma_f32 v[68:69], v[68:69], s[56:57], v[86:87] op_sel_hi:[1,0,0]
    v_pk_fma_f32 v[70:71], v[70:71], s[56:57], v[86:87] op_sel_hi:[1,0,0]
    v_pk_fma_f32 v[80:81], v[80:81], s[56:57], v[86:87] op_sel_hi:[1,0,0]
    v_mfma_f32_32x32x8_bf16 v[104:119], v[24:25], v[26:27], 0
    ds_read_b128 v[100:103], v4 offset:46080
    v_exp_f32 v64, v64
    v_exp_f32 v65, v65
    v_exp_f32 v66, v66
    v_exp_f32 v67, v67
    v_exp_f32 v68, v68
    v_exp_f32 v69, v69
    v_exp_f32 v70, v70
    v_exp_f32 v71, v71
    v_exp_f32 v80, v80
    v_exp_f32 v81, v81
    v_cvt_pk_bf16_f32 v84, v64, v65
    v_cvt_pk_bf16_f32 v85, v66, v67
    v_cvt_pk_bf16_f32 v86, v68, v69
    v_cvt_pk_bf16_f32 v87, v70, v71
    v_add_f32 v88, v88, v89
    v_add_f32 v90, v90, v91
    v_mfma_f32_16x16x32_bf16 v[120:123], v[16:19], v[84:87], 0
    v_cvt_pk_bf16_f32 v26, v80, v81
    v_cvt_pk_bf16_f32 v0, v88, v90
    v_mfma_f32_16x16x32_bf16 v[124:127], v[20:23], v[84:87], 0
    v_add_f32 v92, v92, v93
    v_add_f32 v94, v94, v95
    v_mfma_f32_16x16x16_bf16 v[120:123], v[0:1], v[26:27], v[120:123]
    v_cvt_pk_bf16_f32 v12, v92, v94
    s_add_u32 s38, s38, 0x8000
    s_addc_u32 s39, s39, 0
    v_mfma_f32_16x16x16_bf16 v[124:127], v[12:13], v[26:27], v[124:127]
    ds_read_b128 v[64:67], v4 offset:14336
    v_mfma_f32_16x16x32_bf16 v[80:83], v[84:87], v[28:31], 0
    v_cvt_pk_bf16_f32 v92, v120, v121
    v_cvt_pk_bf16_f32 v93, v122, v123
    v_mfma_f32_16x16x16_bf16 v[80:83], v[26:27], v[28:29], v[80:83]
    v_cvt_pk_bf16_f32 v94, v124, v125
    v_cvt_pk_bf16_f32 v95, v126, v127
    v_cndmask_b32 v88, v94, v92, s[60:61]
    v_cndmask_b32 v89, v95, v93, s[60:61]
    v_smfmac_f32_16x16x64_bf16 v[104:107], v[92:95], a[0:7], v1 abid:1
    ds_write_b64 v13, v[88:89] offset:3232
    v_smfmac_f32_16x16x64_bf16 v[108:111], v[92:95], a[64:71], v1 abid:1
    v_smfmac_f32_16x16x64_bf16 v[112:115], v[92:95], a[8:15], v1 abid:1
    v_smfmac_f32_16x16x64_bf16 v[116:119], v[92:95], a[72:79], v1 abid:1
    v_add_u32 v9, 0x2000, v9
    v_and_b32 v9, 0x7fff, v9
    s_waitcnt lgkmcnt(0)
    s_barrier
    ds_read_b128 v[16:19], v6 offset:30016
    ds_read_b128 v[20:23], v6 offset:29984
    ds_read_b128 v[88:91], v6 offset:28928
    ds_write2_b32 v13, v0, v12 offset0:0 offset1:1
    v_rcp_f32 v0, v82
    v_rcp_f32 v12, v83
    s_waitcnt lgkmcnt(3)
    v_smfmac_f32_16x16x64_bf16 v[104:107], v[16:19], v[128:135], v1 abid:1
    s_waitcnt lgkmcnt(2)
    ds_read_b128 v[68:71], v4 offset:15360
    v_smfmac_f32_16x16x64_bf16 v[104:107], v[20:23], v[48:55], v1 abid:1
    s_waitcnt lgkmcnt(2)
    ds_read_b128 v[120:123], v4 offset:47104
    v_smfmac_f32_16x16x64_bf16 v[104:107], v[88:91], v[56:63], v1 abid:1
    ds_read_b128 v[124:127], v4 offset:48128
    v_smfmac_f32_16x16x64_bf16 v[108:111], v[16:19], v[192:199], v1 abid:1
    v_smfmac_f32_16x16x64_bf16 v[108:111], v[20:23], v[32:39], v1 abid:1
    v_fma_mixlo_f16 v28, v104, v0, 0
    v_fma_mixlo_f16 v30, v105, v12, 0
    v_smfmac_f32_16x16x64_bf16 v[108:111], v[88:91], v[72:79], v1 abid:1
    v_and_or_b32 v28, v28, -2, s30
    v_fma_mixhi_f16 v28, v106, v0, 0
    v_smfmac_f32_16x16x64_bf16 v[112:115], v[16:19], v[136:143], v1 abid:1
    v_fma_mixhi_f16 v30, v107, v12, 0
    v_smfmac_f32_16x16x64_bf16 v[112:115], v[20:23], v[40:47], v1 abid:1
    v_fma_mixlo_f16 v29, v108, v0, 0
    v_fma_mixlo_f16 v31, v109, v12, 0
    v_smfmac_f32_16x16x64_bf16 v[112:115], v[88:91], v[96:103], v1 abid:1
    v_fma_mixhi_f16 v29, v110, v0, 0
    v_fma_mixhi_f16 v31, v111, v12, 0
    v_smfmac_f32_16x16x64_bf16 v[116:119], v[16:19], v[200:207], v1 abid:1
    s_waitcnt lgkmcnt(2)
    global_store_dwordx4 v8, v[28:31], s[34:35] sc1
    v_smfmac_f32_16x16x64_bf16 v[116:119], v[20:23], v[64:71], v1 abid:1
    s_waitcnt lgkmcnt(0)
    v_fma_mixlo_f16 v84, v112, v0, 0
    v_fma_mixlo_f16 v86, v113, v12, 0
    v_smfmac_f32_16x16x64_bf16 v[116:119], v[88:91], v[120:127], v1 abid:1
    v_and_or_b32 v84, v84, -2, s30
    v_fma_mixhi_f16 v84, v114, v0, 0
    v_fma_mixhi_f16 v86, v115, v12, 0
    s_nop 4
    v_fma_mixlo_f16 v85, v116, v0, 0
    v_fma_mixlo_f16 v87, v117, v12, 0
    v_fma_mixhi_f16 v85, v118, v0, 0
    v_fma_mixhi_f16 v87, v119, v12, 0
    global_store_dwordx4 v8, v[84:87], s[50:51] sc1
    s_cmp_lg_u64 s[54:55], 0
    s_cbranch_scc1 CH_KVs1
CH_KVRs1:
    ds_read_b128 v[104:107], v2 offset:40960
    ds_read_b128 v[108:111], v2 offset:41984
    ds_read_b128 v[112:115], v2 offset:43008
    ds_read_b128 v[116:119], v2 offset:44032
    ds_read_b128 v[120:123], v2 offset:45056
    ds_read_b128 v[124:127], v2 offset:46080
    ds_read_b128 v[64:67], v2 offset:47104
    ds_read_b128 v[68:71], v2 offset:48128
    s_add_u32 s40, s40, 0x400
    s_addc_u32 s41, s41, 0
    s_add_u32 s59, s59, 0x2000
    s_and_b32 s59, s59, 0x7fff
    s_add_u32 s42, s52, s59
    s_addc_u32 s43, s53, 0
    s_mov_b32 s12, 0
    s_add_u32 s29, s29, 1
    v_mov_b64 v[72:73], 0
    v_mov_b64 v[74:75], 0
    v_mov_b64 v[76:77], 0
    v_mov_b64 v[78:79], 0
    v_mov_b64 v[80:81], 0
    v_mov_b64 v[82:83], 0
    v_mov_b64 v[84:85], 0
    v_mov_b64 v[86:87], 0
    v_mov_b64 v[88:89], 0
    v_mov_b64 v[90:91], 0
    v_mov_b64 v[92:93], 0
    v_mov_b64 v[94:95], 0
    s_waitcnt lgkmcnt(0)
    global_load_dwordx4 v[32:35], v2, s[36:37] sc1
    global_load_dwordx4 v[36:39], v2, s[36:37] offset:1024 sc1
    v_cndmask_b32 v56, 0, v15, s[20:21]
    v_cndmask_b32 v57, 0, v15, s[22:23]
    v_cndmask_b32 v58, 0, v15, s[24:25]
    v_cndmask_b32 v59, 0, v15, s[26:27]
CH_PAs1:
    s_waitcnt vmcnt(0)
    s_nop 0
    v_mfma_f32_16x16x32_f16 v[60:63], v[56:59], v[32:35], 0
    v_xor_b32 v0, s30, v32
    v_bitop3_b32 v0, v0, v36, s30 bitop3:0xf6
    v_mfma_f32_16x16x32_f16 v[60:63], v[56:59], v[36:39], v[60:63]
    v_and_b32 v0, 1, v0
    v_cmp_ne_u32 vcc, 0, v0
    s_cbranch_vccnz CH_PAs1_R
CH_PJs1:
    s_nop 4
    v_add_f32_dpp v60, v60, v60 row_ror:8 row_mask:0xf bank_mask:0xf
    v_add_f32_dpp v61, v61, v61 row_ror:8 row_mask:0xf bank_mask:0xf
    s_xor_b32 s30, s30, 1
    v_add_f32_dpp v60, v60, v60 row_ror:4 row_mask:0xf bank_mask:0xf
    v_add_f32_dpp v61, v61, v61 row_ror:4 row_mask:0xf bank_mask:0xf
    v_cvt_pk_bf16_f32 v12, v60, v61
    v_med3_u32 v12, v12, v10, v11
    global_store_dword v9, v12, s[32:33] sc1
    s_branch CH_LOOPs1
CH_PAs1_R:
    global_load_dwordx4 v[32:35], v2, s[36:37] sc1
    global_load_dwordx4 v[36:39], v2, s[36:37] offset:1024 sc1
    s_add_u32 s12, s12, 1
    s_mov_b32 s17, 7
    s_cmp_gt_u32 s12, 20000
    s_cbranch_scc1 TIMEOUT2
    s_branch CH_PAs1
CH_RMs1:
    global_load_dwordx4 v[96:99], v2, s[42:43] sc1
    global_load_dwordx4 v[100:103], v2, s[42:43] offset:1024 sc1
    s_add_u32 s12, s12, 1
    s_mov_b32 s17, 5
    s_cmp_gt_u32 s12, 20000
    s_cbranch_scc1 TIMEOUT2
    v_mov_b64 v[88:89], 0
    v_mov_b64 v[90:91], 0
    v_mov_b64 v[92:93], 0
    v_mov_b64 v[94:95], 0
    s_branch CH_PMs1
CH_KVs1:
    s_mov_b32 s12, 0
POLL_240:
    global_load_dword v0, v24, s[40:41] offset:1028 sc1
    s_add_u32 s12, s12, 1
    s_mov_b32 s17, 6
    s_cmp_gt_u32 s12, 20000
    s_cbranch_scc1 TIMEOUT2
    s_waitcnt vmcnt(0)
    v_cmp_ne_u32 vcc, s8, v0
    s_cbranch_vccnz POLL_240
    s_mov_b32 m0, 141312
    s_nop 0
    global_load_lds_dwordx4 v7, s[44:45] offset:0 sc1
    s_mov_b32 m0, 142080
    s_nop 0
    global_load_lds_dwordx4 v7, s[44:45] offset:256 sc1
    s_mov_b32 m0, 149504
    s_nop 0
    global_load_lds_dwordx4 v7, s[62:63] offset:0 sc1
    s_mov_b32 m0, 150272
    s_nop 0
    global_load_lds_dwordx4 v7, s[62:63] offset:256 sc1
    s_branch CH_KVRs1
CH_FINs1:
    ds_read_b128 v[104:107], v3 offset:4096
    ds_read_b128 v[108:111], v3 offset:5120
    ds_read_b128 v[112:115], v3 offset:6144
    ds_read_b128 v[116:119], v3 offset:7168
    ds_read_b128 v[120:123], v3 offset:0
    ds_read_b128 v[124:127], v3 offset:1024
    global_store_dwordx4 v2, v[28:31], s[46:47] sc1
    v_smfmac_f32_16x16x64_bf16 v[80:83], v[96:99], a[128:135], v1
    v_smfmac_f32_16x16x64_bf16 v[84:87], v[96:99], a[192:199], v1
    v_smfmac_f32_16x16x64_bf16 v[80:83], v[100:103], a[136:143], v1
    v_smfmac_f32_16x16x64_bf16 v[84:87], v[100:103], a[200:207], v1
    s_add_u32 s46, s38, 0x6400
    s_addc_u32 s47, s39, 0
    s_waitcnt lgkmcnt(5)
    v_smfmac_f32_16x16x64_bf16 v[80:83], v[104:107], a[144:151], v1
    v_smfmac_f32_16x16x64_bf16 v[84:87], v[104:107], a[208:215], v1
    v_smfmac_f32_16x16x64_bf16 v[88:91], v[104:107], v[144:151], v1
    v_smfmac_f32_16x16x64_bf16 v[92:95], v[104:107], v[208:215], v1
    s_waitcnt lgkmcnt(4)
    v_smfmac_f32_16x16x64_bf16 v[80:83], v[108:111], a[152:159], v1
    v_smfmac_f32_16x16x64_bf16 v[84:87], v[108:111], a[216:223], v1
    v_smfmac_f32_16x16x64_bf16 v[88:91], v[108:111], v[152:159], v1
    v_smfmac_f32_16x16x64_bf16 v[92:95], v[108:111], v[216:223], v1
    s_waitcnt lgkmcnt(3)
    v_smfmac_f32_16x16x64_bf16 v[80:83], v[112:115], a[160:167], v1
    v_smfmac_f32_16x16x64_bf16 v[84:87], v[112:115], a[224:231], v1
    v_smfmac_f32_16x16x64_bf16 v[88:91], v[112:115], v[160:167], v1
    v_smfmac_f32_16x16x64_bf16 v[92:95], v[112:115], v[224:231], v1
    s_waitcnt lgkmcnt(2)
    v_smfmac_f32_16x16x64_bf16 v[80:83], v[116:119], a[168:175], v1
    v_smfmac_f32_16x16x64_bf16 v[84:87], v[116:119], a[232:239], v1
    v_smfmac_f32_16x16x64_bf16 v[88:91], v[116:119], v[168:175], v1
    v_smfmac_f32_16x16x64_bf16 v[92:95], v[116:119], v[232:239], v1
    s_waitcnt lgkmcnt(1)
    v_smfmac_f32_16x16x64_bf16 v[80:83], v[120:123], a[176:183], v1
    v_smfmac_f32_16x16x64_bf16 v[84:87], v[120:123], a[240:247], v1
    s_waitcnt lgkmcnt(0)
    v_smfmac_f32_16x16x64_bf16 v[80:83], v[124:127], a[184:191], v1
    v_smfmac_f32_16x16x64_bf16 v[84:87], v[124:127], a[248:255], v1
    v_smfmac_f32_16x16x64_bf16 v[88:91], v[120:123], v[176:183], v1
    v_smfmac_f32_16x16x64_bf16 v[92:95], v[120:123], v[240:247], v1
    v_smfmac_f32_16x16x64_bf16 v[88:91], v[124:127], v[184:191], v1
    v_add_f32 v80, v80, v81
    v_add_f32 v82, v82, v83
    v_smfmac_f32_16x16x64_bf16 v[92:95], v[124:127], v[248:255], v1
    v_add_f32 v84, v84, v85
    v_add_f32 v86, v86, v87
    v_cvt_pk_bf16_f32 v81, v80, v84
    v_cvt_pk_bf16_f32 v83, v82, v86
    ds_write2_b32 v5, v81, v83 offset0:0 offset1:4
    v_add_f32 v88, v88, v89
    v_add_f32 v90, v90, v91
    s_nop 0
    v_add_f32 v92, v92, v93
    v_add_f32 v94, v94, v95
    v_cvt_pk_bf16_f32 v0, v88, v90
    v_cvt_pk_bf16_f32 v12, v92, v94
    ds_write2_b32 v13, v0, v12 offset0:0 offset1:1
    s_waitcnt lgkmcnt(0)
    ds_read_b128 v[28:31], v25 offset:25664
    s_waitcnt lgkmcnt(0)
    v_min_u32 v28, -2, v28
    global_store_dwordx4 v2, v[28:31], s[46:47] sc1
    s_endpgm
CH_INs2:
    ds_read_b128 v[104:107], v2 offset:49152
    ds_read_b128 v[108:111], v2 offset:50176
    ds_read_b128 v[112:115], v2 offset:51200
    ds_read_b128 v[116:119], v2 offset:52224
    ds_read_b128 v[120:123], v2 offset:53248
    ds_read_b128 v[124:127], v2 offset:54272
    ds_read_b128 v[64:67], v2 offset:55296
    ds_read_b128 v[68:71], v2 offset:56320
    v_mov_b64 v[72:73], 0
    v_mov_b64 v[74:75], 0
    v_mov_b64 v[76:77], 0
    v_mov_b64 v[78:79], 0
    v_mov_b64 v[80:81], 0
    v_mov_b64 v[82:83], 0
    v_mov_b64 v[84:85], 0
    v_mov_b64 v[86:87], 0
    v_mov_b64 v[88:89], 0
    v_mov_b64 v[90:91], 0
    v_mov_b64 v[92:93], 0
    v_mov_b64 v[94:95], 0
CH_LOOPs2:
    ds_read_b128 v[28:31], v25 offset:26752
    ds_read_b128 v[32:35], v2 offset:16384
    ds_read_b128 v[36:39], v2 offset:17408
    ds_read_b128 v[40:43], v2 offset:18432
    ds_read_b128 v[44:47], v2 offset:19456
    ds_read_b128 v[48:51], v2 offset:20480
    ds_read_b128 v[52:55], v2 offset:21504
    ds_read_b128 v[56:59], v2 offset:22528
    ds_read_b128 v[60:63], v2 offset:23552
    ds_read_b128 v[16:19], v3 offset:20480
    ds_read_b128 v[20:23], v3 offset:21504
    s_add_u32 s44, s38, 0xa000
    s_addc_u32 s45, s39, 0
    s_add_u32 s62, s38, 0xc000
    s_addc_u32 s63, s39, 0
    s_waitcnt lgkmcnt(0)
    global_load_dwordx4 v[96:99], v2, s[42:43] sc1
    global_load_dwordx4 v[100:103], v2, s[42:43] offset:1024 sc1
    s_mov_b32 s12, 0
    s_waitcnt lgkmcnt(0)
    v_min_u32 v28, -2, v28
CH_PMs2:
    s_waitcnt vmcnt(0)
    ds_write_b128 v3, v[96:99] offset:4096
    ds_write_b128 v3, v[100:103] offset:5120
    v_max3_u32 v0, v96, v97, v98
    v_max3_u32 v0, v0, v99, v100
    v_max3_u32 v0, v0, v101, v102
    v_max_u32 v0, v0, v103
    v_cmp_eq_u32 vcc, -1, v0
    v_smfmac_f32_16x16x64_bf16 v[88:91], v[96:99], v[104:111], v1
    v_smfmac_f32_16x16x64_bf16 v[92:95], v[96:99], v[112:119], v1
    s_cbranch_vccnz CH_RMs2
    v_smfmac_f32_16x16x64_bf16 v[88:91], v[100:103], v[120:127], v1
    v_smfmac_f32_16x16x64_bf16 v[92:95], v[100:103], v[64:71], v1
    v_smfmac_f32_16x16x64_bf16 v[72:75], v[96:99], v[32:39], v1
    s_cmp_eq_u32 s29, 63
    s_waitcnt lgkmcnt(0)
    s_barrier
    s_cbranch_scc1 CH_FINs2
    ds_read_b128 v[104:107], v3 offset:6144
    ds_read_b128 v[108:111], v3 offset:7168
    v_smfmac_f32_16x16x64_bf16 v[76:79], v[96:99], v[40:47], v1
    ds_read_b128 v[112:115], v3 offset:0
    ds_read_b128 v[116:119], v3 offset:1024
    v_smfmac_f32_16x16x64_bf16 v[72:75], v[100:103], v[48:55], v1
    ds_read_b128 v[120:123], v3 offset:2048
    ds_read_b128 v[124:127], v3 offset:3072
    v_smfmac_f32_16x16x64_bf16 v[76:79], v[100:103], v[56:63], v1
    global_load_dword v14, v24, s[40:41] offset:1032 sc1
    v_smfmac_f32_16x16x64_bf16 v[80:83], v[96:99], a[128:135], v1
    v_smfmac_f32_16x16x64_bf16 v[84:87], v[96:99], a[192:199], v1
    global_store_dwordx4 v2, v[28:31], s[46:47] sc1
    v_smfmac_f32_16x16x64_bf16 v[80:83], v[100:103], a[136:143], v1
    s_add_u32 s46, s38, 0x6800
    s_addc_u32 s47, s39, 0
    v_smfmac_f32_16x16x64_bf16 v[84:87], v[100:103], a[200:207], v1
    s_waitcnt lgkmcnt(5)
    v_mov_b32 v28, 0x3f803f80
    v_smfmac_f32_16x16x64_bf16 v[72:75], v[104:107], a[16:23], v1
    ds_read_b128 v[32:35], v3 offset:8192
    v_mov_b32 v29, 0x3f803f80
    v_smfmac_f32_16x16x64_bf16 v[76:79], v[104:107], a[80:87], v1
    s_waitcnt lgkmcnt(5)
    ds_read_b128 v[36:39], v3 offset:10240
    v_mov_b32 v30, 0x3f803f80
    v_smfmac_f32_16x16x64_bf16 v[72:75], v[108:111], a[24:31], v1
    ds_read_b128 v[40:43], v3 offset:12288
    v_mov_b32 v31, 0x3f803f80
    v_smfmac_f32_16x16x64_bf16 v[76:79], v[108:111], a[88:95], v1
    s_waitcnt lgkmcnt(6)
    ds_read_b128 v[44:47], v3 offset:14336
    v_smfmac_f32_16x16x64_bf16 v[72:75], v[112:115], a[32:39], v1
    ds_read_b128 v[48:51], v3 offset:9216
    v_smfmac_f32_16x16x64_bf16 v[76:79], v[112:115], a[96:103], v1
    s_waitcnt lgkmcnt(7)
    ds_read_b128 v[52:55], v3 offset:11264
    v_smfmac_f32_16x16x64_bf16 v[72:75], v[116:119], a[40:47], v1
    ds_read_b128 v[56:59], v3 offset:13312
    v_smfmac_f32_16x16x64_bf16 v[76:79], v[116:119], a[104:111], v1
    s_waitcnt lgkmcnt(8)
    ds_read_b128 v[60:63], v3 offset:15360
    v_smfmac_f32_16x16x64_bf16 v[72:75], v[120:123], a[48:55], v1
    v_smfmac_f32_16x16x64_bf16 v[76:79], v[120:123], a[112:119], v1
    s_waitcnt lgkmcnt(8)
    v_smfmac_f32_16x16x64_bf16 v[72:75], v[124:127], a[56:63], v1
    v_smfmac_f32_16x16x64_bf16 v[76:79], v[124:127], a[120:127], v1
    v_smfmac_f32_16x16x64_bf16 v[80:83], v[104:107], a[144:151], v1
    v_add_f32 v72, v72, v73
    v_smfmac_f32_16x16x64_bf16 v[84:87], v[104:107], a[208:215], v1
    v_add_f32 v74, v74, v75
    v_smfmac_f32_16x16x64_bf16 v[80:83], v[108:111], a[152:159], v1
    v_add_f32 v76, v76, v77
    v_smfmac_f32_16x16x64_bf16 v[84:87], v[108:111], a[216:223], v1
    v_add_f32 v78, v78, v79
    v_smfmac_f32_16x16x64_bf16 v[80:83], v[112:115], a[160:167], v1
    v_cvt_pk_bf16_f32 v73, v72, v76
    v_smfmac_f32_16x16x64_bf16 v[84:87], v[112:115], a[224:231], v1
    v_cvt_pk_bf16_f32 v75, v74, v78
    v_smfmac_f32_16x16x64_bf16 v[80:83], v[116:119], a[168:175], v1
    ds_write2_b32 v5, v73, v75 offset0:8 offset1:12
    v_smfmac_f32_16x16x64_bf16 v[84:87], v[116:119], a[232:239], v1
    v_smfmac_f32_16x16x64_bf16 v[80:83], v[120:123], a[176:183], v1
    v_smfmac_f32_16x16x64_bf16 v[84:87], v[120:123], a[240:247], v1
    v_smfmac_f32_16x16x64_bf16 v[80:83], v[124:127], a[184:191], v1
    v_smfmac_f32_16x16x64_bf16 v[84:87], v[124:127], a[248:255], v1
    s_waitcnt vmcnt(2)
    s_waitcnt lgkmcnt(0)
    s_barrier
    ds_read_b128 v[72:75], v6 offset:24576
    v_smfmac_f32_16x16x64_bf16 v[88:91], v[104:107], v[144:151], v1
    s_mov_b32 m0, 143360
    ds_read_b128 v[76:79], v6 offset:25664
    v_add_f32 v80, v80, v81
    v_smfmac_f32_16x16x64_bf16 v[92:95], v[104:107], v[208:215], v1
    s_waitcnt vmcnt(1)
    v_cmp_ne_u32 s[54:55], s8, v14
    global_load_lds_dwordx4 v7, s[44:45] offset:0 sc1
    ds_read_b128 v[96:99], v6 offset:26752
    v_add_f32 v82, v82, v83
    v_smfmac_f32_16x16x64_bf16 v[88:91], v[108:111], v[152:159], v1
    s_mov_b32 m0, 144128
    ds_read_b128 v[100:103], v6 offset:27840
    v_add_f32 v84, v84, v85
    v_smfmac_f32_16x16x64_bf16 v[92:95], v[108:111], v[216:223], v1
    s_waitcnt lgkmcnt(3)
    global_load_lds_dwordx4 v7, s[44:45] offset:256 sc1
    v_add_f32 v86, v86, v87
    v_mfma_f32_16x16x32_bf16 v[64:67], v[32:35], v[72:75], 0
    s_mov_b32 m0, 151552
    s_waitcnt lgkmcnt(2)
    v_cvt_pk_bf16_f32 v81, v80, v84
    v_cvt_pk_bf16_f32 v83, v82, v86
    v_mfma_f32_16x16x32_bf16 v[64:67], v[36:39], v[76:79], v[64:67]
    s_waitcnt lgkmcnt(1)
    global_load_lds_dwordx4 v7, s[62:63] offset:0 sc1
    ds_write2_b32 v5, v81, v83 offset0:0 offset1:4
    v_mfma_f32_16x16x32_bf16 v[64:67], v[40:43], v[96:99], v[64:67]
    s_mov_b32 m0, 152320
    s_waitcnt lgkmcnt(1)
    v_mfma_f32_16x16x32_bf16 v[64:67], v[44:47], v[100:103], v[64:67]
    global_load_lds_dwordx4 v7, s[62:63] offset:256 sc1
    v_mfma_f32_16x16x32_bf16 v[68:71], v[48:51], v[72:75], 0
    v_mfma_f32_16x16x32_bf16 v[68:71], v[52:55], v[76:79], v[68:71]
    v_mfma_f32_16x16x32_bf16 v[68:71], v[56:59], v[96:99], v[68:71]
    s_waitcnt lgkmcnt(0)
    s_barrier
    ds_read_b128 v[32:35], v6 offset:24544
    v_mfma_f32_16x16x32_bf16 v[68:71], v[60:63], v[100:103], v[68:71]
    ds_read_b128 v[36:39], v6 offset:25632
    ds_read_b128 v[40:43], v6 offset:26720
    v_smfmac_f32_16x16x64_bf16 v[88:91], v[112:115], v[160:167], v1
    ds_read_b128 v[44:47], v6 offset:27808
    v_smfmac_f32_16x16x64_bf16 v[92:95], v[112:115], v[224:231], v1
    ds_read_b128 v[48:51], v4 offset:16384
    v_max3_f32 v84, v64, v65, v66
    v_smfmac_f32_16x16x64_bf16 v[88:91], v[116:119], v[168:175], v1
    ds_read_b128 v[52:55], v4 offset:17408
    v_max3_f32 v84, v84, v67, v68
    v_smfmac_f32_16x16x64_bf16 v[92:95], v[116:119], v[232:239], v1
    s_waitcnt lgkmcnt(5)
    ds_read_b128 v[56:59], v4 offset:49152
    v_max3_f32 v84, v84, v69, v70
    v_mfma_f32_16x16x32_bf16 v[80:83], v[32:35], v[72:75], 0
    s_waitcnt lgkmcnt(5)
    ds_read_b128 v[60:63], v4 offset:50176
    v_max_f32 v84, v84, v71
    v_mfma_f32_16x16x32_bf16 v[80:83], v[36:39], v[76:79], v[80:83]
    s_waitcnt lgkmcnt(5)
    ds_read_b128 v[32:35], v4 offset:18432
    v_mfma_f32_16x16x32_bf16 v[80:83], v[40:43], v[96:99], v[80:83]
    s_waitcnt lgkmcnt(5)
    ds_read_b128 v[36:39], v4 offset:19456
    v_mfma_f32_16x16x32_bf16 v[80:83], v[44:47], v[100:103], v[80:83]
    ds_read_b128 v[72:75], v4 offset:51200
    v_smfmac_f32_16x16x64_bf16 v[88:91], v[120:123], v[176:183], v1
    ds_read_b128 v[76:79], v4 offset:52224
    v_smfmac_f32_16x16x64_bf16 v[92:95], v[120:123], v[240:247], v1
    ds_read_b128 v[40:43], v4 offset:20480
    v_max3_f32 v85, v84, v80, v81
    v_max3_f32 v84, v84, v80, v81
    v_smfmac_f32_16x16x64_bf16 v[88:91], v[124:127], v[184:191], v1
    ds_read_b128 v[44:47], v4 offset:21504
    v_permlane32_swap_b32 v84, v85
    v_max_f32 v84, v84, v85
    v_mov_b32 v85, v84
    v_smfmac_f32_16x16x64_bf16 v[92:95], v[124:127], v[248:255], v1
    ds_read_b128 v[96:99], v4 offset:53248
    v_permlane16_swap_b32 v84, v85
    v_max_f32 v84, v84, v85
    v_mul_f32 v86, 0xbe0293ee, v84
    v_pk_fma_f32 v[64:65], v[64:65], s[56:57], v[86:87] op_sel_hi:[1,0,0]
    v_pk_fma_f32 v[66:67], v[66:67], s[56:57], v[86:87] op_sel_hi:[1,0,0]
    v_pk_fma_f32 v[68:69], v[68:69], s[56:57], v[86:87] op_sel_hi:[1,0,0]
    v_pk_fma_f32 v[70:71], v[70:71], s[56:57], v[86:87] op_sel_hi:[1,0,0]
    v_pk_fma_f32 v[80:81], v[80:81], s[56:57], v[86:87] op_sel_hi:[1,0,0]
    v_mfma_f32_32x32x8_bf16 v[104:119], v[24:25], v[26:27], 0
    ds_read_b128 v[100:103], v4 offset:54272
    v_exp_f32 v64, v64
    v_exp_f32 v65, v65
    v_exp_f32 v66, v66
    v_exp_f32 v67, v67
    v_exp_f32 v68, v68
    v_exp_f32 v69, v69
    v_exp_f32 v70, v70
    v_exp_f32 v71, v71
    v_exp_f32 v80, v80
    v_exp_f32 v81, v81
    v_cvt_pk_bf16_f32 v84, v64, v65
    v_cvt_pk_bf16_f32 v85, v66, v67
    v_cvt_pk_bf16_f32 v86, v68, v69
    v_cvt_pk_bf16_f32 v87, v70, v71
    v_add_f32 v88, v88, v89
    v_add_f32 v90, v90, v91
    v_mfma_f32_16x16x32_bf16 v[120:123], v[16:19], v[84:87], 0
    v_cvt_pk_bf16_f32 v26, v80, v81
    v_cvt_pk_bf16_f32 v0, v88, v90
    v_mfma_f32_16x16x32_bf16 v[124:127], v[20:23], v[84:87], 0
    v_add_f32 v92, v92, v93
    v_add_f32 v94, v94, v95
    v_mfma_f32_16x16x16_bf16 v[120:123], v[0:1], v[26:27], v[120:123]
    v_cvt_pk_bf16_f32 v12, v92, v94
    s_add_u32 s38, s38, 0x8000
    s_addc_u32 s39, s39, 0
    v_mfma_f32_16x16x16_bf16 v[124:127], v[12:13], v[26:27], v[124:127]
    ds_read_b128 v[64:67], v4 offset:22528
    v_mfma_f32_16x16x32_bf16 v[80:83], v[84:87], v[28:31], 0
    v_cvt_pk_bf16_f32 v92, v120, v121
    v_cvt_pk_bf16_f32 v93, v122, v123
    v_mfma_f32_16x16x16_bf16 v[80:83], v[26:27], v[28:29], v[80:83]
    v_cvt_pk_bf16_f32 v94, v124, v125
    v_cvt_pk_bf16_f32 v95, v126, v127
    v_cndmask_b32 v88, v94, v92, s[60:61]
    v_cndmask_b32 v89, v95, v93, s[60:61]
    v_smfmac_f32_16x16x64_bf16 v[104:107], v[92:95], a[0:7], v1 abid:1
    ds_write_b64 v13, v[88:89] offset:3264
    v_smfmac_f32_16x16x64_bf16 v[108:111], v[92:95], a[64:71], v1 abid:1
    v_smfmac_f32_16x16x64_bf16 v[112:115], v[92:95], a[8:15], v1 abid:1
    v_smfmac_f32_16x16x64_bf16 v[116:119], v[92:95], a[72:79], v1 abid:1
    v_add_u32 v9, 0x2000, v9
    v_and_b32 v9, 0x7fff, v9
    s_waitcnt lgkmcnt(0)
    s_barrier
    ds_read_b128 v[16:19], v6 offset:29984
    ds_read_b128 v[20:23], v6 offset:28928
    ds_read_b128 v[88:91], v6 offset:28896
    ds_write2_b32 v13, v0, v12 offset0:0 offset1:1
    v_rcp_f32 v0, v82
    v_rcp_f32 v12, v83
    s_waitcnt lgkmcnt(3)
    v_smfmac_f32_16x16x64_bf16 v[104:107], v[16:19], v[128:135], v1 abid:1
    s_waitcnt lgkmcnt(2)
    ds_read_b128 v[68:71], v4 offset:23552
    v_smfmac_f32_16x16x64_bf16 v[104:107], v[20:23], v[48:55], v1 abid:1
    s_waitcnt lgkmcnt(2)
    ds_read_b128 v[120:123], v4 offset:55296
    v_smfmac_f32_16x16x64_bf16 v[104:107], v[88:91], v[56:63], v1 abid:1
    ds_read_b128 v[124:127], v4 offset:56320
    v_smfmac_f32_16x16x64_bf16 v[108:111], v[16:19], v[192:199], v1 abid:1
    v_smfmac_f32_16x16x64_bf16 v[108:111], v[20:23], v[32:39], v1 abid:1
    v_fma_mixlo_f16 v28, v104, v0, 0
    v_fma_mixlo_f16 v30, v105, v12, 0
    v_smfmac_f32_16x16x64_bf16 v[108:111], v[88:91], v[72:79], v1 abid:1
    v_and_or_b32 v28, v28, -2, s30
    v_fma_mixhi_f16 v28, v106, v0, 0
    v_smfmac_f32_16x16x64_bf16 v[112:115], v[16:19], v[136:143], v1 abid:1
    v_fma_mixhi_f16 v30, v107, v12, 0
    v_smfmac_f32_16x16x64_bf16 v[112:115], v[20:23], v[40:47], v1 abid:1
    v_fma_mixlo_f16 v29, v108, v0, 0
    v_fma_mixlo_f16 v31, v109, v12, 0
    v_smfmac_f32_16x16x64_bf16 v[112:115], v[88:91], v[96:103], v1 abid:1
    v_fma_mixhi_f16 v29, v110, v0, 0
    v_fma_mixhi_f16 v31, v111, v12, 0
    v_smfmac_f32_16x16x64_bf16 v[116:119], v[16:19], v[200:207], v1 abid:1
    s_waitcnt lgkmcnt(2)
    global_store_dwordx4 v8, v[28:31], s[34:35] sc1
    v_smfmac_f32_16x16x64_bf16 v[116:119], v[20:23], v[64:71], v1 abid:1
    s_waitcnt lgkmcnt(0)
    v_fma_mixlo_f16 v84, v112, v0, 0
    v_fma_mixlo_f16 v86, v113, v12, 0
    v_smfmac_f32_16x16x64_bf16 v[116:119], v[88:91], v[120:127], v1 abid:1
    v_and_or_b32 v84, v84, -2, s30
    v_fma_mixhi_f16 v84, v114, v0, 0
    v_fma_mixhi_f16 v86, v115, v12, 0
    s_nop 4
    v_fma_mixlo_f16 v85, v116, v0, 0
    v_fma_mixlo_f16 v87, v117, v12, 0
    v_fma_mixhi_f16 v85, v118, v0, 0
    v_fma_mixhi_f16 v87, v119, v12, 0
    global_store_dwordx4 v8, v[84:87], s[50:51] sc1
    s_cmp_lg_u64 s[54:55], 0
    s_cbranch_scc1 CH_KVs2
CH_KVRs2:
    ds_read_b128 v[104:107], v2 offset:49152
    ds_read_b128 v[108:111], v2 offset:50176
    ds_read_b128 v[112:115], v2 offset:51200
    ds_read_b128 v[116:119], v2 offset:52224
    ds_read_b128 v[120:123], v2 offset:53248
    ds_read_b128 v[124:127], v2 offset:54272
    ds_read_b128 v[64:67], v2 offset:55296
    ds_read_b128 v[68:71], v2 offset:56320
    s_add_u32 s40, s40, 0x400
    s_addc_u32 s41, s41, 0
    s_add_u32 s59, s59, 0x2000
    s_and_b32 s59, s59, 0x7fff
    s_add_u32 s42, s52, s59
    s_addc_u32 s43, s53, 0
    s_mov_b32 s12, 0
    s_add_u32 s29, s29, 1
    v_mov_b64 v[72:73], 0
    v_mov_b64 v[74:75], 0
    v_mov_b64 v[76:77], 0
    v_mov_b64 v[78:79], 0
    v_mov_b64 v[80:81], 0
    v_mov_b64 v[82:83], 0
    v_mov_b64 v[84:85], 0
    v_mov_b64 v[86:87], 0
    v_mov_b64 v[88:89], 0
    v_mov_b64 v[90:91], 0
    v_mov_b64 v[92:93], 0
    v_mov_b64 v[94:95], 0
    s_waitcnt lgkmcnt(0)
    global_load_dwordx4 v[32:35], v2, s[36:37] sc1
    global_load_dwordx4 v[36:39], v2, s[36:37] offset:1024 sc1
    v_cndmask_b32 v56, 0, v15, s[20:21]
    v_cndmask_b32 v57, 0, v15, s[22:23]
    v_cndmask_b32 v58, 0, v15, s[24:25]
    v_cndmask_b32 v59, 0, v15, s[26:27]
CH_PAs2:
    s_waitcnt vmcnt(0)
    s_nop 0
    v_mfma_f32_16x16x32_f16 v[60:63], v[56:59], v[32:35], 0
    v_xor_b32 v0, s30, v32
    v_bitop3_b32 v0, v0, v36, s30 bitop3:0xf6
    v_mfma_f32_16x16x32_f16 v[60:63], v[56:59], v[36:39], v[60:63]
    v_and_b32 v0, 1, v0
    v_cmp_ne_u32 vcc, 0, v0
    s_cbranch_vccnz CH_PAs2_R
CH_PJs2:
    s_nop 4
    v_add_f32_dpp v60, v60, v60 row_ror:8 row_mask:0xf bank_mask:0xf
    v_add_f32_dpp v61, v61, v61 row_ror:8 row_mask:0xf bank_mask:0xf
    s_xor_b32 s30, s30, 1
    v_add_f32_dpp v60, v60, v60 row_ror:4 row_mask:0xf bank_mask:0xf
    v_add_f32_dpp v61, v61, v61 row_ror:4 row_mask:0xf bank_mask:0xf
    v_cvt_pk_bf16_f32 v12, v60, v61
    v_med3_u32 v12, v12, v10, v11
    global_store_dword v9, v12, s[32:33] sc1
    s_branch CH_LOOPs2
CH_PAs2_R:
    global_load_dwordx4 v[32:35], v2, s[36:37] sc1
    global_load_dwordx4 v[36:39], v2, s[36:37] offset:1024 sc1
    s_add_u32 s12, s12, 1
    s_mov_b32 s17, 7
    s_cmp_gt_u32 s12, 20000
    s_cbranch_scc1 TIMEOUT2
    s_branch CH_PAs2
CH_RMs2:
    global_load_dwordx4 v[96:99], v2, s[42:43] sc1
    global_load_dwordx4 v[100:103], v2, s[42:43] offset:1024 sc1
    s_add_u32 s12, s12, 1
    s_mov_b32 s17, 5
    s_cmp_gt_u32 s12, 20000
    s_cbranch_scc1 TIMEOUT2
    v_mov_b64 v[88:89], 0
    v_mov_b64 v[90:91], 0
    v_mov_b64 v[92:93], 0
    v_mov_b64 v[94:95], 0
    s_branch CH_PMs2
CH_KVs2:
    s_mov_b32 s12, 0
POLL_241:
    global_load_dword v0, v24, s[40:41] offset:1032 sc1
    s_add_u32 s12, s12, 1
    s_mov_b32 s17, 6
    s_cmp_gt_u32 s12, 20000
    s_cbranch_scc1 TIMEOUT2
    s_waitcnt vmcnt(0)
    v_cmp_ne_u32 vcc, s8, v0
    s_cbranch_vccnz POLL_241
    s_mov_b32 m0, 143360
    s_nop 0
    global_load_lds_dwordx4 v7, s[44:45] offset:0 sc1
    s_mov_b32 m0, 144128
    s_nop 0
    global_load_lds_dwordx4 v7, s[44:45] offset:256 sc1
    s_mov_b32 m0, 151552
    s_nop 0
    global_load_lds_dwordx4 v7, s[62:63] offset:0 sc1
    s_mov_b32 m0, 152320
    s_nop 0
    global_load_lds_dwordx4 v7, s[62:63] offset:256 sc1
    s_branch CH_KVRs2
CH_FINs2:
    ds_read_b128 v[104:107], v3 offset:6144
    ds_read_b128 v[108:111], v3 offset:7168
    ds_read_b128 v[112:115], v3 offset:0
    ds_read_b128 v[116:119], v3 offset:1024
    ds_read_b128 v[120:123], v3 offset:2048
    ds_read_b128 v[124:127], v3 offset:3072
    global_store_dwordx4 v2, v[28:31], s[46:47] sc1
    v_smfmac_f32_16x16x64_bf16 v[80:83], v[96:99], a[128:135], v1
    v_smfmac_f32_16x16x64_bf16 v[84:87], v[96:99], a[192:199], v1
    v_smfmac_f32_16x16x64_bf16 v[80:83], v[100:103], a[136:143], v1
    v_smfmac_f32_16x16x64_bf16 v[84:87], v[100:103], a[200:207], v1
    s_add_u32 s46, s38, 0x6800
    s_addc_u32 s47, s39, 0
    s_waitcnt lgkmcnt(5)
    v_smfmac_f32_16x16x64_bf16 v[80:83], v[104:107], a[144:151], v1
    v_smfmac_f32_16x16x64_bf16 v[84:87], v[104:107], a[208:215], v1
    v_smfmac_f32_16x16x64_bf16 v[88:91], v[104:107], v[144:151], v1
    v_smfmac_f32_16x16x64_bf16 v[92:95], v[104:107], v[208:215], v1
    s_waitcnt lgkmcnt(4)
    v_smfmac_f32_16x16x64_bf16 v[80:83], v[108:111], a[152:159], v1
    v_smfmac_f32_16x16x64_bf16 v[84:87], v[108:111], a[216:223], v1
    v_smfmac_f32_16x16x64_bf16 v[88:91], v[108:111], v[152:159], v1
    v_smfmac_f32_16x16x64_bf16 v[92:95], v[108:111], v[216:223], v1
    s_waitcnt lgkmcnt(3)
    v_smfmac_f32_16x16x64_bf16 v[80:83], v[112:115], a[160:167], v1
    v_smfmac_f32_16x16x64_bf16 v[84:87], v[112:115], a[224:231], v1
    v_smfmac_f32_16x16x64_bf16 v[88:91], v[112:115], v[160:167], v1
    v_smfmac_f32_16x16x64_bf16 v[92:95], v[112:115], v[224:231], v1
    s_waitcnt lgkmcnt(2)
    v_smfmac_f32_16x16x64_bf16 v[80:83], v[116:119], a[168:175], v1
    v_smfmac_f32_16x16x64_bf16 v[84:87], v[116:119], a[232:239], v1
    v_smfmac_f32_16x16x64_bf16 v[88:91], v[116:119], v[168:175], v1
    v_smfmac_f32_16x16x64_bf16 v[92:95], v[116:119], v[232:239], v1
    s_waitcnt lgkmcnt(1)
    v_smfmac_f32_16x16x64_bf16 v[80:83], v[120:123], a[176:183], v1
    v_smfmac_f32_16x16x64_bf16 v[84:87], v[120:123], a[240:247], v1
    s_waitcnt lgkmcnt(0)
    v_smfmac_f32_16x16x64_bf16 v[80:83], v[124:127], a[184:191], v1
    v_smfmac_f32_16x16x64_bf16 v[84:87], v[124:127], a[248:255], v1
    v_smfmac_f32_16x16x64_bf16 v[88:91], v[120:123], v[176:183], v1
    v_smfmac_f32_16x16x64_bf16 v[92:95], v[120:123], v[240:247], v1
    v_smfmac_f32_16x16x64_bf16 v[88:91], v[124:127], v[184:191], v1
    v_add_f32 v80, v80, v81
    v_add_f32 v82, v82, v83
    v_smfmac_f32_16x16x64_bf16 v[92:95], v[124:127], v[248:255], v1
    v_add_f32 v84, v84, v85
    v_add_f32 v86, v86, v87
    v_cvt_pk_bf16_f32 v81, v80, v84
    v_cvt_pk_bf16_f32 v83, v82, v86
    ds_write2_b32 v5, v81, v83 offset0:0 offset1:4
    v_add_f32 v88, v88, v89
    v_add_f32 v90, v90, v91
    s_nop 0
    v_add_f32 v92, v92, v93
    v_add_f32 v94, v94, v95
    v_cvt_pk_bf16_f32 v0, v88, v90
    v_cvt_pk_bf16_f32 v12, v92, v94
    ds_write2_b32 v13, v0, v12 offset0:0 offset1:1
    s_waitcnt lgkmcnt(0)
    ds_read_b128 v[28:31], v25 offset:26752
    s_waitcnt lgkmcnt(0)
    v_min_u32 v28, -2, v28
    global_store_dwordx4 v2, v[28:31], s[46:47] sc1
    s_endpgm
CH_INs3:
    ds_read_b128 v[104:107], v2 offset:57344
    ds_read_b128 v[108:111], v2 offset:58368
    ds_read_b128 v[112:115], v2 offset:59392
    ds_read_b128 v[116:119], v2 offset:60416
    ds_read_b128 v[120:123], v2 offset:61440
    ds_read_b128 v[124:127], v2 offset:62464
    ds_read_b128 v[64:67], v2 offset:63488
    ds_read_b128 v[68:71], v2 offset:64512
    v_mov_b64 v[72:73], 0
    v_mov_b64 v[74:75], 0
    v_mov_b64 v[76:77], 0
    v_mov_b64 v[78:79], 0
    v_mov_b64 v[80:81], 0
    v_mov_b64 v[82:83], 0
    v_mov_b64 v[84:85], 0
    v_mov_b64 v[86:87], 0
    v_mov_b64 v[88:89], 0
    v_mov_b64 v[90:91], 0
    v_mov_b64 v[92:93], 0
    v_mov_b64 v[94:95], 0
CH_LOOPs3:
    ds_read_b128 v[28:31], v25 offset:27840
    ds_read_b128 v[32:35], v2 offset:24576
    ds_read_b128 v[36:39], v2 offset:25600
    ds_read_b128 v[40:43], v2 offset:26624
    ds_read_b128 v[44:47], v2 offset:27648
    ds_read_b128 v[48:51], v2 offset:28672
    ds_read_b128 v[52:55], v2 offset:29696
    ds_read_b128 v[56:59], v2 offset:30720
    ds_read_b128 v[60:63], v2 offset:31744
    ds_read_b128 v[16:19], v3 offset:22528
    ds_read_b128 v[20:23], v3 offset:23552
    s_add_u32 s44, s38, 0xa000
    s_addc_u32 s45, s39, 0
    s_add_u32 s62, s38, 0xc000
    s_addc_u32 s63, s39, 0
    s_waitcnt lgkmcnt(0)
    global_load_dwordx4 v[96:99], v2, s[42:43] sc1
    global_load_dwordx4 v[100:103], v2, s[42:43] offset:1024 sc1
    s_mov_b32 s12, 0
    s_waitcnt lgkmcnt(0)
    v_min_u32 v28, -2, v28
CH_PMs3:
    s_waitcnt vmcnt(0)
    ds_write_b128 v3, v[96:99] offset:6144
    ds_write_b128 v3, v[100:103] offset:7168
    v_max3_u32 v0, v96, v97, v98
    v_max3_u32 v0, v0, v99, v100
    v_max3_u32 v0, v0, v101, v102
    v_max_u32 v0, v0, v103
    v_cmp_eq_u32 vcc, -1, v0
    v_smfmac_f32_16x16x64_bf16 v[88:91], v[96:99], v[104:111], v1
    v_smfmac_f32_16x16x64_bf16 v[92:95], v[96:99], v[112:119], v1
    s_cbranch_vccnz CH_RMs3
    v_smfmac_f32_16x16x64_bf16 v[88:91], v[100:103], v[120:127], v1
    v_smfmac_f32_16x16x64_bf16 v[92:95], v[100:103], v[64:71], v1
    v_smfmac_f32_16x16x64_bf16 v[72:75], v[96:99], v[32:39], v1
    s_cmp_eq_u32 s29, 63
    s_waitcnt lgkmcnt(0)
    s_barrier
    s_cbranch_scc1 CH_FINs3
    ds_read_b128 v[104:107], v3 offset:0
    ds_read_b128 v[108:111], v3 offset:1024
    v_smfmac_f32_16x16x64_bf16 v[76:79], v[96:99], v[40:47], v1
    ds_read_b128 v[112:115], v3 offset:2048
    ds_read_b128 v[116:119], v3 offset:3072
    v_smfmac_f32_16x16x64_bf16 v[72:75], v[100:103], v[48:55], v1
    ds_read_b128 v[120:123], v3 offset:4096
    ds_read_b128 v[124:127], v3 offset:5120
    v_smfmac_f32_16x16x64_bf16 v[76:79], v[100:103], v[56:63], v1
    global_load_dword v14, v24, s[40:41] offset:1036 sc1
    v_smfmac_f32_16x16x64_bf16 v[80:83], v[96:99], a[128:135], v1
    v_smfmac_f32_16x16x64_bf16 v[84:87], v[96:99], a[192:199], v1
    global_store_dwordx4 v2, v[28:31], s[46:47] sc1
    v_smfmac_f32_16x16x64_bf16 v[80:83], v[100:103], a[136:143], v1
    s_add_u32 s46, s38, 0x6c00
    s_addc_u32 s47, s39, 0
    v_smfmac_f32_16x16x64_bf16 v[84:87], v[100:103], a[200:207], v1
    s_waitcnt lgkmcnt(5)
    v_mov_b32 v28, 0x3f803f80
    v_smfmac_f32_16x16x64_bf16 v[72:75], v[104:107], a[16:23], v1
    ds_read_b128 v[32:35], v3 offset:8192
    v_mov_b32 v29, 0x3f803f80
    v_smfmac_f32_16x16x64_bf16 v[76:79], v[104:107], a[80:87], v1
    s_waitcnt lgkmcnt(5)
    ds_read_b128 v[36:39], v3 offset:10240
    v_mov_b32 v30, 0x3f803f80
    v_smfmac_f32_16x16x64_bf16 v[72:75], v[108:111], a[24:31], v1
    ds_read_b128 v[40:43], v3 offset:12288
    v_mov_b32 v31, 0x3f803f80
    v_smfmac_f32_16x16x64_bf16 v[76:79], v[108:111], a[88:95], v1
    s_waitcnt lgkmcnt(6)
    ds_read_b128 v[44:47], v3 offset:14336
    v_smfmac_f32_16x16x64_bf16 v[72:75], v[112:115], a[32:39], v1
    ds_read_b128 v[48:51], v3 offset:9216
    v_smfmac_f32_16x16x64_bf16 v[76:79], v[112:115], a[96:103], v1
    s_waitcnt lgkmcnt(7)
    ds_read_b128 v[52:55], v3 offset:11264
    v_smfmac_f32_16x16x64_bf16 v[72:75], v[116:119], a[40:47], v1
    ds_read_b128 v[56:59], v3 offset:13312
    v_smfmac_f32_16x16x64_bf16 v[76:79], v[116:119], a[104:111], v1
    s_waitcnt lgkmcnt(8)
    ds_read_b128 v[60:63], v3 offset:15360
    v_smfmac_f32_16x16x64_bf16 v[72:75], v[120:123], a[48:55], v1
    v_smfmac_f32_16x16x64_bf16 v[76:79], v[120:123], a[112:119], v1
    s_waitcnt lgkmcnt(8)
    v_smfmac_f32_16x16x64_bf16 v[72:75], v[124:127], a[56:63], v1
    v_smfmac_f32_16x16x64_bf16 v[76:79], v[124:127], a[120:127], v1
    v_smfmac_f32_16x16x64_bf16 v[80:83], v[104:107], a[144:151], v1
    v_add_f32 v72, v72, v73
    v_smfmac_f32_16x16x64_bf16 v[84:87], v[104:107], a[208:215], v1
    v_add_f32 v74, v74, v75
    v_smfmac_f32_16x16x64_bf16 v[80:83], v[108:111], a[152:159], v1
    v_add_f32 v76, v76, v77
    v_smfmac_f32_16x16x64_bf16 v[84:87], v[108:111], a[216:223], v1
    v_add_f32 v78, v78, v79
    v_smfmac_f32_16x16x64_bf16 v[80:83], v[112:115], a[160:167], v1
    v_cvt_pk_bf16_f32 v73, v72, v76
    v_smfmac_f32_16x16x64_bf16 v[84:87], v[112:115], a[224:231], v1
    v_cvt_pk_bf16_f32 v75, v74, v78
    v_smfmac_f32_16x16x64_bf16 v[80:83], v[116:119], a[168:175], v1
    ds_write2_b32 v5, v73, v75 offset0:8 offset1:12
    v_smfmac_f32_16x16x64_bf16 v[84:87], v[116:119], a[232:239], v1
    v_smfmac_f32_16x16x64_bf16 v[80:83], v[120:123], a[176:183], v1
    v_smfmac_f32_16x16x64_bf16 v[84:87], v[120:123], a[240:247], v1
    v_smfmac_f32_16x16x64_bf16 v[80:83], v[124:127], a[184:191], v1
    v_smfmac_f32_16x16x64_bf16 v[84:87], v[124:127], a[248:255], v1
    s_waitcnt vmcnt(2)
    s_waitcnt lgkmcnt(0)
    s_barrier
    ds_read_b128 v[72:75], v6 offset:24576
    v_smfmac_f32_16x16x64_bf16 v[88:91], v[104:107], v[144:151], v1
    s_mov_b32 m0, 145408
    ds_read_b128 v[76:79], v6 offset:25664
    v_add_f32 v80, v80, v81
    v_smfmac_f32_16x16x64_bf16 v[92:95], v[104:107], v[208:215], v1
    s_waitcnt vmcnt(1)
    v_cmp_ne_u32 s[54:55], s8, v14
    global_load_lds_dwordx4 v7, s[44:45] offset:0 sc1
    ds_read_b128 v[96:99], v6 offset:26752
    v_add_f32 v82, v82, v83
    v_smfmac_f32_16x16x64_bf16 v[88:91], v[108:111], v[152:159], v1
    s_mov_b32 m0, 146176
    ds_read_b128 v[100:103], v6 offset:27840
    v_add_f32 v84, v84, v85
    v_smfmac_f32_16x16x64_bf16 v[92:95], v[108:111], v[216:223], v1
    s_waitcnt lgkmcnt(3)
    global_load_lds_dwordx4 v7, s[44:45] offset:256 sc1
    v_add_f32 v86, v86, v87
    v_mfma_f32_16x16x32_bf16 v[64:67], v[32:35], v[72:75], 0
    s_mov_b32 m0, 153600
    s_waitcnt lgkmcnt(2)
    v_cvt_pk_bf16_f32 v81, v80, v84
    v_cvt_pk_bf16_f32 v83, v82, v86
    v_mfma_f32_16x16x32_bf16 v[64:67], v[36:39], v[76:79], v[64:67]
    s_waitcnt lgkmcnt(1)
    global_load_lds_dwordx4 v7, s[62:63] offset:0 sc1
    ds_write2_b32 v5, v81, v83 offset0:0 offset1:4
    v_mfma_f32_16x16x32_bf16 v[64:67], v[40:43], v[96:99], v[64:67]
    s_mov_b32 m0, 154368
    s_waitcnt lgkmcnt(1)
    v_mfma_f32_16x16x32_bf16 v[64:67], v[44:47], v[100:103], v[64:67]
    global_load_lds_dwordx4 v7, s[62:63] offset:256 sc1
    v_mfma_f32_16x16x32_bf16 v[68:71], v[48:51], v[72:75], 0
    v_mfma_f32_16x16x32_bf16 v[68:71], v[52:55], v[76:79], v[68:71]
    v_mfma_f32_16x16x32_bf16 v[68:71], v[56:59], v[96:99], v[68:71]
    s_waitcnt lgkmcnt(0)
    s_barrier
    ds_read_b128 v[32:35], v6 offset:24544
    v_mfma_f32_16x16x32_bf16 v[68:71], v[60:63], v[100:103], v[68:71]
    ds_read_b128 v[36:39], v6 offset:25632
    ds_read_b128 v[40:43], v6 offset:26720
    v_smfmac_f32_16x16x64_bf16 v[88:91], v[112:115], v[160:167], v1
    ds_read_b128 v[44:47], v6 offset:27808
    v_smfmac_f32_16x16x64_bf16 v[92:95], v[112:115], v[224:231], v1
    ds_read_b128 v[48:51], v4 offset:24576
    v_max3_f32 v84, v64, v65, v66
    v_smfmac_f32_16x16x64_bf16 v[88:91], v[116:119], v[168:175], v1
    ds_read_b128 v[52:55], v4 offset:25600
    v_max3_f32 v84, v84, v67, v68
    v_smfmac_f32_16x16x64_bf16 v[92:95], v[116:119], v[232:239], v1
    s_waitcnt lgkmcnt(5)
    ds_read_b128 v[56:59], v4 offset:57344
    v_max3_f32 v84, v84, v69, v70
    v_mfma_f32_16x16x32_bf16 v[80:83], v[32:35], v[72:75], 0
    s_waitcnt lgkmcnt(5)
    ds_read_b128 v[60:63], v4 offset:58368
    v_max_f32 v84, v84, v71
    v_mfma_f32_16x16x32_bf16 v[80:83], v[36:39], v[76:79], v[80:83]
    s_waitcnt lgkmcnt(5)
    ds_read_b128 v[32:35], v4 offset:26624
    v_mfma_f32_16x16x32_bf16 v[80:83], v[40:43], v[96:99], v[80:83]
    s_waitcnt lgkmcnt(5)
    ds_read_b128 v[36:39], v4 offset:27648
    v_mfma_f32_16x16x32_bf16 v[80:83], v[44:47], v[100:103], v[80:83]
    ds_read_b128 v[72:75], v4 offset:59392
    v_smfmac_f32_16x16x64_bf16 v[88:91], v[120:123], v[176:183], v1
    ds_read_b128 v[76:79], v4 offset:60416
    v_smfmac_f32_16x16x64_bf16 v[92:95], v[120:123], v[240:247], v1
    ds_read_b128 v[40:43], v4 offset:28672
    v_max3_f32 v85, v84, v80, v81
    v_max3_f32 v84, v84, v80, v81
    v_smfmac_f32_16x16x64_bf16 v[88:91], v[124:127], v[184:191], v1
    ds_read_b128 v[44:47], v4 offset:29696
    v_permlane32_swap_b32 v84, v85
    v_max_f32 v84, v84, v85
    v_mov_b32 v85, v84
    v_smfmac_f32_16x16x64_bf16 v[92:95], v[124:127], v[248:255], v1
    ds_read_b128 v[96:99], v4 offset:61440
    v_permlane16_swap_b32 v84, v85
    v_max_f32 v84, v84, v85
    v_mul_f32 v86, 0xbe0293ee, v84
    v_pk_fma_f32 v[64:65], v[64:65], s[56:57], v[86:87] op_sel_hi:[1,0,0]
    v_pk_fma_f32 v[66:67], v[66:67], s[56:57], v[86:87] op_sel_hi:[1,0,0]
    v_pk_fma_f32 v[68:69], v[68:69], s[56:57], v[86:87] op_sel_hi:[1,0,0]
    v_pk_fma_f32 v[70:71], v[70:71], s[56:57], v[86:87] op_sel_hi:[1,0,0]
    v_pk_fma_f32 v[80:81], v[80:81], s[56:57], v[86:87] op_sel_hi:[1,0,0]
    v_mfma_f32_32x32x8_bf16 v[104:119], v[24:25], v[26:27], 0
    ds_read_b128 v[100:103], v4 offset:62464
    v_exp_f32 v64, v64
    v_exp_f32 v65, v65
    v_exp_f32 v66, v66
    v_exp_f32 v67, v67
    v_exp_f32 v68, v68
    v_exp_f32 v69, v69
    v_exp_f32 v70, v70
    v_exp_f32 v71, v71
    v_exp_f32 v80, v80
    v_exp_f32 v81, v81
    v_cvt_pk_bf16_f32 v84, v64, v65
    v_cvt_pk_bf16_f32 v85, v66, v67
    v_cvt_pk_bf16_f32 v86, v68, v69
    v_cvt_pk_bf16_f32 v87, v70, v71
    v_add_f32 v88, v88, v89
    v_add_f32 v90, v90, v91
    v_mfma_f32_16x16x32_bf16 v[120:123], v[16:19], v[84:87], 0
    v_cvt_pk_bf16_f32 v26, v80, v81
    v_cvt_pk_bf16_f32 v0, v88, v90
    v_mfma_f32_16x16x32_bf16 v[124:127], v[20:23], v[84:87], 0
    v_add_f32 v92, v92, v93
    v_add_f32 v94, v94, v95
    v_mfma_f32_16x16x16_bf16 v[120:123], v[0:1], v[26:27], v[120:123]
    v_cvt_pk_bf16_f32 v12, v92, v94
    s_add_u32 s38, s38, 0x8000
    s_addc_u32 s39, s39, 0
    v_mfma_f32_16x16x16_bf16 v[124:127], v[12:13], v[26:27], v[124:127]
    ds_read_b128 v[64:67], v4 offset:30720
    v_mfma_f32_16x16x32_bf16 v[80:83], v[84:87], v[28:31], 0
    v_cvt_pk_bf16_f32 v92, v120, v121
    v_cvt_pk_bf16_f32 v93, v122, v123
    v_mfma_f32_16x16x16_bf16 v[80:83], v[26:27], v[28:29], v[80:83]
    v_cvt_pk_bf16_f32 v94, v124, v125
    v_cvt_pk_bf16_f32 v95, v126, v127
    v_cndmask_b32 v88, v94, v92, s[60:61]
    v_cndmask_b32 v89, v95, v93, s[60:61]
    v_smfmac_f32_16x16x64_bf16 v[104:107], v[92:95], a[0:7], v1 abid:1
    ds_write_b64 v13, v[88:89] offset:2144
    v_smfmac_f32_16x16x64_bf16 v[108:111], v[92:95], a[64:71], v1 abid:1
    v_smfmac_f32_16x16x64_bf16 v[112:115], v[92:95], a[8:15], v1 abid:1
    v_smfmac_f32_16x16x64_bf16 v[116:119], v[92:95], a[72:79], v1 abid:1
    v_add_u32 v9, 0x2000, v9
    v_and_b32 v9, 0x7fff, v9
    s_waitcnt lgkmcnt(0)
    s_barrier
    ds_read_b128 v[16:19], v6 offset:28928
    ds_read_b128 v[20:23], v6 offset:28896
    ds_read_b128 v[88:91], v6 offset:30016
    ds_write2_b32 v13, v0, v12 offset0:0 offset1:1
    v_rcp_f32 v0, v82
    v_rcp_f32 v12, v83
    s_waitcnt lgkmcnt(3)
    v_smfmac_f32_16x16x64_bf16 v[104:107], v[16:19], v[128:135], v1 abid:1
    s_waitcnt lgkmcnt(2)
    ds_read_b128 v[68:71], v4 offset:31744
    v_smfmac_f32_16x16x64_bf16 v[104:107], v[20:23], v[48:55], v1 abid:1
    s_waitcnt lgkmcnt(2)
    ds_read_b128 v[120:123], v4 offset:63488
    v_smfmac_f32_16x16x64_bf16 v[104:107], v[88:91], v[56:63], v1 abid:1
    ds_read_b128 v[124:127], v4 offset:64512
    v_smfmac_f32_16x16x64_bf16 v[108:111], v[16:19], v[192:199], v1 abid:1
    v_smfmac_f32_16x16x64_bf16 v[108:111], v[20:23], v[32:39], v1 abid:1
    v_fma_mixlo_f16 v28, v104, v0, 0
    v_fma_mixlo_f16 v30, v105, v12, 0
    v_smfmac_f32_16x16x64_bf16 v[108:111], v[88:91], v[72:79], v1 abid:1
    v_and_or_b32 v28, v28, -2, s30
    v_fma_mixhi_f16 v28, v106, v0, 0
    v_smfmac_f32_16x16x64_bf16 v[112:115], v[16:19], v[136:143], v1 abid:1
    v_fma_mixhi_f16 v30, v107, v12, 0
    v_smfmac_f32_16x16x64_bf16 v[112:115], v[20:23], v[40:47], v1 abid:1
    v_fma_mixlo_f16 v29, v108, v0, 0
    v_fma_mixlo_f16 v31, v109, v12, 0
    v_smfmac_f32_16x16x64_bf16 v[112:115], v[88:91], v[96:103], v1 abid:1
    v_fma_mixhi_f16 v29, v110, v0, 0
    v_fma_mixhi_f16 v31, v111, v12, 0
    v_smfmac_f32_16x16x64_bf16 v[116:119], v[16:19], v[200:207], v1 abid:1
    s_waitcnt lgkmcnt(2)
    global_store_dwordx4 v8, v[28:31], s[34:35] sc1
    v_smfmac_f32_16x16x64_bf16 v[116:119], v[20:23], v[64:71], v1 abid:1
    s_waitcnt lgkmcnt(0)
    v_fma_mixlo_f16 v84, v112, v0, 0
    v_fma_mixlo_f16 v86, v113, v12, 0
    v_smfmac_f32_16x16x64_bf16 v[116:119], v[88:91], v[120:127], v1 abid:1
    v_and_or_b32 v84, v84, -2, s30
    v_fma_mixhi_f16 v84, v114, v0, 0
    v_fma_mixhi_f16 v86, v115, v12, 0
    s_nop 4
    v_fma_mixlo_f16 v85, v116, v0, 0
    v_fma_mixlo_f16 v87, v117, v12, 0
    v_fma_mixhi_f16 v85, v118, v0, 0
    v_fma_mixhi_f16 v87, v119, v12, 0
    global_store_dwordx4 v8, v[84:87], s[50:51] sc1
    s_cmp_lg_u64 s[54:55], 0
    s_cbranch_scc1 CH_KVs3
CH_KVRs3:
    ds_read_b128 v[104:107], v2 offset:57344
    ds_read_b128 v[108:111], v2 offset:58368
    ds_read_b128 v[112:115], v2 offset:59392
    ds_read_b128 v[116:119], v2 offset:60416
    ds_read_b128 v[120:123], v2 offset:61440
    ds_read_b128 v[124:127], v2 offset:62464
    ds_read_b128 v[64:67], v2 offset:63488
    ds_read_b128 v[68:71], v2 offset:64512
    s_add_u32 s40, s40, 0x400
    s_addc_u32 s41, s41, 0
    s_add_u32 s59, s59, 0x2000
    s_and_b32 s59, s59, 0x7fff
    s_add_u32 s42, s52, s59
    s_addc_u32 s43, s53, 0
    s_mov_b32 s12, 0
    s_add_u32 s29, s29, 1
    v_mov_b64 v[72:73], 0
    v_mov_b64 v[74:75], 0
    v_mov_b64 v[76:77], 0
    v_mov_b64 v[78:79], 0
    v_mov_b64 v[80:81], 0
    v_mov_b64 v[82:83], 0
    v_mov_b64 v[84:85], 0
    v_mov_b64 v[86:87], 0
    v_mov_b64 v[88:89], 0
    v_mov_b64 v[90:91], 0
    v_mov_b64 v[92:93], 0
    v_mov_b64 v[94:95], 0
    s_waitcnt lgkmcnt(0)
    global_load_dwordx4 v[32:35], v2, s[36:37] sc1
    global_load_dwordx4 v[36:39], v2, s[36:37] offset:1024 sc1
    v_cndmask_b32 v56, 0, v15, s[20:21]
    v_cndmask_b32 v57, 0, v15, s[22:23]
    v_cndmask_b32 v58, 0, v15, s[24:25]
    v_cndmask_b32 v59, 0, v15, s[26:27]
CH_PAs3:
    s_waitcnt vmcnt(0)
    s_nop 0
    v_mfma_f32_16x16x32_f16 v[60:63], v[56:59], v[32:35], 0
    v_xor_b32 v0, s30, v32
    v_bitop3_b32 v0, v0, v36, s30 bitop3:0xf6
    v_mfma_f32_16x16x32_f16 v[60:63], v[56:59], v[36:39], v[60:63]
    v_and_b32 v0, 1, v0
    v_cmp_ne_u32 vcc, 0, v0
    s_cbranch_vccnz CH_PAs3_R
CH_PJs3:
    s_nop 4
    v_add_f32_dpp v60, v60, v60 row_ror:8 row_mask:0xf bank_mask:0xf
    v_add_f32_dpp v61, v61, v61 row_ror:8 row_mask:0xf bank_mask:0xf
    s_xor_b32 s30, s30, 1
    v_add_f32_dpp v60, v60, v60 row_ror:4 row_mask:0xf bank_mask:0xf
    v_add_f32_dpp v61, v61, v61 row_ror:4 row_mask:0xf bank_mask:0xf
    v_cvt_pk_bf16_f32 v12, v60, v61
    v_med3_u32 v12, v12, v10, v11
    global_store_dword v9, v12, s[32:33] sc1
    s_branch CH_LOOPs3
CH_PAs3_R:
    global_load_dwordx4 v[32:35], v2, s[36:37] sc1
    global_load_dwordx4 v[36:39], v2, s[36:37] offset:1024 sc1
    s_add_u32 s12, s12, 1
    s_mov_b32 s17, 7
    s_cmp_gt_u32 s12, 20000
    s_cbranch_scc1 TIMEOUT2
    s_branch CH_PAs3
CH_RMs3:
    global_load_dwordx4 v[96:99], v2, s[42:43] sc1
    global_load_dwordx4 v[100:103], v2, s[42:43] offset:1024 sc1
    s_add_u32 s12, s12, 1
    s_mov_b32 s17, 5
    s_cmp_gt_u32 s12, 20000
    s_cbranch_scc1 TIMEOUT2
    v_mov_b64 v[88:89], 0
    v_mov_b64 v[90:91], 0
    v_mov_b64 v[92:93], 0
    v_mov_b64 v[94:95], 0
    s_branch CH_PMs3
CH_KVs3:
    s_mov_b32 s12, 0
POLL_242:
    global_load_dword v0, v24, s[40:41] offset:1036 sc1
    s_add_u32 s12, s12, 1
    s_mov_b32 s17, 6
    s_cmp_gt_u32 s12, 20000
    s_cbranch_scc1 TIMEOUT2
    s_waitcnt vmcnt(0)
    v_cmp_ne_u32 vcc, s8, v0
    s_cbranch_vccnz POLL_242
    s_mov_b32 m0, 145408
    s_nop 0
    global_load_lds_dwordx4 v7, s[44:45] offset:0 sc1
    s_mov_b32 m0, 146176
    s_nop 0
    global_load_lds_dwordx4 v7, s[44:45] offset:256 sc1
    s_mov_b32 m0, 153600
    s_nop 0
    global_load_lds_dwordx4 v7, s[62:63] offset:0 sc1
    s_mov_b32 m0, 154368
    s_nop 0
    global_load_lds_dwordx4 v7, s[62:63] offset:256 sc1
    s_branch CH_KVRs3
CH_FINs3:
    ds_read_b128 v[104:107], v3 offset:0
    ds_read_b128 v[108:111], v3 offset:1024
    ds_read_b128 v[112:115], v3 offset:2048
    ds_read_b128 v[116:119], v3 offset:3072
    ds_read_b128 v[120:123], v3 offset:4096
    ds_read_b128 v[124:127], v3 offset:5120
    global_store_dwordx4 v2, v[28:31], s[46:47] sc1
    v_smfmac_f32_16x16x64_bf16 v[80:83], v[96:99], a[128:135], v1
    v_smfmac_f32_16x16x64_bf16 v[84:87], v[96:99], a[192:199], v1
    v_smfmac_f32_16x16x64_bf16 v[80:83], v[100:103], a[136:143], v1
    v_smfmac_f32_16x16x64_bf16 v[84:87], v[100:103], a[200:207], v1
    s_add_u32 s46, s38, 0x6c00
    s_addc_u32 s47, s39, 0
    s_waitcnt lgkmcnt(5)
    v_smfmac_f32_16x16x64_bf16 v[80:83], v[104:107], a[144:151], v1
    v_smfmac_f32_16x16x64_bf16 v[84:87], v[104:107], a[208:215], v1
    v_smfmac_f32_16x16x64_bf16 v[88:91], v[104:107], v[144:151], v1
    v_smfmac_f32_16x16x64_bf16 v[92:95], v[104:107], v[208:215], v1
    s_waitcnt lgkmcnt(4)
    v_smfmac_f32_16x16x64_bf16 v[80:83], v[108:111], a[152:159], v1
    v_smfmac_f32_16x16x64_bf16 v[84:87], v[108:111], a[216:223], v1
    v_smfmac_f32_16x16x64_bf16 v[88:91], v[108:111], v[152:159], v1
    v_smfmac_f32_16x16x64_bf16 v[92:95], v[108:111], v[216:223], v1
    s_waitcnt lgkmcnt(3)
    v_smfmac_f32_16x16x64_bf16 v[80:83], v[112:115], a[160:167], v1
    v_smfmac_f32_16x16x64_bf16 v[84:87], v[112:115], a[224:231], v1
    v_smfmac_f32_16x16x64_bf16 v[88:91], v[112:115], v[160:167], v1
    v_smfmac_f32_16x16x64_bf16 v[92:95], v[112:115], v[224:231], v1
    s_waitcnt lgkmcnt(2)
    v_smfmac_f32_16x16x64_bf16 v[80:83], v[116:119], a[168:175], v1
    v_smfmac_f32_16x16x64_bf16 v[84:87], v[116:119], a[232:239], v1
    v_smfmac_f32_16x16x64_bf16 v[88:91], v[116:119], v[168:175], v1
    v_smfmac_f32_16x16x64_bf16 v[92:95], v[116:119], v[232:239], v1
    s_waitcnt lgkmcnt(1)
    v_smfmac_f32_16x16x64_bf16 v[80:83], v[120:123], a[176:183], v1
    v_smfmac_f32_16x16x64_bf16 v[84:87], v[120:123], a[240:247], v1
    s_waitcnt lgkmcnt(0)
    v_smfmac_f32_16x16x64_bf16 v[80:83], v[124:127], a[184:191], v1
    v_smfmac_f32_16x16x64_bf16 v[84:87], v[124:127], a[248:255], v1
    v_smfmac_f32_16x16x64_bf16 v[88:91], v[120:123], v[176:183], v1
    v_smfmac_f32_16x16x64_bf16 v[92:95], v[120:123], v[240:247], v1
    v_smfmac_f32_16x16x64_bf16 v[88:91], v[124:127], v[184:191], v1
    v_add_f32 v80, v80, v81
    v_add_f32 v82, v82, v83
    v_smfmac_f32_16x16x64_bf16 v[92:95], v[124:127], v[248:255], v1
    v_add_f32 v84, v84, v85
    v_add_f32 v86, v86, v87
    v_cvt_pk_bf16_f32 v81, v80, v84
    v_cvt_pk_bf16_f32 v83, v82, v86
    ds_write2_b32 v5, v81, v83 offset0:0 offset1:4
    v_add_f32 v88, v88, v89
    v_add_f32 v90, v90, v91
    s_nop 0
    v_add_f32 v92, v92, v93
    v_add_f32 v94, v94, v95
    v_cvt_pk_bf16_f32 v0, v88, v90
    v_cvt_pk_bf16_f32 v12, v92, v94
    ds_write2_b32 v13, v0, v12 offset0:0 offset1:1
    s_waitcnt lgkmcnt(0)
    ds_read_b128 v[28:31], v25 offset:27840
    s_waitcnt lgkmcnt(0)
    v_min_u32 v28, -2, v28
    global_store_dwordx4 v2, v[28:31], s[46:47] sc1
    s_endpgm
ROLE_FFN:
    s_load_dwordx4 s[20:23], s[0:1], 64
    s_sub_u32 s13, s10, 6
    s_lshl_b32 s24, s9, 13
    v_lshrrev_b32 v14, 4, v0
    v_lshlrev_b32 v15, 2, v14
    v_and_b32 v128, 15, v0
    v_xor_b32 v128, v128, v15
    v_lshlrev_b32 v128, 4, v128
    v_mul_u32_u24 v14, 3584, v14
    v_add_u32 v128, v128, v14
    s_mul_i32 s14, s9, 114688
    s_lshl_b32 s15, s11, 8
    s_add_u32 s14, s14, s15
    v_add_u32 v128, s14, v128
    v_lshrrev_b32 v14, 4, v0
    v_lshlrev_b32 v15, 2, v14
    v_and_b32 v129, 15, v0
    v_xor_b32 v129, v129, v15
    v_lshlrev_b32 v129, 4, v129
    v_mul_u32_u24 v14, 1024, v14
    v_add_u32 v129, v129, v14
    s_lshl_b32 s14, s9, 15
    s_lshl_b32 s15, s11, 17
    s_add_u32 s14, s14, s15
    v_add_u32 v129, s14, v129
    v_bfe_u32 v14, v0, 2, 2
    v_mul_u32_u24 v130, 320, v14
    v_bfe_u32 v14, v0, 4, 1
    v_lshl_add_u32 v130, v14, 5, v130
    v_and_b32 v14, 3, v0
    v_lshl_add_u32 v130, v14, 3, v130
    v_lshrrev_b32 v14, 5, v0
    v_mul_u32_u24 v14, 2048, v14
    v_add_u32 v130, v130, v14
    s_lshl_b32 s14, s9, 6
    v_xor_b32 v130, s14, v130
    v_bfe_u32 v14, v0, 2, 2
    v_mul_u32_u24 v134, 320, v14
    v_bfe_u32 v14, v0, 4, 1
    v_lshl_add_u32 v134, v14, 5, v134
    v_and_b32 v14, 1, v0
    v_lshl_add_u32 v134, v14, 4, v134
    v_bfe_u32 v14, v0, 1, 1
    v_lshl_add_u32 v134, v14, 3, v134
    v_lshrrev_b32 v14, 5, v0
    v_mul_u32_u24 v14, 1024, v14
    v_add_u32 v134, v134, v14
    s_lshl_b32 s14, s9, 6
    v_xor_b32 v134, s14, v134
    v_add_u32 v131, 0x10000, v130
    v_add_u32 v132, 0x20000, v130
    v_lshlrev_b32 v1, 4, v0
    v_add_u32 v6, s24, v1
    s_lshl_b32 s14, s9, 11
    s_add_u32 s14, s14, 32768
    v_add_u32 v10, s14, v1
    s_add_u32 s14, s9, 1
    s_and_b32 s14, s14, 3
    s_lshl_b32 s15, s14, 13
    v_add_u32 v7, s15, v1
    s_lshl_b32 s15, s14, 11
    s_add_u32 s15, s15, 32768
    v_add_u32 v11, s15, v1
    s_add_u32 s14, s9, 2
    s_and_b32 s14, s14, 3
    s_lshl_b32 s15, s14, 13
    v_add_u32 v8, s15, v1
    s_lshl_b32 s15, s14, 11
    s_add_u32 s15, s15, 32768
    v_add_u32 v12, s15, v1
    s_add_u32 s14, s9, 3
    s_and_b32 s14, s14, 3
    s_lshl_b32 s15, s14, 13
    v_add_u32 v9, s15, v1
    s_lshl_b32 s15, s14, 11
    s_add_u32 s15, s15, 32768
    v_add_u32 v13, s15, v1
    v_bfe_u32 v14, v0, 2, 3
    v_lshlrev_b32 v1, 7, v14
    v_lshrrev_b32 v14, 5, v0
    v_lshl_add_u32 v1, v14, 6, v1
    v_and_b32 v14, 3, v0
    v_lshl_add_u32 v1, v14, 4, v1
    v_add_u32 v2, 0, v1
    v_add_u32 v3, 8192, v1
    v_add_u32 v4, 16384, v1
    v_add_u32 v5, 24576, v1
    v_mov_b32 v20, -1
    v_mov_b32 v21, -1
    v_mov_b32 v22, -1
    v_mov_b32 v23, -1
    s_waitcnt lgkmcnt(0)
    s_lshl_b32 s14, s13, 22
    s_add_u32 s14, s14, s24
    s_add_u32 s14, s14, 6295552
    s_add_u32 s34, s4, s14
    s_addc_u32 s35, s5, 0
    s_mov_b64 s[44:45], s[34:35]
    s_mul_i32 s14, s13, 2097152
    s_lshl_b32 s15, s11, 15
    s_add_u32 s14, s14, s15
    s_lshl_b32 s15, s9, 11
    s_add_u32 s14, s14, s15
    s_add_u32 s14, s14, 163577856
    s_add_u32 s38, s4, s14
    s_addc_u32 s39, s5, 0
    v_mov_b32 v14, 0
    global_load_dword v14, v14, s[4:5] sc1
    s_waitcnt vmcnt(0)
    v_readfirstlane_b32 s8, v14
    s_add_u32 s8, s8, 1
    s_lshl_b32 s14, s13, 10
    s_add_u32 s14, s14, 335872
    v_mov_b32 v15, s14
    s_mov_b32 s12, 0
POLL_243:
    global_load_dword v14, v15, s[4:5] offset:0 sc1
    s_add_u32 s12, s12, 1
    s_mov_b32 s17, 28
    s_cmp_gt_u32 s12, 20000
    s_cbranch_scc1 TIMEOUT2
    s_waitcnt vmcnt(0)
    v_cmp_ne_u32 vcc, s8, v14
    s_cbranch_vccnz POLL_243
    s_cmp_eq_u32 s13, 0
    s_cbranch_scc1 LS_244_E
    v_lshlrev_b32 v25, 4, v0
    v_add_u32 v25, 327680, v25
    s_mov_b32 s12, 0
LS_244:
    global_load_dword v24, v25, s[4:5] sc1
    s_add_u32 s12, s12, 1
    s_mov_b32 s17, 22
    s_cmp_gt_u32 s12, 20000
    s_cbranch_scc1 TIMEOUT2
    s_waitcnt vmcnt(0)
    v_cmp_ne_u32 vcc, s8, v24
    s_cbranch_vccnz LS_244
LS_244_E:
    s_add_u32 s26, s20, 0x0
    s_addc_u32 s27, s21, 0
    s_add_u32 m0, s24, 0
    s_nop 0
    global_load_lds_dwordx4 v128, s[26:27]
    s_add_u32 s26, s20, 0x3800
    s_addc_u32 s27, s21, 0
    s_add_u32 m0, s24, 1024
    s_nop 0
    global_load_lds_dwordx4 v128, s[26:27]
    s_add_u32 s26, s20, 0x7000
    s_addc_u32 s27, s21, 0
    s_add_u32 m0, s24, 2048
    s_nop 0
    global_load_lds_dwordx4 v128, s[26:27]
    s_add_u32 s26, s20, 0xa800
    s_addc_u32 s27, s21, 0
    s_add_u32 m0, s24, 3072
    s_nop 0
    global_load_lds_dwordx4 v128, s[26:27]
    s_add_u32 s26, s20, 0xe000
    s_addc_u32 s27, s21, 0
    s_add_u32 m0, s24, 4096
    s_nop 0
    global_load_lds_dwordx4 v128, s[26:27]
    s_add_u32 s26, s20, 0x11800
    s_addc_u32 s27, s21, 0
    s_add_u32 m0, s24, 5120
    s_nop 0
    global_load_lds_dwordx4 v128, s[26:27]
    s_add_u32 s26, s20, 0x15000
    s_addc_u32 s27, s21, 0
    s_add_u32 m0, s24, 6144
    s_nop 0
    global_load_lds_dwordx4 v128, s[26:27]
    s_add_u32 s26, s20, 0x18800
    s_addc_u32 s27, s21, 0
    s_add_u32 m0, s24, 7168
    s_nop 0
    global_load_lds_dwordx4 v128, s[26:27]
    s_add_u32 s26, s20, 0x70000
    s_addc_u32 s27, s21, 0
    s_add_u32 m0, s24, 32768
    s_nop 0
    global_load_lds_dwordx4 v128, s[26:27]
    s_add_u32 s26, s20, 0x73800
    s_addc_u32 s27, s21, 0
    s_add_u32 m0, s24, 33792
    s_nop 0
    global_load_lds_dwordx4 v128, s[26:27]
    s_add_u32 s26, s20, 0x77000
    s_addc_u32 s27, s21, 0
    s_add_u32 m0, s24, 34816
    s_nop 0
    global_load_lds_dwordx4 v128, s[26:27]
    s_add_u32 s26, s20, 0x7a800
    s_addc_u32 s27, s21, 0
    s_add_u32 m0, s24, 35840
    s_nop 0
    global_load_lds_dwordx4 v128, s[26:27]
    s_add_u32 s26, s20, 0x7e000
    s_addc_u32 s27, s21, 0
    s_add_u32 m0, s24, 36864
    s_nop 0
    global_load_lds_dwordx4 v128, s[26:27]
    s_add_u32 s26, s20, 0x81800
    s_addc_u32 s27, s21, 0
    s_add_u32 m0, s24, 37888
    s_nop 0
    global_load_lds_dwordx4 v128, s[26:27]
    s_add_u32 s26, s20, 0x85000
    s_addc_u32 s27, s21, 0
    s_add_u32 m0, s24, 38912
    s_nop 0
    global_load_lds_dwordx4 v128, s[26:27]
    s_add_u32 s26, s20, 0x88800
    s_addc_u32 s27, s21, 0
    s_add_u32 m0, s24, 39936
    s_nop 0
    global_load_lds_dwordx4 v128, s[26:27]
    s_add_u32 s26, s20, 0xe0000
    s_addc_u32 s27, s21, 0
    s_add_u32 m0, s24, 65536
    s_nop 0
    global_load_lds_dwordx4 v128, s[26:27]
    s_add_u32 s26, s20, 0xe3800
    s_addc_u32 s27, s21, 0
    s_add_u32 m0, s24, 66560
    s_nop 0
    global_load_lds_dwordx4 v128, s[26:27]
    s_add_u32 s26, s20, 0xe7000
    s_addc_u32 s27, s21, 0
    s_add_u32 m0, s24, 67584
    s_nop 0
    global_load_lds_dwordx4 v128, s[26:27]
    s_add_u32 s26, s20, 0xea800
    s_addc_u32 s27, s21, 0
    s_add_u32 m0, s24, 68608
    s_nop 0
    global_load_lds_dwordx4 v128, s[26:27]
    s_add_u32 s26, s20, 0xee000
    s_addc_u32 s27, s21, 0
    s_add_u32 m0, s24, 69632
    s_nop 0
    global_load_lds_dwordx4 v128, s[26:27]
    s_add_u32 s26, s20, 0xf1800
    s_addc_u32 s27, s21, 0
    s_add_u32 m0, s24, 70656
    s_nop 0
    global_load_lds_dwordx4 v128, s[26:27]
    s_add_u32 s26, s20, 0xf5000
    s_addc_u32 s27, s21, 0
    s_add_u32 m0, s24, 71680
    s_nop 0
    global_load_lds_dwordx4 v128, s[26:27]
    s_add_u32 s26, s20, 0xf8800
    s_addc_u32 s27, s21, 0
    s_add_u32 m0, s24, 72704
    s_nop 0
    global_load_lds_dwordx4 v128, s[26:27]
    s_add_u32 s26, s20, 0x150000
    s_addc_u32 s27, s21, 0
    s_add_u32 m0, s24, 98304
    s_nop 0
    global_load_lds_dwordx4 v128, s[26:27]
    s_add_u32 s26, s20, 0x153800
    s_addc_u32 s27, s21, 0
    s_add_u32 m0, s24, 99328
    s_nop 0
    global_load_lds_dwordx4 v128, s[26:27]
    s_add_u32 s26, s20, 0x157000
    s_addc_u32 s27, s21, 0
    s_add_u32 m0, s24, 100352
    s_nop 0
    global_load_lds_dwordx4 v128, s[26:27]
    s_add_u32 s26, s20, 0x15a800
    s_addc_u32 s27, s21, 0
    s_add_u32 m0, s24, 101376
    s_nop 0
    global_load_lds_dwordx4 v128, s[26:27]
    s_add_u32 s26, s20, 0x15e000
    s_addc_u32 s27, s21, 0
    s_add_u32 m0, s24, 102400
    s_nop 0
    global_load_lds_dwordx4 v128, s[26:27]
    s_add_u32 s26, s20, 0x161800
    s_addc_u32 s27, s21, 0
    s_add_u32 m0, s24, 103424
    s_nop 0
    global_load_lds_dwordx4 v128, s[26:27]
    s_add_u32 s26, s20, 0x165000
    s_addc_u32 s27, s21, 0
    s_add_u32 m0, s24, 104448
    s_nop 0
    global_load_lds_dwordx4 v128, s[26:27]
    s_add_u32 s26, s20, 0x168800
    s_addc_u32 s27, s21, 0
    s_add_u32 m0, s24, 105472
    s_nop 0
    global_load_lds_dwordx4 v128, s[26:27]
    s_add_u32 s26, s22, 0x0
    s_addc_u32 s27, s23, 0
    s_add_u32 m0, s24, 131072
    s_nop 0
    global_load_lds_dwordx4 v129, s[26:27]
    s_add_u32 s26, s22, 0x1000
    s_addc_u32 s27, s23, 0
    s_add_u32 m0, s24, 132096
    s_nop 0
    global_load_lds_dwordx4 v129, s[26:27]
    s_add_u32 s26, s22, 0x2000
    s_addc_u32 s27, s23, 0
    s_add_u32 m0, s24, 133120
    s_nop 0
    global_load_lds_dwordx4 v129, s[26:27]
    s_add_u32 s26, s22, 0x3000
    s_addc_u32 s27, s23, 0
    s_add_u32 m0, s24, 134144
    s_nop 0
    global_load_lds_dwordx4 v129, s[26:27]
    s_add_u32 s26, s22, 0x4000
    s_addc_u32 s27, s23, 0
    s_add_u32 m0, s24, 135168
    s_nop 0
    global_load_lds_dwordx4 v129, s[26:27]
    s_add_u32 s26, s22, 0x5000
    s_addc_u32 s27, s23, 0
    s_add_u32 m0, s24, 136192
    s_nop 0
    global_load_lds_dwordx4 v129, s[26:27]
    s_add_u32 s26, s22, 0x6000
    s_addc_u32 s27, s23, 0
    s_add_u32 m0, s24, 137216
    s_nop 0
    global_load_lds_dwordx4 v129, s[26:27]
    s_add_u32 s26, s22, 0x7000
    s_addc_u32 s27, s23, 0
    s_add_u32 m0, s24, 138240
    s_nop 0
    global_load_lds_dwordx4 v129, s[26:27]
    s_waitcnt vmcnt(32)
    s_barrier
    s_cmp_lg_u32 s9, 0
    s_cbranch_scc1 FFR_246
    ds_read_b64_tr_b16 a[0:1], v130 offset:0
    ds_read_b64_tr_b16 a[2:3], v130 offset:1024
    ds_read_b64_tr_b16 a[4:5], v130 offset:4096
    ds_read_b64_tr_b16 a[6:7], v130 offset:5120
    ds_read_b64_tr_b16 a[8:9], v130 offset:8192
    ds_read_b64_tr_b16 a[10:11], v130 offset:9216
    ds_read_b64_tr_b16 a[12:13], v130 offset:12288
    ds_read_b64_tr_b16 a[14:15], v130 offset:13312
    ds_read_b64_tr_b16 a[16:17], v130 offset:16384
    ds_read_b64_tr_b16 a[18:19], v130 offset:17408
    ds_read_b64_tr_b16 a[20:21], v130 offset:20480
    ds_read_b64_tr_b16 a[22:23], v130 offset:21504
    ds_read_b64_tr_b16 a[24:25], v130 offset:24576
    ds_read_b64_tr_b16 a[26:27], v130 offset:25600
    ds_read_b64_tr_b16 a[28:29], v130 offset:28672
    ds_read_b64_tr_b16 a[30:31], v130 offset:29696
    s_branch FFR_245
FFR_246:
    s_cmp_lg_u32 s9, 1
    s_cbranch_scc1 FFR_247
    ds_read_b64_tr_b16 a[96:97], v130 offset:0
    ds_read_b64_tr_b16 a[98:99], v130 offset:1024
    ds_read_b64_tr_b16 a[100:101], v130 offset:4096
    ds_read_b64_tr_b16 a[102:103], v130 offset:5120
    ds_read_b64_tr_b16 a[104:105], v130 offset:8192
    ds_read_b64_tr_b16 a[106:107], v130 offset:9216
    ds_read_b64_tr_b16 a[108:109], v130 offset:12288
    ds_read_b64_tr_b16 a[110:111], v130 offset:13312
    ds_read_b64_tr_b16 a[112:113], v130 offset:16384
    ds_read_b64_tr_b16 a[114:115], v130 offset:17408
    ds_read_b64_tr_b16 a[116:117], v130 offset:20480
    ds_read_b64_tr_b16 a[118:119], v130 offset:21504
    ds_read_b64_tr_b16 a[120:121], v130 offset:24576
    ds_read_b64_tr_b16 a[122:123], v130 offset:25600
    ds_read_b64_tr_b16 a[124:125], v130 offset:28672
    ds_read_b64_tr_b16 a[126:127], v130 offset:29696
    s_branch FFR_245
FFR_247:
    s_cmp_lg_u32 s9, 2
    s_cbranch_scc1 FFR_248
    ds_read_b64_tr_b16 a[64:65], v130 offset:0
    ds_read_b64_tr_b16 a[66:67], v130 offset:1024
    ds_read_b64_tr_b16 a[68:69], v130 offset:4096
    ds_read_b64_tr_b16 a[70:71], v130 offset:5120
    ds_read_b64_tr_b16 a[72:73], v130 offset:8192
    ds_read_b64_tr_b16 a[74:75], v130 offset:9216
    ds_read_b64_tr_b16 a[76:77], v130 offset:12288
    ds_read_b64_tr_b16 a[78:79], v130 offset:13312
    ds_read_b64_tr_b16 a[80:81], v130 offset:16384
    ds_read_b64_tr_b16 a[82:83], v130 offset:17408
    ds_read_b64_tr_b16 a[84:85], v130 offset:20480
    ds_read_b64_tr_b16 a[86:87], v130 offset:21504
    ds_read_b64_tr_b16 a[88:89], v130 offset:24576
    ds_read_b64_tr_b16 a[90:91], v130 offset:25600
    ds_read_b64_tr_b16 a[92:93], v130 offset:28672
    ds_read_b64_tr_b16 a[94:95], v130 offset:29696
    s_branch FFR_245
FFR_248:
    ds_read_b64_tr_b16 a[32:33], v130 offset:0
    ds_read_b64_tr_b16 a[34:35], v130 offset:1024
    ds_read_b64_tr_b16 a[36:37], v130 offset:4096
    ds_read_b64_tr_b16 a[38:39], v130 offset:5120
    ds_read_b64_tr_b16 a[40:41], v130 offset:8192
    ds_read_b64_tr_b16 a[42:43], v130 offset:9216
    ds_read_b64_tr_b16 a[44:45], v130 offset:12288
    ds_read_b64_tr_b16 a[46:47], v130 offset:13312
    ds_read_b64_tr_b16 a[48:49], v130 offset:16384
    ds_read_b64_tr_b16 a[50:51], v130 offset:17408
    ds_read_b64_tr_b16 a[52:53], v130 offset:20480
    ds_read_b64_tr_b16 a[54:55], v130 offset:21504
    ds_read_b64_tr_b16 a[56:57], v130 offset:24576
    ds_read_b64_tr_b16 a[58:59], v130 offset:25600
    ds_read_b64_tr_b16 a[60:61], v130 offset:28672
    ds_read_b64_tr_b16 a[62:63], v130 offset:29696
FFR_245:
    s_waitcnt lgkmcnt(0)
    s_barrier
    s_add_u32 s26, s22, 0x100
    s_addc_u32 s27, s23, 0
    s_add_u32 m0, s24, 0
    s_nop 0
    global_load_lds_dwordx4 v129, s[26:27]
    s_add_u32 s26, s22, 0x1100
    s_addc_u32 s27, s23, 0
    s_add_u32 m0, s24, 1024
    s_nop 0
    global_load_lds_dwordx4 v129, s[26:27]
    s_add_u32 s26, s22, 0x2100
    s_addc_u32 s27, s23, 0
    s_add_u32 m0, s24, 2048
    s_nop 0
    global_load_lds_dwordx4 v129, s[26:27]
    s_add_u32 s26, s22, 0x3100
    s_addc_u32 s27, s23, 0
    s_add_u32 m0, s24, 3072
    s_nop 0
    global_load_lds_dwordx4 v129, s[26:27]
    s_add_u32 s26, s22, 0x4100
    s_addc_u32 s27, s23, 0
    s_add_u32 m0, s24, 4096
    s_nop 0
    global_load_lds_dwordx4 v129, s[26:27]
    s_add_u32 s26, s22, 0x5100
    s_addc_u32 s27, s23, 0
    s_add_u32 m0, s24, 5120
    s_nop 0
    global_load_lds_dwordx4 v129, s[26:27]
    s_add_u32 s26, s22, 0x6100
    s_addc_u32 s27, s23, 0
    s_add_u32 m0, s24, 6144
    s_nop 0
    global_load_lds_dwordx4 v129, s[26:27]
    s_add_u32 s26, s22, 0x7100
    s_addc_u32 s27, s23, 0
    s_add_u32 m0, s24, 7168
    s_nop 0
    global_load_lds_dwordx4 v129, s[26:27]
    s_waitcnt vmcnt(32)
    s_barrier
    s_cmp_lg_u32 s9, 0
    s_cbranch_scc1 FFR_251
    ds_read_b64_tr_b16 a[32:33], v130 offset:32768
    ds_read_b64_tr_b16 a[34:35], v130 offset:33792
    ds_read_b64_tr_b16 a[36:37], v130 offset:36864
    ds_read_b64_tr_b16 a[38:39], v130 offset:37888
    ds_read_b64_tr_b16 a[40:41], v130 offset:40960
    ds_read_b64_tr_b16 a[42:43], v130 offset:41984
    ds_read_b64_tr_b16 a[44:45], v130 offset:45056
    ds_read_b64_tr_b16 a[46:47], v130 offset:46080
    ds_read_b64_tr_b16 a[48:49], v130 offset:49152
    ds_read_b64_tr_b16 a[50:51], v130 offset:50176
    ds_read_b64_tr_b16 a[52:53], v130 offset:53248
    ds_read_b64_tr_b16 a[54:55], v130 offset:54272
    ds_read_b64_tr_b16 a[56:57], v130 offset:57344
    ds_read_b64_tr_b16 a[58:59], v130 offset:58368
    ds_read_b64_tr_b16 a[60:61], v130 offset:61440
    ds_read_b64_tr_b16 a[62:63], v130 offset:62464
    s_branch FFR_250
FFR_251:
    s_cmp_lg_u32 s9, 1
    s_cbranch_scc1 FFR_252
    ds_read_b64_tr_b16 a[0:1], v130 offset:32768
    ds_read_b64_tr_b16 a[2:3], v130 offset:33792
    ds_read_b64_tr_b16 a[4:5], v130 offset:36864
    ds_read_b64_tr_b16 a[6:7], v130 offset:37888
    ds_read_b64_tr_b16 a[8:9], v130 offset:40960
    ds_read_b64_tr_b16 a[10:11], v130 offset:41984
    ds_read_b64_tr_b16 a[12:13], v130 offset:45056
    ds_read_b64_tr_b16 a[14:15], v130 offset:46080
    ds_read_b64_tr_b16 a[16:17], v130 offset:49152
    ds_read_b64_tr_b16 a[18:19], v130 offset:50176
    ds_read_b64_tr_b16 a[20:21], v130 offset:53248
    ds_read_b64_tr_b16 a[22:23], v130 offset:54272
    ds_read_b64_tr_b16 a[24:25], v130 offset:57344
    ds_read_b64_tr_b16 a[26:27], v130 offset:58368
    ds_read_b64_tr_b16 a[28:29], v130 offset:61440
    ds_read_b64_tr_b16 a[30:31], v130 offset:62464
    s_branch FFR_250
FFR_252:
    s_cmp_lg_u32 s9, 2
    s_cbranch_scc1 FFR_253
    ds_read_b64_tr_b16 a[96:97], v130 offset:32768
    ds_read_b64_tr_b16 a[98:99], v130 offset:33792
    ds_read_b64_tr_b16 a[100:101], v130 offset:36864
    ds_read_b64_tr_b16 a[102:103], v130 offset:37888
    ds_read_b64_tr_b16 a[104:105], v130 offset:40960
    ds_read_b64_tr_b16 a[106:107], v130 offset:41984
    ds_read_b64_tr_b16 a[108:109], v130 offset:45056
    ds_read_b64_tr_b16 a[110:111], v130 offset:46080
    ds_read_b64_tr_b16 a[112:113], v130 offset:49152
    ds_read_b64_tr_b16 a[114:115], v130 offset:50176
    ds_read_b64_tr_b16 a[116:117], v130 offset:53248
    ds_read_b64_tr_b16 a[118:119], v130 offset:54272
    ds_read_b64_tr_b16 a[120:121], v130 offset:57344
    ds_read_b64_tr_b16 a[122:123], v130 offset:58368
    ds_read_b64_tr_b16 a[124:125], v130 offset:61440
    ds_read_b64_tr_b16 a[126:127], v130 offset:62464
    s_branch FFR_250
FFR_253:
    ds_read_b64_tr_b16 a[64:65], v130 offset:32768
    ds_read_b64_tr_b16 a[66:67], v130 offset:33792
    ds_read_b64_tr_b16 a[68:69], v130 offset:36864
    ds_read_b64_tr_b16 a[70:71], v130 offset:37888
    ds_read_b64_tr_b16 a[72:73], v130 offset:40960
    ds_read_b64_tr_b16 a[74:75], v130 offset:41984
    ds_read_b64_tr_b16 a[76:77], v130 offset:45056
    ds_read_b64_tr_b16 a[78:79], v130 offset:46080
    ds_read_b64_tr_b16 a[80:81], v130 offset:49152
    ds_read_b64_tr_b16 a[82:83], v130 offset:50176
    ds_read_b64_tr_b16 a[84:85], v130 offset:53248
    ds_read_b64_tr_b16 a[86:87], v130 offset:54272
    ds_read_b64_tr_b16 a[88:89], v130 offset:57344
    ds_read_b64_tr_b16 a[90:91], v130 offset:58368
    ds_read_b64_tr_b16 a[92:93], v130 offset:61440
    ds_read_b64_tr_b16 a[94:95], v130 offset:62464
FFR_250:
    s_waitcnt lgkmcnt(0)
    s_barrier
    s_add_u32 s26, s22, 0x200
    s_addc_u32 s27, s23, 0
    s_add_u32 m0, s24, 32768
    s_nop 0
    global_load_lds_dwordx4 v129, s[26:27]
    s_add_u32 s26, s22, 0x1200
    s_addc_u32 s27, s23, 0
    s_add_u32 m0, s24, 33792
    s_nop 0
    global_load_lds_dwordx4 v129, s[26:27]
    s_add_u32 s26, s22, 0x2200
    s_addc_u32 s27, s23, 0
    s_add_u32 m0, s24, 34816
    s_nop 0
    global_load_lds_dwordx4 v129, s[26:27]
    s_add_u32 s26, s22, 0x3200
    s_addc_u32 s27, s23, 0
    s_add_u32 m0, s24, 35840
    s_nop 0
    global_load_lds_dwordx4 v129, s[26:27]
    s_add_u32 s26, s22, 0x4200
    s_addc_u32 s27, s23, 0
    s_add_u32 m0, s24, 36864
    s_nop 0
    global_load_lds_dwordx4 v129, s[26:27]
    s_add_u32 s26, s22, 0x5200
    s_addc_u32 s27, s23, 0
    s_add_u32 m0, s24, 37888
    s_nop 0
    global_load_lds_dwordx4 v129, s[26:27]
    s_add_u32 s26, s22, 0x6200
    s_addc_u32 s27, s23, 0
    s_add_u32 m0, s24, 38912
    s_nop 0
    global_load_lds_dwordx4 v129, s[26:27]
    s_add_u32 s26, s22, 0x7200
    s_addc_u32 s27, s23, 0
    s_add_u32 m0, s24, 39936
    s_nop 0
    global_load_lds_dwordx4 v129, s[26:27]
    s_waitcnt vmcnt(32)
    s_barrier
    s_cmp_lg_u32 s9, 0
    s_cbranch_scc1 FFR_256
    ds_read_b64_tr_b16 a[64:65], v131 offset:0
    ds_read_b64_tr_b16 a[66:67], v131 offset:1024
    ds_read_b64_tr_b16 a[68:69], v131 offset:4096
    ds_read_b64_tr_b16 a[70:71], v131 offset:5120
    ds_read_b64_tr_b16 a[72:73], v131 offset:8192
    ds_read_b64_tr_b16 a[74:75], v131 offset:9216
    ds_read_b64_tr_b16 a[76:77], v131 offset:12288
    ds_read_b64_tr_b16 a[78:79], v131 offset:13312
    ds_read_b64_tr_b16 a[80:81], v131 offset:16384
    ds_read_b64_tr_b16 a[82:83], v131 offset:17408
    ds_read_b64_tr_b16 a[84:85], v131 offset:20480
    ds_read_b64_tr_b16 a[86:87], v131 offset:21504
    ds_read_b64_tr_b16 a[88:89], v131 offset:24576
    ds_read_b64_tr_b16 a[90:91], v131 offset:25600
    ds_read_b64_tr_b16 a[92:93], v131 offset:28672
    ds_read_b64_tr_b16 a[94:95], v131 offset:29696
    s_branch FFR_255
FFR_256:
    s_cmp_lg_u32 s9, 1
    s_cbranch_scc1 FFR_257
    ds_read_b64_tr_b16 a[32:33], v131 offset:0
    ds_read_b64_tr_b16 a[34:35], v131 offset:1024
    ds_read_b64_tr_b16 a[36:37], v131 offset:4096
    ds_read_b64_tr_b16 a[38:39], v131 offset:5120
    ds_read_b64_tr_b16 a[40:41], v131 offset:8192
    ds_read_b64_tr_b16 a[42:43], v131 offset:9216
    ds_read_b64_tr_b16 a[44:45], v131 offset:12288
    ds_read_b64_tr_b16 a[46:47], v131 offset:13312
    ds_read_b64_tr_b16 a[48:49], v131 offset:16384
    ds_read_b64_tr_b16 a[50:51], v131 offset:17408
    ds_read_b64_tr_b16 a[52:53], v131 offset:20480
    ds_read_b64_tr_b16 a[54:55], v131 offset:21504
    ds_read_b64_tr_b16 a[56:57], v131 offset:24576
    ds_read_b64_tr_b16 a[58:59], v131 offset:25600
    ds_read_b64_tr_b16 a[60:61], v131 offset:28672
    ds_read_b64_tr_b16 a[62:63], v131 offset:29696
    s_branch FFR_255
FFR_257:
    s_cmp_lg_u32 s9, 2
    s_cbranch_scc1 FFR_258
    ds_read_b64_tr_b16 a[0:1], v131 offset:0
    ds_read_b64_tr_b16 a[2:3], v131 offset:1024
    ds_read_b64_tr_b16 a[4:5], v131 offset:4096
    ds_read_b64_tr_b16 a[6:7], v131 offset:5120
    ds_read_b64_tr_b16 a[8:9], v131 offset:8192
    ds_read_b64_tr_b16 a[10:11], v131 offset:9216
    ds_read_b64_tr_b16 a[12:13], v131 offset:12288
    ds_read_b64_tr_b16 a[14:15], v131 offset:13312
    ds_read_b64_tr_b16 a[16:17], v131 offset:16384
    ds_read_b64_tr_b16 a[18:19], v131 offset:17408
    ds_read_b64_tr_b16 a[20:21], v131 offset:20480
    ds_read_b64_tr_b16 a[22:23], v131 offset:21504
    ds_read_b64_tr_b16 a[24:25], v131 offset:24576
    ds_read_b64_tr_b16 a[26:27], v131 offset:25600
    ds_read_b64_tr_b16 a[28:29], v131 offset:28672
    ds_read_b64_tr_b16 a[30:31], v131 offset:29696
    s_branch FFR_255
FFR_258:
    ds_read_b64_tr_b16 a[96:97], v131 offset:0
    ds_read_b64_tr_b16 a[98:99], v131 offset:1024
    ds_read_b64_tr_b16 a[100:101], v131 offset:4096
    ds_read_b64_tr_b16 a[102:103], v131 offset:5120
    ds_read_b64_tr_b16 a[104:105], v131 offset:8192
    ds_read_b64_tr_b16 a[106:107], v131 offset:9216
    ds_read_b64_tr_b16 a[108:109], v131 offset:12288
    ds_read_b64_tr_b16 a[110:111], v131 offset:13312
    ds_read_b64_tr_b16 a[112:113], v131 offset:16384
    ds_read_b64_tr_b16 a[114:115], v131 offset:17408
    ds_read_b64_tr_b16 a[116:117], v131 offset:20480
    ds_read_b64_tr_b16 a[118:119], v131 offset:21504
    ds_read_b64_tr_b16 a[120:121], v131 offset:24576
    ds_read_b64_tr_b16 a[122:123], v131 offset:25600
    ds_read_b64_tr_b16 a[124:125], v131 offset:28672
    ds_read_b64_tr_b16 a[126:127], v131 offset:29696
FFR_255:
    s_waitcnt lgkmcnt(0)
    s_barrier
    s_add_u32 s26, s22, 0x300
    s_addc_u32 s27, s23, 0
    s_add_u32 m0, s24, 65536
    s_nop 0
    global_load_lds_dwordx4 v129, s[26:27]
    s_add_u32 s26, s22, 0x1300
    s_addc_u32 s27, s23, 0
    s_add_u32 m0, s24, 66560
    s_nop 0
    global_load_lds_dwordx4 v129, s[26:27]
    s_add_u32 s26, s22, 0x2300
    s_addc_u32 s27, s23, 0
    s_add_u32 m0, s24, 67584
    s_nop 0
    global_load_lds_dwordx4 v129, s[26:27]
    s_add_u32 s26, s22, 0x3300
    s_addc_u32 s27, s23, 0
    s_add_u32 m0, s24, 68608
    s_nop 0
    global_load_lds_dwordx4 v129, s[26:27]
    s_add_u32 s26, s22, 0x4300
    s_addc_u32 s27, s23, 0
    s_add_u32 m0, s24, 69632
    s_nop 0
    global_load_lds_dwordx4 v129, s[26:27]
    s_add_u32 s26, s22, 0x5300
    s_addc_u32 s27, s23, 0
    s_add_u32 m0, s24, 70656
    s_nop 0
    global_load_lds_dwordx4 v129, s[26:27]
    s_add_u32 s26, s22, 0x6300
    s_addc_u32 s27, s23, 0
    s_add_u32 m0, s24, 71680
    s_nop 0
    global_load_lds_dwordx4 v129, s[26:27]
    s_add_u32 s26, s22, 0x7300
    s_addc_u32 s27, s23, 0
    s_add_u32 m0, s24, 72704
    s_nop 0
    global_load_lds_dwordx4 v129, s[26:27]
    s_waitcnt vmcnt(32)
    s_barrier
    s_cmp_lg_u32 s9, 0
    s_cbranch_scc1 FFR_261
    ds_read_b64_tr_b16 a[96:97], v131 offset:32768
    ds_read_b64_tr_b16 a[98:99], v131 offset:33792
    ds_read_b64_tr_b16 a[100:101], v131 offset:36864
    ds_read_b64_tr_b16 a[102:103], v131 offset:37888
    ds_read_b64_tr_b16 a[104:105], v131 offset:40960
    ds_read_b64_tr_b16 a[106:107], v131 offset:41984
    ds_read_b64_tr_b16 a[108:109], v131 offset:45056
    ds_read_b64_tr_b16 a[110:111], v131 offset:46080
    ds_read_b64_tr_b16 a[112:113], v131 offset:49152
    ds_read_b64_tr_b16 a[114:115], v131 offset:50176
    ds_read_b64_tr_b16 a[116:117], v131 offset:53248
    ds_read_b64_tr_b16 a[118:119], v131 offset:54272
    ds_read_b64_tr_b16 a[120:121], v131 offset:57344
    ds_read_b64_tr_b16 a[122:123], v131 offset:58368
    ds_read_b64_tr_b16 a[124:125], v131 offset:61440
    ds_read_b64_tr_b16 a[126:127], v131 offset:62464
    s_branch FFR_260
FFR_261:
    s_cmp_lg_u32 s9, 1
    s_cbranch_scc1 FFR_262
    ds_read_b64_tr_b16 a[64:65], v131 offset:32768
    ds_read_b64_tr_b16 a[66:67], v131 offset:33792
    ds_read_b64_tr_b16 a[68:69], v131 offset:36864
    ds_read_b64_tr_b16 a[70:71], v131 offset:37888
    ds_read_b64_tr_b16 a[72:73], v131 offset:40960
    ds_read_b64_tr_b16 a[74:75], v131 offset:41984
    ds_read_b64_tr_b16 a[76:77], v131 offset:45056
    ds_read_b64_tr_b16 a[78:79], v131 offset:46080
    ds_read_b64_tr_b16 a[80:81], v131 offset:49152
    ds_read_b64_tr_b16 a[82:83], v131 offset:50176
    ds_read_b64_tr_b16 a[84:85], v131 offset:53248
    ds_read_b64_tr_b16 a[86:87], v131 offset:54272
    ds_read_b64_tr_b16 a[88:89], v131 offset:57344
    ds_read_b64_tr_b16 a[90:91], v131 offset:58368
    ds_read_b64_tr_b16 a[92:93], v131 offset:61440
    ds_read_b64_tr_b16 a[94:95], v131 offset:62464
    s_branch FFR_260
FFR_262:
    s_cmp_lg_u32 s9, 2
    s_cbranch_scc1 FFR_263
    ds_read_b64_tr_b16 a[32:33], v131 offset:32768
    ds_read_b64_tr_b16 a[34:35], v131 offset:33792
    ds_read_b64_tr_b16 a[36:37], v131 offset:36864
    ds_read_b64_tr_b16 a[38:39], v131 offset:37888
    ds_read_b64_tr_b16 a[40:41], v131 offset:40960
    ds_read_b64_tr_b16 a[42:43], v131 offset:41984
    ds_read_b64_tr_b16 a[44:45], v131 offset:45056
    ds_read_b64_tr_b16 a[46:47], v131 offset:46080
    ds_read_b64_tr_b16 a[48:49], v131 offset:49152
    ds_read_b64_tr_b16 a[50:51], v131 offset:50176
    ds_read_b64_tr_b16 a[52:53], v131 offset:53248
    ds_read_b64_tr_b16 a[54:55], v131 offset:54272
    ds_read_b64_tr_b16 a[56:57], v131 offset:57344
    ds_read_b64_tr_b16 a[58:59], v131 offset:58368
    ds_read_b64_tr_b16 a[60:61], v131 offset:61440
    ds_read_b64_tr_b16 a[62:63], v131 offset:62464
    s_branch FFR_260
FFR_263:
    ds_read_b64_tr_b16 a[0:1], v131 offset:32768
    ds_read_b64_tr_b16 a[2:3], v131 offset:33792
    ds_read_b64_tr_b16 a[4:5], v131 offset:36864
    ds_read_b64_tr_b16 a[6:7], v131 offset:37888
    ds_read_b64_tr_b16 a[8:9], v131 offset:40960
    ds_read_b64_tr_b16 a[10:11], v131 offset:41984
    ds_read_b64_tr_b16 a[12:13], v131 offset:45056
    ds_read_b64_tr_b16 a[14:15], v131 offset:46080
    ds_read_b64_tr_b16 a[16:17], v131 offset:49152
    ds_read_b64_tr_b16 a[18:19], v131 offset:50176
    ds_read_b64_tr_b16 a[20:21], v131 offset:53248
    ds_read_b64_tr_b16 a[22:23], v131 offset:54272
    ds_read_b64_tr_b16 a[24:25], v131 offset:57344
    ds_read_b64_tr_b16 a[26:27], v131 offset:58368
    ds_read_b64_tr_b16 a[28:29], v131 offset:61440
    ds_read_b64_tr_b16 a[30:31], v131 offset:62464
FFR_260:
    s_waitcnt vmcnt(24)
    s_barrier
    s_add_u32 s14, s9, 0
    s_and_b32 s14, s14, 3
    s_lshl_b32 s14, s14, 13
    s_add_u32 s14, s14, 131072
    v_add_u32 v135, s14, v134
    ds_read_b64_tr_b16 a[128:129], v135 offset:0
    ds_read_b64_tr_b16 a[130:131], v135 offset:2048
    ds_read_b64_tr_b16 a[132:133], v135 offset:4096
    ds_read_b64_tr_b16 a[134:135], v135 offset:6144
    s_add_u32 s14, s9, 1
    s_and_b32 s14, s14, 3
    s_lshl_b32 s14, s14, 13
    s_add_u32 s14, s14, 131072
    v_add_u32 v136, s14, v134
    ds_read_b64_tr_b16 a[136:137], v136 offset:0
    ds_read_b64_tr_b16 a[138:139], v136 offset:2048
    ds_read_b64_tr_b16 a[140:141], v136 offset:4096
    ds_read_b64_tr_b16 a[142:143], v136 offset:6144
    s_add_u32 s14, s9, 2
    s_and_b32 s14, s14, 3
    s_lshl_b32 s14, s14, 13
    s_add_u32 s14, s14, 131072
    v_add_u32 v137, s14, v134
    ds_read_b64_tr_b16 a[144:145], v137 offset:0
    ds_read_b64_tr_b16 a[146:147], v137 offset:2048
    ds_read_b64_tr_b16 a[148:149], v137 offset:4096
    ds_read_b64_tr_b16 a[150:151], v137 offset:6144
    s_add_u32 s14, s9, 3
    s_and_b32 s14, s14, 3
    s_lshl_b32 s14, s14, 13
    s_add_u32 s14, s14, 131072
    v_add_u32 v138, s14, v134
    ds_read_b64_tr_b16 a[152:153], v138 offset:0
    ds_read_b64_tr_b16 a[154:155], v138 offset:2048
    ds_read_b64_tr_b16 a[156:157], v138 offset:4096
    ds_read_b64_tr_b16 a[158:159], v138 offset:6144
    s_waitcnt vmcnt(16)
    s_barrier
    s_add_u32 s14, s9, 0
    s_and_b32 s14, s14, 3
    s_lshl_b32 s14, s14, 13
    s_add_u32 s14, s14, 0
    v_add_u32 v135, s14, v134
    ds_read_b64_tr_b16 a[160:161], v135 offset:0
    ds_read_b64_tr_b16 a[162:163], v135 offset:2048
    ds_read_b64_tr_b16 a[164:165], v135 offset:4096
    ds_read_b64_tr_b16 a[166:167], v135 offset:6144
    s_add_u32 s14, s9, 1
    s_and_b32 s14, s14, 3
    s_lshl_b32 s14, s14, 13
    s_add_u32 s14, s14, 0
    v_add_u32 v136, s14, v134
    ds_read_b64_tr_b16 a[168:169], v136 offset:0
    ds_read_b64_tr_b16 a[170:171], v136 offset:2048
    ds_read_b64_tr_b16 a[172:173], v136 offset:4096
    ds_read_b64_tr_b16 a[174:175], v136 offset:6144
    s_add_u32 s14, s9, 2
    s_and_b32 s14, s14, 3
    s_lshl_b32 s14, s14, 13
    s_add_u32 s14, s14, 0
    v_add_u32 v137, s14, v134
    ds_read_b64_tr_b16 a[176:177], v137 offset:0
    ds_read_b64_tr_b16 a[178:179], v137 offset:2048
    ds_read_b64_tr_b16 a[180:181], v137 offset:4096
    ds_read_b64_tr_b16 a[182:183], v137 offset:6144
    s_add_u32 s14, s9, 3
    s_and_b32 s14, s14, 3
    s_lshl_b32 s14, s14, 13
    s_add_u32 s14, s14, 0
    v_add_u32 v138, s14, v134
    ds_read_b64_tr_b16 a[184:185], v138 offset:0
    ds_read_b64_tr_b16 a[186:187], v138 offset:2048
    ds_read_b64_tr_b16 a[188:189], v138 offset:4096
    ds_read_b64_tr_b16 a[190:191], v138 offset:6144
    s_waitcnt vmcnt(8)
    s_barrier
    s_add_u32 s14, s9, 0
    s_and_b32 s14, s14, 3
    s_lshl_b32 s14, s14, 13
    s_add_u32 s14, s14, 32768
    v_add_u32 v135, s14, v134
    ds_read_b64_tr_b16 a[192:193], v135 offset:0
    ds_read_b64_tr_b16 a[194:195], v135 offset:2048
    ds_read_b64_tr_b16 a[196:197], v135 offset:4096
    ds_read_b64_tr_b16 a[198:199], v135 offset:6144
    s_add_u32 s14, s9, 1
    s_and_b32 s14, s14, 3
    s_lshl_b32 s14, s14, 13
    s_add_u32 s14, s14, 32768
    v_add_u32 v136, s14, v134
    ds_read_b64_tr_b16 a[200:201], v136 offset:0
    ds_read_b64_tr_b16 a[202:203], v136 offset:2048
    ds_read_b64_tr_b16 a[204:205], v136 offset:4096
    ds_read_b64_tr_b16 a[206:207], v136 offset:6144
    s_add_u32 s14, s9, 2
    s_and_b32 s14, s14, 3
    s_lshl_b32 s14, s14, 13
    s_add_u32 s14, s14, 32768
    v_add_u32 v137, s14, v134
    ds_read_b64_tr_b16 a[208:209], v137 offset:0
    ds_read_b64_tr_b16 a[210:211], v137 offset:2048
    ds_read_b64_tr_b16 a[212:213], v137 offset:4096
    ds_read_b64_tr_b16 a[214:215], v137 offset:6144
    s_add_u32 s14, s9, 3
    s_and_b32 s14, s14, 3
    s_lshl_b32 s14, s14, 13
    s_add_u32 s14, s14, 32768
    v_add_u32 v138, s14, v134
    ds_read_b64_tr_b16 a[216:217], v138 offset:0
    ds_read_b64_tr_b16 a[218:219], v138 offset:2048
    ds_read_b64_tr_b16 a[220:221], v138 offset:4096
    ds_read_b64_tr_b16 a[222:223], v138 offset:6144
    s_waitcnt vmcnt(0)
    s_barrier
    s_add_u32 s14, s9, 0
    s_and_b32 s14, s14, 3
    s_lshl_b32 s14, s14, 13
    s_add_u32 s14, s14, 65536
    v_add_u32 v135, s14, v134
    ds_read_b64_tr_b16 a[224:225], v135 offset:0
    ds_read_b64_tr_b16 a[226:227], v135 offset:2048
    ds_read_b64_tr_b16 a[228:229], v135 offset:4096
    ds_read_b64_tr_b16 a[230:231], v135 offset:6144
    s_add_u32 s14, s9, 1
    s_and_b32 s14, s14, 3
    s_lshl_b32 s14, s14, 13
    s_add_u32 s14, s14, 65536
    v_add_u32 v136, s14, v134
    ds_read_b64_tr_b16 a[232:233], v136 offset:0
    ds_read_b64_tr_b16 a[234:235], v136 offset:2048
    ds_read_b64_tr_b16 a[236:237], v136 offset:4096
    ds_read_b64_tr_b16 a[238:239], v136 offset:6144
    s_add_u32 s14, s9, 2
    s_and_b32 s14, s14, 3
    s_lshl_b32 s14, s14, 13
    s_add_u32 s14, s14, 65536
    v_add_u32 v137, s14, v134
    ds_read_b64_tr_b16 a[240:241], v137 offset:0
    ds_read_b64_tr_b16 a[242:243], v137 offset:2048
    ds_read_b64_tr_b16 a[244:245], v137 offset:4096
    ds_read_b64_tr_b16 a[246:247], v137 offset:6144
    s_add_u32 s14, s9, 3
    s_and_b32 s14, s14, 3
    s_lshl_b32 s14, s14, 13
    s_add_u32 s14, s14, 65536
    v_add_u32 v138, s14, v134
    ds_read_b64_tr_b16 a[248:249], v138 offset:0
    ds_read_b64_tr_b16 a[250:251], v138 offset:2048
    ds_read_b64_tr_b16 a[252:253], v138 offset:4096
    ds_read_b64_tr_b16 a[254:255], v138 offset:6144
    s_waitcnt lgkmcnt(0)
    s_barrier
    s_add_u32 s36, s38, 0x0
    s_addc_u32 s37, s39, 0
    global_store_dwordx4 v2, v[20:23], s[36:37] offset:0 sc1
    global_store_dwordx4 v2, v[20:23], s[36:37] offset:1024 sc1
    global_store_dwordx4 v3, v[20:23], s[36:37] offset:0 sc1
    global_store_dwordx4 v3, v[20:23], s[36:37] offset:1024 sc1
    global_store_dwordx4 v4, v[20:23], s[36:37] offset:0 sc1
    global_store_dwordx4 v4, v[20:23], s[36:37] offset:1024 sc1
    global_store_dwordx4 v5, v[20:23], s[36:37] offset:0 sc1
    global_store_dwordx4 v5, v[20:23], s[36:37] offset:1024 sc1
    s_add_u32 s36, s38, 0x70000
    s_addc_u32 s37, s39, 0
    global_store_dwordx4 v2, v[20:23], s[36:37] offset:0 sc1
    global_store_dwordx4 v2, v[20:23], s[36:37] offset:1024 sc1
    global_store_dwordx4 v3, v[20:23], s[36:37] offset:0 sc1
    global_store_dwordx4 v3, v[20:23], s[36:37] offset:1024 sc1
    global_store_dwordx4 v4, v[20:23], s[36:37] offset:0 sc1
    global_store_dwordx4 v4, v[20:23], s[36:37] offset:1024 sc1
    global_store_dwordx4 v5, v[20:23], s[36:37] offset:0 sc1
    global_store_dwordx4 v5, v[20:23], s[36:37] offset:1024 sc1
    s_add_u32 s36, s38, 0xe0000
    s_addc_u32 s37, s39, 0
    global_store_dwordx4 v2, v[20:23], s[36:37] offset:0 sc1
    global_store_dwordx4 v2, v[20:23], s[36:37] offset:1024 sc1
    global_store_dwordx4 v3, v[20:23], s[36:37] offset:0 sc1
    global_store_dwordx4 v3, v[20:23], s[36:37] offset:1024 sc1
    global_store_dwordx4 v4, v[20:23], s[36:37] offset:0 sc1
    global_store_dwordx4 v4, v[20:23], s[36:37] offset:1024 sc1
    global_store_dwordx4 v5, v[20:23], s[36:37] offset:0 sc1
    global_store_dwordx4 v5, v[20:23], s[36:37] offset:1024 sc1
    s_add_u32 s36, s38, 0x150000
    s_addc_u32 s37, s39, 0
    global_store_dwordx4 v2, v[20:23], s[36:37] offset:0 sc1
    global_store_dwordx4 v2, v[20:23], s[36:37] offset:1024 sc1
    global_store_dwordx4 v3, v[20:23], s[36:37] offset:0 sc1
    global_store_dwordx4 v3, v[20:23], s[36:37] offset:1024 sc1
    global_store_dwordx4 v4, v[20:23], s[36:37] offset:0 sc1
    global_store_dwordx4 v4, v[20:23], s[36:37] offset:1024 sc1
    global_store_dwordx4 v5, v[20:23], s[36:37] offset:0 sc1
    global_store_dwordx4 v5, v[20:23], s[36:37] offset:1024 sc1
    s_lshl_b32 s14, s13, 8
    s_add_u32 s14, s14, 342016
    s_add_u32 s40, s4, s14
    s_addc_u32 s41, s5, 0
    v_min_u32 v17, 31, v0
    v_lshlrev_b32 v17, 2, v17
    s_waitcnt vmcnt(0)
    s_barrier
    s_getreg_b32 s19, hwreg(HW_REG_XCC_ID)
    s_and_b32 s19, s19, 15
    s_lshl_b32 s14, s10, 8
    s_lshr_b32 s15, s2, 3
    s_lshl_b32 s15, s15, 3
    s_add_u32 s14, s14, s15
    s_add_u32 s14, s14, 331776
    s_cmp_lg_u32 s9, 0
    s_cbranch_scc1 XP_265
    v_mov_b32 v26, s14
    v_mov_b32 v24, s8
    v_mov_b32 v25, s19
    global_store_dwordx2 v26, v[24:25], s[4:5] sc1
XP_265:
    s_lshl_b32 s14, s10, 8
    s_add_u32 s14, s14, 331776
    v_med3_u32 v26, 14, v0, 29
    v_lshlrev_b32 v26, 3, v26
    v_add_u32 v26, s14, v26
    s_mov_b32 s12, 0
XT_266:
    global_load_dwordx2 v[24:25], v26, s[4:5] sc1
    s_add_u32 s12, s12, 1
    s_mov_b32 s17, 12
    s_cmp_gt_u32 s12, 20000
    s_cbranch_scc1 TIMEOUT2
    s_waitcnt vmcnt(0)
    v_cmp_ne_u32 vcc, s8, v24
    s_cbranch_vccnz XT_266
    v_cmp_ne_u32 vcc, s19, v25
    s_cmp_eq_u64 vcc, 0
    s_cselect_b32 s18, 1, 0
    s_cmp_eq_u32 s18, 0
    s_cbranch_scc1 FF_SLOW
    s_mov_b32 s30, 0
    s_mul_i32 s20, s13, 6
    s_sub_u32 s20, 67, s20
FF_SPINf_0:
    s_mov_b32 s12, 0
FF_SPINf:
    global_load_dwordx4 v[24:27], v1, s[34:35] offset:-4096 sc1
    s_add_u32 s12, s12, 1
    s_mov_b32 s17, 11
    s_cmp_gt_u32 s12, 20000
    s_cbranch_scc1 TIMEOUT2
    s_waitcnt vmcnt(0)
FF_SPINf_C:
    v_cmp_eq_u32 vcc, -1, v24
    s_cbranch_vccnz FF_SPINf
    global_load_dwordx4 v[28:31], v1, s[34:35] offset:-3072 sc1
    global_load_dwordx4 v[32:35], v1, s[34:35] offset:-2048 sc1
    global_load_dwordx4 v[36:39], v1, s[34:35] offset:-1024 sc1
    global_load_dwordx4 v[40:43], v1, s[34:35] offset:0 sc1
    global_load_dwordx4 v[44:47], v1, s[34:35] offset:1024 sc1
    global_load_dwordx4 v[48:51], v1, s[34:35] offset:2048 sc1
    global_load_dwordx4 v[52:55], v1, s[34:35] offset:3072 sc1
    ds_write_b128 v6, v[24:27] offset:0
    v_mfma_f32_32x32x16_bf16 v[88:103], a[0:3], v[24:27], 0
    s_waitcnt vmcnt(6)
    ds_write_b128 v6, v[28:31] offset:1024
    v_mfma_f32_32x32x16_bf16 v[88:103], a[4:7], v[28:31], v[88:103]
    v_max_u32 v18, v24, v28
    s_waitcnt vmcnt(5)
    ds_write_b128 v6, v[32:35] offset:2048
    v_mfma_f32_32x32x16_bf16 v[88:103], a[8:11], v[32:35], v[88:103]
    s_waitcnt vmcnt(4)
    ds_write_b128 v6, v[36:39] offset:3072
    v_mfma_f32_32x32x16_bf16 v[88:103], a[12:15], v[36:39], v[88:103]
    v_max3_u32 v18, v18, v32, v36
    s_waitcnt vmcnt(3)
    ds_write_b128 v6, v[40:43] offset:4096
    v_mfma_f32_32x32x16_bf16 v[88:103], a[16:19], v[40:43], v[88:103]
    s_waitcnt vmcnt(2)
    ds_write_b128 v6, v[44:47] offset:5120
    v_max3_u32 v18, v18, v40, v44
    s_waitcnt vmcnt(1)
    ds_write_b128 v6, v[48:51] offset:6144
    s_waitcnt vmcnt(0)
    ds_write_b128 v6, v[52:55] offset:7168
    v_max3_u32 v18, v18, v48, v52
    v_cmp_eq_u32 vcc, -1, v18
    s_cbranch_vccnz FF_SPINf
    s_waitcnt lgkmcnt(0)
    s_barrier
    ds_read_b128 v[56:59], v7 offset:0
    ds_read_b128 v[60:63], v7 offset:1024
    v_mfma_f32_32x32x16_bf16 v[88:103], a[20:23], v[44:47], v[88:103]
    ds_read_b128 v[64:67], v7 offset:2048
    ds_read_b128 v[68:71], v7 offset:3072
    v_mfma_f32_32x32x16_bf16 v[88:103], a[24:27], v[48:51], v[88:103]
    ds_read_b128 v[72:75], v7 offset:4096
    ds_read_b128 v[76:79], v7 offset:5120
    v_mfma_f32_32x32x16_bf16 v[88:103], a[28:31], v[52:55], v[88:103]
    ds_read_b128 v[80:83], v7 offset:6144
    ds_read_b128 v[84:87], v7 offset:7168
    s_waitcnt lgkmcnt(7)
    v_mfma_f32_32x32x16_bf16 v[88:103], a[32:35], v[56:59], v[88:103]
    ds_read_b128 v[56:59], v8 offset:0
    s_waitcnt lgkmcnt(7)
    v_mfma_f32_32x32x16_bf16 v[88:103], a[36:39], v[60:63], v[88:103]
    ds_read_b128 v[60:63], v8 offset:1024
    s_waitcnt lgkmcnt(7)
    v_mfma_f32_32x32x16_bf16 v[88:103], a[40:43], v[64:67], v[88:103]
    ds_read_b128 v[64:67], v8 offset:2048
    s_waitcnt lgkmcnt(7)
    v_mfma_f32_32x32x16_bf16 v[88:103], a[44:47], v[68:71], v[88:103]
    ds_read_b128 v[68:71], v8 offset:3072
FF_TOPf:
    s_waitcnt lgkmcnt(7)
    v_mfma_f32_32x32x16_bf16 v[88:103], a[48:51], v[72:75], v[88:103]
    ds_read_b128 v[72:75], v8 offset:4096
    s_waitcnt lgkmcnt(7)
    v_mfma_f32_32x32x16_bf16 v[88:103], a[52:55], v[76:79], v[88:103]
    ds_read_b128 v[76:79], v8 offset:5120
    global_load_dword v19, v17, s[40:41] sc1
    s_waitcnt lgkmcnt(7)
    v_mfma_f32_32x32x16_bf16 v[88:103], a[56:59], v[80:83], v[88:103]
    ds_read_b128 v[80:83], v8 offset:6144
    s_waitcnt lgkmcnt(7)
    v_mfma_f32_32x32x16_bf16 v[88:103], a[60:63], v[84:87], v[88:103]
    ds_read_b128 v[84:87], v8 offset:7168
    s_waitcnt lgkmcnt(7)
    v_mfma_f32_32x32x16_bf16 v[88:103], a[64:67], v[56:59], v[88:103]
    ds_read_b128 v[56:59], v9 offset:0
    s_waitcnt lgkmcnt(7)
    v_mfma_f32_32x32x16_bf16 v[88:103], a[68:71], v[60:63], v[88:103]
    ds_read_b128 v[60:63], v9 offset:1024
    s_waitcnt lgkmcnt(7)
    v_mfma_f32_32x32x16_bf16 v[88:103], a[72:75], v[64:67], v[88:103]
    ds_read_b128 v[64:67], v9 offset:2048
    s_waitcnt lgkmcnt(7)
    v_mfma_f32_32x32x16_bf16 v[88:103], a[76:79], v[68:71], v[88:103]
    ds_read_b128 v[68:71], v9 offset:3072
    s_waitcnt lgkmcnt(7)
    v_mfma_f32_32x32x16_bf16 v[88:103], a[80:83], v[72:75], v[88:103]
    ds_read_b128 v[72:75], v9 offset:4096
    s_waitcnt lgkmcnt(7)
    v_mfma_f32_32x32x16_bf16 v[88:103], a[84:87], v[76:79], v[88:103]
    ds_read_b128 v[76:79], v9 offset:5120
    s_waitcnt lgkmcnt(7)
    v_mfma_f32_32x32x16_bf16 v[88:103], a[88:91], v[80:83], v[88:103]
    ds_read_b128 v[80:83], v9 offset:6144
    s_waitcnt lgkmcnt(7)
    v_mfma_f32_32x32x16_bf16 v[88:103], a[92:95], v[84:87], v[88:103]
    ds_read_b128 v[84:87], v9 offset:7168
    s_waitcnt lgkmcnt(7)
    v_mfma_f32_32x32x16_bf16 v[88:103], a[96:99], v[56:59], v[88:103]
    s_waitcnt lgkmcnt(6)
    v_mfma_f32_32x32x16_bf16 v[88:103], a[100:103], v[60:63], v[88:103]
    s_waitcnt lgkmcnt(5)
    v_mfma_f32_32x32x16_bf16 v[88:103], a[104:107], v[64:67], v[88:103]
    s_add_u32 s14, s30, 1
    s_and_b32 s14, s14, 7
    s_lshl_b32 s14, s14, 15
    s_add_u32 s34, s44, s14
    s_addc_u32 s35, s45, 0
    s_waitcnt lgkmcnt(4)
    v_mfma_f32_32x32x16_bf16 v[88:103], a[108:111], v[68:71], v[88:103]
    s_bfe_u32 s42, s30, 0x10002
    s_and_b32 s14, s30, 3
    s_mul_i32 s14, s14, 458752
    s_add_u32 s36, s38, s14
    s_addc_u32 s37, s39, 0
    s_waitcnt lgkmcnt(3)
    v_mfma_f32_32x32x16_bf16 v[88:103], a[112:115], v[72:75], v[88:103]
    s_lshl_b32 s43, s30, 3
    s_sub_u32 s43, s43, 24
    s_add_u32 s30, s30, 1
    s_waitcnt lgkmcnt(2)
    v_mfma_f32_32x32x16_bf16 v[88:103], a[116:119], v[76:79], v[88:103]
    s_waitcnt lgkmcnt(1)
    v_mfma_f32_32x32x16_bf16 v[88:103], a[120:123], v[80:83], v[88:103]
    s_waitcnt lgkmcnt(0)
    v_mfma_f32_32x32x16_bf16 v[88:103], a[124:127], v[84:87], v[88:103]
    s_waitcnt vmcnt(0)
    v_cmp_gt_i32 vcc, s43, v19
    s_cbranch_vccnz FF_CSf
FF_CRf:
    s_nop 8
    v_cvt_pk_bf16_f32 v56, v88, v89
    v_cvt_pk_bf16_f32 v57, v90, v91
    v_cvt_pk_bf16_f32 v58, v92, v93
    v_cvt_pk_bf16_f32 v59, v94, v95
    v_pk_max_i16 v56, v56, 0
    v_pk_max_i16 v57, v57, 0
    v_pk_max_i16 v58, v58, 0
    v_pk_max_i16 v59, v59, 0
    ds_write_b128 v10, v[56:59] offset:0
    v_cvt_pk_bf16_f32 v60, v96, v97
    v_cvt_pk_bf16_f32 v61, v98, v99
    v_cvt_pk_bf16_f32 v62, v100, v101
    v_cvt_pk_bf16_f32 v63, v102, v103
    v_pk_max_i16 v60, v60, 0
    v_pk_max_i16 v61, v61, 0
    v_pk_max_i16 v62, v62, 0
    v_pk_max_i16 v63, v63, 0
    ds_write_b128 v10, v[60:63] offset:1024
    v_mfma_f32_32x32x16_bf16 v[128:143], a[128:131], v[56:59], 0
    v_mfma_f32_32x32x16_bf16 v[144:159], a[160:163], v[56:59], 0
    v_mfma_f32_32x32x16_bf16 v[160:175], a[192:195], v[56:59], 0
    s_waitcnt lgkmcnt(0)
    s_barrier
    ds_read_b128 v[64:67], v11 offset:0
    ds_read_b128 v[68:71], v11 offset:1024
    v_mfma_f32_32x32x16_bf16 v[176:191], a[224:227], v[56:59], 0
    ds_read_b128 v[72:75], v12 offset:0
    ds_read_b128 v[76:79], v12 offset:1024
    global_load_dwordx4 v[24:27], v1, s[34:35] offset:-4096 sc1
    v_mfma_f32_32x32x16_bf16 v[128:143], a[132:135], v[60:63], v[128:143]
    ds_read_b128 v[80:83], v13 offset:0
    ds_read_b128 v[84:87], v13 offset:1024
    v_mfma_f32_32x32x16_bf16 v[144:159], a[164:167], v[60:63], v[144:159]
    v_mfma_f32_32x32x16_bf16 v[160:175], a[196:199], v[60:63], v[160:175]
    v_mfma_f32_32x32x16_bf16 v[176:191], a[228:231], v[60:63], v[176:191]
    s_waitcnt lgkmcnt(5)
    v_mfma_f32_32x32x16_bf16 v[128:143], a[136:139], v[64:67], v[128:143]
    s_waitcnt lgkmcnt(4)
    v_mfma_f32_32x32x16_bf16 v[128:143], a[140:143], v[68:71], v[128:143]
    s_waitcnt lgkmcnt(3)
    v_mfma_f32_32x32x16_bf16 v[128:143], a[144:147], v[72:75], v[128:143]
    s_waitcnt lgkmcnt(2)
    v_mfma_f32_32x32x16_bf16 v[128:143], a[148:151], v[76:79], v[128:143]
    s_waitcnt lgkmcnt(1)
    v_mfma_f32_32x32x16_bf16 v[128:143], a[152:155], v[80:83], v[128:143]
    s_waitcnt lgkmcnt(0)
    v_mfma_f32_32x32x16_bf16 v[128:143], a[156:159], v[84:87], v[128:143]
    s_waitcnt vmcnt(0)
    v_cmp_eq_u32 vcc, -1, v24
    s_cbranch_vccz FF_Pf
    v_mfma_f32_32x32x16_bf16 v[144:159], a[168:171], v[64:67], v[144:159]
    s_nop 3
    v_cvt_pk_f16_f32 v104, v128, v129
    v_cvt_pk_f16_f32 v105, v130, v131
    v_cvt_pk_f16_f32 v106, v132, v133
    v_and_or_b32 v104, v104, -2, s42
    v_cvt_pk_f16_f32 v107, v134, v135
    v_mfma_f32_32x32x16_bf16 v[144:159], a[172:175], v[68:71], v[144:159]
    global_store_dwordx4 v2, v[104:107], s[36:37] offset:0
    v_mfma_f32_32x32x16_bf16 v[144:159], a[176:179], v[72:75], v[144:159]
    v_cvt_pk_f16_f32 v108, v136, v137
    v_cvt_pk_f16_f32 v109, v138, v139
    v_cvt_pk_f16_f32 v110, v140, v141
    v_and_or_b32 v108, v108, -2, s42
    v_cvt_pk_f16_f32 v111, v142, v143
    v_mfma_f32_32x32x16_bf16 v[144:159], a[180:183], v[76:79], v[144:159]
    global_store_dwordx4 v2, v[108:111], s[36:37] offset:1024
    v_mfma_f32_32x32x16_bf16 v[144:159], a[184:187], v[80:83], v[144:159]
    v_mfma_f32_32x32x16_bf16 v[144:159], a[188:191], v[84:87], v[144:159]
    v_mfma_f32_32x32x16_bf16 v[160:175], a[200:203], v[64:67], v[160:175]
    s_nop 3
    v_cvt_pk_f16_f32 v112, v144, v145
    v_cvt_pk_f16_f32 v113, v146, v147
    v_cvt_pk_f16_f32 v114, v148, v149
    v_and_or_b32 v112, v112, -2, s42
    v_cvt_pk_f16_f32 v115, v150, v151
    v_mfma_f32_32x32x16_bf16 v[160:175], a[204:207], v[68:71], v[160:175]
    global_store_dwordx4 v3, v[112:115], s[36:37] offset:0
    v_mfma_f32_32x32x16_bf16 v[160:175], a[208:211], v[72:75], v[160:175]
    v_cvt_pk_f16_f32 v116, v152, v153
    v_cvt_pk_f16_f32 v117, v154, v155
    v_cvt_pk_f16_f32 v118, v156, v157
    v_and_or_b32 v116, v116, -2, s42
    v_cvt_pk_f16_f32 v119, v158, v159
    v_mfma_f32_32x32x16_bf16 v[160:175], a[212:215], v[76:79], v[160:175]
    global_store_dwordx4 v3, v[116:119], s[36:37] offset:1024
    v_mfma_f32_32x32x16_bf16 v[160:175], a[216:219], v[80:83], v[160:175]
    v_mfma_f32_32x32x16_bf16 v[160:175], a[220:223], v[84:87], v[160:175]
    global_load_dwordx4 v[24:27], v1, s[34:35] offset:-4096 sc1
    v_mfma_f32_32x32x16_bf16 v[176:191], a[232:235], v[64:67], v[176:191]
    s_nop 3
    v_cvt_pk_f16_f32 v120, v160, v161
    v_cvt_pk_f16_f32 v121, v162, v163
    v_cvt_pk_f16_f32 v122, v164, v165
    v_and_or_b32 v120, v120, -2, s42
    v_cvt_pk_f16_f32 v123, v166, v167
    v_mfma_f32_32x32x16_bf16 v[176:191], a[236:239], v[68:71], v[176:191]
    global_store_dwordx4 v4, v[120:123], s[36:37] offset:0
    v_mfma_f32_32x32x16_bf16 v[176:191], a[240:243], v[72:75], v[176:191]
    v_cvt_pk_f16_f32 v124, v168, v169
    v_cvt_pk_f16_f32 v125, v170, v171
    v_cvt_pk_f16_f32 v126, v172, v173
    v_and_or_b32 v124, v124, -2, s42
    v_cvt_pk_f16_f32 v127, v174, v175
    v_mfma_f32_32x32x16_bf16 v[176:191], a[244:247], v[76:79], v[176:191]
    global_store_dwordx4 v4, v[124:127], s[36:37] offset:1024
    v_mfma_f32_32x32x16_bf16 v[176:191], a[248:251], v[80:83], v[176:191]
    v_mfma_f32_32x32x16_bf16 v[176:191], a[252:255], v[84:87], v[176:191]
    s_nop 11
    v_cvt_pk_f16_f32 v104, v176, v177
    v_cvt_pk_f16_f32 v105, v178, v179
    v_cvt_pk_f16_f32 v106, v180, v181
    v_and_or_b32 v104, v104, -2, s42
    v_cvt_pk_f16_f32 v107, v182, v183
    global_store_dwordx4 v5, v[104:107], s[36:37] offset:0
    v_cvt_pk_f16_f32 v108, v184, v185
    v_cvt_pk_f16_f32 v109, v186, v187
    v_cvt_pk_f16_f32 v110, v188, v189
    v_and_or_b32 v108, v108, -2, s42
    v_cvt_pk_f16_f32 v111, v190, v191
    global_store_dwordx4 v5, v[108:111], s[36:37] offset:1024
    s_mov_b32 s12, 0
    s_cmp_lt_u32 s30, s20
    s_waitcnt vmcnt(4)
    s_cbranch_scc1 FF_SPINf_C
    s_branch FF_END
FF_Pf:
    v_mfma_f32_32x32x16_bf16 v[144:159], a[168:171], v[64:67], v[144:159]
    global_load_dwordx4 v[28:31], v1, s[34:35] offset:-3072 sc1
    v_mfma_f32_32x32x16_bf16 v[144:159], a[172:175], v[68:71], v[144:159]
    global_load_dwordx4 v[32:35], v1, s[34:35] offset:-2048 sc1
    v_mfma_f32_32x32x16_bf16 v[144:159], a[176:179], v[72:75], v[144:159]
    global_load_dwordx4 v[36:39], v1, s[34:35] offset:-1024 sc1
    v_mfma_f32_32x32x16_bf16 v[144:159], a[180:183], v[76:79], v[144:159]
    global_load_dwordx4 v[40:43], v1, s[34:35] offset:0 sc1
    v_mfma_f32_32x32x16_bf16 v[144:159], a[184:187], v[80:83], v[144:159]
    global_load_dwordx4 v[44:47], v1, s[34:35] offset:1024 sc1
    v_mfma_f32_32x32x16_bf16 v[144:159], a[188:191], v[84:87], v[144:159]
    global_load_dwordx4 v[48:51], v1, s[34:35] offset:2048 sc1
    v_mfma_f32_32x32x16_bf16 v[160:175], a[200:203], v[64:67], v[160:175]
    global_load_dwordx4 v[52:55], v1, s[34:35] offset:3072 sc1
    v_cvt_pk_f16_f32 v104, v128, v129
    v_cvt_pk_f16_f32 v105, v130, v131
    v_cvt_pk_f16_f32 v106, v132, v133
    v_and_or_b32 v104, v104, -2, s42
    v_cvt_pk_f16_f32 v107, v134, v135
    v_mfma_f32_32x32x16_bf16 v[160:175], a[204:207], v[68:71], v[160:175]
    global_store_dwordx4 v2, v[104:107], s[36:37] offset:0
    v_mfma_f32_32x32x16_bf16 v[160:175], a[208:211], v[72:75], v[160:175]
    v_cvt_pk_f16_f32 v108, v136, v137
    v_cvt_pk_f16_f32 v109, v138, v139
    v_cvt_pk_f16_f32 v110, v140, v141
    v_and_or_b32 v108, v108, -2, s42
    v_cvt_pk_f16_f32 v111, v142, v143
    v_mfma_f32_32x32x16_bf16 v[160:175], a[212:215], v[76:79], v[160:175]
    global_store_dwordx4 v2, v[108:111], s[36:37] offset:1024
    v_mfma_f32_32x32x16_bf16 v[160:175], a[216:219], v[80:83], v[160:175]
    v_cvt_pk_f16_f32 v112, v144, v145
    v_cvt_pk_f16_f32 v113, v146, v147
    v_cvt_pk_f16_f32 v114, v148, v149
    v_and_or_b32 v112, v112, -2, s42
    v_cvt_pk_f16_f32 v115, v150, v151
    v_mfma_f32_32x32x16_bf16 v[160:175], a[220:223], v[84:87], v[160:175]
    global_store_dwordx4 v3, v[112:115], s[36:37] offset:0
    v_mfma_f32_32x32x16_bf16 v[176:191], a[232:235], v[64:67], v[176:191]
    v_cvt_pk_f16_f32 v116, v152, v153
    v_cvt_pk_f16_f32 v117, v154, v155
    v_cvt_pk_f16_f32 v118, v156, v157
    v_and_or_b32 v116, v116, -2, s42
    v_cvt_pk_f16_f32 v119, v158, v159
    v_mfma_f32_32x32x16_bf16 v[176:191], a[236:239], v[68:71], v[176:191]
    global_store_dwordx4 v3, v[116:119], s[36:37] offset:1024
    v_mfma_f32_32x32x16_bf16 v[176:191], a[240:243], v[72:75], v[176:191]
    v_cvt_pk_f16_f32 v120, v160, v161
    v_cvt_pk_f16_f32 v121, v162, v163
    v_cvt_pk_f16_f32 v122, v164, v165
    v_and_or_b32 v120, v120, -2, s42
    v_cvt_pk_f16_f32 v123, v166, v167
    v_mfma_f32_32x32x16_bf16 v[176:191], a[244:247], v[76:79], v[176:191]
    global_store_dwordx4 v4, v[120:123], s[36:37] offset:0
    v_mfma_f32_32x32x16_bf16 v[176:191], a[248:251], v[80:83], v[176:191]
    v_cvt_pk_f16_f32 v124, v168, v169
    v_cvt_pk_f16_f32 v125, v170, v171
    v_cvt_pk_f16_f32 v126, v172, v173
    v_and_or_b32 v124, v124, -2, s42
    v_cvt_pk_f16_f32 v127, v174, v175
    v_mfma_f32_32x32x16_bf16 v[176:191], a[252:255], v[84:87], v[176:191]
    global_store_dwordx4 v4, v[124:127], s[36:37] offset:1024
    s_waitcnt vmcnt(6)
    v_max_u32 v18, v24, v28
    v_max3_u32 v18, v18, v32, v36
    v_max3_u32 v18, v18, v40, v44
    v_max3_u32 v18, v18, v48, v52
    v_cmp_eq_u32 vcc, -1, v18
    s_cmp_ge_u32 s30, s20
    s_cbranch_scc1 FF_NRf
    s_cbranch_vccnz FF_NRf
    ds_write_b128 v6, v[24:27] offset:0
    ds_write_b128 v6, v[28:31] offset:1024
    ds_write_b128 v6, v[32:35] offset:2048
    v_mfma_f32_32x32x16_bf16 v[88:103], a[0:3], v[24:27], 0
    ds_write_b128 v6, v[36:39] offset:3072
    ds_write_b128 v6, v[40:43] offset:4096
    v_mfma_f32_32x32x16_bf16 v[88:103], a[4:7], v[28:31], v[88:103]
    ds_write_b128 v6, v[44:47] offset:5120
    ds_write_b128 v6, v[48:51] offset:6144
    v_mfma_f32_32x32x16_bf16 v[88:103], a[8:11], v[32:35], v[88:103]
    ds_write_b128 v6, v[52:55] offset:7168
    v_mfma_f32_32x32x16_bf16 v[88:103], a[12:15], v[36:39], v[88:103]
    v_cvt_pk_f16_f32 v104, v176, v177
    v_cvt_pk_f16_f32 v105, v178, v179
    v_cvt_pk_f16_f32 v106, v180, v181
    v_and_or_b32 v104, v104, -2, s42
    v_cvt_pk_f16_f32 v107, v182, v183
    v_mfma_f32_32x32x16_bf16 v[88:103], a[16:19], v[40:43], v[88:103]
    s_waitcnt lgkmcnt(0)
    s_barrier
    ds_read_b128 v[56:59], v7 offset:0
    ds_read_b128 v[60:63], v7 offset:1024
    v_mfma_f32_32x32x16_bf16 v[88:103], a[20:23], v[44:47], v[88:103]
    ds_read_b128 v[64:67], v7 offset:2048
    ds_read_b128 v[68:71], v7 offset:3072
    global_store_dwordx4 v5, v[104:107], s[36:37] offset:0
    v_mfma_f32_32x32x16_bf16 v[88:103], a[24:27], v[48:51], v[88:103]
    ds_read_b128 v[72:75], v7 offset:4096
    ds_read_b128 v[76:79], v7 offset:5120
    v_mfma_f32_32x32x16_bf16 v[88:103], a[28:31], v[52:55], v[88:103]
    ds_read_b128 v[80:83], v7 offset:6144
    ds_read_b128 v[84:87], v7 offset:7168
    s_waitcnt lgkmcnt(7)
    v_mfma_f32_32x32x16_bf16 v[88:103], a[32:35], v[56:59], v[88:103]
    ds_read_b128 v[56:59], v8 offset:0
    v_cvt_pk_f16_f32 v108, v184, v185
    v_cvt_pk_f16_f32 v109, v186, v187
    v_cvt_pk_f16_f32 v110, v188, v189
    v_and_or_b32 v108, v108, -2, s42
    v_cvt_pk_f16_f32 v111, v190, v191
    s_waitcnt lgkmcnt(7)
    v_mfma_f32_32x32x16_bf16 v[88:103], a[36:39], v[60:63], v[88:103]
    ds_read_b128 v[60:63], v8 offset:1024
    global_store_dwordx4 v5, v[108:111], s[36:37] offset:1024
    s_waitcnt lgkmcnt(7)
    v_mfma_f32_32x32x16_bf16 v[88:103], a[40:43], v[64:67], v[88:103]
    ds_read_b128 v[64:67], v8 offset:2048
    s_waitcnt lgkmcnt(7)
    v_mfma_f32_32x32x16_bf16 v[88:103], a[44:47], v[68:71], v[88:103]
    ds_read_b128 v[68:71], v8 offset:3072
    s_branch FF_TOPf
FF_NRf:
    s_nop 2
    v_cvt_pk_f16_f32 v104, v176, v177
    v_cvt_pk_f16_f32 v105, v178, v179
    v_cvt_pk_f16_f32 v106, v180, v181
    v_and_or_b32 v104, v104, -2, s42
    v_cvt_pk_f16_f32 v107, v182, v183
    global_store_dwordx4 v5, v[104:107], s[36:37] offset:0
    v_cvt_pk_f16_f32 v108, v184, v185
    v_cvt_pk_f16_f32 v109, v186, v187
    v_cvt_pk_f16_f32 v110, v188, v189
    v_and_or_b32 v108, v108, -2, s42
    v_cvt_pk_f16_f32 v111, v190, v191
    global_store_dwordx4 v5, v[108:111], s[36:37] offset:1024
    s_cmp_lt_u32 s30, s20
    s_cbranch_scc1 FF_SPINf_0
    s_branch FF_END
FF_CSf:
    s_mov_b32 s12, 0
FF_CSf_L:
    global_load_dword v19, v17, s[40:41] sc1
    s_add_u32 s12, s12, 1
    s_mov_b32 s17, 26
    s_cmp_gt_u32 s12, 20000
    s_cbranch_scc1 TIMEOUT2
    s_waitcnt vmcnt(0)
    v_cmp_gt_i32 vcc, s43, v19
    s_cbranch_vccnz FF_CSf_L
    s_branch FF_CRf
FF_SLOW:
    s_mov_b32 s30, 0
    s_mul_i32 s20, s13, 6
    s_sub_u32 s20, 67, s20
FF_SPINs_0:
    s_mov_b32 s12, 0
FF_SPINs:
    global_load_dwordx4 v[24:27], v1, s[34:35] offset:-4096 sc1
    s_add_u32 s12, s12, 1
    s_mov_b32 s17, 11
    s_cmp_gt_u32 s12, 20000
    s_cbranch_scc1 TIMEOUT2
    s_waitcnt vmcnt(0)
FF_SPINs_C:
    v_cmp_eq_u32 vcc, -1, v24
    s_cbranch_vccnz FF_SPINs
    global_load_dwordx4 v[28:31], v1, s[34:35] offset:-3072 sc1
    global_load_dwordx4 v[32:35], v1, s[34:35] offset:-2048 sc1
    global_load_dwordx4 v[36:39], v1, s[34:35] offset:-1024 sc1
    global_load_dwordx4 v[40:43], v1, s[34:35] offset:0 sc1
    global_load_dwordx4 v[44:47], v1, s[34:35] offset:1024 sc1
    global_load_dwordx4 v[48:51], v1, s[34:35] offset:2048 sc1
    global_load_dwordx4 v[52:55], v1, s[34:35] offset:3072 sc1
    ds_write_b128 v6, v[24:27] offset:0
    v_mfma_f32_32x32x16_bf16 v[88:103], a[0:3], v[24:27], 0
    s_waitcnt vmcnt(6)
    ds_write_b128 v6, v[28:31] offset:1024
    v_mfma_f32_32x32x16_bf16 v[88:103], a[4:7], v[28:31], v[88:103]
    v_max_u32 v18, v24, v28
    s_waitcnt vmcnt(5)
    ds_write_b128 v6, v[32:35] offset:2048
    v_mfma_f32_32x32x16_bf16 v[88:103], a[8:11], v[32:35], v[88:103]
    s_waitcnt vmcnt(4)
    ds_write_b128 v6, v[36:39] offset:3072
    v_mfma_f32_32x32x16_bf16 v[88:103], a[12:15], v[36:39], v[88:103]
    v_max3_u32 v18, v18, v32, v36
    s_waitcnt vmcnt(3)
    ds_write_b128 v6, v[40:43] offset:4096
    v_mfma_f32_32x32x16_bf16 v[88:103], a[16:19], v[40:43], v[88:103]
    s_waitcnt vmcnt(2)
    ds_write_b128 v6, v[44:47] offset:5120
    v_max3_u32 v18, v18, v40, v44
    s_waitcnt vmcnt(1)
    ds_write_b128 v6, v[48:51] offset:6144
    s_waitcnt vmcnt(0)
    ds_write_b128 v6, v[52:55] offset:7168
    v_max3_u32 v18, v18, v48, v52
    v_cmp_eq_u32 vcc, -1, v18
    s_cbranch_vccnz FF_SPINs
    s_waitcnt lgkmcnt(0)
    s_barrier
    ds_read_b128 v[56:59], v7 offset:0
    ds_read_b128 v[60:63], v7 offset:1024
    v_mfma_f32_32x32x16_bf16 v[88:103], a[20:23], v[44:47], v[88:103]
    ds_read_b128 v[64:67], v7 offset:2048
    ds_read_b128 v[68:71], v7 offset:3072
    v_mfma_f32_32x32x16_bf16 v[88:103], a[24:27], v[48:51], v[88:103]
    ds_read_b128 v[72:75], v7 offset:4096
    ds_read_b128 v[76:79], v7 offset:5120
    v_mfma_f32_32x32x16_bf16 v[88:103], a[28:31], v[52:55], v[88:103]
    ds_read_b128 v[80:83], v7 offset:6144
    ds_read_b128 v[84:87], v7 offset:7168
    s_waitcnt lgkmcnt(7)
    v_mfma_f32_32x32x16_bf16 v[88:103], a[32:35], v[56:59], v[88:103]
    ds_read_b128 v[56:59], v8 offset:0
    s_waitcnt lgkmcnt(7)
    v_mfma_f32_32x32x16_bf16 v[88:103], a[36:39], v[60:63], v[88:103]
    ds_read_b128 v[60:63], v8 offset:1024
    s_waitcnt lgkmcnt(7)
    v_mfma_f32_32x32x16_bf16 v[88:103], a[40:43], v[64:67], v[88:103]
    ds_read_b128 v[64:67], v8 offset:2048
    s_waitcnt lgkmcnt(7)
    v_mfma_f32_32x32x16_bf16 v[88:103], a[44:47], v[68:71], v[88:103]
    ds_read_b128 v[68:71], v8 offset:3072
FF_TOPs:
    s_waitcnt lgkmcnt(7)
    v_mfma_f32_32x32x16_bf16 v[88:103], a[48:51], v[72:75], v[88:103]
    ds_read_b128 v[72:75], v8 offset:4096
    s_waitcnt lgkmcnt(7)
    v_mfma_f32_32x32x16_bf16 v[88:103], a[52:55], v[76:79], v[88:103]
    ds_read_b128 v[76:79], v8 offset:5120
    global_load_dword v19, v17, s[40:41] sc1
    s_waitcnt lgkmcnt(7)
    v_mfma_f32_32x32x16_bf16 v[88:103], a[56:59], v[80:83], v[88:103]
    ds_read_b128 v[80:83], v8 offset:6144
    s_waitcnt lgkmcnt(7)
    v_mfma_f32_32x32x16_bf16 v[88:103], a[60:63], v[84:87], v[88:103]
    ds_read_b128 v[84:87], v8 offset:7168
    s_waitcnt lgkmcnt(7)
    v_mfma_f32_32x32x16_bf16 v[88:103], a[64:67], v[56:59], v[88:103]
    ds_read_b128 v[56:59], v9 offset:0
    s_waitcnt lgkmcnt(7)
    v_mfma_f32_32x32x16_bf16 v[88:103], a[68:71], v[60:63], v[88:103]
    ds_read_b128 v[60:63], v9 offset:1024
    s_waitcnt lgkmcnt(7)
    v_mfma_f32_32x32x16_bf16 v[88:103], a[72:75], v[64:67], v[88:103]
    ds_read_b128 v[64:67], v9 offset:2048
    s_waitcnt lgkmcnt(7)
    v_mfma_f32_32x32x16_bf16 v[88:103], a[76:79], v[68:71], v[88:103]
    ds_read_b128 v[68:71], v9 offset:3072
    s_waitcnt lgkmcnt(7)
    v_mfma_f32_32x32x16_bf16 v[88:103], a[80:83], v[72:75], v[88:103]
    ds_read_b128 v[72:75], v9 offset:4096
    s_waitcnt lgkmcnt(7)
    v_mfma_f32_32x32x16_bf16 v[88:103], a[84:87], v[76:79], v[88:103]
    ds_read_b128 v[76:79], v9 offset:5120
    s_waitcnt lgkmcnt(7)
    v_mfma_f32_32x32x16_bf16 v[88:103], a[88:91], v[80:83], v[88:103]
    ds_read_b128 v[80:83], v9 offset:6144
    s_waitcnt lgkmcnt(7)
    v_mfma_f32_32x32x16_bf16 v[88:103], a[92:95], v[84:87], v[88:103]
    ds_read_b128 v[84:87], v9 offset:7168
    s_waitcnt lgkmcnt(7)
    v_mfma_f32_32x32x16_bf16 v[88:103], a[96:99], v[56:59], v[88:103]
    s_waitcnt lgkmcnt(6)
    v_mfma_f32_32x32x16_bf16 v[88:103], a[100:103], v[60:63], v[88:103]
    s_waitcnt lgkmcnt(5)
    v_mfma_f32_32x32x16_bf16 v[88:103], a[104:107], v[64:67], v[88:103]
    s_add_u32 s14, s30, 1
    s_and_b32 s14, s14, 7
    s_lshl_b32 s14, s14, 15
    s_add_u32 s34, s44, s14
    s_addc_u32 s35, s45, 0
    s_waitcnt lgkmcnt(4)
    v_mfma_f32_32x32x16_bf16 v[88:103], a[108:111], v[68:71], v[88:103]
    s_bfe_u32 s42, s30, 0x10002
    s_and_b32 s14, s30, 3
    s_mul_i32 s14, s14, 458752
    s_add_u32 s36, s38, s14
    s_addc_u32 s37, s39, 0
    s_waitcnt lgkmcnt(3)
    v_mfma_f32_32x32x16_bf16 v[88:103], a[112:115], v[72:75], v[88:103]
    s_lshl_b32 s43, s30, 3
    s_sub_u32 s43, s43, 24
    s_add_u32 s30, s30, 1
    s_waitcnt lgkmcnt(2)
    v_mfma_f32_32x32x16_bf16 v[88:103], a[116:119], v[76:79], v[88:103]
    s_waitcnt lgkmcnt(1)
    v_mfma_f32_32x32x16_bf16 v[88:103], a[120:123], v[80:83], v[88:103]
    s_waitcnt lgkmcnt(0)
    v_mfma_f32_32x32x16_bf16 v[88:103], a[124:127], v[84:87], v[88:103]
    s_waitcnt vmcnt(0)
    v_cmp_gt_i32 vcc, s43, v19
    s_cbranch_vccnz FF_CSs
FF_CRs:
    s_nop 8
    v_cvt_pk_bf16_f32 v56, v88, v89
    v_cvt_pk_bf16_f32 v57, v90, v91
    v_cvt_pk_bf16_f32 v58, v92, v93
    v_cvt_pk_bf16_f32 v59, v94, v95
    v_pk_max_i16 v56, v56, 0
    v_pk_max_i16 v57, v57, 0
    v_pk_max_i16 v58, v58, 0
    v_pk_max_i16 v59, v59, 0
    ds_write_b128 v10, v[56:59] offset:0
    v_cvt_pk_bf16_f32 v60, v96, v97
    v_cvt_pk_bf16_f32 v61, v98, v99
    v_cvt_pk_bf16_f32 v62, v100, v101
    v_cvt_pk_bf16_f32 v63, v102, v103
    v_pk_max_i16 v60, v60, 0
    v_pk_max_i16 v61, v61, 0
    v_pk_max_i16 v62, v62, 0
    v_pk_max_i16 v63, v63, 0
    ds_write_b128 v10, v[60:63] offset:1024
    v_mfma_f32_32x32x16_bf16 v[128:143], a[128:131], v[56:59], 0
    v_mfma_f32_32x32x16_bf16 v[144:159], a[160:163], v[56:59], 0
    v_mfma_f32_32x32x16_bf16 v[160:175], a[192:195], v[56:59], 0
    s_waitcnt lgkmcnt(0)
    s_barrier
    ds_read_b128 v[64:67], v11 offset:0
    ds_read_b128 v[68:71], v11 offset:1024
    v_mfma_f32_32x32x16_bf16 v[176:191], a[224:227], v[56:59], 0
    ds_read_b128 v[72:75], v12 offset:0
    ds_read_b128 v[76:79], v12 offset:1024
    global_load_dwordx4 v[24:27], v1, s[34:35] offset:-4096 sc1
    v_mfma_f32_32x32x16_bf16 v[128:143], a[132:135], v[60:63], v[128:143]
    ds_read_b128 v[80:83], v13 offset:0
    ds_read_b128 v[84:87], v13 offset:1024
    v_mfma_f32_32x32x16_bf16 v[144:159], a[164:167], v[60:63], v[144:159]
    v_mfma_f32_32x32x16_bf16 v[160:175], a[196:199], v[60:63], v[160:175]
    v_mfma_f32_32x32x16_bf16 v[176:191], a[228:231], v[60:63], v[176:191]
    s_waitcnt lgkmcnt(5)
    v_mfma_f32_32x32x16_bf16 v[128:143], a[136:139], v[64:67], v[128:143]
    s_waitcnt lgkmcnt(4)
    v_mfma_f32_32x32x16_bf16 v[128:143], a[140:143], v[68:71], v[128:143]
    s_waitcnt lgkmcnt(3)
    v_mfma_f32_32x32x16_bf16 v[128:143], a[144:147], v[72:75], v[128:143]
    s_waitcnt lgkmcnt(2)
    v_mfma_f32_32x32x16_bf16 v[128:143], a[148:151], v[76:79], v[128:143]
    s_waitcnt lgkmcnt(1)
    v_mfma_f32_32x32x16_bf16 v[128:143], a[152:155], v[80:83], v[128:143]
    s_waitcnt lgkmcnt(0)
    v_mfma_f32_32x32x16_bf16 v[128:143], a[156:159], v[84:87], v[128:143]
    s_waitcnt vmcnt(0)
    v_cmp_eq_u32 vcc, -1, v24
    s_cbranch_vccz FF_Ps
    v_mfma_f32_32x32x16_bf16 v[144:159], a[168:171], v[64:67], v[144:159]
    s_nop 3
    v_cvt_pk_f16_f32 v104, v128, v129
    v_cvt_pk_f16_f32 v105, v130, v131
    v_cvt_pk_f16_f32 v106, v132, v133
    v_and_or_b32 v104, v104, -2, s42
    v_cvt_pk_f16_f32 v107, v134, v135
    v_mfma_f32_32x32x16_bf16 v[144:159], a[172:175], v[68:71], v[144:159]
    global_store_dwordx4 v2, v[104:107], s[36:37] offset:0 sc1
    v_mfma_f32_32x32x16_bf16 v[144:159], a[176:179], v[72:75], v[144:159]
    v_cvt_pk_f16_f32 v108, v136, v137
    v_cvt_pk_f16_f32 v109, v138, v139
    v_cvt_pk_f16_f32 v110, v140, v141
    v_and_or_b32 v108, v108, -2, s42
    v_cvt_pk_f16_f32 v111, v142, v143
    v_mfma_f32_32x32x16_bf16 v[144:159], a[180:183], v[76:79], v[144:159]
    global_store_dwordx4 v2, v[108:111], s[36:37] offset:1024 sc1
    v_mfma_f32_32x32x16_bf16 v[144:159], a[184:187], v[80:83], v[144:159]
    v_mfma_f32_32x32x16_bf16 v[144:159], a[188:191], v[84:87], v[144:159]
    v_mfma_f32_32x32x16_bf16 v[160:175], a[200:203], v[64:67], v[160:175]
    s_nop 3
    v_cvt_pk_f16_f32 v112, v144, v145
    v_cvt_pk_f16_f32 v113, v146, v147
    v_cvt_pk_f16_f32 v114, v148, v149
    v_and_or_b32 v112, v112, -2, s42
    v_cvt_pk_f16_f32 v115, v150, v151
    v_mfma_f32_32x32x16_bf16 v[160:175], a[204:207], v[68:71], v[160:175]
    global_store_dwordx4 v3, v[112:115], s[36:37] offset:0 sc1
    v_mfma_f32_32x32x16_bf16 v[160:175], a[208:211], v[72:75], v[160:175]
    v_cvt_pk_f16_f32 v116, v152, v153
    v_cvt_pk_f16_f32 v117, v154, v155
    v_cvt_pk_f16_f32 v118, v156, v157
    v_and_or_b32 v116, v116, -2, s42
    v_cvt_pk_f16_f32 v119, v158, v159
    v_mfma_f32_32x32x16_bf16 v[160:175], a[212:215], v[76:79], v[160:175]
    global_store_dwordx4 v3, v[116:119], s[36:37] offset:1024 sc1
    v_mfma_f32_32x32x16_bf16 v[160:175], a[216:219], v[80:83], v[160:175]
    v_mfma_f32_32x32x16_bf16 v[160:175], a[220:223], v[84:87], v[160:175]
    global_load_dwordx4 v[24:27], v1, s[34:35] offset:-4096 sc1
    v_mfma_f32_32x32x16_bf16 v[176:191], a[232:235], v[64:67], v[176:191]
    s_nop 3
    v_cvt_pk_f16_f32 v120, v160, v161
    v_cvt_pk_f16_f32 v121, v162, v163
    v_cvt_pk_f16_f32 v122, v164, v165
    v_and_or_b32 v120, v120, -2, s42
    v_cvt_pk_f16_f32 v123, v166, v167
    v_mfma_f32_32x32x16_bf16 v[176:191], a[236:239], v[68:71], v[176:191]
    global_store_dwordx4 v4, v[120:123], s[36:37] offset:0 sc1
    v_mfma_f32_32x32x16_bf16 v[176:191], a[240:243], v[72:75], v[176:191]
    v_cvt_pk_f16_f32 v124, v168, v169
    v_cvt_pk_f16_f32 v125, v170, v171
    v_cvt_pk_f16_f32 v126, v172, v173
    v_and_or_b32 v124, v124, -2, s42
    v_cvt_pk_f16_f32 v127, v174, v175
    v_mfma_f32_32x32x16_bf16 v[176:191], a[244:247], v[76:79], v[176:191]
    global_store_dwordx4 v4, v[124:127], s[36:37] offset:1024 sc1
    v_mfma_f32_32x32x16_bf16 v[176:191], a[248:251], v[80:83], v[176:191]
    v_mfma_f32_32x32x16_bf16 v[176:191], a[252:255], v[84:87], v[176:191]
    s_nop 11
    v_cvt_pk_f16_f32 v104, v176, v177
    v_cvt_pk_f16_f32 v105, v178, v179
    v_cvt_pk_f16_f32 v106, v180, v181
    v_and_or_b32 v104, v104, -2, s42
    v_cvt_pk_f16_f32 v107, v182, v183
    global_store_dwordx4 v5, v[104:107], s[36:37] offset:0 sc1
    v_cvt_pk_f16_f32 v108, v184, v185
    v_cvt_pk_f16_f32 v109, v186, v187
    v_cvt_pk_f16_f32 v110, v188, v189
    v_and_or_b32 v108, v108, -2, s42
    v_cvt_pk_f16_f32 v111, v190, v191
    global_store_dwordx4 v5, v[108:111], s[36:37] offset:1024 sc1
    s_mov_b32 s12, 0
    s_cmp_lt_u32 s30, s20
    s_waitcnt vmcnt(4)
    s_cbranch_scc1 FF_SPINs_C
    s_branch FF_END
FF_Ps:
    v_mfma_f32_32x32x16_bf16 v[144:159], a[168:171], v[64:67], v[144:159]
    global_load_dwordx4 v[28:31], v1, s[34:35] offset:-3072 sc1
    v_mfma_f32_32x32x16_bf16 v[144:159], a[172:175], v[68:71], v[144:159]
    global_load_dwordx4 v[32:35], v1, s[34:35] offset:-2048 sc1
    v_mfma_f32_32x32x16_bf16 v[144:159], a[176:179], v[72:75], v[144:159]
    global_load_dwordx4 v[36:39], v1, s[34:35] offset:-1024 sc1
    v_mfma_f32_32x32x16_bf16 v[144:159], a[180:183], v[76:79], v[144:159]
    global_load_dwordx4 v[40:43], v1, s[34:35] offset:0 sc1
    v_mfma_f32_32x32x16_bf16 v[144:159], a[184:187], v[80:83], v[144:159]
    global_load_dwordx4 v[44:47], v1, s[34:35] offset:1024 sc1
    v_mfma_f32_32x32x16_bf16 v[144:159], a[188:191], v[84:87], v[144:159]
    global_load_dwordx4 v[48:51], v1, s[34:35] offset:2048 sc1
    v_mfma_f32_32x32x16_bf16 v[160:175], a[200:203], v[64:67], v[160:175]
    global_load_dwordx4 v[52:55], v1, s[34:35] offset:3072 sc1
    v_cvt_pk_f16_f32 v104, v128, v129
    v_cvt_pk_f16_f32 v105, v130, v131
    v_cvt_pk_f16_f32 v106, v132, v133
    v_and_or_b32 v104, v104, -2, s42
    v_cvt_pk_f16_f32 v107, v134, v135
    v_mfma_f32_32x32x16_bf16 v[160:175], a[204:207], v[68:71], v[160:175]
    global_store_dwordx4 v2, v[104:107], s[36:37] offset:0 sc1
    v_mfma_f32_32x32x16_bf16 v[160:175], a[208:211], v[72:75], v[160:175]
    v_cvt_pk_f16_f32 v108, v136, v137
    v_cvt_pk_f16_f32 v109, v138, v139
    v_cvt_pk_f16_f32 v110, v140, v141
    v_and_or_b32 v108, v108, -2, s42
    v_cvt_pk_f16_f32 v111, v142, v143
    v_mfma_f32_32x32x16_bf16 v[160:175], a[212:215], v[76:79], v[160:175]
    global_store_dwordx4 v2, v[108:111], s[36:37] offset:1024 sc1
    v_mfma_f32_32x32x16_bf16 v[160:175], a[216:219], v[80:83], v[160:175]
    v_cvt_pk_f16_f32 v112, v144, v145
    v_cvt_pk_f16_f32 v113, v146, v147
    v_cvt_pk_f16_f32 v114, v148, v149
    v_and_or_b32 v112, v112, -2, s42
    v_cvt_pk_f16_f32 v115, v150, v151
    v_mfma_f32_32x32x16_bf16 v[160:175], a[220:223], v[84:87], v[160:175]
    global_store_dwordx4 v3, v[112:115], s[36:37] offset:0 sc1
    v_mfma_f32_32x32x16_bf16 v[176:191], a[232:235], v[64:67], v[176:191]
    v_cvt_pk_f16_f32 v116, v152, v153
    v_cvt_pk_f16_f32 v117, v154, v155
    v_cvt_pk_f16_f32 v118, v156, v157
    v_and_or_b32 v116, v116, -2, s42
    v_cvt_pk_f16_f32 v119, v158, v159
    v_mfma_f32_32x32x16_bf16 v[176:191], a[236:239], v[68:71], v[176:191]
    global_store_dwordx4 v3, v[116:119], s[36:37] offset:1024 sc1
    v_mfma_f32_32x32x16_bf16 v[176:191], a[240:243], v[72:75], v[176:191]
    v_cvt_pk_f16_f32 v120, v160, v161
    v_cvt_pk_f16_f32 v121, v162, v163
    v_cvt_pk_f16_f32 v122, v164, v165
    v_and_or_b32 v120, v120, -2, s42
    v_cvt_pk_f16_f32 v123, v166, v167
    v_mfma_f32_32x32x16_bf16 v[176:191], a[244:247], v[76:79], v[176:191]
    global_store_dwordx4 v4, v[120:123], s[36:37] offset:0 sc1
    v_mfma_f32_32x32x16_bf16 v[176:191], a[248:251], v[80:83], v[176:191]
    v_cvt_pk_f16_f32 v124, v168, v169
    v_cvt_pk_f16_f32 v125, v170, v171
    v_cvt_pk_f16_f32 v126, v172, v173
    v_and_or_b32 v124, v124, -2, s42
    v_cvt_pk_f16_f32 v127, v174, v175
    v_mfma_f32_32x32x16_bf16 v[176:191], a[252:255], v[84:87], v[176:191]
    global_store_dwordx4 v4, v[124:127], s[36:37] offset:1024 sc1
    s_waitcnt vmcnt(6)
    v_max_u32 v18, v24, v28
    v_max3_u32 v18, v18, v32, v36
    v_max3_u32 v18, v18, v40, v44
    v_max3_u32 v18, v18, v48, v52
    v_cmp_eq_u32 vcc, -1, v18
    s_cmp_ge_u32 s30, s20
    s_cbranch_scc1 FF_NRs
    s_cbranch_vccnz FF_NRs
    ds_write_b128 v6, v[24:27] offset:0
    ds_write_b128 v6, v[28:31] offset:1024
    ds_write_b128 v6, v[32:35] offset:2048
    v_mfma_f32_32x32x16_bf16 v[88:103], a[0:3], v[24:27], 0
    ds_write_b128 v6, v[36:39] offset:3072
    ds_write_b128 v6, v[40:43] offset:4096
    v_mfma_f32_32x32x16_bf16 v[88:103], a[4:7], v[28:31], v[88:103]
    ds_write_b128 v6, v[44:47] offset:5120
    ds_write_b128 v6, v[48:51] offset:6144
    v_mfma_f32_32x32x16_bf16 v[88:103], a[8:11], v[32:35], v[88:103]
    ds_write_b128 v6, v[52:55] offset:7168
    v_mfma_f32_32x32x16_bf16 v[88:103], a[12:15], v[36:39], v[88:103]
    v_cvt_pk_f16_f32 v104, v176, v177
    v_cvt_pk_f16_f32 v105, v178, v179
    v_cvt_pk_f16_f32 v106, v180, v181
    v_and_or_b32 v104, v104, -2, s42
    v_cvt_pk_f16_f32 v107, v182, v183
    v_mfma_f32_32x32x16_bf16 v[88:103], a[16:19], v[40:43], v[88:103]
    s_waitcnt lgkmcnt(0)
    s_barrier
    ds_read_b128 v[56:59], v7 offset:0
    ds_read_b128 v[60:63], v7 offset:1024
    v_mfma_f32_32x32x16_bf16 v[88:103], a[20:23], v[44:47], v[88:103]
    ds_read_b128 v[64:67], v7 offset:2048
    ds_read_b128 v[68:71], v7 offset:3072
    global_store_dwordx4 v5, v[104:107], s[36:37] offset:0 sc1
    v_mfma_f32_32x32x16_bf16 v[88:103], a[24:27], v[48:51], v[88:103]
    ds_read_b128 v[72:75], v7 offset:4096
    ds_read_b128 v[76:79], v7 offset:5120
    v_mfma_f32_32x32x16_bf16 v[88:103], a[28:31], v[52:55], v[88:103]
    ds_read_b128 v[80:83], v7 offset:6144
    ds_read_b128 v[84:87], v7 offset:7168
    s_waitcnt lgkmcnt(7)
    v_mfma_f32_32x32x16_bf16 v[88:103], a[32:35], v[56:59], v[88:103]
    ds_read_b128 v[56:59], v8 offset:0
    v_cvt_pk_f16_f32 v108, v184, v185
    v_cvt_pk_f16_f32 v109, v186, v187
    v_cvt_pk_f16_f32 v110, v188, v189
    v_and_or_b32 v108, v108, -2, s42
    v_cvt_pk_f16_f32 v111, v190, v191
    s_waitcnt lgkmcnt(7)
    v_mfma_f32_32x32x16_bf16 v[88:103], a[36:39], v[60:63], v[88:103]
    ds_read_b128 v[60:63], v8 offset:1024
    global_store_dwordx4 v5, v[108:111], s[36:37] offset:1024 sc1
    s_waitcnt lgkmcnt(7)
    v_mfma_f32_32x32x16_bf16 v[88:103], a[40:43], v[64:67], v[88:103]
    ds_read_b128 v[64:67], v8 offset:2048
    s_waitcnt lgkmcnt(7)
    v_mfma_f32_32x32x16_bf16 v[88:103], a[44:47], v[68:71], v[88:103]
    ds_read_b128 v[68:71], v8 offset:3072
    s_branch FF_TOPs
FF_NRs:
    s_nop 2
    v_cvt_pk_f16_f32 v104, v176, v177
    v_cvt_pk_f16_f32 v105, v178, v179
    v_cvt_pk_f16_f32 v106, v180, v181
    v_and_or_b32 v104, v104, -2, s42
    v_cvt_pk_f16_f32 v107, v182, v183
    global_store_dwordx4 v5, v[104:107], s[36:37] offset:0 sc1
    v_cvt_pk_f16_f32 v108, v184, v185
    v_cvt_pk_f16_f32 v109, v186, v187
    v_cvt_pk_f16_f32 v110, v188, v189
    v_and_or_b32 v108, v108, -2, s42
    v_cvt_pk_f16_f32 v111, v190, v191
    global_store_dwordx4 v5, v[108:111], s[36:37] offset:1024 sc1
    s_cmp_lt_u32 s30, s20
    s_cbranch_scc1 FF_SPINs_0
    s_branch FF_END
FF_CSs:
    s_mov_b32 s12, 0
FF_CSs_L:
    global_load_dword v19, v17, s[40:41] sc1
    s_add_u32 s12, s12, 1
    s_mov_b32 s17, 26
    s_cmp_gt_u32 s12, 20000
    s_cbranch_scc1 TIMEOUT2
    s_waitcnt vmcnt(0)
    v_cmp_gt_i32 vcc, s43, v19
    s_cbranch_vccnz FF_CSs_L
    s_branch FF_CRs
FF_END:
    s_endpgm
.section .rodata,"a"
.p2align 6
.amdhsa_kernel interleave_layers__memory_aug_recurrent_mem_tr__dense_activation_relu__prompt_kernel
  .amdhsa_next_free_vgpr 512
  .amdhsa_next_free_sgpr 102
  .amdhsa_accum_offset 256
  .amdhsa_group_segment_fixed_size 0
  .amdhsa_kernarg_size 104
  .amdhsa_user_sgpr_count 2
  .amdhsa_user_sgpr_kernarg_segment_ptr 1
  .amdhsa_system_sgpr_workgroup_id_x 1
.end_amdhsa_kernel
```
